```python
import torch

def _softmax(x, axis=-1):
    return torch.softmax(x, dim=axis)

def _gelu(x):
    return torch.nn.functional.gelu(x, approximate='tanh')

def _silu(x):
    return torch.nn.functional.silu(x)

def _sigmoid(x):
    return torch.sigmoid(x)

def _layernorm(x, axis=-1, eps=1e-05):
    m = x.mean(dim=axis, keepdim=True)
    v = x.var(dim=axis, keepdim=True, unbiased=False)
    return (x - m) / torch.sqrt(v + eps)

def _scatter_add(tgt, idx, src, axis=0):
    return tgt.clone().index_add_(axis, idx, src)

def _segment_sum(src, seg, n):
    out = torch.zeros((n,) + src.shape[1:], dtype=src.dtype)
    return out.index_add_(0, seg, src)

def _pad(x, pw):
    flat = tuple((v for pair in reversed(pw) for v in pair))
    return torch.nn.functional.pad(x, flat)
kernel_name = 'parallel_sum__memory_aug_recurrent_mem_tr__mixer_channel_mlp__prompt'

def setup_inputs():

    _w = lambda a: (lambda t: t.to(torch.bfloat16) if t.is_floating_point() else t)(torch.as_tensor(a))

    def _A_setup():
        B, S, Dm = (1, 2048, 576)
        H, Dh = (32, 128)
        M, seg = (8, 32)
        seg = min(seg, S)
        S = S // seg * seg
        return {'x': _w((lambda *s: torch.randn(*s, dtype=torch.bfloat16) * 0.05)(B, S, Dm)), 'mem0': _w((lambda *s: torch.randn(*s, dtype=torch.bfloat16) * 0.2)(B, M, Dm)), 'Wq': _w((lambda *s: torch.randn(*s, dtype=torch.bfloat16) * 1.6)(Dm, H, Dh) * Dm ** (-0.5)), 'Wk': _w((lambda *s: torch.randn(*s, dtype=torch.bfloat16) * 1.6)(Dm, H, Dh) * Dm ** (-0.5)), 'Wv': _w((lambda *s: torch.randn(*s, dtype=torch.bfloat16) * 0.2)(Dm, H, Dh) * Dm ** (-0.5)), 'Wo': _w((lambda *s: torch.randn(*s, dtype=torch.bfloat16) * 0.2)(H, Dh, Dm) * (H * Dh) ** (-0.5)), 'seg_len': seg}
    _A_in = _A_setup()

    def _B_setup():
        B, S, D, F = (1, 2048, 576, 4608)
        return {'x': _w((lambda *s: torch.randn(*s, dtype=torch.bfloat16) * 0.05)(B, S, D)), 'w1': _w((lambda *s: torch.randn(*s, dtype=torch.bfloat16) * 0.8)(D, F) * D ** (-0.5)), 'b1': _w((lambda *s: torch.randn(*s, dtype=torch.bfloat16) * 0.4)(F)), 'w2': _w((lambda *s: torch.randn(*s, dtype=torch.bfloat16) * 0.05)(F, D) * F ** (-0.5)), 'b2': _w((lambda *s: torch.randn(*s, dtype=torch.bfloat16) * 0.05)(D))}
    _B_in = _B_setup()
    return {'A_x': _A_in['x'], 'A_mem0': _A_in['mem0'], 'A_Wq': _A_in['Wq'], 'A_Wk': _A_in['Wk'], 'A_Wv': _A_in['Wv'], 'A_Wo': _A_in['Wo'], 'A_seg_len': _A_in['seg_len'], 'B_x': _B_in['x'], 'B_w1': _B_in['w1'], 'B_b1': _B_in['b1'], 'B_w2': _B_in['w2'], 'B_b2': _B_in['b2']}

def reference(A_x, A_mem0, A_Wq, A_Wk, A_Wv, A_Wo, A_seg_len, B_x, B_w1, B_b1, B_w2, B_b2):

    def _A_ref(x, mem0, Wq, Wk, Wv, Wo, seg_len):
        B, S, Dm = x.shape
        H, Dh = (Wq.shape[1], Wq.shape[2])
        M = mem0.shape[1]
        scale = Dh ** (-0.5)
        n_seg = S // seg_len
        L = M + seg_len
        idx = torch.arange(L)
        mask = (idx[:, None] < M) | (idx[:, None] >= idx[None, :])
        mem = mem0
        outs = []
        for s in range(n_seg):
            xs = x[:, s * seg_len:(s + 1) * seg_len, :].clone()
            h = torch.concatenate([mem, xs], axis=1)
            q = torch.einsum('btd,dhe->bhte', h, Wq)
            k = torch.einsum('btd,dhe->bhte', h, Wk)
            v = torch.einsum('btd,dhe->bhte', h, Wv)
            scores = torch.einsum('bhqe,bhke->bhqk', q, k) * scale
            scores = torch.where(mask[None, None], scores, -1000000000.0)
            p = _softmax(scores, axis=-1)
            o = torch.einsum('bhqk,bhke->bhqe', p, v)
            o = torch.einsum('bhte,hed->btd', o, Wo)
            mem = o[:, :M, :].clone()
            outs.append(o[:, M:, :])
        return torch.concatenate(outs, axis=1)

    def _B_ref(x, w1, b1, w2, b2):
        y = _layernorm(x, axis=-1)
        h = _gelu(torch.einsum('bsd,df->bsf', y, w1) + b1)
        return torch.einsum('bsf,fd->bsd', h, w2) + b2
    x = A_x
    xn = _layernorm(x, axis=-1)
    return x + _A_ref(xn, A_mem0, A_Wq, A_Wk, A_Wv, A_Wo, A_seg_len) + _B_ref(xn, B_w1, B_b1, B_w2, B_b2)
```

```asm
; @launch grid=(256,1,1) block=(256,1,1) lds=163840
.amdgcn_target "amdgcn-amd-amdhsa--gfx950"

.text
.globl parallel_sum__memory_aug_recurrent_mem_tr__mixer_channel_mlp__prompt_kernel
.p2align 8
.type parallel_sum__memory_aug_recurrent_mem_tr__mixer_channel_mlp__prompt_kernel,@function
parallel_sum__memory_aug_recurrent_mem_tr__mixer_channel_mlp__prompt_kernel:
  s_cmp_ge_u32 s2, 256
  s_cbranch_scc1 k_end
  s_load_dwordx2 s[14:15], s[0:1], 104
  s_load_dwordx2 s[12:13], s[0:1], 112
  s_getreg_b32 s3, hwreg(HW_REG_XCC_ID, 0, 4)
  s_and_b32 s3, s3, 7
  s_getpc_b64 s[28:29]
  s_add_u32 s28, s28, chain_tab@rel32@lo+4
  s_addc_u32 s29, s29, chain_tab@rel32@hi+12
  v_lshrrev_b32 v1, 6, v0
  s_waitcnt lgkmcnt(0)
  v_readfirstlane_b32 s17, v1
  s_mov_b32 s4, s12
  s_and_b32 s5, s13, 0xffff
  s_mov_b32 s6, 0x10000000
  s_mov_b32 s7, 0x20000
  s_lshl_b32 s16, s3, 2
  v_mov_b32 v2, s16
  v_mov_b32 v3, 1
  s_cmp_eq_u32 s17, 0
  s_cbranch_scc0 k_noatom
  s_mov_b64 exec, 1
  global_atomic_add v4, v2, v3, s[14:15] sc0
  s_mov_b64 exec, -1
k_noatom:
  v_lshlrev_b32 v13, 7, v0
  global_load_dwordx4 v[16:19], v13, s[28:29] offset:0
  global_load_dwordx4 v[20:23], v13, s[28:29] offset:16
  global_load_dwordx4 v[24:27], v13, s[28:29] offset:32
  global_load_dwordx4 v[28:31], v13, s[28:29] offset:48
  global_load_dwordx4 v[32:35], v13, s[28:29] offset:64
  global_load_dwordx4 v[36:39], v13, s[28:29] offset:80
  s_load_dwordx2 s[30:31], s[0:1], 16
  s_load_dwordx2 s[32:33], s[0:1], 24
  s_load_dwordx2 s[34:35], s[0:1], 32
  s_load_dwordx2 s[36:37], s[0:1], 40
  s_load_dwordx2 s[38:39], s[0:1], 8
  s_waitcnt lgkmcnt(0)
  s_cmp_eq_u32 s3, 0
  s_cbranch_scc1 k_nowarm
  s_sub_u32 s44, s3, 1
  s_lshl_b32 s44, s44, 5
  s_lshr_b32 s45, s2, 3
  s_and_b32 s45, s45, 31
  s_add_u32 s44, s44, s45
  s_lshl_b32 s44, s44, 15
  v_lshlrev_b32 v6, 7, v0
  s_mov_b32 s40, s30
  s_and_b32 s41, s31, 0xffff
  s_mov_b32 s42, 4718592
  s_mov_b32 s43, 0x20000
  buffer_load_dword v7, v6, s[40:43], s44 offen
  buffer_load_dword v11, v6, s[40:43], s44 offen offset:64
  s_mov_b32 s40, s34
  s_and_b32 s41, s35, 0xffff
  s_mov_b32 s42, 4718592
  s_mov_b32 s43, 0x20000
  buffer_load_dword v8, v6, s[40:43], s44 offen
  buffer_load_dword v11, v6, s[40:43], s44 offen offset:64
  s_mov_b32 s40, s36
  s_and_b32 s41, s37, 0xffff
  s_mov_b32 s42, 4718592
  s_mov_b32 s43, 0x20000
  buffer_load_dword v9, v6, s[40:43], s44 offen
  buffer_load_dword v11, v6, s[40:43], s44 offen offset:64
  s_mov_b32 s40, s32
  s_and_b32 s41, s33, 0xffff
  s_mov_b32 s42, 4718592
  s_mov_b32 s43, 0x20000
  buffer_load_dword v10, v6, s[40:43], s44 offen
  buffer_load_dword v11, v6, s[40:43], s44 offen offset:64
k_nowarm:
  s_cmp_eq_u32 s17, 0
  s_cbranch_scc0 k_noticket
  s_mov_b64 exec, 1
  v_mov_b32 v5, 0x27f00
  s_waitcnt vmcnt(6)
  ds_write_b32 v5, v4
  s_mov_b64 exec, -1
  s_waitcnt lgkmcnt(0)
k_noticket:
  s_barrier
  v_mov_b32 v5, 0x27f00
  ds_read_b32 v4, v5
  s_waitcnt lgkmcnt(0)
  v_readfirstlane_b32 s16, v4
  s_barrier
  s_nop 2
  s_cmp_lt_u32 s16, 32
  s_cbranch_scc1 k_role
  s_cmp_eq_u32 s17, 0
  s_cbranch_scc0 k_ov_w
  s_mov_b64 exec, 1
  v_mov_b32 v2, 32
  v_mov_b32 v3, 1
  global_atomic_add v4, v2, v3, s[14:15] sc0
  s_waitcnt vmcnt(0)
  v_readfirstlane_b32 s20, v4
  s_mov_b64 exec, -1
  v_and_b32 v2, 7, v0
  v_lshlrev_b32 v2, 2, v2
  s_mov_b32 s21, 0
k_ov_poll:
  global_load_dword v3, v2, s[14:15] sc1
  s_add_u32 s21, s21, 1
  s_waitcnt vmcnt(0)
  s_mov_b32 s22, 0
  v_readlane_b32 s40, v3, 0
  v_readlane_b32 s41, v3, 1
  v_readlane_b32 s42, v3, 2
  v_readlane_b32 s43, v3, 3
  v_readlane_b32 s44, v3, 4
  v_readlane_b32 s45, v3, 5
  v_readlane_b32 s46, v3, 6
  v_readlane_b32 s47, v3, 7
  s_add_u32 s22, s22, s40
  s_add_u32 s22, s22, s41
  s_add_u32 s22, s22, s42
  s_add_u32 s22, s22, s43
  s_add_u32 s22, s22, s44
  s_add_u32 s22, s22, s45
  s_add_u32 s22, s22, s46
  s_add_u32 s22, s22, s47
  s_cmp_ge_u32 s22, 256
  s_cbranch_scc1 k_ov_done
  s_sleep 4
  s_cmp_lt_u32 s21, 0x40000
  s_cbranch_scc1 k_ov_poll
k_ov_done:
  s_mov_b32 s23, 0
  s_mov_b32 s24, 0
  s_mov_b32 s25, 0
  s_cmp_lg_u32 s25, 0
  s_cbranch_scc1 ovx_1
  s_min_u32 s26, s40, 32
  s_sub_u32 s27, 32, s26
  s_cmp_lt_u32 s20, s27
  s_cbranch_scc0 ovy_2
  s_mov_b32 s23, 0
  s_add_u32 s24, s26, s20
  s_mov_b32 s25, 1
  s_branch ovx_1
ovy_2:
  s_sub_u32 s20, s20, s27
ovx_1:
  s_cmp_lg_u32 s25, 0
  s_cbranch_scc1 ovx_3
  s_min_u32 s26, s41, 32
  s_sub_u32 s27, 32, s26
  s_cmp_lt_u32 s20, s27
  s_cbranch_scc0 ovy_4
  s_mov_b32 s23, 1
  s_add_u32 s24, s26, s20
  s_mov_b32 s25, 1
  s_branch ovx_3
ovy_4:
  s_sub_u32 s20, s20, s27
ovx_3:
  s_cmp_lg_u32 s25, 0
  s_cbranch_scc1 ovx_5
  s_min_u32 s26, s42, 32
  s_sub_u32 s27, 32, s26
  s_cmp_lt_u32 s20, s27
  s_cbranch_scc0 ovy_6
  s_mov_b32 s23, 2
  s_add_u32 s24, s26, s20
  s_mov_b32 s25, 1
  s_branch ovx_5
ovy_6:
  s_sub_u32 s20, s20, s27
ovx_5:
  s_cmp_lg_u32 s25, 0
  s_cbranch_scc1 ovx_7
  s_min_u32 s26, s43, 32
  s_sub_u32 s27, 32, s26
  s_cmp_lt_u32 s20, s27
  s_cbranch_scc0 ovy_8
  s_mov_b32 s23, 3
  s_add_u32 s24, s26, s20
  s_mov_b32 s25, 1
  s_branch ovx_7
ovy_8:
  s_sub_u32 s20, s20, s27
ovx_7:
  s_cmp_lg_u32 s25, 0
  s_cbranch_scc1 ovx_9
  s_min_u32 s26, s44, 32
  s_sub_u32 s27, 32, s26
  s_cmp_lt_u32 s20, s27
  s_cbranch_scc0 ovy_10
  s_mov_b32 s23, 4
  s_add_u32 s24, s26, s20
  s_mov_b32 s25, 1
  s_branch ovx_9
ovy_10:
  s_sub_u32 s20, s20, s27
ovx_9:
  s_cmp_lg_u32 s25, 0
  s_cbranch_scc1 ovx_11
  s_min_u32 s26, s45, 32
  s_sub_u32 s27, 32, s26
  s_cmp_lt_u32 s20, s27
  s_cbranch_scc0 ovy_12
  s_mov_b32 s23, 5
  s_add_u32 s24, s26, s20
  s_mov_b32 s25, 1
  s_branch ovx_11
ovy_12:
  s_sub_u32 s20, s20, s27
ovx_11:
  s_cmp_lg_u32 s25, 0
  s_cbranch_scc1 ovx_13
  s_min_u32 s26, s46, 32
  s_sub_u32 s27, 32, s26
  s_cmp_lt_u32 s20, s27
  s_cbranch_scc0 ovy_14
  s_mov_b32 s23, 6
  s_add_u32 s24, s26, s20
  s_mov_b32 s25, 1
  s_branch ovx_13
ovy_14:
  s_sub_u32 s20, s20, s27
ovx_13:
  s_cmp_lg_u32 s25, 0
  s_cbranch_scc1 ovx_15
  s_min_u32 s26, s47, 32
  s_sub_u32 s27, 32, s26
  s_cmp_lt_u32 s20, s27
  s_cbranch_scc0 ovy_16
  s_mov_b32 s23, 7
  s_add_u32 s24, s26, s20
  s_mov_b32 s25, 1
  s_branch ovx_15
ovy_16:
  s_sub_u32 s20, s20, s27
ovx_15:
  s_lshl_b32 s23, s23, 8
  s_or_b32 s23, s23, s24
  v_mov_b32 v4, s23
  v_mov_b32 v5, 0x27f00
  ds_write_b32 v5, v4
  s_waitcnt lgkmcnt(0)
k_ov_w:
  s_barrier
  v_mov_b32 v5, 0x27f00
  ds_read_b32 v4, v5
  s_waitcnt lgkmcnt(0)
  v_readfirstlane_b32 s20, v4
  s_barrier
  s_nop 2
  s_lshr_b32 s3, s20, 8
  s_and_b32 s16, s20, 31
k_role:
  s_cmp_eq_u32 s3, 0
  s_cbranch_scc0 k_worker
  s_waitcnt vmcnt(0) lgkmcnt(0)
  v_mov_b32 v1, v16
  v_mov_b32 v2, v17
  v_mov_b32 v3, v18
  v_mov_b32 v4, v19
  v_mov_b32 v5, v20
  v_mov_b32 v6, v21
  v_mov_b32 v7, v22
  v_mov_b32 v8, v23
  v_mov_b32 v9, v24
  v_mov_b32 v10, v25
  v_mov_b32 v11, v26
  v_mov_b32 v12, v27
  s_lshl_b32 s40, s16, 8
  s_mul_i32 s41, s16, 147456
  s_lshl_b32 s42, s17, 10
  s_mov_b32 s8, s30
  s_and_b32 s9, s31, 0xffff
  s_mov_b32 s10, 4718592
  s_mov_b32 s11, 0x20000
  s_add_u32 s43, s40, 0
  s_add_u32 m0, s42, 0
  s_nop 0
  buffer_load_dwordx4 v28, s[8:11], s43 offen lds
  s_add_u32 s43, s40, 131072
  s_add_u32 m0, s42, 4096
  s_nop 0
  buffer_load_dwordx4 v28, s[8:11], s43 offen lds
  s_add_u32 s43, s40, 262144
  s_add_u32 m0, s42, 8192
  s_nop 0
  buffer_load_dwordx4 v28, s[8:11], s43 offen lds
  s_add_u32 s43, s40, 393216
  s_add_u32 m0, s42, 12288
  s_nop 0
  buffer_load_dwordx4 v28, s[8:11], s43 offen lds
  s_add_u32 s43, s40, 524288
  s_add_u32 m0, s42, 16384
  s_nop 0
  buffer_load_dwordx4 v28, s[8:11], s43 offen lds
  s_add_u32 s43, s40, 655360
  s_add_u32 m0, s42, 20480
  s_nop 0
  buffer_load_dwordx4 v28, s[8:11], s43 offen lds
  s_add_u32 s43, s40, 786432
  s_add_u32 m0, s42, 24576
  s_nop 0
  buffer_load_dwordx4 v28, s[8:11], s43 offen lds
  s_add_u32 s43, s40, 917504
  s_add_u32 m0, s42, 28672
  s_nop 0
  buffer_load_dwordx4 v28, s[8:11], s43 offen lds
  s_add_u32 s43, s40, 1048576
  s_add_u32 m0, s42, 32768
  s_nop 0
  buffer_load_dwordx4 v28, s[8:11], s43 offen lds
  s_add_u32 s43, s40, 1179648
  s_add_u32 m0, s42, 36864
  s_nop 0
  buffer_load_dwordx4 v28, s[8:11], s43 offen lds
  s_add_u32 s43, s40, 1310720
  s_add_u32 m0, s42, 40960
  s_nop 0
  buffer_load_dwordx4 v28, s[8:11], s43 offen lds
  s_add_u32 s43, s40, 1441792
  s_add_u32 m0, s42, 45056
  s_nop 0
  buffer_load_dwordx4 v28, s[8:11], s43 offen lds
  s_add_u32 s43, s40, 1572864
  s_add_u32 m0, s42, 49152
  s_nop 0
  buffer_load_dwordx4 v28, s[8:11], s43 offen lds
  s_add_u32 s43, s40, 1703936
  s_add_u32 m0, s42, 53248
  s_nop 0
  buffer_load_dwordx4 v28, s[8:11], s43 offen lds
  s_add_u32 s43, s40, 1835008
  s_add_u32 m0, s42, 57344
  s_nop 0
  buffer_load_dwordx4 v28, s[8:11], s43 offen lds
  s_add_u32 s43, s40, 1966080
  s_add_u32 m0, s42, 61440
  s_nop 0
  buffer_load_dwordx4 v28, s[8:11], s43 offen lds
  s_add_u32 s43, s40, 2097152
  s_add_u32 m0, s42, 65536
  s_nop 0
  buffer_load_dwordx4 v28, s[8:11], s43 offen lds
  s_add_u32 s43, s40, 2228224
  s_add_u32 m0, s42, 69632
  s_nop 0
  buffer_load_dwordx4 v28, s[8:11], s43 offen lds
  s_add_u32 s43, s40, 2359296
  s_add_u32 m0, s42, 73728
  s_nop 0
  buffer_load_dwordx4 v28, s[8:11], s43 offen lds
  s_add_u32 s43, s40, 2490368
  s_add_u32 m0, s42, 77824
  s_nop 0
  buffer_load_dwordx4 v28, s[8:11], s43 offen lds
  s_add_u32 s43, s40, 2621440
  s_add_u32 m0, s42, 81920
  s_nop 0
  buffer_load_dwordx4 v28, s[8:11], s43 offen lds
  s_add_u32 s43, s40, 2752512
  s_add_u32 m0, s42, 86016
  s_nop 0
  buffer_load_dwordx4 v28, s[8:11], s43 offen lds
  s_add_u32 s43, s40, 2883584
  s_add_u32 m0, s42, 90112
  s_nop 0
  buffer_load_dwordx4 v28, s[8:11], s43 offen lds
  s_add_u32 s43, s40, 3014656
  s_add_u32 m0, s42, 94208
  s_nop 0
  buffer_load_dwordx4 v28, s[8:11], s43 offen lds
  s_add_u32 s43, s40, 3145728
  s_add_u32 m0, s42, 98304
  s_nop 0
  buffer_load_dwordx4 v28, s[8:11], s43 offen lds
  s_add_u32 s43, s40, 3276800
  s_add_u32 m0, s42, 102400
  s_nop 0
  buffer_load_dwordx4 v28, s[8:11], s43 offen lds
  s_add_u32 s43, s40, 3407872
  s_add_u32 m0, s42, 106496
  s_nop 0
  buffer_load_dwordx4 v28, s[8:11], s43 offen lds
  s_add_u32 s43, s40, 3538944
  s_add_u32 m0, s42, 110592
  s_nop 0
  buffer_load_dwordx4 v28, s[8:11], s43 offen lds
  s_add_u32 s43, s40, 3670016
  s_add_u32 m0, s42, 114688
  s_nop 0
  buffer_load_dwordx4 v28, s[8:11], s43 offen lds
  s_add_u32 s43, s40, 3801088
  s_add_u32 m0, s42, 118784
  s_nop 0
  buffer_load_dwordx4 v28, s[8:11], s43 offen lds
  s_add_u32 s43, s40, 3932160
  s_add_u32 m0, s42, 122880
  s_nop 0
  buffer_load_dwordx4 v28, s[8:11], s43 offen lds
  s_add_u32 s43, s40, 4063232
  s_add_u32 m0, s42, 126976
  s_nop 0
  buffer_load_dwordx4 v28, s[8:11], s43 offen lds
  ds_write_b128 v1, v[34:37] offset:31744
  v_mov_b64 v[40:41], 0
  v_mov_b64 v[42:43], 0
  s_mul_i32 s27, s16, 9472
  s_mul_i32 s28, s17, 2304
  s_add_u32 s27, s27, s28
  s_lshl_b32 s57, s17, 9
  s_add_u32 s57, s57, 15360
  s_add_u32 s21, s27, 917504
  s_sub_u32 s59, s21, s57
  buffer_store_dwordx4 v[40:43], v1, s[4:7], s21 offen sc1
  buffer_store_dwordx4 v[40:43], v1, s[4:7], s21 offen offset:1024 sc1
  s_sub_u32 s28, s21, s57
  buffer_store_dword v40, v6, s[4:7], s28 offen sc1
  v_mov_b64 v[44:45], -1
  v_mov_b64 v[46:47], -1
  s_mul_i32 s27, s16, 1536
  s_min_u32 s28, s17, 1
  s_lshl_b32 s28, s28, 9
  s_add_u32 s27, s27, s28
  s_add_u32 s27, s27, 1966080
  buffer_store_dwordx4 v[44:47], v1, s[4:7], s27 offen sc1
  v_lshrrev_b32 v48, 4, v1
  v_and_b32 v48, 63, v48
  v_lshlrev_b32 v49, 7, v48
  s_mul_i32 s27, s16, 124
  s_add_u32 s27, s27, 0x1000
  v_mov_b32 v50, s27
  v_cmp_eq_u32 vcc, 8, v48
  s_nop 1
  v_cndmask_b32 v49, v49, v50, vcc
  v_mov_b32 v50, 0
  s_lshl_b32 s27, s16, 2
  s_add_u32 s27, s27, 2162688
  s_mov_b64 exec, 0x1ff
  buffer_store_dword v50, v49, s[4:7], s27 offen sc1
  s_mov_b64 exec, -1
  s_waitcnt vmcnt(33) lgkmcnt(0)
  s_barrier
  s_add_u32 s43, s40, 4194304
  s_add_u32 m0, s42, 131072
  s_nop 0
  buffer_load_dwordx4 v28, s[8:11], s43 offen lds
  s_add_u32 s43, s40, 4325376
  s_add_u32 m0, s42, 135168
  s_nop 0
  buffer_load_dwordx4 v28, s[8:11], s43 offen lds
  s_add_u32 s43, s40, 4456448
  s_add_u32 m0, s42, 139264
  s_nop 0
  buffer_load_dwordx4 v28, s[8:11], s43 offen lds
  s_add_u32 s43, s40, 4587520
  s_add_u32 m0, s42, 143360
  s_nop 0
  buffer_load_dwordx4 v28, s[8:11], s43 offen lds
  v_add_u32 v13, 0, v31
  v_add_u32 v14, 0, v32
  ds_read_b64_tr_b16 v[72:73], v13 offset:0
  ds_read_b64_tr_b16 v[74:75], v13 offset:1024
  ds_read_b64_tr_b16 v[76:77], v13 offset:8192
  ds_read_b64_tr_b16 v[78:79], v13 offset:9216
  ds_read_b64_tr_b16 v[80:81], v14 offset:0
  ds_read_b64_tr_b16 v[82:83], v14 offset:1024
  ds_read_b64_tr_b16 v[84:85], v14 offset:8192
  ds_read_b64_tr_b16 v[86:87], v14 offset:9216
  s_waitcnt vmcnt(33) lgkmcnt(0)
  s_barrier
  s_mov_b32 s8, s34
  s_and_b32 s9, s35, 0xffff
  s_mov_b32 s10, 4718592
  s_mov_b32 s11, 0x20000
  s_add_u32 s43, s40, 0
  s_add_u32 m0, s42, 0
  s_nop 0
  buffer_load_dwordx4 v28, s[8:11], s43 offen lds
  s_add_u32 s43, s40, 131072
  s_add_u32 m0, s42, 4096
  s_nop 0
  buffer_load_dwordx4 v28, s[8:11], s43 offen lds
  s_add_u32 s43, s40, 262144
  s_add_u32 m0, s42, 8192
  s_nop 0
  buffer_load_dwordx4 v28, s[8:11], s43 offen lds
  s_add_u32 s43, s40, 393216
  s_add_u32 m0, s42, 12288
  s_nop 0
  buffer_load_dwordx4 v28, s[8:11], s43 offen lds
  v_add_u32 v13, 16384, v31
  v_add_u32 v14, 16384, v32
  ds_read_b64_tr_b16 v[88:89], v13 offset:0
  ds_read_b64_tr_b16 v[90:91], v13 offset:1024
  ds_read_b64_tr_b16 v[92:93], v13 offset:8192
  ds_read_b64_tr_b16 v[94:95], v13 offset:9216
  ds_read_b64_tr_b16 v[96:97], v14 offset:0
  ds_read_b64_tr_b16 v[98:99], v14 offset:1024
  ds_read_b64_tr_b16 v[100:101], v14 offset:8192
  ds_read_b64_tr_b16 v[102:103], v14 offset:9216
  s_waitcnt vmcnt(33) lgkmcnt(0)
  s_barrier
  s_add_u32 s43, s40, 524288
  s_add_u32 m0, s42, 16384
  s_nop 0
  buffer_load_dwordx4 v28, s[8:11], s43 offen lds
  s_add_u32 s43, s40, 655360
  s_add_u32 m0, s42, 20480
  s_nop 0
  buffer_load_dwordx4 v28, s[8:11], s43 offen lds
  s_add_u32 s43, s40, 786432
  s_add_u32 m0, s42, 24576
  s_nop 0
  buffer_load_dwordx4 v28, s[8:11], s43 offen lds
  s_add_u32 s43, s40, 917504
  s_add_u32 m0, s42, 28672
  s_nop 0
  buffer_load_dwordx4 v28, s[8:11], s43 offen lds
  v_add_u32 v13, 32768, v31
  v_add_u32 v14, 32768, v32
  ds_read_b64_tr_b16 v[104:105], v13 offset:0
  ds_read_b64_tr_b16 v[106:107], v13 offset:1024
  ds_read_b64_tr_b16 v[108:109], v13 offset:8192
  ds_read_b64_tr_b16 v[110:111], v13 offset:9216
  ds_read_b64_tr_b16 v[112:113], v14 offset:0
  ds_read_b64_tr_b16 v[114:115], v14 offset:1024
  ds_read_b64_tr_b16 v[116:117], v14 offset:8192
  ds_read_b64_tr_b16 v[118:119], v14 offset:9216
  s_waitcnt vmcnt(33) lgkmcnt(0)
  s_barrier
  s_add_u32 s43, s40, 1048576
  s_add_u32 m0, s42, 32768
  s_nop 0
  buffer_load_dwordx4 v28, s[8:11], s43 offen lds
  s_add_u32 s43, s40, 1179648
  s_add_u32 m0, s42, 36864
  s_nop 0
  buffer_load_dwordx4 v28, s[8:11], s43 offen lds
  s_add_u32 s43, s40, 1310720
  s_add_u32 m0, s42, 40960
  s_nop 0
  buffer_load_dwordx4 v28, s[8:11], s43 offen lds
  s_add_u32 s43, s40, 1441792
  s_add_u32 m0, s42, 45056
  s_nop 0
  buffer_load_dwordx4 v28, s[8:11], s43 offen lds
  v_add_u32 v13, 49152, v31
  v_add_u32 v14, 49152, v32
  ds_read_b64_tr_b16 v[120:121], v13 offset:0
  ds_read_b64_tr_b16 v[122:123], v13 offset:1024
  ds_read_b64_tr_b16 v[124:125], v13 offset:8192
  ds_read_b64_tr_b16 v[126:127], v13 offset:9216
  ds_read_b64_tr_b16 v[128:129], v14 offset:0
  ds_read_b64_tr_b16 v[130:131], v14 offset:1024
  ds_read_b64_tr_b16 v[132:133], v14 offset:8192
  ds_read_b64_tr_b16 v[134:135], v14 offset:9216
  s_waitcnt vmcnt(33) lgkmcnt(0)
  s_barrier
  s_add_u32 s43, s40, 1572864
  s_add_u32 m0, s42, 49152
  s_nop 0
  buffer_load_dwordx4 v28, s[8:11], s43 offen lds
  s_add_u32 s43, s40, 1703936
  s_add_u32 m0, s42, 53248
  s_nop 0
  buffer_load_dwordx4 v28, s[8:11], s43 offen lds
  s_add_u32 s43, s40, 1835008
  s_add_u32 m0, s42, 57344
  s_nop 0
  buffer_load_dwordx4 v28, s[8:11], s43 offen lds
  s_add_u32 s43, s40, 1966080
  s_add_u32 m0, s42, 61440
  s_nop 0
  buffer_load_dwordx4 v28, s[8:11], s43 offen lds
  v_add_u32 v13, 65536, v31
  v_add_u32 v14, 65536, v32
  ds_read_b64_tr_b16 v[136:137], v13 offset:0
  ds_read_b64_tr_b16 v[138:139], v13 offset:1024
  ds_read_b64_tr_b16 v[140:141], v13 offset:8192
  ds_read_b64_tr_b16 v[142:143], v13 offset:9216
  ds_read_b64_tr_b16 v[144:145], v14 offset:0
  ds_read_b64_tr_b16 v[146:147], v14 offset:1024
  ds_read_b64_tr_b16 v[148:149], v14 offset:8192
  ds_read_b64_tr_b16 v[150:151], v14 offset:9216
  s_waitcnt vmcnt(33) lgkmcnt(0)
  s_barrier
  s_add_u32 s43, s40, 2097152
  s_add_u32 m0, s42, 65536
  s_nop 0
  buffer_load_dwordx4 v28, s[8:11], s43 offen lds
  s_add_u32 s43, s40, 2228224
  s_add_u32 m0, s42, 69632
  s_nop 0
  buffer_load_dwordx4 v28, s[8:11], s43 offen lds
  s_add_u32 s43, s40, 2359296
  s_add_u32 m0, s42, 73728
  s_nop 0
  buffer_load_dwordx4 v28, s[8:11], s43 offen lds
  s_add_u32 s43, s40, 2490368
  s_add_u32 m0, s42, 77824
  s_nop 0
  buffer_load_dwordx4 v28, s[8:11], s43 offen lds
  v_add_u32 v13, 81920, v31
  v_add_u32 v14, 81920, v32
  ds_read_b64_tr_b16 v[152:153], v13 offset:0
  ds_read_b64_tr_b16 v[154:155], v13 offset:1024
  ds_read_b64_tr_b16 v[156:157], v13 offset:8192
  ds_read_b64_tr_b16 v[158:159], v13 offset:9216
  ds_read_b64_tr_b16 v[160:161], v14 offset:0
  ds_read_b64_tr_b16 v[162:163], v14 offset:1024
  ds_read_b64_tr_b16 v[164:165], v14 offset:8192
  ds_read_b64_tr_b16 v[166:167], v14 offset:9216
  s_waitcnt vmcnt(33) lgkmcnt(0)
  s_barrier
  s_add_u32 s43, s40, 2621440
  s_add_u32 m0, s42, 81920
  s_nop 0
  buffer_load_dwordx4 v28, s[8:11], s43 offen lds
  s_add_u32 s43, s40, 2752512
  s_add_u32 m0, s42, 86016
  s_nop 0
  buffer_load_dwordx4 v28, s[8:11], s43 offen lds
  s_add_u32 s43, s40, 2883584
  s_add_u32 m0, s42, 90112
  s_nop 0
  buffer_load_dwordx4 v28, s[8:11], s43 offen lds
  s_add_u32 s43, s40, 3014656
  s_add_u32 m0, s42, 94208
  s_nop 0
  buffer_load_dwordx4 v28, s[8:11], s43 offen lds
  v_add_u32 v13, 98304, v31
  v_add_u32 v14, 98304, v32
  ds_read_b64_tr_b16 v[168:169], v13 offset:0
  ds_read_b64_tr_b16 v[170:171], v13 offset:1024
  ds_read_b64_tr_b16 v[172:173], v13 offset:8192
  ds_read_b64_tr_b16 v[174:175], v13 offset:9216
  ds_read_b64_tr_b16 v[176:177], v14 offset:0
  ds_read_b64_tr_b16 v[178:179], v14 offset:1024
  ds_read_b64_tr_b16 v[180:181], v14 offset:8192
  ds_read_b64_tr_b16 v[182:183], v14 offset:9216
  s_waitcnt vmcnt(33) lgkmcnt(0)
  s_barrier
  s_add_u32 s43, s40, 3145728
  s_add_u32 m0, s42, 98304
  s_nop 0
  buffer_load_dwordx4 v28, s[8:11], s43 offen lds
  s_add_u32 s43, s40, 3276800
  s_add_u32 m0, s42, 102400
  s_nop 0
  buffer_load_dwordx4 v28, s[8:11], s43 offen lds
  s_add_u32 s43, s40, 3407872
  s_add_u32 m0, s42, 106496
  s_nop 0
  buffer_load_dwordx4 v28, s[8:11], s43 offen lds
  s_add_u32 s43, s40, 3538944
  s_add_u32 m0, s42, 110592
  s_nop 0
  buffer_load_dwordx4 v28, s[8:11], s43 offen lds
  v_add_u32 v13, 114688, v31
  v_add_u32 v14, 114688, v32
  ds_read_b64_tr_b16 v[184:185], v13 offset:0
  ds_read_b64_tr_b16 v[186:187], v13 offset:1024
  ds_read_b64_tr_b16 v[188:189], v13 offset:8192
  ds_read_b64_tr_b16 v[190:191], v13 offset:9216
  ds_read_b64_tr_b16 v[192:193], v14 offset:0
  ds_read_b64_tr_b16 v[194:195], v14 offset:1024
  ds_read_b64_tr_b16 v[196:197], v14 offset:8192
  ds_read_b64_tr_b16 v[198:199], v14 offset:9216
  s_waitcnt vmcnt(28) lgkmcnt(0)
  s_barrier
  s_cmp_eq_u32 s17, 0
  s_cbranch_scc0 dbga_17
  s_mov_b64 exec, 1
  v_mov_b32 v13, 36
  v_mov_b32 v14, 1
  global_atomic_add v13, v14, s[14:15]
  s_mov_b64 exec, -1
dbga_17:
  s_add_u32 s43, s40, 3670016
  s_add_u32 m0, s42, 114688
  s_nop 0
  buffer_load_dwordx4 v28, s[8:11], s43 offen lds
  s_add_u32 s43, s40, 3801088
  s_add_u32 m0, s42, 118784
  s_nop 0
  buffer_load_dwordx4 v28, s[8:11], s43 offen lds
  s_add_u32 s43, s40, 3932160
  s_add_u32 m0, s42, 122880
  s_nop 0
  buffer_load_dwordx4 v28, s[8:11], s43 offen lds
  s_add_u32 s43, s40, 4063232
  s_add_u32 m0, s42, 126976
  s_nop 0
  buffer_load_dwordx4 v28, s[8:11], s43 offen lds
  v_add_u32 v13, 131072, v31
  v_add_u32 v14, 131072, v32
  ds_read_b64_tr_b16 v[200:201], v13 offset:0
  ds_read_b64_tr_b16 v[202:203], v13 offset:1024
  ds_read_b64_tr_b16 v[204:205], v13 offset:8192
  ds_read_b64_tr_b16 v[206:207], v13 offset:9216
  ds_read_b64_tr_b16 v[208:209], v14 offset:0
  ds_read_b64_tr_b16 v[210:211], v14 offset:1024
  ds_read_b64_tr_b16 v[212:213], v14 offset:8192
  ds_read_b64_tr_b16 v[214:215], v14 offset:9216
  s_waitcnt vmcnt(28) lgkmcnt(0)
  s_barrier
  s_add_u32 s43, s40, 4194304
  s_add_u32 m0, s42, 131072
  s_nop 0
  buffer_load_dwordx4 v28, s[8:11], s43 offen lds
  s_add_u32 s43, s40, 4325376
  s_add_u32 m0, s42, 135168
  s_nop 0
  buffer_load_dwordx4 v28, s[8:11], s43 offen lds
  s_add_u32 s43, s40, 4456448
  s_add_u32 m0, s42, 139264
  s_nop 0
  buffer_load_dwordx4 v28, s[8:11], s43 offen lds
  s_add_u32 s43, s40, 4587520
  s_add_u32 m0, s42, 143360
  s_nop 0
  buffer_load_dwordx4 v28, s[8:11], s43 offen lds
  v_add_u32 v13, 0, v31
  v_add_u32 v14, 0, v32
  ds_read_b64_tr_b16 v[216:217], v13 offset:0
  ds_read_b64_tr_b16 v[218:219], v13 offset:1024
  ds_read_b64_tr_b16 v[220:221], v13 offset:8192
  ds_read_b64_tr_b16 v[222:223], v13 offset:9216
  ds_read_b64_tr_b16 v[224:225], v14 offset:0
  ds_read_b64_tr_b16 v[226:227], v14 offset:1024
  ds_read_b64_tr_b16 v[228:229], v14 offset:8192
  ds_read_b64_tr_b16 v[230:231], v14 offset:9216
  s_waitcnt vmcnt(28) lgkmcnt(0)
  s_barrier
  s_mov_b32 s8, s36
  s_and_b32 s9, s37, 0xffff
  s_mov_b32 s10, 4718592
  s_mov_b32 s11, 0x20000
  s_add_u32 s43, s41, 0
  s_add_u32 m0, s42, 0
  s_nop 0
  buffer_load_dwordx4 v29, s[8:11], s43 offen lds
  s_add_u32 s43, s41, 9216
  s_add_u32 m0, s42, 4096
  s_nop 0
  buffer_load_dwordx4 v29, s[8:11], s43 offen lds
  s_add_u32 s43, s41, 36864
  s_add_u32 m0, s42, 8192
  s_nop 0
  buffer_load_dwordx4 v29, s[8:11], s43 offen lds
  s_add_u32 s43, s41, 46080
  s_add_u32 m0, s42, 12288
  s_nop 0
  buffer_load_dwordx4 v29, s[8:11], s43 offen lds
  v_add_u32 v13, 16384, v31
  v_add_u32 v14, 16384, v32
  ds_read_b64_tr_b16 v[232:233], v13 offset:0
  ds_read_b64_tr_b16 v[234:235], v13 offset:1024
  ds_read_b64_tr_b16 v[236:237], v13 offset:8192
  ds_read_b64_tr_b16 v[238:239], v13 offset:9216
  ds_read_b64_tr_b16 v[240:241], v14 offset:0
  ds_read_b64_tr_b16 v[242:243], v14 offset:1024
  ds_read_b64_tr_b16 v[244:245], v14 offset:8192
  ds_read_b64_tr_b16 v[246:247], v14 offset:9216
  s_waitcnt vmcnt(28) lgkmcnt(0)
  s_barrier
  s_add_u32 s43, s41, 64
  s_add_u32 m0, s42, 16384
  s_nop 0
  buffer_load_dwordx4 v29, s[8:11], s43 offen lds
  s_add_u32 s43, s41, 9280
  s_add_u32 m0, s42, 20480
  s_nop 0
  buffer_load_dwordx4 v29, s[8:11], s43 offen lds
  s_add_u32 s43, s41, 36928
  s_add_u32 m0, s42, 24576
  s_nop 0
  buffer_load_dwordx4 v29, s[8:11], s43 offen lds
  s_add_u32 s43, s41, 46144
  s_add_u32 m0, s42, 28672
  s_nop 0
  buffer_load_dwordx4 v29, s[8:11], s43 offen lds
  v_add_u32 v13, 32768, v31
  v_add_u32 v14, 32768, v32
  ds_read_b64_tr_b16 v[248:249], v13 offset:0
  ds_read_b64_tr_b16 v[250:251], v13 offset:1024
  ds_read_b64_tr_b16 v[252:253], v13 offset:8192
  ds_read_b64_tr_b16 v[254:255], v13 offset:9216
  ds_read_b64_tr_b16 a[0:1], v14 offset:0
  ds_read_b64_tr_b16 a[2:3], v14 offset:1024
  ds_read_b64_tr_b16 a[4:5], v14 offset:8192
  ds_read_b64_tr_b16 a[6:7], v14 offset:9216
  s_waitcnt vmcnt(28) lgkmcnt(0)
  s_barrier
  s_add_u32 s43, s41, 128
  s_add_u32 m0, s42, 32768
  s_nop 0
  buffer_load_dwordx4 v29, s[8:11], s43 offen lds
  s_add_u32 s43, s41, 9344
  s_add_u32 m0, s42, 36864
  s_nop 0
  buffer_load_dwordx4 v29, s[8:11], s43 offen lds
  s_add_u32 s43, s41, 36992
  s_add_u32 m0, s42, 40960
  s_nop 0
  buffer_load_dwordx4 v29, s[8:11], s43 offen lds
  s_add_u32 s43, s41, 46208
  s_add_u32 m0, s42, 45056
  s_nop 0
  buffer_load_dwordx4 v29, s[8:11], s43 offen lds
  v_add_u32 v13, 49152, v31
  v_add_u32 v14, 49152, v32
  ds_read_b64_tr_b16 a[8:9], v13 offset:0
  ds_read_b64_tr_b16 a[10:11], v13 offset:1024
  ds_read_b64_tr_b16 a[12:13], v13 offset:8192
  ds_read_b64_tr_b16 a[14:15], v13 offset:9216
  ds_read_b64_tr_b16 a[16:17], v14 offset:0
  ds_read_b64_tr_b16 a[18:19], v14 offset:1024
  ds_read_b64_tr_b16 a[20:21], v14 offset:8192
  ds_read_b64_tr_b16 a[22:23], v14 offset:9216
  s_waitcnt vmcnt(28) lgkmcnt(0)
  s_barrier
  s_add_u32 s43, s41, 192
  s_add_u32 m0, s42, 49152
  s_nop 0
  buffer_load_dwordx4 v29, s[8:11], s43 offen lds
  s_add_u32 s43, s41, 9408
  s_add_u32 m0, s42, 53248
  s_nop 0
  buffer_load_dwordx4 v29, s[8:11], s43 offen lds
  s_add_u32 s43, s41, 37056
  s_add_u32 m0, s42, 57344
  s_nop 0
  buffer_load_dwordx4 v29, s[8:11], s43 offen lds
  s_add_u32 s43, s41, 46272
  s_add_u32 m0, s42, 61440
  s_nop 0
  buffer_load_dwordx4 v29, s[8:11], s43 offen lds
  v_add_u32 v13, 65536, v31
  v_add_u32 v14, 65536, v32
  ds_read_b64_tr_b16 a[24:25], v13 offset:0
  ds_read_b64_tr_b16 a[26:27], v13 offset:1024
  ds_read_b64_tr_b16 a[28:29], v13 offset:8192
  ds_read_b64_tr_b16 a[30:31], v13 offset:9216
  ds_read_b64_tr_b16 a[32:33], v14 offset:0
  ds_read_b64_tr_b16 a[34:35], v14 offset:1024
  ds_read_b64_tr_b16 a[36:37], v14 offset:8192
  ds_read_b64_tr_b16 a[38:39], v14 offset:9216
  s_waitcnt vmcnt(28) lgkmcnt(0)
  s_barrier
  s_add_u32 s43, s41, 73728
  s_add_u32 m0, s42, 65536
  s_nop 0
  buffer_load_dwordx4 v29, s[8:11], s43 offen lds
  s_add_u32 s43, s41, 82944
  s_add_u32 m0, s42, 69632
  s_nop 0
  buffer_load_dwordx4 v29, s[8:11], s43 offen lds
  s_add_u32 s43, s41, 110592
  s_add_u32 m0, s42, 73728
  s_nop 0
  buffer_load_dwordx4 v29, s[8:11], s43 offen lds
  s_add_u32 s43, s41, 119808
  s_add_u32 m0, s42, 77824
  s_nop 0
  buffer_load_dwordx4 v29, s[8:11], s43 offen lds
  v_add_u32 v13, 81920, v31
  v_add_u32 v14, 81920, v32
  ds_read_b64_tr_b16 a[40:41], v13 offset:0
  ds_read_b64_tr_b16 a[42:43], v13 offset:1024
  ds_read_b64_tr_b16 a[44:45], v13 offset:8192
  ds_read_b64_tr_b16 a[46:47], v13 offset:9216
  ds_read_b64_tr_b16 a[48:49], v14 offset:0
  ds_read_b64_tr_b16 a[50:51], v14 offset:1024
  ds_read_b64_tr_b16 a[52:53], v14 offset:8192
  ds_read_b64_tr_b16 a[54:55], v14 offset:9216
  s_waitcnt vmcnt(28) lgkmcnt(0)
  s_barrier
  s_add_u32 s43, s41, 73792
  s_add_u32 m0, s42, 81920
  s_nop 0
  buffer_load_dwordx4 v29, s[8:11], s43 offen lds
  s_add_u32 s43, s41, 83008
  s_add_u32 m0, s42, 86016
  s_nop 0
  buffer_load_dwordx4 v29, s[8:11], s43 offen lds
  s_add_u32 s43, s41, 110656
  s_add_u32 m0, s42, 90112
  s_nop 0
  buffer_load_dwordx4 v29, s[8:11], s43 offen lds
  s_add_u32 s43, s41, 119872
  s_add_u32 m0, s42, 94208
  s_nop 0
  buffer_load_dwordx4 v29, s[8:11], s43 offen lds
  v_add_u32 v13, 98304, v31
  v_add_u32 v14, 98304, v32
  ds_read_b64_tr_b16 a[56:57], v13 offset:0
  ds_read_b64_tr_b16 a[58:59], v13 offset:1024
  ds_read_b64_tr_b16 a[60:61], v13 offset:8192
  ds_read_b64_tr_b16 a[62:63], v13 offset:9216
  ds_read_b64_tr_b16 a[64:65], v14 offset:0
  ds_read_b64_tr_b16 a[66:67], v14 offset:1024
  ds_read_b64_tr_b16 a[68:69], v14 offset:8192
  ds_read_b64_tr_b16 a[70:71], v14 offset:9216
  s_waitcnt vmcnt(28) lgkmcnt(0)
  s_barrier
  s_add_u32 s43, s41, 73856
  s_add_u32 m0, s42, 98304
  s_nop 0
  buffer_load_dwordx4 v29, s[8:11], s43 offen lds
  s_add_u32 s43, s41, 83072
  s_add_u32 m0, s42, 102400
  s_nop 0
  buffer_load_dwordx4 v29, s[8:11], s43 offen lds
  s_add_u32 s43, s41, 110720
  s_add_u32 m0, s42, 106496
  s_nop 0
  buffer_load_dwordx4 v29, s[8:11], s43 offen lds
  s_add_u32 s43, s41, 119936
  s_add_u32 m0, s42, 110592
  s_nop 0
  buffer_load_dwordx4 v29, s[8:11], s43 offen lds
  v_add_u32 v13, 114688, v31
  v_add_u32 v14, 114688, v32
  ds_read_b64_tr_b16 a[72:73], v13 offset:0
  ds_read_b64_tr_b16 a[74:75], v13 offset:1024
  ds_read_b64_tr_b16 a[76:77], v13 offset:8192
  ds_read_b64_tr_b16 a[78:79], v13 offset:9216
  ds_read_b64_tr_b16 a[80:81], v14 offset:0
  ds_read_b64_tr_b16 a[82:83], v14 offset:1024
  ds_read_b64_tr_b16 a[84:85], v14 offset:8192
  ds_read_b64_tr_b16 a[86:87], v14 offset:9216
  s_waitcnt vmcnt(28) lgkmcnt(0)
  s_barrier
  s_add_u32 s43, s41, 73920
  s_add_u32 m0, s42, 114688
  s_nop 0
  buffer_load_dwordx4 v29, s[8:11], s43 offen lds
  s_add_u32 s43, s41, 83136
  s_add_u32 m0, s42, 118784
  s_nop 0
  buffer_load_dwordx4 v29, s[8:11], s43 offen lds
  s_add_u32 s43, s41, 110784
  s_add_u32 m0, s42, 122880
  s_nop 0
  buffer_load_dwordx4 v29, s[8:11], s43 offen lds
  s_add_u32 s43, s41, 120000
  s_add_u32 m0, s42, 126976
  s_nop 0
  buffer_load_dwordx4 v29, s[8:11], s43 offen lds
  v_add_u32 v13, 131072, v31
  v_add_u32 v14, 131072, v32
  ds_read_b64_tr_b16 a[88:89], v13 offset:0
  ds_read_b64_tr_b16 a[90:91], v13 offset:1024
  ds_read_b64_tr_b16 a[92:93], v13 offset:8192
  ds_read_b64_tr_b16 a[94:95], v13 offset:9216
  ds_read_b64_tr_b16 a[96:97], v14 offset:0
  ds_read_b64_tr_b16 a[98:99], v14 offset:1024
  ds_read_b64_tr_b16 a[100:101], v14 offset:8192
  ds_read_b64_tr_b16 a[102:103], v14 offset:9216
  s_waitcnt vmcnt(28) lgkmcnt(0)
  s_barrier
  s_add_u32 s43, s41, 256
  s_add_u32 m0, s42, 131072
  s_nop 0
  buffer_load_dwordx4 v30, s[8:11], s43 offen lds
  s_add_u32 s43, s41, 9472
  s_add_u32 m0, s42, 135168
  s_nop 0
  buffer_load_dwordx4 v30, s[8:11], s43 offen lds
  s_add_u32 s43, s41, 37120
  s_add_u32 m0, s42, 139264
  s_nop 0
  buffer_load_dwordx4 v30, s[8:11], s43 offen lds
  s_add_u32 s43, s41, 46336
  s_add_u32 m0, s42, 143360
  s_nop 0
  buffer_load_dwordx4 v30, s[8:11], s43 offen lds
  v_add_u32 v13, 0, v31
  v_add_u32 v14, 0, v32
  ds_read_b64_tr_b16 a[112:113], v13 offset:0
  ds_read_b64_tr_b16 a[114:115], v13 offset:1024
  ds_read_b64_tr_b16 a[116:117], v13 offset:8192
  ds_read_b64_tr_b16 a[118:119], v13 offset:9216
  ds_read_b64_tr_b16 a[128:129], v14 offset:0
  ds_read_b64_tr_b16 a[130:131], v14 offset:1024
  ds_read_b64_tr_b16 a[132:133], v14 offset:8192
  ds_read_b64_tr_b16 a[134:135], v14 offset:9216
  s_waitcnt vmcnt(28) lgkmcnt(0)
  s_barrier
  s_mov_b32 s8, s32
  s_and_b32 s9, s33, 0xffff
  s_mov_b32 s10, 4718592
  s_mov_b32 s11, 0x20000
  s_add_u32 s43, s40, 0
  s_add_u32 m0, s42, 0
  s_nop 0
  buffer_load_dwordx4 v28, s[8:11], s43 offen lds
  s_add_u32 s43, s40, 131072
  s_add_u32 m0, s42, 4096
  s_nop 0
  buffer_load_dwordx4 v28, s[8:11], s43 offen lds
  s_add_u32 s43, s40, 262144
  s_add_u32 m0, s42, 8192
  s_nop 0
  buffer_load_dwordx4 v28, s[8:11], s43 offen lds
  s_add_u32 s43, s40, 393216
  s_add_u32 m0, s42, 12288
  s_nop 0
  buffer_load_dwordx4 v28, s[8:11], s43 offen lds
  v_add_u32 v13, 16384, v31
  v_add_u32 v14, 16384, v32
  ds_read_b64_tr_b16 a[144:145], v13 offset:0
  ds_read_b64_tr_b16 a[146:147], v13 offset:1024
  ds_read_b64_tr_b16 a[148:149], v13 offset:8192
  ds_read_b64_tr_b16 a[150:151], v13 offset:9216
  ds_read_b64_tr_b16 a[160:161], v14 offset:0
  ds_read_b64_tr_b16 a[162:163], v14 offset:1024
  ds_read_b64_tr_b16 a[164:165], v14 offset:8192
  ds_read_b64_tr_b16 a[166:167], v14 offset:9216
  s_waitcnt vmcnt(28) lgkmcnt(0)
  s_barrier
  s_add_u32 s43, s40, 524288
  s_add_u32 m0, s42, 16384
  s_nop 0
  buffer_load_dwordx4 v28, s[8:11], s43 offen lds
  s_add_u32 s43, s40, 655360
  s_add_u32 m0, s42, 20480
  s_nop 0
  buffer_load_dwordx4 v28, s[8:11], s43 offen lds
  s_add_u32 s43, s40, 786432
  s_add_u32 m0, s42, 24576
  s_nop 0
  buffer_load_dwordx4 v28, s[8:11], s43 offen lds
  s_add_u32 s43, s40, 917504
  s_add_u32 m0, s42, 28672
  s_nop 0
  buffer_load_dwordx4 v28, s[8:11], s43 offen lds
  v_add_u32 v13, 32768, v31
  v_add_u32 v14, 32768, v32
  ds_read_b64_tr_b16 a[176:177], v13 offset:0
  ds_read_b64_tr_b16 a[178:179], v13 offset:1024
  ds_read_b64_tr_b16 a[180:181], v13 offset:8192
  ds_read_b64_tr_b16 a[182:183], v13 offset:9216
  ds_read_b64_tr_b16 a[192:193], v14 offset:0
  ds_read_b64_tr_b16 a[194:195], v14 offset:1024
  ds_read_b64_tr_b16 a[196:197], v14 offset:8192
  ds_read_b64_tr_b16 a[198:199], v14 offset:9216
  s_waitcnt vmcnt(28) lgkmcnt(0)
  s_barrier
  s_add_u32 s43, s40, 1048576
  s_add_u32 m0, s42, 32768
  s_nop 0
  buffer_load_dwordx4 v28, s[8:11], s43 offen lds
  s_add_u32 s43, s40, 1179648
  s_add_u32 m0, s42, 36864
  s_nop 0
  buffer_load_dwordx4 v28, s[8:11], s43 offen lds
  s_add_u32 s43, s40, 1310720
  s_add_u32 m0, s42, 40960
  s_nop 0
  buffer_load_dwordx4 v28, s[8:11], s43 offen lds
  s_add_u32 s43, s40, 1441792
  s_add_u32 m0, s42, 45056
  s_nop 0
  buffer_load_dwordx4 v28, s[8:11], s43 offen lds
  v_add_u32 v13, 49152, v31
  v_add_u32 v14, 49152, v32
  ds_read_b64_tr_b16 a[208:209], v13 offset:0
  ds_read_b64_tr_b16 a[210:211], v13 offset:1024
  ds_read_b64_tr_b16 a[212:213], v13 offset:8192
  ds_read_b64_tr_b16 a[214:215], v13 offset:9216
  ds_read_b64_tr_b16 a[224:225], v14 offset:0
  ds_read_b64_tr_b16 a[226:227], v14 offset:1024
  ds_read_b64_tr_b16 a[228:229], v14 offset:8192
  ds_read_b64_tr_b16 a[230:231], v14 offset:9216
  s_waitcnt vmcnt(28) lgkmcnt(0)
  s_barrier
  s_add_u32 s43, s40, 1572864
  s_add_u32 m0, s42, 49152
  s_nop 0
  buffer_load_dwordx4 v28, s[8:11], s43 offen lds
  s_add_u32 s43, s40, 1703936
  s_add_u32 m0, s42, 53248
  s_nop 0
  buffer_load_dwordx4 v28, s[8:11], s43 offen lds
  s_add_u32 s43, s40, 1835008
  s_add_u32 m0, s42, 57344
  s_nop 0
  buffer_load_dwordx4 v28, s[8:11], s43 offen lds
  s_add_u32 s43, s40, 1966080
  s_add_u32 m0, s42, 61440
  s_nop 0
  buffer_load_dwordx4 v28, s[8:11], s43 offen lds
  v_add_u32 v13, 65536, v31
  v_add_u32 v14, 65536, v32
  ds_read_b64_tr_b16 a[120:121], v13 offset:0
  ds_read_b64_tr_b16 a[122:123], v13 offset:1024
  ds_read_b64_tr_b16 a[124:125], v13 offset:8192
  ds_read_b64_tr_b16 a[126:127], v13 offset:9216
  ds_read_b64_tr_b16 a[136:137], v14 offset:0
  ds_read_b64_tr_b16 a[138:139], v14 offset:1024
  ds_read_b64_tr_b16 a[140:141], v14 offset:8192
  ds_read_b64_tr_b16 a[142:143], v14 offset:9216
  s_waitcnt vmcnt(28) lgkmcnt(0)
  s_barrier
  s_add_u32 s43, s40, 2097152
  s_add_u32 m0, s42, 65536
  s_nop 0
  buffer_load_dwordx4 v28, s[8:11], s43 offen lds
  s_add_u32 s43, s40, 2228224
  s_add_u32 m0, s42, 69632
  s_nop 0
  buffer_load_dwordx4 v28, s[8:11], s43 offen lds
  s_add_u32 s43, s40, 2359296
  s_add_u32 m0, s42, 73728
  s_nop 0
  buffer_load_dwordx4 v28, s[8:11], s43 offen lds
  s_add_u32 s43, s40, 2490368
  s_add_u32 m0, s42, 77824
  s_nop 0
  buffer_load_dwordx4 v28, s[8:11], s43 offen lds
  v_add_u32 v13, 81920, v31
  v_add_u32 v14, 81920, v32
  ds_read_b64_tr_b16 a[152:153], v13 offset:0
  ds_read_b64_tr_b16 a[154:155], v13 offset:1024
  ds_read_b64_tr_b16 a[156:157], v13 offset:8192
  ds_read_b64_tr_b16 a[158:159], v13 offset:9216
  ds_read_b64_tr_b16 a[168:169], v14 offset:0
  ds_read_b64_tr_b16 a[170:171], v14 offset:1024
  ds_read_b64_tr_b16 a[172:173], v14 offset:8192
  ds_read_b64_tr_b16 a[174:175], v14 offset:9216
  s_waitcnt vmcnt(28) lgkmcnt(0)
  s_barrier
  s_add_u32 s43, s40, 2621440
  s_add_u32 m0, s42, 81920
  s_nop 0
  buffer_load_dwordx4 v28, s[8:11], s43 offen lds
  s_add_u32 s43, s40, 2752512
  s_add_u32 m0, s42, 86016
  s_nop 0
  buffer_load_dwordx4 v28, s[8:11], s43 offen lds
  s_add_u32 s43, s40, 2883584
  s_add_u32 m0, s42, 90112
  s_nop 0
  buffer_load_dwordx4 v28, s[8:11], s43 offen lds
  s_add_u32 s43, s40, 3014656
  s_add_u32 m0, s42, 94208
  s_nop 0
  buffer_load_dwordx4 v28, s[8:11], s43 offen lds
  v_add_u32 v13, 98304, v31
  v_add_u32 v14, 98304, v32
  ds_read_b64_tr_b16 a[184:185], v13 offset:0
  ds_read_b64_tr_b16 a[186:187], v13 offset:1024
  ds_read_b64_tr_b16 a[188:189], v13 offset:8192
  ds_read_b64_tr_b16 a[190:191], v13 offset:9216
  ds_read_b64_tr_b16 a[200:201], v14 offset:0
  ds_read_b64_tr_b16 a[202:203], v14 offset:1024
  ds_read_b64_tr_b16 a[204:205], v14 offset:8192
  ds_read_b64_tr_b16 a[206:207], v14 offset:9216
  s_waitcnt vmcnt(28) lgkmcnt(0)
  s_barrier
  s_add_u32 s43, s40, 3145728
  s_add_u32 m0, s42, 98304
  s_nop 0
  buffer_load_dwordx4 v28, s[8:11], s43 offen lds
  s_add_u32 s43, s40, 3276800
  s_add_u32 m0, s42, 102400
  s_nop 0
  buffer_load_dwordx4 v28, s[8:11], s43 offen lds
  s_add_u32 s43, s40, 3407872
  s_add_u32 m0, s42, 106496
  s_nop 0
  buffer_load_dwordx4 v28, s[8:11], s43 offen lds
  s_add_u32 s43, s40, 3538944
  s_add_u32 m0, s42, 110592
  s_nop 0
  buffer_load_dwordx4 v28, s[8:11], s43 offen lds
  v_add_u32 v13, 114688, v31
  v_add_u32 v14, 114688, v32
  ds_read_b64_tr_b16 a[216:217], v13 offset:0
  ds_read_b64_tr_b16 a[218:219], v13 offset:1024
  ds_read_b64_tr_b16 a[220:221], v13 offset:8192
  ds_read_b64_tr_b16 a[222:223], v13 offset:9216
  ds_read_b64_tr_b16 a[232:233], v14 offset:0
  ds_read_b64_tr_b16 a[234:235], v14 offset:1024
  ds_read_b64_tr_b16 a[236:237], v14 offset:8192
  ds_read_b64_tr_b16 a[238:239], v14 offset:9216
  s_waitcnt vmcnt(28) lgkmcnt(0)
  s_barrier
  s_add_u32 s43, s40, 3670016
  s_add_u32 m0, s42, 114688
  s_nop 0
  buffer_load_dwordx4 v28, s[8:11], s43 offen lds
  s_add_u32 s43, s40, 3801088
  s_add_u32 m0, s42, 118784
  s_nop 0
  buffer_load_dwordx4 v28, s[8:11], s43 offen lds
  s_add_u32 s43, s40, 3932160
  s_add_u32 m0, s42, 122880
  s_nop 0
  buffer_load_dwordx4 v28, s[8:11], s43 offen lds
  s_add_u32 s43, s40, 4063232
  s_add_u32 m0, s42, 126976
  s_nop 0
  buffer_load_dwordx4 v28, s[8:11], s43 offen lds
  v_add_u32 v13, 131072, v31
  v_add_u32 v14, 131072, v32
  ds_read_b64_tr_b16 a[240:241], v13 offset:0
  ds_read_b64_tr_b16 a[242:243], v13 offset:1024
  ds_read_b64_tr_b16 a[244:245], v13 offset:8192
  ds_read_b64_tr_b16 a[246:247], v13 offset:9216
  ds_read_b64_tr_b16 a[248:249], v14 offset:0
  ds_read_b64_tr_b16 a[250:251], v14 offset:1024
  ds_read_b64_tr_b16 a[252:253], v14 offset:8192
  ds_read_b64_tr_b16 a[254:255], v14 offset:9216
  s_waitcnt vmcnt(28) lgkmcnt(0)
  s_barrier
  s_add_u32 s43, s40, 4194304
  s_add_u32 m0, s42, 131072
  s_nop 0
  buffer_load_dwordx4 v28, s[8:11], s43 offen lds
  s_add_u32 s43, s40, 4325376
  s_add_u32 m0, s42, 135168
  s_nop 0
  buffer_load_dwordx4 v28, s[8:11], s43 offen lds
  s_add_u32 s43, s40, 4456448
  s_add_u32 m0, s42, 139264
  s_nop 0
  buffer_load_dwordx4 v28, s[8:11], s43 offen lds
  s_add_u32 s43, s40, 4587520
  s_add_u32 m0, s42, 143360
  s_nop 0
  buffer_load_dwordx4 v28, s[8:11], s43 offen lds
  v_add_u32 v13, 0, v31
  v_add_u32 v14, 0, v32
  ds_read_b64_tr_b16 v[56:57], v13 offset:0
  ds_read_b64_tr_b16 v[58:59], v13 offset:1024
  ds_read_b64_tr_b16 v[60:61], v13 offset:8192
  ds_read_b64_tr_b16 v[62:63], v13 offset:9216
  ds_read_b64_tr_b16 v[64:65], v14 offset:0
  ds_read_b64_tr_b16 v[66:67], v14 offset:1024
  ds_read_b64_tr_b16 v[68:69], v14 offset:8192
  ds_read_b64_tr_b16 v[70:71], v14 offset:9216
  s_waitcnt vmcnt(28) lgkmcnt(0)
  s_barrier
  ds_write_b128 v2, v[56:59] offset:0
  ds_write_b128 v2, v[60:63] offset:1024
  ds_write_b128 v2, v[64:67] offset:8192
  ds_write_b128 v2, v[68:71] offset:9216
  s_mov_b32 s44, s38
  s_and_b32 s45, s39, 0xffff
  s_mov_b32 s46, 9216
  s_mov_b32 s47, 0x20000
  s_lshl_b32 s43, s17, 8
  buffer_load_dwordx4 v[16:19], v33, s[44:47], s43 offen
  buffer_load_dwordx4 v[20:23], v33, s[44:47], s43 offen offset:128
  s_mov_b32 s43, 1024
  buffer_load_dwordx4 v[24:27], v33, s[44:47], s43 offen
  v_lshrrev_b32 v38, 2, v1
  v_and_b32 v38, 60, v38
  global_load_dword v38, v38, s[14:15] sc1
  v_lshrrev_b32 v39, 4, v1
  v_and_b32 v39, 1, v39
  v_lshlrev_b32 v39, 7, v39
  s_lshl_b32 s43, s16, 2
  s_add_u32 s43, s43, 2162816
  buffer_load_dword v39, v39, s[4:7], s43 offen sc1
  v_add_u32 v13, 16384, v31
  v_add_u32 v14, 16384, v32
  ds_read_b64_tr_b16 v[40:41], v13 offset:0
  ds_read_b64_tr_b16 v[42:43], v13 offset:1024
  ds_read_b64_tr_b16 v[44:45], v13 offset:8192
  ds_read_b64_tr_b16 v[46:47], v13 offset:9216
  ds_read_b64_tr_b16 v[48:49], v14 offset:0
  ds_read_b64_tr_b16 v[50:51], v14 offset:1024
  ds_read_b64_tr_b16 v[52:53], v14 offset:8192
  ds_read_b64_tr_b16 v[54:55], v14 offset:9216
  s_waitcnt vmcnt(29) lgkmcnt(0)
  s_barrier
  ds_write_b128 v2, v[40:43] offset:16384
  ds_write_b128 v2, v[44:47] offset:17408
  ds_write_b128 v2, v[48:51] offset:24576
  ds_write_b128 v2, v[52:55] offset:25600
  v_add_u32 v13, 32768, v31
  v_add_u32 v14, 32768, v32
  ds_read_b64_tr_b16 v[56:57], v13 offset:0
  ds_read_b64_tr_b16 v[58:59], v13 offset:1024
  ds_read_b64_tr_b16 v[60:61], v13 offset:8192
  ds_read_b64_tr_b16 v[62:63], v13 offset:9216
  ds_read_b64_tr_b16 v[64:65], v14 offset:0
  ds_read_b64_tr_b16 v[66:67], v14 offset:1024
  ds_read_b64_tr_b16 v[68:69], v14 offset:8192
  ds_read_b64_tr_b16 v[70:71], v14 offset:9216
  s_waitcnt vmcnt(25) lgkmcnt(0)
  s_barrier
  ds_write_b128 v2, v[56:59] offset:32768
  ds_write_b128 v2, v[60:63] offset:33792
  ds_write_b128 v2, v[64:67] offset:40960
  ds_write_b128 v2, v[68:71] offset:41984
  v_add_u32 v13, 49152, v31
  v_add_u32 v14, 49152, v32
  ds_read_b64_tr_b16 v[40:41], v13 offset:0
  ds_read_b64_tr_b16 v[42:43], v13 offset:1024
  ds_read_b64_tr_b16 v[44:45], v13 offset:8192
  ds_read_b64_tr_b16 v[46:47], v13 offset:9216
  ds_read_b64_tr_b16 v[48:49], v14 offset:0
  ds_read_b64_tr_b16 v[50:51], v14 offset:1024
  ds_read_b64_tr_b16 v[52:53], v14 offset:8192
  ds_read_b64_tr_b16 v[54:55], v14 offset:9216
  s_waitcnt vmcnt(21) lgkmcnt(0)
  s_barrier
  ds_write_b128 v2, v[40:43] offset:49152
  ds_write_b128 v2, v[44:47] offset:50176
  ds_write_b128 v2, v[48:51] offset:57344
  ds_write_b128 v2, v[52:55] offset:58368
  v_add_u32 v13, 65536, v31
  v_add_u32 v14, 65536, v32
  ds_read_b64_tr_b16 v[56:57], v13 offset:0
  ds_read_b64_tr_b16 v[58:59], v13 offset:1024
  ds_read_b64_tr_b16 v[60:61], v13 offset:8192
  ds_read_b64_tr_b16 v[62:63], v13 offset:9216
  ds_read_b64_tr_b16 v[64:65], v14 offset:0
  ds_read_b64_tr_b16 v[66:67], v14 offset:1024
  ds_read_b64_tr_b16 v[68:69], v14 offset:8192
  ds_read_b64_tr_b16 v[70:71], v14 offset:9216
  s_waitcnt vmcnt(17) lgkmcnt(0)
  s_barrier
  ds_write_b128 v3, v[56:59] offset:0
  ds_write_b128 v3, v[60:63] offset:1024
  ds_write_b128 v3, v[64:67] offset:8192
  ds_write_b128 v3, v[68:71] offset:9216
  v_add_u32 v13, 81920, v31
  v_add_u32 v14, 81920, v32
  ds_read_b64_tr_b16 v[40:41], v13 offset:0
  ds_read_b64_tr_b16 v[42:43], v13 offset:1024
  ds_read_b64_tr_b16 v[44:45], v13 offset:8192
  ds_read_b64_tr_b16 v[46:47], v13 offset:9216
  ds_read_b64_tr_b16 v[48:49], v14 offset:0
  ds_read_b64_tr_b16 v[50:51], v14 offset:1024
  ds_read_b64_tr_b16 v[52:53], v14 offset:8192
  ds_read_b64_tr_b16 v[54:55], v14 offset:9216
  s_waitcnt vmcnt(13) lgkmcnt(0)
  s_barrier
  ds_write_b128 v3, v[40:43] offset:16384
  ds_write_b128 v3, v[44:47] offset:17408
  ds_write_b128 v3, v[48:51] offset:24576
  ds_write_b128 v3, v[52:55] offset:25600
  v_add_u32 v13, 98304, v31
  v_add_u32 v14, 98304, v32
  ds_read_b64_tr_b16 v[56:57], v13 offset:0
  ds_read_b64_tr_b16 v[58:59], v13 offset:1024
  ds_read_b64_tr_b16 v[60:61], v13 offset:8192
  ds_read_b64_tr_b16 v[62:63], v13 offset:9216
  ds_read_b64_tr_b16 v[64:65], v14 offset:0
  ds_read_b64_tr_b16 v[66:67], v14 offset:1024
  ds_read_b64_tr_b16 v[68:69], v14 offset:8192
  ds_read_b64_tr_b16 v[70:71], v14 offset:9216
  s_waitcnt vmcnt(9) lgkmcnt(0)
  s_barrier
  ds_write_b128 v3, v[56:59] offset:32768
  ds_write_b128 v3, v[60:63] offset:33792
  ds_write_b128 v3, v[64:67] offset:40960
  ds_write_b128 v3, v[68:71] offset:41984
  v_add_u32 v13, 114688, v31
  v_add_u32 v14, 114688, v32
  ds_read_b64_tr_b16 v[40:41], v13 offset:0
  ds_read_b64_tr_b16 v[42:43], v13 offset:1024
  ds_read_b64_tr_b16 v[44:45], v13 offset:8192
  ds_read_b64_tr_b16 v[46:47], v13 offset:9216
  ds_read_b64_tr_b16 v[48:49], v14 offset:0
  ds_read_b64_tr_b16 v[50:51], v14 offset:1024
  ds_read_b64_tr_b16 v[52:53], v14 offset:8192
  ds_read_b64_tr_b16 v[54:55], v14 offset:9216
  s_waitcnt vmcnt(5) lgkmcnt(0)
  s_barrier
  ds_write_b128 v3, v[40:43] offset:49152
  ds_write_b128 v3, v[44:47] offset:50176
  ds_write_b128 v3, v[48:51] offset:57344
  ds_write_b128 v3, v[52:55] offset:58368
  v_add_u32 v13, 131072, v31
  v_add_u32 v14, 131072, v32
  ds_read_b64_tr_b16 v[56:57], v13 offset:0
  ds_read_b64_tr_b16 v[58:59], v13 offset:1024
  ds_read_b64_tr_b16 v[60:61], v13 offset:8192
  ds_read_b64_tr_b16 v[62:63], v13 offset:9216
  ds_read_b64_tr_b16 a[104:105], v14 offset:0
  ds_read_b64_tr_b16 a[106:107], v14 offset:1024
  ds_read_b64_tr_b16 a[108:109], v14 offset:8192
  ds_read_b64_tr_b16 a[110:111], v14 offset:9216
  s_waitcnt lgkmcnt(0)
  s_barrier
  ds_write_b128 v4, v[56:59] offset:0
  ds_write_b128 v4, v[60:63] offset:1024
  s_waitcnt lgkmcnt(0)
  s_barrier
  s_waitcnt vmcnt(0)
  s_mov_b32 s40, 0x05040100
  s_mov_b32 s41, 0x07060302
  v_perm_b32 v60, v17, v16, s40
  v_perm_b32 v61, v19, v18, s40
  v_perm_b32 v62, v17, v16, s41
  v_perm_b32 v63, v19, v18, s41
  v_perm_b32 v64, v21, v20, s40
  v_perm_b32 v65, v23, v22, s40
  v_perm_b32 v66, v21, v20, s41
  v_perm_b32 v67, v23, v22, s41
  v_perm_b32 v68, v25, v24, s40
  v_perm_b32 v69, v27, v26, s40
  v_perm_b32 v70, v25, v24, s41
  v_perm_b32 v71, v27, v26, s41
  ds_write_b128 v4, v[60:63] offset:8192
  ds_write_b128 v4, v[64:67] offset:9216
  ds_write_b128 v1, v[68:71] offset:16384
  v_readlane_b32 s90, v38, 0
  v_readlane_b32 s91, v38, 9
  v_readlane_b32 s92, v39, 0
  v_readlane_b32 s93, v39, 1
  s_mov_b32 s18, 0
  s_mov_b32 s22, 1966080
  s_mov_b32 s23, 1982464
  s_mov_b32 s24, 1998848
  s_mov_b32 s54, 1048576
  s_lshr_b32 s27, s16, 3
  s_mul_i32 s28, s27, 2304
  s_bfe_u32 s29, s16, 0x10002
  s_and_b32 s30, s16, 3
  s_lshl_b32 s31, s29, 10
  s_lshl_b32 s32, s30, 8
  s_add_u32 s25, s28, s31
  s_add_u32 s25, s25, s32
  s_lshl_b32 s32, s17, 7
  s_add_u32 s25, s25, s32
  s_mul_i32 s26, s27, 2304
  s_add_u32 s26, s26, s31
  s_lshl_b32 s32, s30, 6
  s_add_u32 s26, s26, s32
  s_lshl_b32 s32, s17, 5
  s_add_u32 s26, s26, s32
  s_cmp_lt_u32 s17, 2
  s_cbranch_scc1 ch_t_18
  s_mov_b32 s25, -1
  s_cmp_eq_u32 s17, 2
  s_cbranch_scc0 ch_t_18
  s_cmp_eq_u32 s30, 0
  s_cbranch_scc0 ch_t_18
  s_lshl_b32 s32, s29, 7
  s_add_u32 s25, s28, s32
  s_add_u32 s25, s25, 2048
  s_mul_i32 s26, s27, 2304
  s_lshl_b32 s32, s29, 5
  s_add_u32 s26, s26, s32
  s_add_u32 s26, s26, 2048
  s_waitcnt vmcnt(0) lgkmcnt(0)
ch_t_18:
  s_add_u32 s46, s25, 1048576
  s_add_u32 s47, s46, 75776
  s_add_u32 s48, s47, 75776
  s_add_u32 s49, s48, 75776
  s_add_u32 s26, s26, 131072
  s_lshl_b32 s56, s16, 1
  s_add_u32 s56, s56, s17
  s_lshr_b32 s27, s16, 2
  s_add_u32 s27, s27, 64
  s_cmp_eq_u32 s17, 2
  s_cselect_b32 s56, s27, s56
  s_add_u32 s56, s56, 2129920
  s_and_b32 s83, s16, 3
  s_mul_i32 s83, s83, 256
  s_add_u32 s83, s83, 2129920
  s_sub_u32 s55, s17, 1
  s_lshl_b32 s55, s55, 11
  s_add_u32 s55, s55, 9216
  s_cmp_eq_u32 s17, 0
  s_cselect_b32 s55, 0, s55
  s_and_b32 s98, s17, 1
  s_lshl_b32 s98, s98, 12
  s_lshl_b32 s45, s16, 13
  s_add_u32 s45, s45, s98
  s_add_u32 s45, s45, 4325376
  s_cmp_ge_u32 s17, 2
  s_cselect_b32 s27, 16777216, 0
  s_add_u32 s45, s45, s27
  s_lshl_b32 s27, s16, 13
  s_add_u32 s36, s27, 4063232
  s_lshl_b32 s28, s17, 11
  s_add_u32 s37, s27, s28
  s_add_u32 s37, s37, 20840448
  s_lshl_b32 s27, s16, 12
  s_lshl_b32 s28, s17, 10
  s_add_u32 s27, s27, s28
  s_lshr_b32 s27, s27, 1
  s_add_u32 s38, s27, 37683200
  s_add_u32 s39, s27, 46071808
  s_mov_b32 s40, 0x3e0293ee
  s_mov_b32 s41, 0x3e0293ee
  s_mov_b32 s42, 0x00ff00ff
  s_mov_b32 s43, 0x00ff00ff
  s_mov_b32 s44, 0
  s_mov_b32 s60, 0
  s_mov_b32 s61, 0
  s_mov_b32 s62, 0
  s_mov_b32 s63, 0
  s_mov_b32 s64, 0
  s_mov_b32 s65, 0
  s_mov_b32 s66, 0
  s_mov_b32 s67, 0
  s_mov_b32 s68, 0
  s_mov_b32 s69, 0
  s_mov_b32 s70, 0
  s_mov_b32 s71, 0
  s_mov_b32 s72, 0
  s_mov_b32 s73, 0
  s_mov_b32 s74, 0
  s_mov_b32 s75, 0
  s_mov_b32 s76, 0
  s_mov_b32 s77, 0
  s_mov_b32 s78, 0
  s_mov_b32 s79, 0
  s_cmp_ge_u32 s91, 32
  s_cbranch_scc1 i9_19
  s_mov_b32 s27, 0
  v_mov_b32 v13, 36
dbgw_20:
  global_load_dword v14, v13, s[14:15] sc1
  s_add_u32 s27, s27, 1
  s_waitcnt vmcnt(0)
  v_readfirstlane_b32 s28, v14
  s_nop 3
  s_cmp_ge_u32 s28, 32
  s_cbranch_scc1 dbgd_21
  s_sleep 2
  s_cmp_lt_u32 s27, 0x40000
  s_cbranch_scc1 dbgw_20
  s_mov_b32 s44, 1
dbgd_21:
  v_mov_b32 v13, 0
  global_load_dword v14, v13, s[14:15] sc1
  s_waitcnt vmcnt(0)
  v_readfirstlane_b32 s90, v14
i9_19:
  s_cmp_lt_u32 s90, 32
  s_cselect_b32 s80, 1, 0
  s_lshl_b32 s99, s16, 7
  s_add_u32 s99, s99, 2166784
  s_mov_b32 s100, 0
  s_mov_b32 s101, 0
  s_min_u32 s92, s92, s93
  s_cmp_ge_u32 s92, 1
  s_cbranch_scc1 ikv_22
  s_lshl_b32 s27, s100, 7
  s_lshl_b32 s28, s16, 2
  s_add_u32 s27, s27, s28
  s_add_u32 s27, s27, 2162816
  s_mov_b32 s28, 0
  v_mov_b32 v13, 0
kvw_23:
  buffer_load_dword v14, v13, s[4:7], s27 offen sc1
  s_add_u32 s28, s28, 1
  s_waitcnt vmcnt(0)
  v_readfirstlane_b32 s29, v14
  s_nop 3
  s_cmp_gt_u32 s29, s101
  s_cbranch_scc1 kvd_24
  s_sleep 2
  s_cmp_lg_u32 s44, 0
  s_cbranch_scc1 kvd_24
  s_cmp_lt_u32 s28, 0x40000
  s_cbranch_scc1 kvw_23
  s_mov_b32 s44, 1
kvd_24:
  s_mov_b32 s100, 1
  s_lshl_b32 s27, s100, 7
  s_lshl_b32 s28, s16, 2
  s_add_u32 s27, s27, s28
  s_add_u32 s27, s27, 2162816
  s_mov_b32 s28, 0
  v_mov_b32 v13, 0
kvw_25:
  buffer_load_dword v14, v13, s[4:7], s27 offen sc1
  s_add_u32 s28, s28, 1
  s_waitcnt vmcnt(0)
  v_readfirstlane_b32 s29, v14
  s_nop 3
  s_cmp_gt_u32 s29, s101
  s_cbranch_scc1 kvd_26
  s_sleep 2
  s_cmp_lg_u32 s44, 0
  s_cbranch_scc1 kvd_26
  s_cmp_lt_u32 s28, 0x40000
  s_cbranch_scc1 kvw_25
  s_mov_b32 s44, 1
kvd_26:
ikv_22:
  s_mov_b32 s100, 2
  s_lshl_b32 s81, s16, 2
  s_add_u32 s81, s81, 2162816
  s_add_u32 s82, s81, 256
  s_mov_b32 s88, 0
  s_mov_b32 s89, 0
  s_mov_b32 s90, 0
  s_mov_b32 s91, 0
  s_mov_b32 s92, 0
  s_mov_b32 s93, 0
  s_mov_b32 s94, 0
  s_mov_b32 s95, 0
  s_lshl_b32 s27, s17, 11
  s_add_u32 s28, s36, s27
  s_add_u32 m0, s27, 154624
  s_nop 0
  buffer_load_dwordx4 v1, s[4:7], s28 offen sc1 lds
  s_add_u32 m0, s27, 154624
  s_nop 0
  buffer_load_dwordx4 v1, s[4:7], s28 offen offset:1024 sc1 lds
  s_waitcnt vmcnt(0) lgkmcnt(0)
  s_barrier
  s_cmp_lg_u32 s80, 0
  s_cbranch_scc1 ch_slow_entry
  v_mov_b64 v[24:25], 0
  v_mov_b64 v[26:27], 0
  v_mov_b64 v[28:29], 0
  v_mov_b64 v[30:31], 0
  v_mov_b64 v[32:33], 0
  v_mov_b64 v[34:35], 0
  v_mov_b64 v[36:37], 0
  v_mov_b64 v[38:39], 0
  v_mov_b64 v[40:41], 0
  v_mov_b64 v[42:43], 0
  v_mov_b64 v[44:45], 0
  v_mov_b64 v[46:47], 0
  s_lshl_b32 s27, s17, 15
  v_add_u32 v15, s27, v2
  ds_read_b128 v[48:51], v15 offset:0
  ds_read_b128 v[52:55], v15 offset:1024
  ds_read_b128 v[56:59], v15 offset:8192
  ds_read_b128 v[60:63], v15 offset:9216
  ds_read_b128 v[16:19], v4 offset:8192
  ds_read_b128 v[20:23], v4 offset:9216
  s_waitcnt lgkmcnt(0)
ch_loop_f:
  s_cmp_eq_u32 s17, 1
  s_cbranch_scc1 p1w_29
  s_cmp_eq_u32 s17, 2
  s_cbranch_scc1 p1w_30
  s_cmp_eq_u32 s17, 3
  s_cbranch_scc1 p1w_31
  ds_read_b128 v[64:67], v2 offset:16384
  ds_read_b128 v[68:71], v2 offset:17408
  s_waitcnt lgkmcnt(4)
  s_cmp_eq_u32 s17, 3
  s_cbranch_scc0 kf_32
  buffer_load_dword v12, off, s[4:7], s82 sc1
kf_32:
  v_smfmac_f32_16x16x64_bf16 v[24:27], v[16:19], v[72:79], v5
  v_smfmac_f32_16x16x64_bf16 v[28:31], v[16:19], v[80:87], v5
  buffer_load_dword v13, v1, s[4:7], s45 offen offset:0 sc1
  v_smfmac_f32_16x16x64_bf16 v[32:35], v[16:19], v[48:55], v5
  ds_read_b128 v[48:51], v2 offset:24576
  v_smfmac_f32_16x16x64_bf16 v[36:39], v[16:19], v[56:63], v5
  ds_read_b128 v[52:55], v2 offset:25600
  v_smfmac_f32_16x16x64_bf16 v[40:43], v[16:19], v[216:223], v5
  ds_read_b128 v[56:59], v2 offset:32768
  v_smfmac_f32_16x16x64_bf16 v[44:47], v[16:19], v[224:231], v5
  ds_read_b128 v[60:63], v2 offset:33792
  v_smfmac_f32_16x16x64_bf16 v[24:27], v[20:23], v[88:95], v5
  s_waitcnt lgkmcnt(6)
  s_barrier
  s_cmp_eq_u32 s17, 3
  s_cbranch_scc0 pf_33
  s_mov_b64 exec, 1
  v_mov_b32 v14, s18
  buffer_store_dword v14, off, s[4:7], s99 sc1
  s_mov_b64 exec, -1
pf_33:
  ds_read_b128 v[16:19], v1 offset:10240
  v_smfmac_f32_16x16x64_bf16 v[28:31], v[20:23], v[96:103], v5
  buffer_load_dword v13, v1, s[4:7], s45 offen offset:1024 sc1
  s_waitcnt lgkmcnt(5)
  v_smfmac_f32_16x16x64_bf16 v[32:35], v[20:23], v[64:71], v5
  ds_read_b128 v[64:67], v2 offset:40960
  s_waitcnt lgkmcnt(4)
  v_smfmac_f32_16x16x64_bf16 v[36:39], v[20:23], v[48:55], v5
  ds_read_b128 v[68:71], v2 offset:41984
  v_smfmac_f32_16x16x64_bf16 v[40:43], v[20:23], v[232:239], v5
  ds_read_b128 v[48:51], v2 offset:49152
  v_smfmac_f32_16x16x64_bf16 v[44:47], v[20:23], v[240:247], v5
  ds_read_b128 v[52:55], v2 offset:50176
  s_waitcnt lgkmcnt(4)
  v_smfmac_f32_16x16x64_bf16 v[24:27], v[16:19], v[104:111], v5
  ds_read_b128 v[20:23], v1 offset:11264
  v_smfmac_f32_16x16x64_bf16 v[28:31], v[16:19], v[112:119], v5
  buffer_load_dword v13, v1, s[4:7], s45 offen offset:2048 sc1
  v_smfmac_f32_16x16x64_bf16 v[32:35], v[16:19], v[56:63], v5
  ds_read_b128 v[56:59], v2 offset:57344
  s_waitcnt lgkmcnt(4)
  v_smfmac_f32_16x16x64_bf16 v[36:39], v[16:19], v[64:71], v5
  ds_read_b128 v[60:63], v2 offset:58368
  v_smfmac_f32_16x16x64_bf16 v[40:43], v[16:19], v[248:255], v5
  ds_read_b128 v[64:67], v3 offset:0
  v_smfmac_f32_16x16x64_bf16 v[44:47], v[16:19], a[0:7], v5
  ds_read_b128 v[68:71], v3 offset:1024
  s_waitcnt lgkmcnt(4)
  v_smfmac_f32_16x16x64_bf16 v[24:27], v[20:23], v[120:127], v5
  ds_read_b128 v[16:19], v1 offset:12288
  v_smfmac_f32_16x16x64_bf16 v[28:31], v[20:23], v[128:135], v5
  buffer_load_dword v13, v1, s[4:7], s45 offen offset:3072 sc1
  v_smfmac_f32_16x16x64_bf16 v[32:35], v[20:23], v[48:55], v5
  ds_read_b128 v[48:51], v3 offset:8192
  s_waitcnt lgkmcnt(4)
  v_smfmac_f32_16x16x64_bf16 v[36:39], v[20:23], v[56:63], v5
  ds_read_b128 v[52:55], v3 offset:9216
  v_smfmac_f32_16x16x64_bf16 v[40:43], v[20:23], a[8:15], v5
  ds_read_b128 v[56:59], v3 offset:16384
  v_smfmac_f32_16x16x64_bf16 v[44:47], v[20:23], a[16:23], v5
  ds_read_b128 v[60:63], v3 offset:17408
  s_waitcnt lgkmcnt(4)
  v_smfmac_f32_16x16x64_bf16 v[24:27], v[16:19], v[136:143], v5
  ds_read_b128 v[20:23], v1 offset:13312
  v_smfmac_f32_16x16x64_bf16 v[28:31], v[16:19], v[144:151], v5
  v_smfmac_f32_16x16x64_bf16 v[32:35], v[16:19], v[64:71], v5
  ds_read_b128 v[64:67], v3 offset:24576
  s_waitcnt lgkmcnt(4)
  v_smfmac_f32_16x16x64_bf16 v[36:39], v[16:19], v[48:55], v5
  ds_read_b128 v[68:71], v3 offset:25600
  v_smfmac_f32_16x16x64_bf16 v[40:43], v[16:19], a[24:31], v5
  ds_read_b128 v[48:51], v3 offset:32768
  v_smfmac_f32_16x16x64_bf16 v[44:47], v[16:19], a[32:39], v5
  ds_read_b128 v[52:55], v3 offset:33792
  s_waitcnt lgkmcnt(4)
  v_smfmac_f32_16x16x64_bf16 v[24:27], v[20:23], v[152:159], v5
  ds_read_b128 v[16:19], v1 offset:14336
  v_smfmac_f32_16x16x64_bf16 v[28:31], v[20:23], v[160:167], v5
  v_smfmac_f32_16x16x64_bf16 v[32:35], v[20:23], v[56:63], v5
  ds_read_b128 v[56:59], v3 offset:40960
  ds_read_b128 v[60:63], v3 offset:41984
  s_waitcnt lgkmcnt(5)
  v_smfmac_f32_16x16x64_bf16 v[36:39], v[20:23], v[64:71], v5
  ds_read_b128 v[64:67], v3 offset:49152
  ds_read_b128 v[68:71], v3 offset:50176
  s_waitcnt lgkmcnt(4)
  v_smfmac_f32_16x16x64_bf16 v[24:27], v[16:19], v[168:175], v5
  ds_read_b128 v[20:23], v1 offset:15360
  v_smfmac_f32_16x16x64_bf16 v[28:31], v[16:19], v[176:183], v5
  v_smfmac_f32_16x16x64_bf16 v[32:35], v[16:19], v[48:55], v5
  ds_read_b128 v[48:51], v3 offset:57344
  ds_read_b128 v[52:55], v3 offset:58368
  s_waitcnt lgkmcnt(5)
  v_smfmac_f32_16x16x64_bf16 v[36:39], v[16:19], v[56:63], v5
  ds_read_b128 v[56:59], v4 offset:0
  ds_read_b128 v[60:63], v4 offset:1024
  s_waitcnt lgkmcnt(4)
  v_smfmac_f32_16x16x64_bf16 v[24:27], v[20:23], v[184:191], v5
  ds_read_b128 v[16:19], v1 offset:16384
  v_smfmac_f32_16x16x64_bf16 v[28:31], v[20:23], v[192:199], v5
  v_smfmac_f32_16x16x64_bf16 v[32:35], v[20:23], v[64:71], v5
  ds_read_b128 v[64:67], v1 offset:13312
  s_waitcnt lgkmcnt(4)
  v_smfmac_f32_16x16x64_bf16 v[36:39], v[20:23], v[48:55], v5
  ds_read_b128 v[68:71], v1 offset:14336
  s_waitcnt lgkmcnt(2)
  v_smfmac_f32_16x16x64_bf16 v[24:27], v[16:19], v[200:207], v5
  v_smfmac_f32_16x16x64_bf16 v[28:31], v[16:19], v[208:215], v5
  v_smfmac_f32_16x16x64_bf16 v[32:35], v[16:19], v[56:63], v5
  v_smfmac_f32_16x16x64_bf16 v[36:39], v[16:19], a[104:111], v5
  v_smfmac_f32_16x16x64_bf16 v[40:43], v[16:19], a[88:95], v5
  ds_read_b128 v[48:51], v1 offset:23552
  v_smfmac_f32_16x16x64_bf16 v[44:47], v[16:19], a[96:103], v5
  ds_read_b128 v[52:55], v1 offset:24576
  s_nop 0
  v_add_f32 v24, v24, v26
  v_add_f32 v25, v25, v27
  v_add_f32 v28, v28, v30
  v_add_f32 v29, v29, v31
  v_cvt_pk_bf16_f32 v24, v24, v25
  v_cvt_pk_bf16_f32 v28, v28, v29
  ds_write2_b32 v6, v24, v28 offset0:0 offset1:64
  v_add_f32 v32, v32, v34
  v_add_f32 v33, v33, v35
  v_add_f32 v36, v36, v38
  v_add_f32 v37, v37, v39
  v_cvt_pk_bf16_f32 v14, v32, v33
  v_cvt_pk_bf16_f32 v15, v36, v37
  ds_write2_b32 v7, v14, v14 offset0:0 offset1:1
  ds_write2_b32 v7, v15, v15 offset0:128 offset1:129
  v_smfmac_f32_16x16x64_bf16 v[40:43], v[20:23], a[72:79], v5
  ds_read_b128 v[56:59], v1 offset:25600
  v_smfmac_f32_16x16x64_bf16 v[44:47], v[20:23], a[80:87], v5
  ds_read_b128 v[60:63], v1 offset:26624
  s_waitcnt lgkmcnt(8)
  v_smfmac_f32_16x16x64_bf16 v[40:43], v[64:67], a[40:47], v5
  v_smfmac_f32_16x16x64_bf16 v[44:47], v[64:67], a[48:55], v5
  s_waitcnt lgkmcnt(7)
  v_smfmac_f32_16x16x64_bf16 v[40:43], v[68:71], a[56:63], v5
  v_smfmac_f32_16x16x64_bf16 v[44:47], v[68:71], a[64:71], v5
  s_branch p1j_27
p1w_29:
  ds_read_b128 v[64:67], v2 offset:49152
  ds_read_b128 v[68:71], v2 offset:50176
  s_waitcnt lgkmcnt(4)
  s_cmp_eq_u32 s17, 3
  s_cbranch_scc0 kf_34
  buffer_load_dword v12, off, s[4:7], s82 sc1
kf_34:
  v_smfmac_f32_16x16x64_bf16 v[24:27], v[16:19], v[104:111], v5
  v_smfmac_f32_16x16x64_bf16 v[28:31], v[16:19], v[112:119], v5
  buffer_load_dword v13, v1, s[4:7], s45 offen offset:0 sc1
  v_smfmac_f32_16x16x64_bf16 v[32:35], v[16:19], v[48:55], v5
  ds_read_b128 v[48:51], v2 offset:57344
  v_smfmac_f32_16x16x64_bf16 v[36:39], v[16:19], v[56:63], v5
  ds_read_b128 v[52:55], v2 offset:58368
  v_smfmac_f32_16x16x64_bf16 v[40:43], v[16:19], v[248:255], v5
  ds_read_b128 v[56:59], v2 offset:0
  v_smfmac_f32_16x16x64_bf16 v[44:47], v[16:19], a[0:7], v5
  ds_read_b128 v[60:63], v2 offset:1024
  v_smfmac_f32_16x16x64_bf16 v[24:27], v[20:23], v[120:127], v5
  s_waitcnt lgkmcnt(6)
  s_barrier
  s_cmp_eq_u32 s17, 3
  s_cbranch_scc0 pf_35
  s_mov_b64 exec, 1
  v_mov_b32 v14, s18
  buffer_store_dword v14, off, s[4:7], s99 sc1
  s_mov_b64 exec, -1
pf_35:
  ds_read_b128 v[16:19], v1 offset:8192
  v_smfmac_f32_16x16x64_bf16 v[28:31], v[20:23], v[128:135], v5
  buffer_load_dword v13, v1, s[4:7], s45 offen offset:1024 sc1
  s_waitcnt lgkmcnt(5)
  v_smfmac_f32_16x16x64_bf16 v[32:35], v[20:23], v[64:71], v5
  ds_read_b128 v[64:67], v2 offset:8192
  s_waitcnt lgkmcnt(4)
  v_smfmac_f32_16x16x64_bf16 v[36:39], v[20:23], v[48:55], v5
  ds_read_b128 v[68:71], v2 offset:9216
  v_smfmac_f32_16x16x64_bf16 v[40:43], v[20:23], a[8:15], v5
  ds_read_b128 v[48:51], v2 offset:16384
  v_smfmac_f32_16x16x64_bf16 v[44:47], v[20:23], a[16:23], v5
  ds_read_b128 v[52:55], v2 offset:17408
  s_waitcnt lgkmcnt(4)
  v_smfmac_f32_16x16x64_bf16 v[24:27], v[16:19], v[72:79], v5
  ds_read_b128 v[20:23], v1 offset:9216
  v_smfmac_f32_16x16x64_bf16 v[28:31], v[16:19], v[80:87], v5
  buffer_load_dword v13, v1, s[4:7], s45 offen offset:2048 sc1
  v_smfmac_f32_16x16x64_bf16 v[32:35], v[16:19], v[56:63], v5
  ds_read_b128 v[56:59], v2 offset:24576
  s_waitcnt lgkmcnt(4)
  v_smfmac_f32_16x16x64_bf16 v[36:39], v[16:19], v[64:71], v5
  ds_read_b128 v[60:63], v2 offset:25600
  v_smfmac_f32_16x16x64_bf16 v[40:43], v[16:19], v[216:223], v5
  ds_read_b128 v[64:67], v3 offset:0
  v_smfmac_f32_16x16x64_bf16 v[44:47], v[16:19], v[224:231], v5
  ds_read_b128 v[68:71], v3 offset:1024
  s_waitcnt lgkmcnt(4)
  v_smfmac_f32_16x16x64_bf16 v[24:27], v[20:23], v[88:95], v5
  ds_read_b128 v[16:19], v1 offset:12288
  v_smfmac_f32_16x16x64_bf16 v[28:31], v[20:23], v[96:103], v5
  buffer_load_dword v13, v1, s[4:7], s45 offen offset:3072 sc1
  v_smfmac_f32_16x16x64_bf16 v[32:35], v[20:23], v[48:55], v5
  ds_read_b128 v[48:51], v3 offset:8192
  s_waitcnt lgkmcnt(4)
  v_smfmac_f32_16x16x64_bf16 v[36:39], v[20:23], v[56:63], v5
  ds_read_b128 v[52:55], v3 offset:9216
  v_smfmac_f32_16x16x64_bf16 v[40:43], v[20:23], v[232:239], v5
  ds_read_b128 v[56:59], v3 offset:16384
  v_smfmac_f32_16x16x64_bf16 v[44:47], v[20:23], v[240:247], v5
  ds_read_b128 v[60:63], v3 offset:17408
  s_waitcnt lgkmcnt(4)
  v_smfmac_f32_16x16x64_bf16 v[24:27], v[16:19], v[136:143], v5
  ds_read_b128 v[20:23], v1 offset:13312
  v_smfmac_f32_16x16x64_bf16 v[28:31], v[16:19], v[144:151], v5
  v_smfmac_f32_16x16x64_bf16 v[32:35], v[16:19], v[64:71], v5
  ds_read_b128 v[64:67], v3 offset:24576
  s_waitcnt lgkmcnt(4)
  v_smfmac_f32_16x16x64_bf16 v[36:39], v[16:19], v[48:55], v5
  ds_read_b128 v[68:71], v3 offset:25600
  v_smfmac_f32_16x16x64_bf16 v[40:43], v[16:19], a[24:31], v5
  ds_read_b128 v[48:51], v3 offset:32768
  v_smfmac_f32_16x16x64_bf16 v[44:47], v[16:19], a[32:39], v5
  ds_read_b128 v[52:55], v3 offset:33792
  s_waitcnt lgkmcnt(4)
  v_smfmac_f32_16x16x64_bf16 v[24:27], v[20:23], v[152:159], v5
  ds_read_b128 v[16:19], v1 offset:14336
  v_smfmac_f32_16x16x64_bf16 v[28:31], v[20:23], v[160:167], v5
  v_smfmac_f32_16x16x64_bf16 v[32:35], v[20:23], v[56:63], v5
  ds_read_b128 v[56:59], v3 offset:40960
  ds_read_b128 v[60:63], v3 offset:41984
  s_waitcnt lgkmcnt(5)
  v_smfmac_f32_16x16x64_bf16 v[36:39], v[20:23], v[64:71], v5
  ds_read_b128 v[64:67], v3 offset:49152
  ds_read_b128 v[68:71], v3 offset:50176
  s_waitcnt lgkmcnt(4)
  v_smfmac_f32_16x16x64_bf16 v[24:27], v[16:19], v[168:175], v5
  ds_read_b128 v[20:23], v1 offset:15360
  v_smfmac_f32_16x16x64_bf16 v[28:31], v[16:19], v[176:183], v5
  v_smfmac_f32_16x16x64_bf16 v[32:35], v[16:19], v[48:55], v5
  ds_read_b128 v[48:51], v3 offset:57344
  ds_read_b128 v[52:55], v3 offset:58368
  s_waitcnt lgkmcnt(5)
  v_smfmac_f32_16x16x64_bf16 v[36:39], v[16:19], v[56:63], v5
  ds_read_b128 v[56:59], v4 offset:0
  ds_read_b128 v[60:63], v4 offset:1024
  s_waitcnt lgkmcnt(4)
  v_smfmac_f32_16x16x64_bf16 v[24:27], v[20:23], v[184:191], v5
  ds_read_b128 v[16:19], v1 offset:16384
  v_smfmac_f32_16x16x64_bf16 v[28:31], v[20:23], v[192:199], v5
  v_smfmac_f32_16x16x64_bf16 v[32:35], v[20:23], v[64:71], v5
  ds_read_b128 v[64:67], v1 offset:13312
  s_waitcnt lgkmcnt(4)
  v_smfmac_f32_16x16x64_bf16 v[36:39], v[20:23], v[48:55], v5
  ds_read_b128 v[68:71], v1 offset:14336
  s_waitcnt lgkmcnt(2)
  v_smfmac_f32_16x16x64_bf16 v[24:27], v[16:19], v[200:207], v5
  v_smfmac_f32_16x16x64_bf16 v[28:31], v[16:19], v[208:215], v5
  v_smfmac_f32_16x16x64_bf16 v[32:35], v[16:19], v[56:63], v5
  v_smfmac_f32_16x16x64_bf16 v[36:39], v[16:19], a[104:111], v5
  v_smfmac_f32_16x16x64_bf16 v[40:43], v[16:19], a[88:95], v5
  ds_read_b128 v[48:51], v1 offset:23552
  v_smfmac_f32_16x16x64_bf16 v[44:47], v[16:19], a[96:103], v5
  ds_read_b128 v[52:55], v1 offset:24576
  s_nop 0
  v_add_f32 v24, v24, v26
  v_add_f32 v25, v25, v27
  v_add_f32 v28, v28, v30
  v_add_f32 v29, v29, v31
  v_cvt_pk_bf16_f32 v24, v24, v25
  v_cvt_pk_bf16_f32 v28, v28, v29
  ds_write2_b32 v6, v24, v28 offset0:0 offset1:64
  v_add_f32 v32, v32, v34
  v_add_f32 v33, v33, v35
  v_add_f32 v36, v36, v38
  v_add_f32 v37, v37, v39
  v_cvt_pk_bf16_f32 v14, v32, v33
  v_cvt_pk_bf16_f32 v15, v36, v37
  ds_write2_b32 v7, v14, v14 offset0:0 offset1:1
  ds_write2_b32 v7, v15, v15 offset0:128 offset1:129
  v_smfmac_f32_16x16x64_bf16 v[40:43], v[20:23], a[72:79], v5
  ds_read_b128 v[56:59], v1 offset:25600
  v_smfmac_f32_16x16x64_bf16 v[44:47], v[20:23], a[80:87], v5
  ds_read_b128 v[60:63], v1 offset:26624
  s_waitcnt lgkmcnt(8)
  v_smfmac_f32_16x16x64_bf16 v[40:43], v[64:67], a[40:47], v5
  v_smfmac_f32_16x16x64_bf16 v[44:47], v[64:67], a[48:55], v5
  s_waitcnt lgkmcnt(7)
  v_smfmac_f32_16x16x64_bf16 v[40:43], v[68:71], a[56:63], v5
  v_smfmac_f32_16x16x64_bf16 v[44:47], v[68:71], a[64:71], v5
  s_branch p1j_27
p1w_30:
  ds_read_b128 v[64:67], v3 offset:16384
  ds_read_b128 v[68:71], v3 offset:17408
  s_waitcnt lgkmcnt(4)
  s_cmp_eq_u32 s17, 3
  s_cbranch_scc0 kf_36
  buffer_load_dword v12, off, s[4:7], s82 sc1
kf_36:
  v_smfmac_f32_16x16x64_bf16 v[24:27], v[16:19], v[136:143], v5
  v_smfmac_f32_16x16x64_bf16 v[28:31], v[16:19], v[144:151], v5
  buffer_load_dword v13, v1, s[4:7], s45 offen offset:0 sc1
  v_smfmac_f32_16x16x64_bf16 v[32:35], v[16:19], v[48:55], v5
  ds_read_b128 v[48:51], v3 offset:24576
  v_smfmac_f32_16x16x64_bf16 v[36:39], v[16:19], v[56:63], v5
  ds_read_b128 v[52:55], v3 offset:25600
  v_smfmac_f32_16x16x64_bf16 v[40:43], v[16:19], a[24:31], v5
  ds_read_b128 v[56:59], v2 offset:0
  v_smfmac_f32_16x16x64_bf16 v[44:47], v[16:19], a[32:39], v5
  ds_read_b128 v[60:63], v2 offset:1024
  v_smfmac_f32_16x16x64_bf16 v[24:27], v[20:23], v[152:159], v5
  s_waitcnt lgkmcnt(6)
  s_barrier
  s_cmp_eq_u32 s17, 3
  s_cbranch_scc0 pf_37
  s_mov_b64 exec, 1
  v_mov_b32 v14, s18
  buffer_store_dword v14, off, s[4:7], s99 sc1
  s_mov_b64 exec, -1
pf_37:
  ds_read_b128 v[16:19], v1 offset:8192
  v_smfmac_f32_16x16x64_bf16 v[28:31], v[20:23], v[160:167], v5
  buffer_load_dword v13, v1, s[4:7], s45 offen offset:1024 sc1
  s_waitcnt lgkmcnt(5)
  v_smfmac_f32_16x16x64_bf16 v[32:35], v[20:23], v[64:71], v5
  ds_read_b128 v[64:67], v2 offset:8192
  s_waitcnt lgkmcnt(4)
  v_smfmac_f32_16x16x64_bf16 v[36:39], v[20:23], v[48:55], v5
  ds_read_b128 v[68:71], v2 offset:9216
  v_smfmac_f32_16x16x64_bf16 v[40:43], v[20:23], a[40:47], v5
  ds_read_b128 v[48:51], v2 offset:16384
  v_smfmac_f32_16x16x64_bf16 v[44:47], v[20:23], a[48:55], v5
  ds_read_b128 v[52:55], v2 offset:17408
  s_waitcnt lgkmcnt(4)
  v_smfmac_f32_16x16x64_bf16 v[24:27], v[16:19], v[72:79], v5
  ds_read_b128 v[20:23], v1 offset:9216
  v_smfmac_f32_16x16x64_bf16 v[28:31], v[16:19], v[80:87], v5
  buffer_load_dword v13, v1, s[4:7], s45 offen offset:2048 sc1
  v_smfmac_f32_16x16x64_bf16 v[32:35], v[16:19], v[56:63], v5
  ds_read_b128 v[56:59], v2 offset:24576
  s_waitcnt lgkmcnt(4)
  v_smfmac_f32_16x16x64_bf16 v[36:39], v[16:19], v[64:71], v5
  ds_read_b128 v[60:63], v2 offset:25600
  v_smfmac_f32_16x16x64_bf16 v[40:43], v[16:19], v[216:223], v5
  ds_read_b128 v[64:67], v2 offset:32768
  v_smfmac_f32_16x16x64_bf16 v[44:47], v[16:19], v[224:231], v5
  ds_read_b128 v[68:71], v2 offset:33792
  s_waitcnt lgkmcnt(4)
  v_smfmac_f32_16x16x64_bf16 v[24:27], v[20:23], v[88:95], v5
  ds_read_b128 v[16:19], v1 offset:10240
  v_smfmac_f32_16x16x64_bf16 v[28:31], v[20:23], v[96:103], v5
  buffer_load_dword v13, v1, s[4:7], s45 offen offset:3072 sc1
  v_smfmac_f32_16x16x64_bf16 v[32:35], v[20:23], v[48:55], v5
  ds_read_b128 v[48:51], v2 offset:40960
  s_waitcnt lgkmcnt(4)
  v_smfmac_f32_16x16x64_bf16 v[36:39], v[20:23], v[56:63], v5
  ds_read_b128 v[52:55], v2 offset:41984
  v_smfmac_f32_16x16x64_bf16 v[40:43], v[20:23], v[232:239], v5
  ds_read_b128 v[56:59], v2 offset:49152
  v_smfmac_f32_16x16x64_bf16 v[44:47], v[20:23], v[240:247], v5
  ds_read_b128 v[60:63], v2 offset:50176
  s_waitcnt lgkmcnt(4)
  v_smfmac_f32_16x16x64_bf16 v[24:27], v[16:19], v[104:111], v5
  ds_read_b128 v[20:23], v1 offset:11264
  v_smfmac_f32_16x16x64_bf16 v[28:31], v[16:19], v[112:119], v5
  v_smfmac_f32_16x16x64_bf16 v[32:35], v[16:19], v[64:71], v5
  ds_read_b128 v[64:67], v2 offset:57344
  s_waitcnt lgkmcnt(4)
  v_smfmac_f32_16x16x64_bf16 v[36:39], v[16:19], v[48:55], v5
  ds_read_b128 v[68:71], v2 offset:58368
  v_smfmac_f32_16x16x64_bf16 v[40:43], v[16:19], v[248:255], v5
  ds_read_b128 v[48:51], v3 offset:32768
  v_smfmac_f32_16x16x64_bf16 v[44:47], v[16:19], a[0:7], v5
  ds_read_b128 v[52:55], v3 offset:33792
  s_waitcnt lgkmcnt(4)
  v_smfmac_f32_16x16x64_bf16 v[24:27], v[20:23], v[120:127], v5
  ds_read_b128 v[16:19], v1 offset:14336
  v_smfmac_f32_16x16x64_bf16 v[28:31], v[20:23], v[128:135], v5
  v_smfmac_f32_16x16x64_bf16 v[32:35], v[20:23], v[56:63], v5
  ds_read_b128 v[56:59], v3 offset:40960
  ds_read_b128 v[60:63], v3 offset:41984
  s_waitcnt lgkmcnt(5)
  v_smfmac_f32_16x16x64_bf16 v[36:39], v[20:23], v[64:71], v5
  ds_read_b128 v[64:67], v3 offset:49152
  ds_read_b128 v[68:71], v3 offset:50176
  s_waitcnt lgkmcnt(4)
  v_smfmac_f32_16x16x64_bf16 v[24:27], v[16:19], v[168:175], v5
  ds_read_b128 v[20:23], v1 offset:15360
  v_smfmac_f32_16x16x64_bf16 v[28:31], v[16:19], v[176:183], v5
  v_smfmac_f32_16x16x64_bf16 v[32:35], v[16:19], v[48:55], v5
  ds_read_b128 v[48:51], v3 offset:57344
  ds_read_b128 v[52:55], v3 offset:58368
  s_waitcnt lgkmcnt(5)
  v_smfmac_f32_16x16x64_bf16 v[36:39], v[16:19], v[56:63], v5
  ds_read_b128 v[56:59], v4 offset:0
  ds_read_b128 v[60:63], v4 offset:1024
  s_waitcnt lgkmcnt(4)
  v_smfmac_f32_16x16x64_bf16 v[24:27], v[20:23], v[184:191], v5
  ds_read_b128 v[16:19], v1 offset:16384
  v_smfmac_f32_16x16x64_bf16 v[28:31], v[20:23], v[192:199], v5
  v_smfmac_f32_16x16x64_bf16 v[32:35], v[20:23], v[64:71], v5
  ds_read_b128 v[64:67], v1 offset:11264
  s_waitcnt lgkmcnt(4)
  v_smfmac_f32_16x16x64_bf16 v[36:39], v[20:23], v[48:55], v5
  ds_read_b128 v[68:71], v1 offset:14336
  s_waitcnt lgkmcnt(2)
  v_smfmac_f32_16x16x64_bf16 v[24:27], v[16:19], v[200:207], v5
  v_smfmac_f32_16x16x64_bf16 v[28:31], v[16:19], v[208:215], v5
  v_smfmac_f32_16x16x64_bf16 v[32:35], v[16:19], v[56:63], v5
  v_smfmac_f32_16x16x64_bf16 v[36:39], v[16:19], a[104:111], v5
  v_smfmac_f32_16x16x64_bf16 v[40:43], v[16:19], a[88:95], v5
  ds_read_b128 v[48:51], v1 offset:23552
  v_smfmac_f32_16x16x64_bf16 v[44:47], v[16:19], a[96:103], v5
  ds_read_b128 v[52:55], v1 offset:24576
  s_nop 0
  v_add_f32 v24, v24, v26
  v_add_f32 v25, v25, v27
  v_add_f32 v28, v28, v30
  v_add_f32 v29, v29, v31
  v_cvt_pk_bf16_f32 v24, v24, v25
  v_cvt_pk_bf16_f32 v28, v28, v29
  ds_write2_b32 v6, v24, v28 offset0:0 offset1:64
  v_add_f32 v32, v32, v34
  v_add_f32 v33, v33, v35
  v_add_f32 v36, v36, v38
  v_add_f32 v37, v37, v39
  v_cvt_pk_bf16_f32 v14, v32, v33
  v_cvt_pk_bf16_f32 v15, v36, v37
  ds_write2_b32 v7, v14, v14 offset0:0 offset1:1
  ds_write2_b32 v7, v15, v15 offset0:128 offset1:129
  v_smfmac_f32_16x16x64_bf16 v[40:43], v[20:23], a[72:79], v5
  ds_read_b128 v[56:59], v1 offset:25600
  v_smfmac_f32_16x16x64_bf16 v[44:47], v[20:23], a[80:87], v5
  ds_read_b128 v[60:63], v1 offset:26624
  s_waitcnt lgkmcnt(8)
  v_smfmac_f32_16x16x64_bf16 v[40:43], v[64:67], a[8:15], v5
  v_smfmac_f32_16x16x64_bf16 v[44:47], v[64:67], a[16:23], v5
  s_waitcnt lgkmcnt(7)
  v_smfmac_f32_16x16x64_bf16 v[40:43], v[68:71], a[56:63], v5
  v_smfmac_f32_16x16x64_bf16 v[44:47], v[68:71], a[64:71], v5
  s_branch p1j_27
p1w_31:
  ds_read_b128 v[64:67], v3 offset:49152
  ds_read_b128 v[68:71], v3 offset:50176
  s_waitcnt lgkmcnt(4)
  s_cmp_eq_u32 s17, 3
  s_cbranch_scc0 kf_38
  buffer_load_dword v12, off, s[4:7], s82 sc1
kf_38:
  v_smfmac_f32_16x16x64_bf16 v[24:27], v[16:19], v[168:175], v5
  v_smfmac_f32_16x16x64_bf16 v[28:31], v[16:19], v[176:183], v5
  buffer_load_dword v13, v1, s[4:7], s45 offen offset:0 sc1
  v_smfmac_f32_16x16x64_bf16 v[32:35], v[16:19], v[48:55], v5
  ds_read_b128 v[48:51], v3 offset:57344
  v_smfmac_f32_16x16x64_bf16 v[36:39], v[16:19], v[56:63], v5
  ds_read_b128 v[52:55], v3 offset:58368
  v_smfmac_f32_16x16x64_bf16 v[40:43], v[16:19], a[56:63], v5
  ds_read_b128 v[56:59], v2 offset:0
  v_smfmac_f32_16x16x64_bf16 v[44:47], v[16:19], a[64:71], v5
  ds_read_b128 v[60:63], v2 offset:1024
  v_smfmac_f32_16x16x64_bf16 v[24:27], v[20:23], v[184:191], v5
  s_waitcnt lgkmcnt(6)
  s_barrier
  s_cmp_eq_u32 s17, 3
  s_cbranch_scc0 pf_39
  s_mov_b64 exec, 1
  v_mov_b32 v14, s18
  buffer_store_dword v14, off, s[4:7], s99 sc1
  s_mov_b64 exec, -1
pf_39:
  ds_read_b128 v[16:19], v1 offset:8192
  v_smfmac_f32_16x16x64_bf16 v[28:31], v[20:23], v[192:199], v5
  buffer_load_dword v13, v1, s[4:7], s45 offen offset:1024 sc1
  s_waitcnt lgkmcnt(5)
  v_smfmac_f32_16x16x64_bf16 v[32:35], v[20:23], v[64:71], v5
  ds_read_b128 v[64:67], v2 offset:8192
  s_waitcnt lgkmcnt(4)
  v_smfmac_f32_16x16x64_bf16 v[36:39], v[20:23], v[48:55], v5
  ds_read_b128 v[68:71], v2 offset:9216
  v_smfmac_f32_16x16x64_bf16 v[40:43], v[20:23], a[72:79], v5
  ds_read_b128 v[48:51], v2 offset:16384
  v_smfmac_f32_16x16x64_bf16 v[44:47], v[20:23], a[80:87], v5
  ds_read_b128 v[52:55], v2 offset:17408
  s_waitcnt lgkmcnt(4)
  v_smfmac_f32_16x16x64_bf16 v[24:27], v[16:19], v[72:79], v5
  ds_read_b128 v[20:23], v1 offset:9216
  v_smfmac_f32_16x16x64_bf16 v[28:31], v[16:19], v[80:87], v5
  buffer_load_dword v13, v1, s[4:7], s45 offen offset:2048 sc1
  v_smfmac_f32_16x16x64_bf16 v[32:35], v[16:19], v[56:63], v5
  ds_read_b128 v[56:59], v2 offset:24576
  s_waitcnt lgkmcnt(4)
  v_smfmac_f32_16x16x64_bf16 v[36:39], v[16:19], v[64:71], v5
  ds_read_b128 v[60:63], v2 offset:25600
  v_smfmac_f32_16x16x64_bf16 v[40:43], v[16:19], v[216:223], v5
  ds_read_b128 v[64:67], v2 offset:32768
  v_smfmac_f32_16x16x64_bf16 v[44:47], v[16:19], v[224:231], v5
  ds_read_b128 v[68:71], v2 offset:33792
  s_waitcnt lgkmcnt(4)
  v_smfmac_f32_16x16x64_bf16 v[24:27], v[20:23], v[88:95], v5
  ds_read_b128 v[16:19], v1 offset:10240
  v_smfmac_f32_16x16x64_bf16 v[28:31], v[20:23], v[96:103], v5
  buffer_load_dword v13, v1, s[4:7], s45 offen offset:3072 sc1
  v_smfmac_f32_16x16x64_bf16 v[32:35], v[20:23], v[48:55], v5
  ds_read_b128 v[48:51], v2 offset:40960
  s_waitcnt lgkmcnt(4)
  v_smfmac_f32_16x16x64_bf16 v[36:39], v[20:23], v[56:63], v5
  ds_read_b128 v[52:55], v2 offset:41984
  v_smfmac_f32_16x16x64_bf16 v[40:43], v[20:23], v[232:239], v5
  ds_read_b128 v[56:59], v2 offset:49152
  v_smfmac_f32_16x16x64_bf16 v[44:47], v[20:23], v[240:247], v5
  ds_read_b128 v[60:63], v2 offset:50176
  s_waitcnt lgkmcnt(4)
  v_smfmac_f32_16x16x64_bf16 v[24:27], v[16:19], v[104:111], v5
  ds_read_b128 v[20:23], v1 offset:11264
  v_smfmac_f32_16x16x64_bf16 v[28:31], v[16:19], v[112:119], v5
  v_smfmac_f32_16x16x64_bf16 v[32:35], v[16:19], v[64:71], v5
  ds_read_b128 v[64:67], v2 offset:57344
  s_waitcnt lgkmcnt(4)
  v_smfmac_f32_16x16x64_bf16 v[36:39], v[16:19], v[48:55], v5
  ds_read_b128 v[68:71], v2 offset:58368
  v_smfmac_f32_16x16x64_bf16 v[40:43], v[16:19], v[248:255], v5
  ds_read_b128 v[48:51], v3 offset:0
  v_smfmac_f32_16x16x64_bf16 v[44:47], v[16:19], a[0:7], v5
  ds_read_b128 v[52:55], v3 offset:1024
  s_waitcnt lgkmcnt(4)
  v_smfmac_f32_16x16x64_bf16 v[24:27], v[20:23], v[120:127], v5
  ds_read_b128 v[16:19], v1 offset:12288
  v_smfmac_f32_16x16x64_bf16 v[28:31], v[20:23], v[128:135], v5
  v_smfmac_f32_16x16x64_bf16 v[32:35], v[20:23], v[56:63], v5
  ds_read_b128 v[56:59], v3 offset:8192
  ds_read_b128 v[60:63], v3 offset:9216
  s_waitcnt lgkmcnt(5)
  v_smfmac_f32_16x16x64_bf16 v[36:39], v[20:23], v[64:71], v5
  ds_read_b128 v[64:67], v3 offset:16384
  ds_read_b128 v[68:71], v3 offset:17408
  s_waitcnt lgkmcnt(4)
  v_smfmac_f32_16x16x64_bf16 v[24:27], v[16:19], v[136:143], v5
  ds_read_b128 v[20:23], v1 offset:13312
  v_smfmac_f32_16x16x64_bf16 v[28:31], v[16:19], v[144:151], v5
  v_smfmac_f32_16x16x64_bf16 v[32:35], v[16:19], v[48:55], v5
  ds_read_b128 v[48:51], v3 offset:24576
  ds_read_b128 v[52:55], v3 offset:25600
  s_waitcnt lgkmcnt(5)
  v_smfmac_f32_16x16x64_bf16 v[36:39], v[16:19], v[56:63], v5
  ds_read_b128 v[56:59], v4 offset:0
  ds_read_b128 v[60:63], v4 offset:1024
  s_waitcnt lgkmcnt(4)
  v_smfmac_f32_16x16x64_bf16 v[24:27], v[20:23], v[152:159], v5
  ds_read_b128 v[16:19], v1 offset:16384
  v_smfmac_f32_16x16x64_bf16 v[28:31], v[20:23], v[160:167], v5
  v_smfmac_f32_16x16x64_bf16 v[32:35], v[20:23], v[64:71], v5
  ds_read_b128 v[64:67], v1 offset:11264
  s_waitcnt lgkmcnt(4)
  v_smfmac_f32_16x16x64_bf16 v[36:39], v[20:23], v[48:55], v5
  ds_read_b128 v[68:71], v1 offset:12288
  s_waitcnt lgkmcnt(2)
  v_smfmac_f32_16x16x64_bf16 v[24:27], v[16:19], v[200:207], v5
  v_smfmac_f32_16x16x64_bf16 v[28:31], v[16:19], v[208:215], v5
  v_smfmac_f32_16x16x64_bf16 v[32:35], v[16:19], v[56:63], v5
  v_smfmac_f32_16x16x64_bf16 v[36:39], v[16:19], a[104:111], v5
  v_smfmac_f32_16x16x64_bf16 v[40:43], v[16:19], a[88:95], v5
  ds_read_b128 v[48:51], v1 offset:23552
  v_smfmac_f32_16x16x64_bf16 v[44:47], v[16:19], a[96:103], v5
  ds_read_b128 v[52:55], v1 offset:24576
  s_nop 0
  v_add_f32 v24, v24, v26
  v_add_f32 v25, v25, v27
  v_add_f32 v28, v28, v30
  v_add_f32 v29, v29, v31
  v_cvt_pk_bf16_f32 v24, v24, v25
  v_cvt_pk_bf16_f32 v28, v28, v29
  ds_write2_b32 v6, v24, v28 offset0:0 offset1:64
  v_add_f32 v32, v32, v34
  v_add_f32 v33, v33, v35
  v_add_f32 v36, v36, v38
  v_add_f32 v37, v37, v39
  v_cvt_pk_bf16_f32 v14, v32, v33
  v_cvt_pk_bf16_f32 v15, v36, v37
  ds_write2_b32 v7, v14, v14 offset0:0 offset1:1
  ds_write2_b32 v7, v15, v15 offset0:128 offset1:129
  v_smfmac_f32_16x16x64_bf16 v[40:43], v[20:23], a[40:47], v5
  ds_read_b128 v[56:59], v1 offset:25600
  v_smfmac_f32_16x16x64_bf16 v[44:47], v[20:23], a[48:55], v5
  ds_read_b128 v[60:63], v1 offset:26624
  s_waitcnt lgkmcnt(8)
  v_smfmac_f32_16x16x64_bf16 v[40:43], v[64:67], a[8:15], v5
  v_smfmac_f32_16x16x64_bf16 v[44:47], v[64:67], a[16:23], v5
  s_waitcnt lgkmcnt(7)
  v_smfmac_f32_16x16x64_bf16 v[40:43], v[68:71], a[24:31], v5
  v_smfmac_f32_16x16x64_bf16 v[44:47], v[68:71], a[32:39], v5
p1j_27:
  s_waitcnt lgkmcnt(2)
  s_barrier
  ds_read_b64_tr_b16 v[16:17], v8 offset:0
  ds_read_b64_tr_b16 v[18:19], v8 offset:128
  ds_read_b64_tr_b16 v[20:21], v9 offset:0
  ds_read_b64_tr_b16 v[22:23], v9 offset:256
  ds_read_b64_tr_b16 v[36:37], v8 offset:512
  ds_read_b64_tr_b16 v[38:39], v8 offset:640
  ds_read_b128 v[64:67], v1 offset:27648
  ds_read_b128 v[68:71], v1 offset:28672
  v_add_f32 v40, v40, v42
  v_add_f32 v41, v41, v43
  v_add_f32 v44, v44, v46
  v_add_f32 v45, v45, v47
  v_cvt_pk_bf16_f32 v40, v40, v41
  v_cvt_pk_bf16_f32 v41, v44, v45
  ds_read_b64_tr_b16 v[44:45], v9 offset:1024
  ds_read_b64_tr_b16 v[46:47], v9 offset:1280
  s_waitcnt lgkmcnt(8)
  v_mfma_f32_16x16x32_bf16 v[24:27], v[48:51], v[16:19], 0
  v_mfma_f32_16x16x32_bf16 v[28:31], v[52:55], v[16:19], 0
  s_waitcnt lgkmcnt(6)
  v_mfma_f32_16x16x32_bf16 v[32:35], v[20:23], v[16:19], 0
  buffer_load_dwordx4 v[48:51], v1, s[4:7], s37 offen sc1
  buffer_load_dwordx4 v[52:55], v1, s[4:7], s37 offen offset:1024 sc1
  v_lshrrev_b32 v43, 1, v1
  buffer_store_dwordx2 v[14:15], v43, s[4:7], s38 offen sc1
  buffer_store_dwordx2 v[40:41], v43, s[4:7], s39 offen sc1
  ds_read_b64_tr_b16 v[16:17], v8 offset:1024
  ds_read_b64_tr_b16 v[18:19], v8 offset:1152
  ds_read_b64_tr_b16 v[20:21], v9 offset:2048
  ds_read_b64_tr_b16 v[22:23], v9 offset:2304
  s_waitcnt lgkmcnt(8)
  v_mfma_f32_16x16x32_bf16 v[24:27], v[56:59], v[36:39], v[24:27]
  v_mfma_f32_16x16x32_bf16 v[28:31], v[60:63], v[36:39], v[28:31]
  s_waitcnt lgkmcnt(4)
  v_mfma_f32_16x16x32_bf16 v[32:35], v[44:47], v[36:39], v[32:35]
  ds_read_b128 v[56:59], v1 offset:29696
  ds_read_b128 v[60:63], v1 offset:30720
  ds_read_b64_tr_b16 v[36:37], v8 offset:1536
  ds_read_b64_tr_b16 v[38:39], v8 offset:1664
  ds_read_b64_tr_b16 v[44:45], v9 offset:3072
  ds_read_b64_tr_b16 v[46:47], v9 offset:3328
  s_waitcnt lgkmcnt(8)
  v_mfma_f32_16x16x32_bf16 v[24:27], v[64:67], v[16:19], v[24:27]
  v_mfma_f32_16x16x32_bf16 v[28:31], v[68:71], v[16:19], v[28:31]
  s_waitcnt lgkmcnt(6)
  v_mfma_f32_16x16x32_bf16 v[32:35], v[20:23], v[16:19], v[32:35]
  v_mov_b32 v16, 0x3f803f80
  v_mov_b32 v17, 0x3f803f80
  v_mov_b32 v18, 0x3f803f80
  v_mov_b32 v19, 0x3f803f80
  s_waitcnt lgkmcnt(2)
  v_mfma_f32_16x16x32_bf16 v[24:27], v[56:59], v[36:39], v[24:27]
  v_mov_b32 v21, 0
  v_mfma_f32_16x16x32_bf16 v[28:31], v[60:63], v[36:39], v[28:31]
  v_mov_b32 v22, 0
  s_waitcnt lgkmcnt(0)
  v_mfma_f32_16x16x32_bf16 v[32:35], v[44:47], v[36:39], v[32:35]
  s_nop 2
  v_max3_f32 v42, v24, v25, v26
  s_nop 0
  v_max3_f32 v14, v28, v29, v30
  v_max3_f32 v42, v42, v27, v31
  v_max_f32 v42, v42, v14
  v_max3_f32 v42, v42, v32, v33
  v_mov_b32 v14, v42
  s_nop 1
  v_permlane16_swap_b32 v42, v14
  v_max_f32 v42, v42, v14
  v_mov_b32 v14, v42
  s_nop 1
  v_permlane32_swap_b32 v42, v14
  v_max_f32 v42, v42, v14
  v_mul_f32 v14, s40, v42
  v_pk_fma_f32 v[24:25], v[24:25], s[40:41], v[14:15] op_sel_hi:[1,1,0] neg_lo:[0,0,1] neg_hi:[0,0,1]
  v_pk_fma_f32 v[26:27], v[26:27], s[40:41], v[14:15] op_sel_hi:[1,1,0] neg_lo:[0,0,1] neg_hi:[0,0,1]
  v_pk_fma_f32 v[28:29], v[28:29], s[40:41], v[14:15] op_sel_hi:[1,1,0] neg_lo:[0,0,1] neg_hi:[0,0,1]
  v_pk_fma_f32 v[30:31], v[30:31], s[40:41], v[14:15] op_sel_hi:[1,1,0] neg_lo:[0,0,1] neg_hi:[0,0,1]
  v_pk_fma_f32 v[32:33], v[32:33], s[40:41], v[14:15] op_sel_hi:[1,1,0] neg_lo:[0,0,1] neg_hi:[0,0,1]
  v_exp_f32 v24, v24
  v_exp_f32 v25, v25
  v_exp_f32 v26, v26
  v_exp_f32 v27, v27
  v_exp_f32 v28, v28
  v_exp_f32 v29, v29
  v_exp_f32 v30, v30
  v_exp_f32 v31, v31
  v_exp_f32 v32, v32
  v_exp_f32 v33, v33
  v_cvt_pk_bf16_f32 v56, v24, v25
  v_cvt_pk_bf16_f32 v57, v26, v27
  v_cvt_pk_bf16_f32 v58, v28, v29
  v_cvt_pk_bf16_f32 v59, v30, v31
  v_cvt_pk_bf16_f32 v20, v32, v33
  v_cvt_pk_bf16_f32 v23, v32, v33
  v_mfma_f32_16x16x32_bf16 v[32:35], v[16:19], v[56:59], 0
  s_waitcnt vmcnt(3)
  v_mfma_f32_16x16x32_bf16 v[24:27], v[48:51], v[56:59], 0
  s_waitcnt vmcnt(2)
  v_mfma_f32_16x16x32_bf16 v[28:31], v[52:55], v[56:59], 0
  v_mfma_f32_16x16x16_bf16 v[32:35], v[16:17], v[20:21], v[32:35]
  v_mfma_f32_16x16x16_bf16 v[24:27], v[40:41], v[20:21], v[24:27]
  v_mfma_f32_16x16x16_bf16 v[28:31], v[40:41], v[22:23], v[28:31]
  v_mov_b64 v[36:37], 0
  v_mov_b64 v[38:39], 0
  v_mov_b64 v[40:41], 0
  v_mov_b64 v[42:43], 0
  v_mov_b64 v[44:45], 0
  v_mov_b64 v[46:47], 0
  v_rcp_f32 v13, v32
  v_mov_b64 v[48:49], 0
  v_mul_f32 v24, v13, v24
  v_mul_f32 v25, v13, v25
  v_mul_f32 v26, v13, v26
  v_mul_f32 v27, v13, v27
  v_cvt_pk_bf16_f32 v24, v24, v25
  v_cvt_pk_bf16_f32 v25, v26, v27
  v_mul_f32 v28, v13, v28
  v_mul_f32 v29, v13, v29
  v_mul_f32 v30, v13, v30
  v_mul_f32 v31, v13, v31
  v_cvt_pk_bf16_f32 v26, v28, v29
  v_cvt_pk_bf16_f32 v27, v30, v31
  s_mov_b64 exec, s[42:43]
  ds_write_b128 v10, v[24:27]
  s_mov_b64 exec, -1
  v_mov_b64 v[50:51], 0
  v_mov_b64 v[52:53], 0
  v_mov_b64 v[54:55], 0
  v_mov_b64 v[56:57], 0
  v_mov_b64 v[58:59], 0
  v_mov_b64 v[60:61], 0
  v_mov_b64 v[62:63], 0
  v_mov_b64 v[64:65], 0
  v_mov_b64 v[66:67], 0
  v_mov_b64 v[68:69], 0
  v_mov_b64 v[70:71], 0
  s_waitcnt lgkmcnt(0)
  s_barrier
  ds_read_b128 v[16:19], v1 offset:8192
  ds_read_b128 v[20:23], v1 offset:9216
  s_waitcnt lgkmcnt(1)
  v_smfmac_f32_16x16x64_bf16 v[36:39], v[16:19], a[112:119], v5
  s_waitcnt lgkmcnt(0)
  v_smfmac_f32_16x16x64_bf16 v[36:39], v[20:23], a[120:127], v5
  v_smfmac_f32_16x16x64_bf16 v[40:43], v[16:19], a[128:135], v5
  v_smfmac_f32_16x16x64_bf16 v[40:43], v[20:23], a[136:143], v5
  v_smfmac_f32_16x16x64_bf16 v[44:47], v[16:19], a[144:151], v5
  v_smfmac_f32_16x16x64_bf16 v[44:47], v[20:23], a[152:159], v5
  v_smfmac_f32_16x16x64_bf16 v[48:51], v[16:19], a[160:167], v5
  s_nop 2
  v_add_f32 v36, v36, v38
  v_add_f32 v37, v37, v39
  v_smfmac_f32_16x16x64_bf16 v[48:51], v[20:23], a[168:175], v5
  v_cvt_pk_bf16_f32 v24, v36, v37
  v_or_b32 v24, 1, v24
  v_smfmac_f32_16x16x64_bf16 v[52:55], v[16:19], a[176:183], v5
  v_add_f32 v40, v40, v42
  v_add_f32 v41, v41, v43
  v_smfmac_f32_16x16x64_bf16 v[52:55], v[20:23], a[184:191], v5
  v_cvt_pk_bf16_f32 v25, v40, v41
  v_or_b32 v25, 1, v25
  v_smfmac_f32_16x16x64_bf16 v[56:59], v[16:19], a[192:199], v5
  v_add_f32 v44, v44, v46
  v_add_f32 v45, v45, v47
  v_smfmac_f32_16x16x64_bf16 v[56:59], v[20:23], a[200:207], v5
  v_cvt_pk_bf16_f32 v26, v44, v45
  v_or_b32 v26, 1, v26
  v_smfmac_f32_16x16x64_bf16 v[60:63], v[16:19], a[208:215], v5
  v_add_f32 v48, v48, v50
  v_add_f32 v49, v49, v51
  v_smfmac_f32_16x16x64_bf16 v[60:63], v[20:23], a[216:223], v5
  v_cvt_pk_bf16_f32 v27, v48, v49
  v_or_b32 v27, 1, v27
  v_smfmac_f32_16x16x64_bf16 v[64:67], v[16:19], a[224:231], v5
  buffer_store_dwordx4 v[24:27], v1, s[4:7], s21 offen offset:0
  v_add_f32 v52, v52, v54
  v_smfmac_f32_16x16x64_bf16 v[64:67], v[20:23], a[232:239], v5
  v_add_f32 v53, v53, v55
  v_cvt_pk_bf16_f32 v28, v52, v53
  v_smfmac_f32_16x16x64_bf16 v[68:71], v[16:19], a[240:247], v5
  v_or_b32 v28, 1, v28
  v_add_f32 v56, v56, v58
  v_smfmac_f32_16x16x64_bf16 v[68:71], v[20:23], a[248:255], v5
  v_add_f32 v57, v57, v59
  v_cvt_pk_bf16_f32 v29, v56, v57
  ds_read_b128 v[16:19], v1 offset:31744
  v_or_b32 v29, 1, v29
  v_add_f32 v60, v60, v62
  v_add_f32 v61, v61, v63
  v_cvt_pk_bf16_f32 v30, v60, v61
  v_or_b32 v30, 1, v30
  v_add_f32 v64, v64, v66
  v_add_f32 v65, v65, v67
  v_cvt_pk_bf16_f32 v31, v64, v65
  v_or_b32 v31, 1, v31
  buffer_store_dwordx4 v[28:31], v1, s[4:7], s21 offen offset:1024
  v_add_f32 v68, v68, v70
  v_add_f32 v69, v69, v71
  v_cvt_pk_bf16_f32 v32, v68, v69
  v_or_b32 v32, 1, v32
  buffer_store_dword v32, v6, s[4:7], s59 offen
  s_cmp_eq_u32 s25, -1
  s_cbranch_scc1 nored_40
  s_mov_b32 s29, 0
  v_mov_b64 v[24:25], 0
  v_mov_b64 v[26:27], 0
  v_mov_b64 v[28:29], 0
  v_mov_b64 v[30:31], 0
  v_mov_b64 v[32:33], 0
  v_mov_b64 v[34:35], 0
  v_mov_b64 v[36:37], 0
  v_mov_b64 v[38:39], 0
  v_mov_b64 v[40:41], 0
  v_mov_b64 v[42:43], 0
  v_mov_b64 v[44:45], 0
  v_mov_b64 v[46:47], 0
  s_add_u32 s19, s23, s26
  s_add_u32 s20, s22, s26
  s_mov_b32 s58, s23
  s_mov_b32 s27, s22
  s_mov_b32 s22, s23
  s_mov_b32 s23, s24
  s_mov_b32 s24, s27
  s_add_u32 s37, s37, 262144
  s_add_u32 s45, s45, 262144
  s_add_u32 s38, s38, 65536
  s_add_u32 s39, s39, 65536
  s_add_u32 s18, s18, 1
  s_add_u32 s100, s100, 1
  s_cmp_eq_u32 s100, 7
  s_cselect_b32 s100, 0, s100
  s_addc_u32 s101, s101, 0
  s_lshl_b32 s82, s100, 7
  s_add_u32 s82, s82, s81
  v_mov_b64 v[64:65], 0
  v_mov_b64 v[66:67], 0
  s_sleep 4
  buffer_load_dwordx4 v[48:51], v11, s[4:7], s46 offen sc1
  buffer_load_dwordx4 v[52:55], v11, s[4:7], s47 offen sc1
  buffer_load_dwordx4 v[56:59], v11, s[4:7], s48 offen sc1
  buffer_load_dwordx4 v[60:63], v11, s[4:7], s49 offen sc1
  s_waitcnt lgkmcnt(0)
  s_waitcnt vmcnt(3)
  v_mfma_f32_16x16x32_bf16 v[20:23], v[48:51], v[16:19], 0
  v_bitop3_b32 v13, v48, v49, v50 bitop3:0x80
  s_waitcnt vmcnt(2)
  v_mfma_f32_16x16x32_bf16 v[20:23], v[52:55], v[16:19], v[20:23]
  v_bitop3_b32 v13, v13, v51, v52 bitop3:0x80
  v_bitop3_b32 v13, v13, v53, v54 bitop3:0x80
  s_waitcnt vmcnt(1)
  v_mfma_f32_16x16x32_bf16 v[20:23], v[56:59], v[16:19], v[20:23]
  v_bitop3_b32 v13, v13, v55, v56 bitop3:0x80
  v_bitop3_b32 v13, v13, v57, v58 bitop3:0x80
  s_waitcnt vmcnt(0)
  v_mfma_f32_16x16x32_bf16 v[20:23], v[60:63], v[16:19], v[20:23]
  v_bitop3_b32 v13, v13, v59, v60 bitop3:0x80
  v_bitop3_b32 v13, v13, v61, v62 bitop3:0x80
  v_bitop3_b32 v13, v13, v63, v63 bitop3:0x80
  s_add_u32 s29, s29, 1
  v_and_b32 v13, 1, v13
  v_cmp_eq_u32 vcc, 0, v13
  s_cbranch_vccz redok_43
redp_42:
  buffer_load_dwordx4 v[48:51], v11, s[4:7], s46 offen sc1
  buffer_load_dwordx4 v[52:55], v11, s[4:7], s47 offen sc1
  buffer_load_dwordx4 v[56:59], v11, s[4:7], s48 offen sc1
  buffer_load_dwordx4 v[60:63], v11, s[4:7], s49 offen sc1
  s_add_u32 s29, s29, 1
  s_waitcnt vmcnt(3)
  v_mfma_f32_16x16x32_bf16 v[20:23], v[48:51], v[16:19], 0
  v_bitop3_b32 v13, v48, v49, v50 bitop3:0x80
  s_waitcnt vmcnt(2)
  v_mfma_f32_16x16x32_bf16 v[20:23], v[52:55], v[16:19], v[20:23]
  v_bitop3_b32 v13, v13, v51, v52 bitop3:0x80
  v_bitop3_b32 v13, v13, v53, v54 bitop3:0x80
  s_waitcnt vmcnt(1)
  v_mfma_f32_16x16x32_bf16 v[20:23], v[56:59], v[16:19], v[20:23]
  v_bitop3_b32 v13, v13, v55, v56 bitop3:0x80
  v_bitop3_b32 v13, v13, v57, v58 bitop3:0x80
  s_waitcnt vmcnt(0)
  v_mfma_f32_16x16x32_bf16 v[20:23], v[60:63], v[16:19], v[20:23]
  v_bitop3_b32 v13, v13, v59, v60 bitop3:0x80
  v_bitop3_b32 v13, v13, v61, v62 bitop3:0x80
  v_bitop3_b32 v13, v13, v63, v63 bitop3:0x80
  s_nop 0
  v_and_b32 v13, 1, v13
  v_cmp_eq_u32 vcc, 0, v13
  s_cbranch_vccz redok_43
  s_cmp_lg_u32 s44, 0
  s_cbranch_scc1 redok_43_d
  s_cmp_lt_u32 s29, 0x10000
  s_cbranch_scc1 redp_42
  s_mov_b32 s44, 1
redok_43_d:
  s_waitcnt vmcnt(0)
redok_43_m:
  v_mfma_f32_16x16x32_bf16 v[20:23], v[48:51], v[16:19], 0
  v_mfma_f32_16x16x32_bf16 v[20:23], v[52:55], v[16:19], v[20:23]
  v_mfma_f32_16x16x32_bf16 v[20:23], v[56:59], v[16:19], v[20:23]
  v_mfma_f32_16x16x32_bf16 v[20:23], v[60:63], v[16:19], v[20:23]
  s_nop 5
redok_43:
  s_nop 1
  v_permlane32_swap_b32 v20, v21
  v_permlane32_swap_b32 v22, v23
  v_add_f32 v20, v20, v21
  v_add_f32 v22, v22, v23
  v_cvt_pk_bf16_f32 v20, v20, v22
  s_mov_b64 exec, s[42:43]
  buffer_store_dword v20, v12, s[4:7], s19 offen
  v_mov_b32 v22, -1
  buffer_store_dword v22, v12, s[4:7], s20 offen
  s_mov_b64 exec, -1
  s_waitcnt vmcnt(2)
  s_add_u32 s76, s76, s29
  s_branch gat_41
nored_40:
  s_cmp_eq_u32 s17, 3
  s_cbranch_scc0 nkv_44
  s_cmp_lt_u32 s18, 62
  s_cbranch_scc0 nkv_44
  v_readfirstlane_b32 s29, v12
  s_nop 3
  s_cmp_gt_u32 s29, s101
  s_cbranch_scc1 nkv_44
  s_lshl_b32 s27, s100, 7
  s_lshl_b32 s28, s16, 2
  s_add_u32 s27, s27, s28
  s_add_u32 s27, s27, 2162816
  s_mov_b32 s28, 0
  v_mov_b32 v13, 0
kvw_45:
  buffer_load_dword v14, v13, s[4:7], s27 offen sc1
  s_add_u32 s28, s28, 1
  s_waitcnt vmcnt(0)
  v_readfirstlane_b32 s29, v14
  s_nop 3
  s_cmp_gt_u32 s29, s101
  s_cbranch_scc1 kvd_46
  s_sleep 2
  s_cmp_lg_u32 s44, 0
  s_cbranch_scc1 kvd_46
  s_cmp_lt_u32 s28, 0x40000
  s_cbranch_scc1 kvw_45
  s_mov_b32 s44, 1
kvd_46:
nkv_44:
  s_cmp_eq_u32 s17, 3
  s_cbranch_scc0 nkx_47
  s_add_u32 s36, s36, 262144
  s_mov_b32 m0, 154624
  s_add_u32 s29, s36, 4096
  buffer_load_dwordx4 v1, s[4:7], s36 offen offset:0 sc1 lds
  buffer_load_dwordx4 v1, s[4:7], s36 offen offset:1024 sc1 lds
  buffer_load_dwordx4 v1, s[4:7], s36 offen offset:2048 sc1 lds
  buffer_load_dwordx4 v1, s[4:7], s36 offen offset:3072 sc1 lds
  s_mov_b32 m0, 158720
  s_nop 0
  buffer_load_dwordx4 v1, s[4:7], s29 offen offset:0 sc1 lds
  buffer_load_dwordx4 v1, s[4:7], s29 offen offset:1024 sc1 lds
  buffer_load_dwordx4 v1, s[4:7], s29 offen offset:2048 sc1 lds
  buffer_load_dwordx4 v1, s[4:7], s29 offen offset:3072 sc1 lds
nkx_47:
  v_mov_b64 v[24:25], 0
  v_mov_b64 v[26:27], 0
  v_mov_b64 v[28:29], 0
  v_mov_b64 v[30:31], 0
  v_mov_b64 v[32:33], 0
  v_mov_b64 v[34:35], 0
  v_mov_b64 v[36:37], 0
  v_mov_b64 v[38:39], 0
  v_mov_b64 v[40:41], 0
  v_mov_b64 v[42:43], 0
  v_mov_b64 v[44:45], 0
  v_mov_b64 v[46:47], 0
  s_add_u32 s19, s23, s26
  s_add_u32 s20, s22, s26
  s_mov_b32 s58, s23
  s_mov_b32 s27, s22
  s_mov_b32 s22, s23
  s_mov_b32 s23, s24
  s_mov_b32 s24, s27
  s_add_u32 s37, s37, 262144
  s_add_u32 s45, s45, 262144
  s_add_u32 s38, s38, 65536
  s_add_u32 s39, s39, 65536
  s_add_u32 s18, s18, 1
  s_add_u32 s100, s100, 1
  s_cmp_eq_u32 s100, 7
  s_cselect_b32 s100, 0, s100
  s_addc_u32 s101, s101, 0
  s_lshl_b32 s82, s100, 7
  s_add_u32 s82, s82, s81
  v_mov_b64 v[64:65], 0
  v_mov_b64 v[66:67], 0
gat_41:
  s_lshl_b32 s27, s17, 15
  v_add_u32 v15, s27, v2
  ds_read_b128 v[48:51], v15 offset:0
  ds_read_b128 v[52:55], v15 offset:1024
  ds_read_b128 v[56:59], v15 offset:8192
  ds_read_b128 v[60:63], v15 offset:9216
  s_barrier
  s_mov_b32 s29, 0
  s_add_u32 s28, s58, 8192
  s_sleep 3
  buffer_load_dwordx4 v[16:19], v4, s[4:7], s58 offen sc1
  buffer_load_dwordx4 v[20:23], v4, s[4:7], s58 offen offset:1024 sc1
  s_cmp_eq_u32 s17, 3
  s_cbranch_scc0 gat3_52
  buffer_load_dwordx4 v[64:67], v1, s[4:7], s28 offen sc1
gat3_52:
  s_add_u32 s29, s29, 1
  s_waitcnt vmcnt(0)
  v_max3_u32 v13, v16, v17, v18
  v_max3_u32 v14, v20, v21, v22
  v_max3_u32 v13, v13, v19, v23
  v_max3_u32 v14, v14, v64, v65
  v_max3_u32 v13, v13, v66, v67
  v_max_u32 v13, v13, v14
  v_cmp_eq_u32 vcc, -1, v13
  s_cbranch_vccz gatok_49
gatp_48:
  buffer_load_dwordx4 v[16:19], v4, s[4:7], s58 offen sc1
  buffer_load_dwordx4 v[20:23], v4, s[4:7], s58 offen offset:1024 sc1
  s_cmp_eq_u32 s17, 3
  s_cbranch_scc0 gat3_53
  buffer_load_dwordx4 v[64:67], v1, s[4:7], s28 offen sc1
gat3_53:
  s_add_u32 s29, s29, 1
  s_waitcnt vmcnt(0)
  v_max3_u32 v13, v16, v17, v18
  v_max3_u32 v14, v20, v21, v22
  v_max3_u32 v13, v13, v19, v23
  v_max3_u32 v14, v14, v64, v65
  v_max3_u32 v13, v13, v66, v67
  v_max_u32 v13, v13, v14
  v_cmp_eq_u32 vcc, -1, v13
  s_cbranch_vccz gatok_49
  s_cmp_lg_u32 s44, 0
  s_cbranch_scc1 gatok_49
  s_cmp_lt_u32 s29, 0x10000
  s_cbranch_scc1 gatp_48
  s_mov_b32 s44, 1
gatok_49:
  ds_write_b128 v4, v[16:19] offset:8192
  ds_write_b128 v4, v[20:23] offset:9216
  s_cmp_eq_u32 s17, 3
  s_cbranch_scc0 gat3b_54
  ds_write_b128 v1, v[64:67] offset:16384
gat3b_54:
  s_add_u32 s77, s77, s29
  s_cmp_eq_u32 s17, 1
  s_cbranch_scc1 p1w_57
  s_cmp_eq_u32 s17, 2
  s_cbranch_scc1 p1w_58
  s_cmp_eq_u32 s17, 3
  s_cbranch_scc1 p1w_59
  ds_read_b128 v[64:67], v2 offset:16384
  ds_read_b128 v[68:71], v2 offset:17408
  s_waitcnt lgkmcnt(4)
  s_cmp_eq_u32 s17, 3
  s_cbranch_scc0 kf_60
  buffer_load_dword v12, off, s[4:7], s82 sc1
kf_60:
  v_smfmac_f32_16x16x64_bf16 v[24:27], v[16:19], v[72:79], v5
  v_smfmac_f32_16x16x64_bf16 v[28:31], v[16:19], v[80:87], v5
  buffer_load_dword v13, v1, s[4:7], s45 offen offset:0 sc1
  v_smfmac_f32_16x16x64_bf16 v[32:35], v[16:19], v[48:55], v5
  ds_read_b128 v[48:51], v2 offset:24576
  v_smfmac_f32_16x16x64_bf16 v[36:39], v[16:19], v[56:63], v5
  ds_read_b128 v[52:55], v2 offset:25600
  v_smfmac_f32_16x16x64_bf16 v[40:43], v[16:19], v[216:223], v5
  ds_read_b128 v[56:59], v2 offset:32768
  v_smfmac_f32_16x16x64_bf16 v[44:47], v[16:19], v[224:231], v5
  ds_read_b128 v[60:63], v2 offset:33792
  v_smfmac_f32_16x16x64_bf16 v[24:27], v[20:23], v[88:95], v5
  s_waitcnt lgkmcnt(6)
  s_barrier
  s_cmp_eq_u32 s17, 3
  s_cbranch_scc0 pf_61
  s_mov_b64 exec, 1
  v_mov_b32 v14, s18
  buffer_store_dword v14, off, s[4:7], s99 sc1
  s_mov_b64 exec, -1
pf_61:
  ds_read_b128 v[16:19], v1 offset:10240
  v_smfmac_f32_16x16x64_bf16 v[28:31], v[20:23], v[96:103], v5
  buffer_load_dword v13, v1, s[4:7], s45 offen offset:1024 sc1
  s_waitcnt lgkmcnt(5)
  v_smfmac_f32_16x16x64_bf16 v[32:35], v[20:23], v[64:71], v5
  ds_read_b128 v[64:67], v2 offset:40960
  s_waitcnt lgkmcnt(4)
  v_smfmac_f32_16x16x64_bf16 v[36:39], v[20:23], v[48:55], v5
  ds_read_b128 v[68:71], v2 offset:41984
  v_smfmac_f32_16x16x64_bf16 v[40:43], v[20:23], v[232:239], v5
  ds_read_b128 v[48:51], v2 offset:49152
  v_smfmac_f32_16x16x64_bf16 v[44:47], v[20:23], v[240:247], v5
  ds_read_b128 v[52:55], v2 offset:50176
  s_waitcnt lgkmcnt(4)
  v_smfmac_f32_16x16x64_bf16 v[24:27], v[16:19], v[104:111], v5
  ds_read_b128 v[20:23], v1 offset:11264
  v_smfmac_f32_16x16x64_bf16 v[28:31], v[16:19], v[112:119], v5
  buffer_load_dword v13, v1, s[4:7], s45 offen offset:2048 sc1
  v_smfmac_f32_16x16x64_bf16 v[32:35], v[16:19], v[56:63], v5
  ds_read_b128 v[56:59], v2 offset:57344
  s_waitcnt lgkmcnt(4)
  v_smfmac_f32_16x16x64_bf16 v[36:39], v[16:19], v[64:71], v5
  ds_read_b128 v[60:63], v2 offset:58368
  v_smfmac_f32_16x16x64_bf16 v[40:43], v[16:19], v[248:255], v5
  ds_read_b128 v[64:67], v3 offset:0
  v_smfmac_f32_16x16x64_bf16 v[44:47], v[16:19], a[0:7], v5
  ds_read_b128 v[68:71], v3 offset:1024
  s_waitcnt lgkmcnt(4)
  v_smfmac_f32_16x16x64_bf16 v[24:27], v[20:23], v[120:127], v5
  ds_read_b128 v[16:19], v1 offset:12288
  v_smfmac_f32_16x16x64_bf16 v[28:31], v[20:23], v[128:135], v5
  buffer_load_dword v13, v1, s[4:7], s45 offen offset:3072 sc1
  v_smfmac_f32_16x16x64_bf16 v[32:35], v[20:23], v[48:55], v5
  ds_read_b128 v[48:51], v3 offset:8192
  s_waitcnt lgkmcnt(4)
  v_smfmac_f32_16x16x64_bf16 v[36:39], v[20:23], v[56:63], v5
  ds_read_b128 v[52:55], v3 offset:9216
  v_smfmac_f32_16x16x64_bf16 v[40:43], v[20:23], a[8:15], v5
  ds_read_b128 v[56:59], v3 offset:16384
  v_smfmac_f32_16x16x64_bf16 v[44:47], v[20:23], a[16:23], v5
  ds_read_b128 v[60:63], v3 offset:17408
  s_waitcnt lgkmcnt(4)
  v_smfmac_f32_16x16x64_bf16 v[24:27], v[16:19], v[136:143], v5
  ds_read_b128 v[20:23], v1 offset:13312
  v_smfmac_f32_16x16x64_bf16 v[28:31], v[16:19], v[144:151], v5
  v_smfmac_f32_16x16x64_bf16 v[32:35], v[16:19], v[64:71], v5
  ds_read_b128 v[64:67], v3 offset:24576
  s_waitcnt lgkmcnt(4)
  v_smfmac_f32_16x16x64_bf16 v[36:39], v[16:19], v[48:55], v5
  ds_read_b128 v[68:71], v3 offset:25600
  v_smfmac_f32_16x16x64_bf16 v[40:43], v[16:19], a[24:31], v5
  ds_read_b128 v[48:51], v3 offset:32768
  v_smfmac_f32_16x16x64_bf16 v[44:47], v[16:19], a[32:39], v5
  ds_read_b128 v[52:55], v3 offset:33792
  s_waitcnt lgkmcnt(4)
  v_smfmac_f32_16x16x64_bf16 v[24:27], v[20:23], v[152:159], v5
  ds_read_b128 v[16:19], v1 offset:14336
  v_smfmac_f32_16x16x64_bf16 v[28:31], v[20:23], v[160:167], v5
  v_smfmac_f32_16x16x64_bf16 v[32:35], v[20:23], v[56:63], v5
  ds_read_b128 v[56:59], v3 offset:40960
  ds_read_b128 v[60:63], v3 offset:41984
  s_waitcnt lgkmcnt(5)
  v_smfmac_f32_16x16x64_bf16 v[36:39], v[20:23], v[64:71], v5
  ds_read_b128 v[64:67], v3 offset:49152
  ds_read_b128 v[68:71], v3 offset:50176
  s_waitcnt lgkmcnt(4)
  v_smfmac_f32_16x16x64_bf16 v[24:27], v[16:19], v[168:175], v5
  ds_read_b128 v[20:23], v1 offset:15360
  v_smfmac_f32_16x16x64_bf16 v[28:31], v[16:19], v[176:183], v5
  v_smfmac_f32_16x16x64_bf16 v[32:35], v[16:19], v[48:55], v5
  ds_read_b128 v[48:51], v3 offset:57344
  ds_read_b128 v[52:55], v3 offset:58368
  s_waitcnt lgkmcnt(5)
  v_smfmac_f32_16x16x64_bf16 v[36:39], v[16:19], v[56:63], v5
  ds_read_b128 v[56:59], v4 offset:0
  ds_read_b128 v[60:63], v4 offset:1024
  s_waitcnt lgkmcnt(4)
  v_smfmac_f32_16x16x64_bf16 v[24:27], v[20:23], v[184:191], v5
  ds_read_b128 v[16:19], v1 offset:16384
  v_smfmac_f32_16x16x64_bf16 v[28:31], v[20:23], v[192:199], v5
  v_smfmac_f32_16x16x64_bf16 v[32:35], v[20:23], v[64:71], v5
  ds_read_b128 v[64:67], v1 offset:13312
  s_waitcnt lgkmcnt(4)
  v_smfmac_f32_16x16x64_bf16 v[36:39], v[20:23], v[48:55], v5
  ds_read_b128 v[68:71], v1 offset:14336
  s_waitcnt lgkmcnt(2)
  v_smfmac_f32_16x16x64_bf16 v[24:27], v[16:19], v[200:207], v5
  v_smfmac_f32_16x16x64_bf16 v[28:31], v[16:19], v[208:215], v5
  v_smfmac_f32_16x16x64_bf16 v[32:35], v[16:19], v[56:63], v5
  v_smfmac_f32_16x16x64_bf16 v[36:39], v[16:19], a[104:111], v5
  v_smfmac_f32_16x16x64_bf16 v[40:43], v[16:19], a[88:95], v5
  ds_read_b128 v[48:51], v1 offset:23552
  v_smfmac_f32_16x16x64_bf16 v[44:47], v[16:19], a[96:103], v5
  ds_read_b128 v[52:55], v1 offset:24576
  s_nop 0
  v_add_f32 v24, v24, v26
  v_add_f32 v25, v25, v27
  v_add_f32 v28, v28, v30
  v_add_f32 v29, v29, v31
  v_cvt_pk_bf16_f32 v24, v24, v25
  v_cvt_pk_bf16_f32 v28, v28, v29
  ds_write2_b32 v6, v24, v28 offset0:0 offset1:64
  v_add_f32 v32, v32, v34
  v_add_f32 v33, v33, v35
  v_add_f32 v36, v36, v38
  v_add_f32 v37, v37, v39
  v_cvt_pk_bf16_f32 v14, v32, v33
  v_cvt_pk_bf16_f32 v15, v36, v37
  ds_write2_b32 v7, v14, v14 offset0:0 offset1:1
  ds_write2_b32 v7, v15, v15 offset0:128 offset1:129
  v_smfmac_f32_16x16x64_bf16 v[40:43], v[20:23], a[72:79], v5
  ds_read_b128 v[56:59], v1 offset:25600
  v_smfmac_f32_16x16x64_bf16 v[44:47], v[20:23], a[80:87], v5
  ds_read_b128 v[60:63], v1 offset:26624
  s_waitcnt lgkmcnt(8)
  v_smfmac_f32_16x16x64_bf16 v[40:43], v[64:67], a[40:47], v5
  v_smfmac_f32_16x16x64_bf16 v[44:47], v[64:67], a[48:55], v5
  s_waitcnt lgkmcnt(7)
  v_smfmac_f32_16x16x64_bf16 v[40:43], v[68:71], a[56:63], v5
  v_smfmac_f32_16x16x64_bf16 v[44:47], v[68:71], a[64:71], v5
  s_branch p1j_55
p1w_57:
  ds_read_b128 v[64:67], v2 offset:49152
  ds_read_b128 v[68:71], v2 offset:50176
  s_waitcnt lgkmcnt(4)
  s_cmp_eq_u32 s17, 3
  s_cbranch_scc0 kf_62
  buffer_load_dword v12, off, s[4:7], s82 sc1
kf_62:
  v_smfmac_f32_16x16x64_bf16 v[24:27], v[16:19], v[104:111], v5
  v_smfmac_f32_16x16x64_bf16 v[28:31], v[16:19], v[112:119], v5
  buffer_load_dword v13, v1, s[4:7], s45 offen offset:0 sc1
  v_smfmac_f32_16x16x64_bf16 v[32:35], v[16:19], v[48:55], v5
  ds_read_b128 v[48:51], v2 offset:57344
  v_smfmac_f32_16x16x64_bf16 v[36:39], v[16:19], v[56:63], v5
  ds_read_b128 v[52:55], v2 offset:58368
  v_smfmac_f32_16x16x64_bf16 v[40:43], v[16:19], v[248:255], v5
  ds_read_b128 v[56:59], v2 offset:0
  v_smfmac_f32_16x16x64_bf16 v[44:47], v[16:19], a[0:7], v5
  ds_read_b128 v[60:63], v2 offset:1024
  v_smfmac_f32_16x16x64_bf16 v[24:27], v[20:23], v[120:127], v5
  s_waitcnt lgkmcnt(6)
  s_barrier
  s_cmp_eq_u32 s17, 3
  s_cbranch_scc0 pf_63
  s_mov_b64 exec, 1
  v_mov_b32 v14, s18
  buffer_store_dword v14, off, s[4:7], s99 sc1
  s_mov_b64 exec, -1
pf_63:
  ds_read_b128 v[16:19], v1 offset:8192
  v_smfmac_f32_16x16x64_bf16 v[28:31], v[20:23], v[128:135], v5
  buffer_load_dword v13, v1, s[4:7], s45 offen offset:1024 sc1
  s_waitcnt lgkmcnt(5)
  v_smfmac_f32_16x16x64_bf16 v[32:35], v[20:23], v[64:71], v5
  ds_read_b128 v[64:67], v2 offset:8192
  s_waitcnt lgkmcnt(4)
  v_smfmac_f32_16x16x64_bf16 v[36:39], v[20:23], v[48:55], v5
  ds_read_b128 v[68:71], v2 offset:9216
  v_smfmac_f32_16x16x64_bf16 v[40:43], v[20:23], a[8:15], v5
  ds_read_b128 v[48:51], v2 offset:16384
  v_smfmac_f32_16x16x64_bf16 v[44:47], v[20:23], a[16:23], v5
  ds_read_b128 v[52:55], v2 offset:17408
  s_waitcnt lgkmcnt(4)
  v_smfmac_f32_16x16x64_bf16 v[24:27], v[16:19], v[72:79], v5
  ds_read_b128 v[20:23], v1 offset:9216
  v_smfmac_f32_16x16x64_bf16 v[28:31], v[16:19], v[80:87], v5
  buffer_load_dword v13, v1, s[4:7], s45 offen offset:2048 sc1
  v_smfmac_f32_16x16x64_bf16 v[32:35], v[16:19], v[56:63], v5
  ds_read_b128 v[56:59], v2 offset:24576
  s_waitcnt lgkmcnt(4)
  v_smfmac_f32_16x16x64_bf16 v[36:39], v[16:19], v[64:71], v5
  ds_read_b128 v[60:63], v2 offset:25600
  v_smfmac_f32_16x16x64_bf16 v[40:43], v[16:19], v[216:223], v5
  ds_read_b128 v[64:67], v3 offset:0
  v_smfmac_f32_16x16x64_bf16 v[44:47], v[16:19], v[224:231], v5
  ds_read_b128 v[68:71], v3 offset:1024
  s_waitcnt lgkmcnt(4)
  v_smfmac_f32_16x16x64_bf16 v[24:27], v[20:23], v[88:95], v5
  ds_read_b128 v[16:19], v1 offset:12288
  v_smfmac_f32_16x16x64_bf16 v[28:31], v[20:23], v[96:103], v5
  buffer_load_dword v13, v1, s[4:7], s45 offen offset:3072 sc1
  v_smfmac_f32_16x16x64_bf16 v[32:35], v[20:23], v[48:55], v5
  ds_read_b128 v[48:51], v3 offset:8192
  s_waitcnt lgkmcnt(4)
  v_smfmac_f32_16x16x64_bf16 v[36:39], v[20:23], v[56:63], v5
  ds_read_b128 v[52:55], v3 offset:9216
  v_smfmac_f32_16x16x64_bf16 v[40:43], v[20:23], v[232:239], v5
  ds_read_b128 v[56:59], v3 offset:16384
  v_smfmac_f32_16x16x64_bf16 v[44:47], v[20:23], v[240:247], v5
  ds_read_b128 v[60:63], v3 offset:17408
  s_waitcnt lgkmcnt(4)
  v_smfmac_f32_16x16x64_bf16 v[24:27], v[16:19], v[136:143], v5
  ds_read_b128 v[20:23], v1 offset:13312
  v_smfmac_f32_16x16x64_bf16 v[28:31], v[16:19], v[144:151], v5
  v_smfmac_f32_16x16x64_bf16 v[32:35], v[16:19], v[64:71], v5
  ds_read_b128 v[64:67], v3 offset:24576
  s_waitcnt lgkmcnt(4)
  v_smfmac_f32_16x16x64_bf16 v[36:39], v[16:19], v[48:55], v5
  ds_read_b128 v[68:71], v3 offset:25600
  v_smfmac_f32_16x16x64_bf16 v[40:43], v[16:19], a[24:31], v5
  ds_read_b128 v[48:51], v3 offset:32768
  v_smfmac_f32_16x16x64_bf16 v[44:47], v[16:19], a[32:39], v5
  ds_read_b128 v[52:55], v3 offset:33792
  s_waitcnt lgkmcnt(4)
  v_smfmac_f32_16x16x64_bf16 v[24:27], v[20:23], v[152:159], v5
  ds_read_b128 v[16:19], v1 offset:14336
  v_smfmac_f32_16x16x64_bf16 v[28:31], v[20:23], v[160:167], v5
  v_smfmac_f32_16x16x64_bf16 v[32:35], v[20:23], v[56:63], v5
  ds_read_b128 v[56:59], v3 offset:40960
  ds_read_b128 v[60:63], v3 offset:41984
  s_waitcnt lgkmcnt(5)
  v_smfmac_f32_16x16x64_bf16 v[36:39], v[20:23], v[64:71], v5
  ds_read_b128 v[64:67], v3 offset:49152
  ds_read_b128 v[68:71], v3 offset:50176
  s_waitcnt lgkmcnt(4)
  v_smfmac_f32_16x16x64_bf16 v[24:27], v[16:19], v[168:175], v5
  ds_read_b128 v[20:23], v1 offset:15360
  v_smfmac_f32_16x16x64_bf16 v[28:31], v[16:19], v[176:183], v5
  v_smfmac_f32_16x16x64_bf16 v[32:35], v[16:19], v[48:55], v5
  ds_read_b128 v[48:51], v3 offset:57344
  ds_read_b128 v[52:55], v3 offset:58368
  s_waitcnt lgkmcnt(5)
  v_smfmac_f32_16x16x64_bf16 v[36:39], v[16:19], v[56:63], v5
  ds_read_b128 v[56:59], v4 offset:0
  ds_read_b128 v[60:63], v4 offset:1024
  s_waitcnt lgkmcnt(4)
  v_smfmac_f32_16x16x64_bf16 v[24:27], v[20:23], v[184:191], v5
  ds_read_b128 v[16:19], v1 offset:16384
  v_smfmac_f32_16x16x64_bf16 v[28:31], v[20:23], v[192:199], v5
  v_smfmac_f32_16x16x64_bf16 v[32:35], v[20:23], v[64:71], v5
  ds_read_b128 v[64:67], v1 offset:13312
  s_waitcnt lgkmcnt(4)
  v_smfmac_f32_16x16x64_bf16 v[36:39], v[20:23], v[48:55], v5
  ds_read_b128 v[68:71], v1 offset:14336
  s_waitcnt lgkmcnt(2)
  v_smfmac_f32_16x16x64_bf16 v[24:27], v[16:19], v[200:207], v5
  v_smfmac_f32_16x16x64_bf16 v[28:31], v[16:19], v[208:215], v5
  v_smfmac_f32_16x16x64_bf16 v[32:35], v[16:19], v[56:63], v5
  v_smfmac_f32_16x16x64_bf16 v[36:39], v[16:19], a[104:111], v5
  v_smfmac_f32_16x16x64_bf16 v[40:43], v[16:19], a[88:95], v5
  ds_read_b128 v[48:51], v1 offset:23552
  v_smfmac_f32_16x16x64_bf16 v[44:47], v[16:19], a[96:103], v5
  ds_read_b128 v[52:55], v1 offset:24576
  s_nop 0
  v_add_f32 v24, v24, v26
  v_add_f32 v25, v25, v27
  v_add_f32 v28, v28, v30
  v_add_f32 v29, v29, v31
  v_cvt_pk_bf16_f32 v24, v24, v25
  v_cvt_pk_bf16_f32 v28, v28, v29
  ds_write2_b32 v6, v24, v28 offset0:0 offset1:64
  v_add_f32 v32, v32, v34
  v_add_f32 v33, v33, v35
  v_add_f32 v36, v36, v38
  v_add_f32 v37, v37, v39
  v_cvt_pk_bf16_f32 v14, v32, v33
  v_cvt_pk_bf16_f32 v15, v36, v37
  ds_write2_b32 v7, v14, v14 offset0:0 offset1:1
  ds_write2_b32 v7, v15, v15 offset0:128 offset1:129
  v_smfmac_f32_16x16x64_bf16 v[40:43], v[20:23], a[72:79], v5
  ds_read_b128 v[56:59], v1 offset:25600
  v_smfmac_f32_16x16x64_bf16 v[44:47], v[20:23], a[80:87], v5
  ds_read_b128 v[60:63], v1 offset:26624
  s_waitcnt lgkmcnt(8)
  v_smfmac_f32_16x16x64_bf16 v[40:43], v[64:67], a[40:47], v5
  v_smfmac_f32_16x16x64_bf16 v[44:47], v[64:67], a[48:55], v5
  s_waitcnt lgkmcnt(7)
  v_smfmac_f32_16x16x64_bf16 v[40:43], v[68:71], a[56:63], v5
  v_smfmac_f32_16x16x64_bf16 v[44:47], v[68:71], a[64:71], v5
  s_branch p1j_55
p1w_58:
  ds_read_b128 v[64:67], v3 offset:16384
  ds_read_b128 v[68:71], v3 offset:17408
  s_waitcnt lgkmcnt(4)
  s_cmp_eq_u32 s17, 3
  s_cbranch_scc0 kf_64
  buffer_load_dword v12, off, s[4:7], s82 sc1
kf_64:
  v_smfmac_f32_16x16x64_bf16 v[24:27], v[16:19], v[136:143], v5
  v_smfmac_f32_16x16x64_bf16 v[28:31], v[16:19], v[144:151], v5
  buffer_load_dword v13, v1, s[4:7], s45 offen offset:0 sc1
  v_smfmac_f32_16x16x64_bf16 v[32:35], v[16:19], v[48:55], v5
  ds_read_b128 v[48:51], v3 offset:24576
  v_smfmac_f32_16x16x64_bf16 v[36:39], v[16:19], v[56:63], v5
  ds_read_b128 v[52:55], v3 offset:25600
  v_smfmac_f32_16x16x64_bf16 v[40:43], v[16:19], a[24:31], v5
  ds_read_b128 v[56:59], v2 offset:0
  v_smfmac_f32_16x16x64_bf16 v[44:47], v[16:19], a[32:39], v5
  ds_read_b128 v[60:63], v2 offset:1024
  v_smfmac_f32_16x16x64_bf16 v[24:27], v[20:23], v[152:159], v5
  s_waitcnt lgkmcnt(6)
  s_barrier
  s_cmp_eq_u32 s17, 3
  s_cbranch_scc0 pf_65
  s_mov_b64 exec, 1
  v_mov_b32 v14, s18
  buffer_store_dword v14, off, s[4:7], s99 sc1
  s_mov_b64 exec, -1
pf_65:
  ds_read_b128 v[16:19], v1 offset:8192
  v_smfmac_f32_16x16x64_bf16 v[28:31], v[20:23], v[160:167], v5
  buffer_load_dword v13, v1, s[4:7], s45 offen offset:1024 sc1
  s_waitcnt lgkmcnt(5)
  v_smfmac_f32_16x16x64_bf16 v[32:35], v[20:23], v[64:71], v5
  ds_read_b128 v[64:67], v2 offset:8192
  s_waitcnt lgkmcnt(4)
  v_smfmac_f32_16x16x64_bf16 v[36:39], v[20:23], v[48:55], v5
  ds_read_b128 v[68:71], v2 offset:9216
  v_smfmac_f32_16x16x64_bf16 v[40:43], v[20:23], a[40:47], v5
  ds_read_b128 v[48:51], v2 offset:16384
  v_smfmac_f32_16x16x64_bf16 v[44:47], v[20:23], a[48:55], v5
  ds_read_b128 v[52:55], v2 offset:17408
  s_waitcnt lgkmcnt(4)
  v_smfmac_f32_16x16x64_bf16 v[24:27], v[16:19], v[72:79], v5
  ds_read_b128 v[20:23], v1 offset:9216
  v_smfmac_f32_16x16x64_bf16 v[28:31], v[16:19], v[80:87], v5
  buffer_load_dword v13, v1, s[4:7], s45 offen offset:2048 sc1
  v_smfmac_f32_16x16x64_bf16 v[32:35], v[16:19], v[56:63], v5
  ds_read_b128 v[56:59], v2 offset:24576
  s_waitcnt lgkmcnt(4)
  v_smfmac_f32_16x16x64_bf16 v[36:39], v[16:19], v[64:71], v5
  ds_read_b128 v[60:63], v2 offset:25600
  v_smfmac_f32_16x16x64_bf16 v[40:43], v[16:19], v[216:223], v5
  ds_read_b128 v[64:67], v2 offset:32768
  v_smfmac_f32_16x16x64_bf16 v[44:47], v[16:19], v[224:231], v5
  ds_read_b128 v[68:71], v2 offset:33792
  s_waitcnt lgkmcnt(4)
  v_smfmac_f32_16x16x64_bf16 v[24:27], v[20:23], v[88:95], v5
  ds_read_b128 v[16:19], v1 offset:10240
  v_smfmac_f32_16x16x64_bf16 v[28:31], v[20:23], v[96:103], v5
  buffer_load_dword v13, v1, s[4:7], s45 offen offset:3072 sc1
  v_smfmac_f32_16x16x64_bf16 v[32:35], v[20:23], v[48:55], v5
  ds_read_b128 v[48:51], v2 offset:40960
  s_waitcnt lgkmcnt(4)
  v_smfmac_f32_16x16x64_bf16 v[36:39], v[20:23], v[56:63], v5
  ds_read_b128 v[52:55], v2 offset:41984
  v_smfmac_f32_16x16x64_bf16 v[40:43], v[20:23], v[232:239], v5
  ds_read_b128 v[56:59], v2 offset:49152
  v_smfmac_f32_16x16x64_bf16 v[44:47], v[20:23], v[240:247], v5
  ds_read_b128 v[60:63], v2 offset:50176
  s_waitcnt lgkmcnt(4)
  v_smfmac_f32_16x16x64_bf16 v[24:27], v[16:19], v[104:111], v5
  ds_read_b128 v[20:23], v1 offset:11264
  v_smfmac_f32_16x16x64_bf16 v[28:31], v[16:19], v[112:119], v5
  v_smfmac_f32_16x16x64_bf16 v[32:35], v[16:19], v[64:71], v5
  ds_read_b128 v[64:67], v2 offset:57344
  s_waitcnt lgkmcnt(4)
  v_smfmac_f32_16x16x64_bf16 v[36:39], v[16:19], v[48:55], v5
  ds_read_b128 v[68:71], v2 offset:58368
  v_smfmac_f32_16x16x64_bf16 v[40:43], v[16:19], v[248:255], v5
  ds_read_b128 v[48:51], v3 offset:32768
  v_smfmac_f32_16x16x64_bf16 v[44:47], v[16:19], a[0:7], v5
  ds_read_b128 v[52:55], v3 offset:33792
  s_waitcnt lgkmcnt(4)
  v_smfmac_f32_16x16x64_bf16 v[24:27], v[20:23], v[120:127], v5
  ds_read_b128 v[16:19], v1 offset:14336
  v_smfmac_f32_16x16x64_bf16 v[28:31], v[20:23], v[128:135], v5
  v_smfmac_f32_16x16x64_bf16 v[32:35], v[20:23], v[56:63], v5
  ds_read_b128 v[56:59], v3 offset:40960
  ds_read_b128 v[60:63], v3 offset:41984
  s_waitcnt lgkmcnt(5)
  v_smfmac_f32_16x16x64_bf16 v[36:39], v[20:23], v[64:71], v5
  ds_read_b128 v[64:67], v3 offset:49152
  ds_read_b128 v[68:71], v3 offset:50176
  s_waitcnt lgkmcnt(4)
  v_smfmac_f32_16x16x64_bf16 v[24:27], v[16:19], v[168:175], v5
  ds_read_b128 v[20:23], v1 offset:15360
  v_smfmac_f32_16x16x64_bf16 v[28:31], v[16:19], v[176:183], v5
  v_smfmac_f32_16x16x64_bf16 v[32:35], v[16:19], v[48:55], v5
  ds_read_b128 v[48:51], v3 offset:57344
  ds_read_b128 v[52:55], v3 offset:58368
  s_waitcnt lgkmcnt(5)
  v_smfmac_f32_16x16x64_bf16 v[36:39], v[16:19], v[56:63], v5
  ds_read_b128 v[56:59], v4 offset:0
  ds_read_b128 v[60:63], v4 offset:1024
  s_waitcnt lgkmcnt(4)
  v_smfmac_f32_16x16x64_bf16 v[24:27], v[20:23], v[184:191], v5
  ds_read_b128 v[16:19], v1 offset:16384
  v_smfmac_f32_16x16x64_bf16 v[28:31], v[20:23], v[192:199], v5
  v_smfmac_f32_16x16x64_bf16 v[32:35], v[20:23], v[64:71], v5
  ds_read_b128 v[64:67], v1 offset:11264
  s_waitcnt lgkmcnt(4)
  v_smfmac_f32_16x16x64_bf16 v[36:39], v[20:23], v[48:55], v5
  ds_read_b128 v[68:71], v1 offset:14336
  s_waitcnt lgkmcnt(2)
  v_smfmac_f32_16x16x64_bf16 v[24:27], v[16:19], v[200:207], v5
  v_smfmac_f32_16x16x64_bf16 v[28:31], v[16:19], v[208:215], v5
  v_smfmac_f32_16x16x64_bf16 v[32:35], v[16:19], v[56:63], v5
  v_smfmac_f32_16x16x64_bf16 v[36:39], v[16:19], a[104:111], v5
  v_smfmac_f32_16x16x64_bf16 v[40:43], v[16:19], a[88:95], v5
  ds_read_b128 v[48:51], v1 offset:23552
  v_smfmac_f32_16x16x64_bf16 v[44:47], v[16:19], a[96:103], v5
  ds_read_b128 v[52:55], v1 offset:24576
  s_nop 0
  v_add_f32 v24, v24, v26
  v_add_f32 v25, v25, v27
  v_add_f32 v28, v28, v30
  v_add_f32 v29, v29, v31
  v_cvt_pk_bf16_f32 v24, v24, v25
  v_cvt_pk_bf16_f32 v28, v28, v29
  ds_write2_b32 v6, v24, v28 offset0:0 offset1:64
  v_add_f32 v32, v32, v34
  v_add_f32 v33, v33, v35
  v_add_f32 v36, v36, v38
  v_add_f32 v37, v37, v39
  v_cvt_pk_bf16_f32 v14, v32, v33
  v_cvt_pk_bf16_f32 v15, v36, v37
  ds_write2_b32 v7, v14, v14 offset0:0 offset1:1
  ds_write2_b32 v7, v15, v15 offset0:128 offset1:129
  v_smfmac_f32_16x16x64_bf16 v[40:43], v[20:23], a[72:79], v5
  ds_read_b128 v[56:59], v1 offset:25600
  v_smfmac_f32_16x16x64_bf16 v[44:47], v[20:23], a[80:87], v5
  ds_read_b128 v[60:63], v1 offset:26624
  s_waitcnt lgkmcnt(8)
  v_smfmac_f32_16x16x64_bf16 v[40:43], v[64:67], a[8:15], v5
  v_smfmac_f32_16x16x64_bf16 v[44:47], v[64:67], a[16:23], v5
  s_waitcnt lgkmcnt(7)
  v_smfmac_f32_16x16x64_bf16 v[40:43], v[68:71], a[56:63], v5
  v_smfmac_f32_16x16x64_bf16 v[44:47], v[68:71], a[64:71], v5
  s_branch p1j_55
p1w_59:
  ds_read_b128 v[64:67], v3 offset:49152
  ds_read_b128 v[68:71], v3 offset:50176
  s_waitcnt lgkmcnt(4)
  s_cmp_eq_u32 s17, 3
  s_cbranch_scc0 kf_66
  buffer_load_dword v12, off, s[4:7], s82 sc1
kf_66:
  v_smfmac_f32_16x16x64_bf16 v[24:27], v[16:19], v[168:175], v5
  v_smfmac_f32_16x16x64_bf16 v[28:31], v[16:19], v[176:183], v5
  buffer_load_dword v13, v1, s[4:7], s45 offen offset:0 sc1
  v_smfmac_f32_16x16x64_bf16 v[32:35], v[16:19], v[48:55], v5
  ds_read_b128 v[48:51], v3 offset:57344
  v_smfmac_f32_16x16x64_bf16 v[36:39], v[16:19], v[56:63], v5
  ds_read_b128 v[52:55], v3 offset:58368
  v_smfmac_f32_16x16x64_bf16 v[40:43], v[16:19], a[56:63], v5
  ds_read_b128 v[56:59], v2 offset:0
  v_smfmac_f32_16x16x64_bf16 v[44:47], v[16:19], a[64:71], v5
  ds_read_b128 v[60:63], v2 offset:1024
  v_smfmac_f32_16x16x64_bf16 v[24:27], v[20:23], v[184:191], v5
  s_waitcnt lgkmcnt(6)
  s_barrier
  s_cmp_eq_u32 s17, 3
  s_cbranch_scc0 pf_67
  s_mov_b64 exec, 1
  v_mov_b32 v14, s18
  buffer_store_dword v14, off, s[4:7], s99 sc1
  s_mov_b64 exec, -1
pf_67:
  ds_read_b128 v[16:19], v1 offset:8192
  v_smfmac_f32_16x16x64_bf16 v[28:31], v[20:23], v[192:199], v5
  buffer_load_dword v13, v1, s[4:7], s45 offen offset:1024 sc1
  s_waitcnt lgkmcnt(5)
  v_smfmac_f32_16x16x64_bf16 v[32:35], v[20:23], v[64:71], v5
  ds_read_b128 v[64:67], v2 offset:8192
  s_waitcnt lgkmcnt(4)
  v_smfmac_f32_16x16x64_bf16 v[36:39], v[20:23], v[48:55], v5
  ds_read_b128 v[68:71], v2 offset:9216
  v_smfmac_f32_16x16x64_bf16 v[40:43], v[20:23], a[72:79], v5
  ds_read_b128 v[48:51], v2 offset:16384
  v_smfmac_f32_16x16x64_bf16 v[44:47], v[20:23], a[80:87], v5
  ds_read_b128 v[52:55], v2 offset:17408
  s_waitcnt lgkmcnt(4)
  v_smfmac_f32_16x16x64_bf16 v[24:27], v[16:19], v[72:79], v5
  ds_read_b128 v[20:23], v1 offset:9216
  v_smfmac_f32_16x16x64_bf16 v[28:31], v[16:19], v[80:87], v5
  buffer_load_dword v13, v1, s[4:7], s45 offen offset:2048 sc1
  v_smfmac_f32_16x16x64_bf16 v[32:35], v[16:19], v[56:63], v5
  ds_read_b128 v[56:59], v2 offset:24576
  s_waitcnt lgkmcnt(4)
  v_smfmac_f32_16x16x64_bf16 v[36:39], v[16:19], v[64:71], v5
  ds_read_b128 v[60:63], v2 offset:25600
  v_smfmac_f32_16x16x64_bf16 v[40:43], v[16:19], v[216:223], v5
  ds_read_b128 v[64:67], v2 offset:32768
  v_smfmac_f32_16x16x64_bf16 v[44:47], v[16:19], v[224:231], v5
  ds_read_b128 v[68:71], v2 offset:33792
  s_waitcnt lgkmcnt(4)
  v_smfmac_f32_16x16x64_bf16 v[24:27], v[20:23], v[88:95], v5
  ds_read_b128 v[16:19], v1 offset:10240
  v_smfmac_f32_16x16x64_bf16 v[28:31], v[20:23], v[96:103], v5
  buffer_load_dword v13, v1, s[4:7], s45 offen offset:3072 sc1
  v_smfmac_f32_16x16x64_bf16 v[32:35], v[20:23], v[48:55], v5
  ds_read_b128 v[48:51], v2 offset:40960
  s_waitcnt lgkmcnt(4)
  v_smfmac_f32_16x16x64_bf16 v[36:39], v[20:23], v[56:63], v5
  ds_read_b128 v[52:55], v2 offset:41984
  v_smfmac_f32_16x16x64_bf16 v[40:43], v[20:23], v[232:239], v5
  ds_read_b128 v[56:59], v2 offset:49152
  v_smfmac_f32_16x16x64_bf16 v[44:47], v[20:23], v[240:247], v5
  ds_read_b128 v[60:63], v2 offset:50176
  s_waitcnt lgkmcnt(4)
  v_smfmac_f32_16x16x64_bf16 v[24:27], v[16:19], v[104:111], v5
  ds_read_b128 v[20:23], v1 offset:11264
  v_smfmac_f32_16x16x64_bf16 v[28:31], v[16:19], v[112:119], v5
  v_smfmac_f32_16x16x64_bf16 v[32:35], v[16:19], v[64:71], v5
  ds_read_b128 v[64:67], v2 offset:57344
  s_waitcnt lgkmcnt(4)
  v_smfmac_f32_16x16x64_bf16 v[36:39], v[16:19], v[48:55], v5
  ds_read_b128 v[68:71], v2 offset:58368
  v_smfmac_f32_16x16x64_bf16 v[40:43], v[16:19], v[248:255], v5
  ds_read_b128 v[48:51], v3 offset:0
  v_smfmac_f32_16x16x64_bf16 v[44:47], v[16:19], a[0:7], v5
  ds_read_b128 v[52:55], v3 offset:1024
  s_waitcnt lgkmcnt(4)
  v_smfmac_f32_16x16x64_bf16 v[24:27], v[20:23], v[120:127], v5
  ds_read_b128 v[16:19], v1 offset:12288
  v_smfmac_f32_16x16x64_bf16 v[28:31], v[20:23], v[128:135], v5
  v_smfmac_f32_16x16x64_bf16 v[32:35], v[20:23], v[56:63], v5
  ds_read_b128 v[56:59], v3 offset:8192
  ds_read_b128 v[60:63], v3 offset:9216
  s_waitcnt lgkmcnt(5)
  v_smfmac_f32_16x16x64_bf16 v[36:39], v[20:23], v[64:71], v5
  ds_read_b128 v[64:67], v3 offset:16384
  ds_read_b128 v[68:71], v3 offset:17408
  s_waitcnt lgkmcnt(4)
  v_smfmac_f32_16x16x64_bf16 v[24:27], v[16:19], v[136:143], v5
  ds_read_b128 v[20:23], v1 offset:13312
  v_smfmac_f32_16x16x64_bf16 v[28:31], v[16:19], v[144:151], v5
  v_smfmac_f32_16x16x64_bf16 v[32:35], v[16:19], v[48:55], v5
  ds_read_b128 v[48:51], v3 offset:24576
  ds_read_b128 v[52:55], v3 offset:25600
  s_waitcnt lgkmcnt(5)
  v_smfmac_f32_16x16x64_bf16 v[36:39], v[16:19], v[56:63], v5
  ds_read_b128 v[56:59], v4 offset:0
  ds_read_b128 v[60:63], v4 offset:1024
  s_waitcnt lgkmcnt(4)
  v_smfmac_f32_16x16x64_bf16 v[24:27], v[20:23], v[152:159], v5
  ds_read_b128 v[16:19], v1 offset:16384
  v_smfmac_f32_16x16x64_bf16 v[28:31], v[20:23], v[160:167], v5
  v_smfmac_f32_16x16x64_bf16 v[32:35], v[20:23], v[64:71], v5
  ds_read_b128 v[64:67], v1 offset:11264
  s_waitcnt lgkmcnt(4)
  v_smfmac_f32_16x16x64_bf16 v[36:39], v[20:23], v[48:55], v5
  ds_read_b128 v[68:71], v1 offset:12288
  s_waitcnt lgkmcnt(2)
  v_smfmac_f32_16x16x64_bf16 v[24:27], v[16:19], v[200:207], v5
  v_smfmac_f32_16x16x64_bf16 v[28:31], v[16:19], v[208:215], v5
  v_smfmac_f32_16x16x64_bf16 v[32:35], v[16:19], v[56:63], v5
  v_smfmac_f32_16x16x64_bf16 v[36:39], v[16:19], a[104:111], v5
  v_smfmac_f32_16x16x64_bf16 v[40:43], v[16:19], a[88:95], v5
  ds_read_b128 v[48:51], v1 offset:23552
  v_smfmac_f32_16x16x64_bf16 v[44:47], v[16:19], a[96:103], v5
  ds_read_b128 v[52:55], v1 offset:24576
  s_nop 0
  v_add_f32 v24, v24, v26
  v_add_f32 v25, v25, v27
  v_add_f32 v28, v28, v30
  v_add_f32 v29, v29, v31
  v_cvt_pk_bf16_f32 v24, v24, v25
  v_cvt_pk_bf16_f32 v28, v28, v29
  ds_write2_b32 v6, v24, v28 offset0:0 offset1:64
  v_add_f32 v32, v32, v34
  v_add_f32 v33, v33, v35
  v_add_f32 v36, v36, v38
  v_add_f32 v37, v37, v39
  v_cvt_pk_bf16_f32 v14, v32, v33
  v_cvt_pk_bf16_f32 v15, v36, v37
  ds_write2_b32 v7, v14, v14 offset0:0 offset1:1
  ds_write2_b32 v7, v15, v15 offset0:128 offset1:129
  v_smfmac_f32_16x16x64_bf16 v[40:43], v[20:23], a[40:47], v5
  ds_read_b128 v[56:59], v1 offset:25600
  v_smfmac_f32_16x16x64_bf16 v[44:47], v[20:23], a[48:55], v5
  ds_read_b128 v[60:63], v1 offset:26624
  s_waitcnt lgkmcnt(8)
  v_smfmac_f32_16x16x64_bf16 v[40:43], v[64:67], a[8:15], v5
  v_smfmac_f32_16x16x64_bf16 v[44:47], v[64:67], a[16:23], v5
  s_waitcnt lgkmcnt(7)
  v_smfmac_f32_16x16x64_bf16 v[40:43], v[68:71], a[24:31], v5
  v_smfmac_f32_16x16x64_bf16 v[44:47], v[68:71], a[32:39], v5
p1j_55:
  s_waitcnt lgkmcnt(2)
  s_barrier
  ds_read_b64_tr_b16 v[16:17], v8 offset:0
  ds_read_b64_tr_b16 v[18:19], v8 offset:128
  ds_read_b64_tr_b16 v[20:21], v9 offset:0
  ds_read_b64_tr_b16 v[22:23], v9 offset:256
  ds_read_b64_tr_b16 v[36:37], v8 offset:512
  ds_read_b64_tr_b16 v[38:39], v8 offset:640
  ds_read_b128 v[64:67], v1 offset:27648
  ds_read_b128 v[68:71], v1 offset:28672
  v_add_f32 v40, v40, v42
  v_add_f32 v41, v41, v43
  v_add_f32 v44, v44, v46
  v_add_f32 v45, v45, v47
  v_cvt_pk_bf16_f32 v40, v40, v41
  v_cvt_pk_bf16_f32 v41, v44, v45
  ds_read_b64_tr_b16 v[44:45], v9 offset:1024
  ds_read_b64_tr_b16 v[46:47], v9 offset:1280
  s_waitcnt lgkmcnt(8)
  v_mfma_f32_16x16x32_bf16 v[24:27], v[48:51], v[16:19], 0
  v_mfma_f32_16x16x32_bf16 v[28:31], v[52:55], v[16:19], 0
  s_waitcnt lgkmcnt(6)
  v_mfma_f32_16x16x32_bf16 v[32:35], v[20:23], v[16:19], 0
  buffer_load_dwordx4 v[48:51], v1, s[4:7], s37 offen sc1
  buffer_load_dwordx4 v[52:55], v1, s[4:7], s37 offen offset:1024 sc1
  v_lshrrev_b32 v43, 1, v1
  buffer_store_dwordx2 v[14:15], v43, s[4:7], s38 offen sc1
  buffer_store_dwordx2 v[40:41], v43, s[4:7], s39 offen sc1
  s_cmp_eq_u32 s18, 63
  s_cbranch_scc1 ch_last_f
  ds_read_b64_tr_b16 v[16:17], v8 offset:1024
  ds_read_b64_tr_b16 v[18:19], v8 offset:1152
  ds_read_b64_tr_b16 v[20:21], v9 offset:2048
  ds_read_b64_tr_b16 v[22:23], v9 offset:2304
  s_waitcnt lgkmcnt(8)
  v_mfma_f32_16x16x32_bf16 v[24:27], v[56:59], v[36:39], v[24:27]
  v_mfma_f32_16x16x32_bf16 v[28:31], v[60:63], v[36:39], v[28:31]
  s_waitcnt lgkmcnt(4)
  v_mfma_f32_16x16x32_bf16 v[32:35], v[44:47], v[36:39], v[32:35]
  ds_read_b128 v[56:59], v1 offset:29696
  ds_read_b128 v[60:63], v1 offset:30720
  ds_read_b64_tr_b16 v[36:37], v8 offset:1536
  ds_read_b64_tr_b16 v[38:39], v8 offset:1664
  ds_read_b64_tr_b16 v[44:45], v9 offset:3072
  ds_read_b64_tr_b16 v[46:47], v9 offset:3328
  s_waitcnt lgkmcnt(8)
  v_mfma_f32_16x16x32_bf16 v[24:27], v[64:67], v[16:19], v[24:27]
  v_mfma_f32_16x16x32_bf16 v[28:31], v[68:71], v[16:19], v[28:31]
  s_waitcnt lgkmcnt(6)
  v_mfma_f32_16x16x32_bf16 v[32:35], v[20:23], v[16:19], v[32:35]
  v_mov_b32 v16, 0x3f803f80
  v_mov_b32 v17, 0x3f803f80
  v_mov_b32 v18, 0x3f803f80
  v_mov_b32 v19, 0x3f803f80
  s_waitcnt lgkmcnt(2)
  v_mfma_f32_16x16x32_bf16 v[24:27], v[56:59], v[36:39], v[24:27]
  v_mov_b32 v21, 0
  v_mfma_f32_16x16x32_bf16 v[28:31], v[60:63], v[36:39], v[28:31]
  v_mov_b32 v22, 0
  s_waitcnt lgkmcnt(0)
  v_mfma_f32_16x16x32_bf16 v[32:35], v[44:47], v[36:39], v[32:35]
  s_nop 2
  v_max3_f32 v42, v24, v25, v26
  s_nop 0
  v_max3_f32 v14, v28, v29, v30
  v_max3_f32 v42, v42, v27, v31
  v_max_f32 v42, v42, v14
  v_max3_f32 v42, v42, v32, v33
  v_mov_b32 v14, v42
  s_nop 1
  v_permlane16_swap_b32 v42, v14
  v_max_f32 v42, v42, v14
  v_mov_b32 v14, v42
  s_nop 1
  v_permlane32_swap_b32 v42, v14
  v_max_f32 v42, v42, v14
  v_mul_f32 v14, s40, v42
  v_pk_fma_f32 v[24:25], v[24:25], s[40:41], v[14:15] op_sel_hi:[1,1,0] neg_lo:[0,0,1] neg_hi:[0,0,1]
  v_pk_fma_f32 v[26:27], v[26:27], s[40:41], v[14:15] op_sel_hi:[1,1,0] neg_lo:[0,0,1] neg_hi:[0,0,1]
  v_pk_fma_f32 v[28:29], v[28:29], s[40:41], v[14:15] op_sel_hi:[1,1,0] neg_lo:[0,0,1] neg_hi:[0,0,1]
  v_pk_fma_f32 v[30:31], v[30:31], s[40:41], v[14:15] op_sel_hi:[1,1,0] neg_lo:[0,0,1] neg_hi:[0,0,1]
  v_pk_fma_f32 v[32:33], v[32:33], s[40:41], v[14:15] op_sel_hi:[1,1,0] neg_lo:[0,0,1] neg_hi:[0,0,1]
  v_exp_f32 v24, v24
  v_exp_f32 v25, v25
  v_exp_f32 v26, v26
  v_exp_f32 v27, v27
  v_exp_f32 v28, v28
  v_exp_f32 v29, v29
  v_exp_f32 v30, v30
  v_exp_f32 v31, v31
  v_exp_f32 v32, v32
  v_exp_f32 v33, v33
  v_cvt_pk_bf16_f32 v56, v24, v25
  v_cvt_pk_bf16_f32 v57, v26, v27
  v_cvt_pk_bf16_f32 v58, v28, v29
  v_cvt_pk_bf16_f32 v59, v30, v31
  v_cvt_pk_bf16_f32 v20, v32, v33
  v_cvt_pk_bf16_f32 v23, v32, v33
  v_mfma_f32_16x16x32_bf16 v[32:35], v[16:19], v[56:59], 0
  s_waitcnt vmcnt(3)
  v_mfma_f32_16x16x32_bf16 v[24:27], v[48:51], v[56:59], 0
  s_waitcnt vmcnt(2)
  v_mfma_f32_16x16x32_bf16 v[28:31], v[52:55], v[56:59], 0
  v_mfma_f32_16x16x16_bf16 v[32:35], v[16:17], v[20:21], v[32:35]
  v_mfma_f32_16x16x16_bf16 v[24:27], v[40:41], v[20:21], v[24:27]
  v_mfma_f32_16x16x16_bf16 v[28:31], v[40:41], v[22:23], v[28:31]
  v_mov_b64 v[36:37], 0
  v_mov_b64 v[38:39], 0
  v_mov_b64 v[40:41], 0
  v_mov_b64 v[42:43], 0
  v_mov_b64 v[44:45], 0
  v_mov_b64 v[46:47], 0
  v_rcp_f32 v13, v32
  v_mov_b64 v[48:49], 0
  v_mul_f32 v24, v13, v24
  v_mul_f32 v25, v13, v25
  v_mul_f32 v26, v13, v26
  v_mul_f32 v27, v13, v27
  v_cvt_pk_bf16_f32 v24, v24, v25
  v_cvt_pk_bf16_f32 v25, v26, v27
  v_mul_f32 v28, v13, v28
  v_mul_f32 v29, v13, v29
  v_mul_f32 v30, v13, v30
  v_mul_f32 v31, v13, v31
  v_cvt_pk_bf16_f32 v26, v28, v29
  v_cvt_pk_bf16_f32 v27, v30, v31
  s_mov_b64 exec, s[42:43]
  ds_write_b128 v10, v[24:27]
  s_mov_b64 exec, -1
  v_mov_b64 v[50:51], 0
  v_mov_b64 v[52:53], 0
  v_mov_b64 v[54:55], 0
  v_mov_b64 v[56:57], 0
  v_mov_b64 v[58:59], 0
  v_mov_b64 v[60:61], 0
  v_mov_b64 v[62:63], 0
  v_mov_b64 v[64:65], 0
  v_mov_b64 v[66:67], 0
  v_mov_b64 v[68:69], 0
  v_mov_b64 v[70:71], 0
  s_waitcnt lgkmcnt(0)
  s_barrier
  ds_read_b128 v[16:19], v1 offset:8192
  ds_read_b128 v[20:23], v1 offset:9216
  s_waitcnt lgkmcnt(1)
  v_smfmac_f32_16x16x64_bf16 v[36:39], v[16:19], a[112:119], v5
  s_waitcnt lgkmcnt(0)
  v_smfmac_f32_16x16x64_bf16 v[36:39], v[20:23], a[120:127], v5
  v_smfmac_f32_16x16x64_bf16 v[40:43], v[16:19], a[128:135], v5
  v_smfmac_f32_16x16x64_bf16 v[40:43], v[20:23], a[136:143], v5
  v_smfmac_f32_16x16x64_bf16 v[44:47], v[16:19], a[144:151], v5
  v_smfmac_f32_16x16x64_bf16 v[44:47], v[20:23], a[152:159], v5
  v_smfmac_f32_16x16x64_bf16 v[48:51], v[16:19], a[160:167], v5
  s_nop 2
  v_add_f32 v36, v36, v38
  v_add_f32 v37, v37, v39
  v_smfmac_f32_16x16x64_bf16 v[48:51], v[20:23], a[168:175], v5
  v_cvt_pk_bf16_f32 v24, v36, v37
  v_and_b32 v24, -2, v24
  v_smfmac_f32_16x16x64_bf16 v[52:55], v[16:19], a[176:183], v5
  v_add_f32 v40, v40, v42
  v_add_f32 v41, v41, v43
  v_smfmac_f32_16x16x64_bf16 v[52:55], v[20:23], a[184:191], v5
  v_cvt_pk_bf16_f32 v25, v40, v41
  v_and_b32 v25, -2, v25
  v_smfmac_f32_16x16x64_bf16 v[56:59], v[16:19], a[192:199], v5
  v_add_f32 v44, v44, v46
  v_add_f32 v45, v45, v47
  v_smfmac_f32_16x16x64_bf16 v[56:59], v[20:23], a[200:207], v5
  v_cvt_pk_bf16_f32 v26, v44, v45
  v_and_b32 v26, -2, v26
  v_smfmac_f32_16x16x64_bf16 v[60:63], v[16:19], a[208:215], v5
  v_add_f32 v48, v48, v50
  v_add_f32 v49, v49, v51
  v_smfmac_f32_16x16x64_bf16 v[60:63], v[20:23], a[216:223], v5
  v_cvt_pk_bf16_f32 v27, v48, v49
  v_and_b32 v27, -2, v27
  v_smfmac_f32_16x16x64_bf16 v[64:67], v[16:19], a[224:231], v5
  buffer_store_dwordx4 v[24:27], v1, s[4:7], s21 offen offset:0
  v_add_f32 v52, v52, v54
  v_smfmac_f32_16x16x64_bf16 v[64:67], v[20:23], a[232:239], v5
  v_add_f32 v53, v53, v55
  v_cvt_pk_bf16_f32 v28, v52, v53
  v_smfmac_f32_16x16x64_bf16 v[68:71], v[16:19], a[240:247], v5
  v_and_b32 v28, -2, v28
  v_add_f32 v56, v56, v58
  v_smfmac_f32_16x16x64_bf16 v[68:71], v[20:23], a[248:255], v5
  v_add_f32 v57, v57, v59
  v_cvt_pk_bf16_f32 v29, v56, v57
  ds_read_b128 v[16:19], v1 offset:31744
  v_and_b32 v29, -2, v29
  v_add_f32 v60, v60, v62
  v_add_f32 v61, v61, v63
  v_cvt_pk_bf16_f32 v30, v60, v61
  v_and_b32 v30, -2, v30
  v_add_f32 v64, v64, v66
  v_add_f32 v65, v65, v67
  v_cvt_pk_bf16_f32 v31, v64, v65
  v_and_b32 v31, -2, v31
  buffer_store_dwordx4 v[28:31], v1, s[4:7], s21 offen offset:1024
  v_add_f32 v68, v68, v70
  v_add_f32 v69, v69, v71
  v_cvt_pk_bf16_f32 v32, v68, v69
  v_and_b32 v32, -2, v32
  buffer_store_dword v32, v6, s[4:7], s59 offen
  s_cmp_eq_u32 s25, -1
  s_cbranch_scc1 nored_68
  s_mov_b32 s29, 0
  v_mov_b64 v[24:25], 0
  v_mov_b64 v[26:27], 0
  v_mov_b64 v[28:29], 0
  v_mov_b64 v[30:31], 0
  v_mov_b64 v[32:33], 0
  v_mov_b64 v[34:35], 0
  v_mov_b64 v[36:37], 0
  v_mov_b64 v[38:39], 0
  v_mov_b64 v[40:41], 0
  v_mov_b64 v[42:43], 0
  v_mov_b64 v[44:45], 0
  v_mov_b64 v[46:47], 0
  s_add_u32 s19, s23, s26
  s_add_u32 s20, s22, s26
  s_mov_b32 s58, s23
  s_mov_b32 s27, s22
  s_mov_b32 s22, s23
  s_mov_b32 s23, s24
  s_mov_b32 s24, s27
  s_add_u32 s37, s37, 262144
  s_add_u32 s45, s45, 262144
  s_add_u32 s38, s38, 65536
  s_add_u32 s39, s39, 65536
  s_add_u32 s18, s18, 1
  s_add_u32 s100, s100, 1
  s_cmp_eq_u32 s100, 7
  s_cselect_b32 s100, 0, s100
  s_addc_u32 s101, s101, 0
  s_lshl_b32 s82, s100, 7
  s_add_u32 s82, s82, s81
  v_mov_b64 v[64:65], 0
  v_mov_b64 v[66:67], 0
  s_sleep 4
  buffer_load_dwordx4 v[48:51], v11, s[4:7], s46 offen sc1
  buffer_load_dwordx4 v[52:55], v11, s[4:7], s47 offen sc1
  buffer_load_dwordx4 v[56:59], v11, s[4:7], s48 offen sc1
  buffer_load_dwordx4 v[60:63], v11, s[4:7], s49 offen sc1
  s_waitcnt lgkmcnt(0)
  s_waitcnt vmcnt(3)
  v_mfma_f32_16x16x32_bf16 v[20:23], v[48:51], v[16:19], 0
  v_bitop3_b32 v13, v48, v49, v50 bitop3:0xfe
  s_waitcnt vmcnt(2)
  v_mfma_f32_16x16x32_bf16 v[20:23], v[52:55], v[16:19], v[20:23]
  v_bitop3_b32 v13, v13, v51, v52 bitop3:0xfe
  v_bitop3_b32 v13, v13, v53, v54 bitop3:0xfe
  s_waitcnt vmcnt(1)
  v_mfma_f32_16x16x32_bf16 v[20:23], v[56:59], v[16:19], v[20:23]
  v_bitop3_b32 v13, v13, v55, v56 bitop3:0xfe
  v_bitop3_b32 v13, v13, v57, v58 bitop3:0xfe
  s_waitcnt vmcnt(0)
  v_mfma_f32_16x16x32_bf16 v[20:23], v[60:63], v[16:19], v[20:23]
  v_bitop3_b32 v13, v13, v59, v60 bitop3:0xfe
  v_bitop3_b32 v13, v13, v61, v62 bitop3:0xfe
  v_bitop3_b32 v13, v13, v63, v63 bitop3:0xfe
  s_add_u32 s29, s29, 1
  v_and_b32 v13, 1, v13
  v_cmp_ne_u32 vcc, 0, v13
  s_cbranch_vccz redok_71
redp_70:
  buffer_load_dwordx4 v[48:51], v11, s[4:7], s46 offen sc1
  buffer_load_dwordx4 v[52:55], v11, s[4:7], s47 offen sc1
  buffer_load_dwordx4 v[56:59], v11, s[4:7], s48 offen sc1
  buffer_load_dwordx4 v[60:63], v11, s[4:7], s49 offen sc1
  s_add_u32 s29, s29, 1
  s_waitcnt vmcnt(3)
  v_mfma_f32_16x16x32_bf16 v[20:23], v[48:51], v[16:19], 0
  v_bitop3_b32 v13, v48, v49, v50 bitop3:0xfe
  s_waitcnt vmcnt(2)
  v_mfma_f32_16x16x32_bf16 v[20:23], v[52:55], v[16:19], v[20:23]
  v_bitop3_b32 v13, v13, v51, v52 bitop3:0xfe
  v_bitop3_b32 v13, v13, v53, v54 bitop3:0xfe
  s_waitcnt vmcnt(1)
  v_mfma_f32_16x16x32_bf16 v[20:23], v[56:59], v[16:19], v[20:23]
  v_bitop3_b32 v13, v13, v55, v56 bitop3:0xfe
  v_bitop3_b32 v13, v13, v57, v58 bitop3:0xfe
  s_waitcnt vmcnt(0)
  v_mfma_f32_16x16x32_bf16 v[20:23], v[60:63], v[16:19], v[20:23]
  v_bitop3_b32 v13, v13, v59, v60 bitop3:0xfe
  v_bitop3_b32 v13, v13, v61, v62 bitop3:0xfe
  v_bitop3_b32 v13, v13, v63, v63 bitop3:0xfe
  s_nop 0
  v_and_b32 v13, 1, v13
  v_cmp_ne_u32 vcc, 0, v13
  s_cbranch_vccz redok_71
  s_cmp_lg_u32 s44, 0
  s_cbranch_scc1 redok_71_d
  s_cmp_lt_u32 s29, 0x10000
  s_cbranch_scc1 redp_70
  s_mov_b32 s44, 1
redok_71_d:
  s_waitcnt vmcnt(0)
redok_71_m:
  v_mfma_f32_16x16x32_bf16 v[20:23], v[48:51], v[16:19], 0
  v_mfma_f32_16x16x32_bf16 v[20:23], v[52:55], v[16:19], v[20:23]
  v_mfma_f32_16x16x32_bf16 v[20:23], v[56:59], v[16:19], v[20:23]
  v_mfma_f32_16x16x32_bf16 v[20:23], v[60:63], v[16:19], v[20:23]
  s_nop 5
redok_71:
  s_nop 1
  v_permlane32_swap_b32 v20, v21
  v_permlane32_swap_b32 v22, v23
  v_add_f32 v20, v20, v21
  v_add_f32 v22, v22, v23
  v_cvt_pk_bf16_f32 v20, v20, v22
  s_mov_b64 exec, s[42:43]
  buffer_store_dword v20, v12, s[4:7], s19 offen
  v_mov_b32 v22, -1
  buffer_store_dword v22, v12, s[4:7], s20 offen
  s_mov_b64 exec, -1
  s_waitcnt vmcnt(2)
  s_add_u32 s76, s76, s29
  s_branch gat_69
nored_68:
  s_cmp_eq_u32 s17, 3
  s_cbranch_scc0 nkv_72
  s_cmp_lt_u32 s18, 62
  s_cbranch_scc0 nkv_72
  v_readfirstlane_b32 s29, v12
  s_nop 3
  s_cmp_gt_u32 s29, s101
  s_cbranch_scc1 nkv_72
  s_lshl_b32 s27, s100, 7
  s_lshl_b32 s28, s16, 2
  s_add_u32 s27, s27, s28
  s_add_u32 s27, s27, 2162816
  s_mov_b32 s28, 0
  v_mov_b32 v13, 0
kvw_73:
  buffer_load_dword v14, v13, s[4:7], s27 offen sc1
  s_add_u32 s28, s28, 1
  s_waitcnt vmcnt(0)
  v_readfirstlane_b32 s29, v14
  s_nop 3
  s_cmp_gt_u32 s29, s101
  s_cbranch_scc1 kvd_74
  s_sleep 2
  s_cmp_lg_u32 s44, 0
  s_cbranch_scc1 kvd_74
  s_cmp_lt_u32 s28, 0x40000
  s_cbranch_scc1 kvw_73
  s_mov_b32 s44, 1
kvd_74:
nkv_72:
  s_cmp_eq_u32 s17, 3
  s_cbranch_scc0 nkx_75
  s_add_u32 s36, s36, 262144
  s_mov_b32 m0, 154624
  s_add_u32 s29, s36, 4096
  buffer_load_dwordx4 v1, s[4:7], s36 offen offset:0 sc1 lds
  buffer_load_dwordx4 v1, s[4:7], s36 offen offset:1024 sc1 lds
  buffer_load_dwordx4 v1, s[4:7], s36 offen offset:2048 sc1 lds
  buffer_load_dwordx4 v1, s[4:7], s36 offen offset:3072 sc1 lds
  s_mov_b32 m0, 158720
  s_nop 0
  buffer_load_dwordx4 v1, s[4:7], s29 offen offset:0 sc1 lds
  buffer_load_dwordx4 v1, s[4:7], s29 offen offset:1024 sc1 lds
  buffer_load_dwordx4 v1, s[4:7], s29 offen offset:2048 sc1 lds
  buffer_load_dwordx4 v1, s[4:7], s29 offen offset:3072 sc1 lds
nkx_75:
  v_mov_b64 v[24:25], 0
  v_mov_b64 v[26:27], 0
  v_mov_b64 v[28:29], 0
  v_mov_b64 v[30:31], 0
  v_mov_b64 v[32:33], 0
  v_mov_b64 v[34:35], 0
  v_mov_b64 v[36:37], 0
  v_mov_b64 v[38:39], 0
  v_mov_b64 v[40:41], 0
  v_mov_b64 v[42:43], 0
  v_mov_b64 v[44:45], 0
  v_mov_b64 v[46:47], 0
  s_add_u32 s19, s23, s26
  s_add_u32 s20, s22, s26
  s_mov_b32 s58, s23
  s_mov_b32 s27, s22
  s_mov_b32 s22, s23
  s_mov_b32 s23, s24
  s_mov_b32 s24, s27
  s_add_u32 s37, s37, 262144
  s_add_u32 s45, s45, 262144
  s_add_u32 s38, s38, 65536
  s_add_u32 s39, s39, 65536
  s_add_u32 s18, s18, 1
  s_add_u32 s100, s100, 1
  s_cmp_eq_u32 s100, 7
  s_cselect_b32 s100, 0, s100
  s_addc_u32 s101, s101, 0
  s_lshl_b32 s82, s100, 7
  s_add_u32 s82, s82, s81
  v_mov_b64 v[64:65], 0
  v_mov_b64 v[66:67], 0
gat_69:
  s_lshl_b32 s27, s17, 15
  v_add_u32 v15, s27, v2
  ds_read_b128 v[48:51], v15 offset:0
  ds_read_b128 v[52:55], v15 offset:1024
  ds_read_b128 v[56:59], v15 offset:8192
  ds_read_b128 v[60:63], v15 offset:9216
  s_barrier
  s_mov_b32 s29, 0
  s_add_u32 s28, s58, 8192
  s_sleep 3
  buffer_load_dwordx4 v[16:19], v4, s[4:7], s58 offen sc1
  buffer_load_dwordx4 v[20:23], v4, s[4:7], s58 offen offset:1024 sc1
  s_cmp_eq_u32 s17, 3
  s_cbranch_scc0 gat3_80
  buffer_load_dwordx4 v[64:67], v1, s[4:7], s28 offen sc1
gat3_80:
  s_add_u32 s29, s29, 1
  s_waitcnt vmcnt(0)
  v_max3_u32 v13, v16, v17, v18
  v_max3_u32 v14, v20, v21, v22
  v_max3_u32 v13, v13, v19, v23
  v_max3_u32 v14, v14, v64, v65
  v_max3_u32 v13, v13, v66, v67
  v_max_u32 v13, v13, v14
  v_cmp_eq_u32 vcc, -1, v13
  s_cbranch_vccz gatok_77
gatp_76:
  buffer_load_dwordx4 v[16:19], v4, s[4:7], s58 offen sc1
  buffer_load_dwordx4 v[20:23], v4, s[4:7], s58 offen offset:1024 sc1
  s_cmp_eq_u32 s17, 3
  s_cbranch_scc0 gat3_81
  buffer_load_dwordx4 v[64:67], v1, s[4:7], s28 offen sc1
gat3_81:
  s_add_u32 s29, s29, 1
  s_waitcnt vmcnt(0)
  v_max3_u32 v13, v16, v17, v18
  v_max3_u32 v14, v20, v21, v22
  v_max3_u32 v13, v13, v19, v23
  v_max3_u32 v14, v14, v64, v65
  v_max3_u32 v13, v13, v66, v67
  v_max_u32 v13, v13, v14
  v_cmp_eq_u32 vcc, -1, v13
  s_cbranch_vccz gatok_77
  s_cmp_lg_u32 s44, 0
  s_cbranch_scc1 gatok_77
  s_cmp_lt_u32 s29, 0x10000
  s_cbranch_scc1 gatp_76
  s_mov_b32 s44, 1
gatok_77:
  ds_write_b128 v4, v[16:19] offset:8192
  ds_write_b128 v4, v[20:23] offset:9216
  s_cmp_eq_u32 s17, 3
  s_cbranch_scc0 gat3b_82
  ds_write_b128 v1, v[64:67] offset:16384
gat3b_82:
  s_add_u32 s77, s77, s29
  s_cmp_lt_u32 s18, 64
  s_cbranch_scc1 ch_loop_f
ch_last_f:
  s_waitcnt vmcnt(0) lgkmcnt(0)
  s_barrier
  s_cmp_eq_u32 s17, 3
  s_cbranch_scc0 pfl_83
  s_mov_b64 exec, 1
  v_mov_b32 v13, 0
  v_mov_b32 v14, 64
  buffer_store_dword v14, v13, s[4:7], s99 offen sc1
  s_mov_b64 exec, -1
pfl_83:
  s_branch ch_done
ch_slow_entry:
  v_mov_b64 v[24:25], 0
  v_mov_b64 v[26:27], 0
  v_mov_b64 v[28:29], 0
  v_mov_b64 v[30:31], 0
  v_mov_b64 v[32:33], 0
  v_mov_b64 v[34:35], 0
  v_mov_b64 v[36:37], 0
  v_mov_b64 v[38:39], 0
  v_mov_b64 v[40:41], 0
  v_mov_b64 v[42:43], 0
  v_mov_b64 v[44:45], 0
  v_mov_b64 v[46:47], 0
  s_lshl_b32 s27, s17, 15
  v_add_u32 v15, s27, v2
  ds_read_b128 v[48:51], v15 offset:0
  ds_read_b128 v[52:55], v15 offset:1024
  ds_read_b128 v[56:59], v15 offset:8192
  ds_read_b128 v[60:63], v15 offset:9216
  ds_read_b128 v[16:19], v4 offset:8192
  ds_read_b128 v[20:23], v4 offset:9216
  s_waitcnt lgkmcnt(0)
ch_loop_s:
  s_cmp_eq_u32 s17, 1
  s_cbranch_scc1 p1w_86
  s_cmp_eq_u32 s17, 2
  s_cbranch_scc1 p1w_87
  s_cmp_eq_u32 s17, 3
  s_cbranch_scc1 p1w_88
  ds_read_b128 v[64:67], v2 offset:16384
  ds_read_b128 v[68:71], v2 offset:17408
  s_waitcnt lgkmcnt(4)
  s_cmp_eq_u32 s17, 3
  s_cbranch_scc0 kf_89
  buffer_load_dword v12, off, s[4:7], s82 sc1
kf_89:
  v_smfmac_f32_16x16x64_bf16 v[24:27], v[16:19], v[72:79], v5
  v_smfmac_f32_16x16x64_bf16 v[28:31], v[16:19], v[80:87], v5
  buffer_load_dword v13, v1, s[4:7], s45 offen offset:0 sc1
  v_smfmac_f32_16x16x64_bf16 v[32:35], v[16:19], v[48:55], v5
  ds_read_b128 v[48:51], v2 offset:24576
  v_smfmac_f32_16x16x64_bf16 v[36:39], v[16:19], v[56:63], v5
  ds_read_b128 v[52:55], v2 offset:25600
  v_smfmac_f32_16x16x64_bf16 v[40:43], v[16:19], v[216:223], v5
  ds_read_b128 v[56:59], v2 offset:32768
  v_smfmac_f32_16x16x64_bf16 v[44:47], v[16:19], v[224:231], v5
  ds_read_b128 v[60:63], v2 offset:33792
  v_smfmac_f32_16x16x64_bf16 v[24:27], v[20:23], v[88:95], v5
  s_waitcnt lgkmcnt(6)
  s_barrier
  s_cmp_eq_u32 s17, 3
  s_cbranch_scc0 pf_90
  s_mov_b64 exec, 1
  v_mov_b32 v14, s18
  buffer_store_dword v14, off, s[4:7], s99 sc1
  s_mov_b64 exec, -1
pf_90:
  ds_read_b128 v[16:19], v1 offset:10240
  v_smfmac_f32_16x16x64_bf16 v[28:31], v[20:23], v[96:103], v5
  buffer_load_dword v13, v1, s[4:7], s45 offen offset:1024 sc1
  s_waitcnt lgkmcnt(5)
  v_smfmac_f32_16x16x64_bf16 v[32:35], v[20:23], v[64:71], v5
  ds_read_b128 v[64:67], v2 offset:40960
  s_waitcnt lgkmcnt(4)
  v_smfmac_f32_16x16x64_bf16 v[36:39], v[20:23], v[48:55], v5
  ds_read_b128 v[68:71], v2 offset:41984
  v_smfmac_f32_16x16x64_bf16 v[40:43], v[20:23], v[232:239], v5
  ds_read_b128 v[48:51], v2 offset:49152
  v_smfmac_f32_16x16x64_bf16 v[44:47], v[20:23], v[240:247], v5
  ds_read_b128 v[52:55], v2 offset:50176
  s_waitcnt lgkmcnt(4)
  v_smfmac_f32_16x16x64_bf16 v[24:27], v[16:19], v[104:111], v5
  ds_read_b128 v[20:23], v1 offset:11264
  v_smfmac_f32_16x16x64_bf16 v[28:31], v[16:19], v[112:119], v5
  buffer_load_dword v13, v1, s[4:7], s45 offen offset:2048 sc1
  v_smfmac_f32_16x16x64_bf16 v[32:35], v[16:19], v[56:63], v5
  ds_read_b128 v[56:59], v2 offset:57344
  s_waitcnt lgkmcnt(4)
  v_smfmac_f32_16x16x64_bf16 v[36:39], v[16:19], v[64:71], v5
  ds_read_b128 v[60:63], v2 offset:58368
  v_smfmac_f32_16x16x64_bf16 v[40:43], v[16:19], v[248:255], v5
  ds_read_b128 v[64:67], v3 offset:0
  v_smfmac_f32_16x16x64_bf16 v[44:47], v[16:19], a[0:7], v5
  ds_read_b128 v[68:71], v3 offset:1024
  s_waitcnt lgkmcnt(4)
  v_smfmac_f32_16x16x64_bf16 v[24:27], v[20:23], v[120:127], v5
  ds_read_b128 v[16:19], v1 offset:12288
  v_smfmac_f32_16x16x64_bf16 v[28:31], v[20:23], v[128:135], v5
  buffer_load_dword v13, v1, s[4:7], s45 offen offset:3072 sc1
  v_smfmac_f32_16x16x64_bf16 v[32:35], v[20:23], v[48:55], v5
  ds_read_b128 v[48:51], v3 offset:8192
  s_waitcnt lgkmcnt(4)
  v_smfmac_f32_16x16x64_bf16 v[36:39], v[20:23], v[56:63], v5
  ds_read_b128 v[52:55], v3 offset:9216
  v_smfmac_f32_16x16x64_bf16 v[40:43], v[20:23], a[8:15], v5
  ds_read_b128 v[56:59], v3 offset:16384
  v_smfmac_f32_16x16x64_bf16 v[44:47], v[20:23], a[16:23], v5
  ds_read_b128 v[60:63], v3 offset:17408
  s_waitcnt lgkmcnt(4)
  v_smfmac_f32_16x16x64_bf16 v[24:27], v[16:19], v[136:143], v5
  ds_read_b128 v[20:23], v1 offset:13312
  v_smfmac_f32_16x16x64_bf16 v[28:31], v[16:19], v[144:151], v5
  v_smfmac_f32_16x16x64_bf16 v[32:35], v[16:19], v[64:71], v5
  ds_read_b128 v[64:67], v3 offset:24576
  s_waitcnt lgkmcnt(4)
  v_smfmac_f32_16x16x64_bf16 v[36:39], v[16:19], v[48:55], v5
  ds_read_b128 v[68:71], v3 offset:25600
  v_smfmac_f32_16x16x64_bf16 v[40:43], v[16:19], a[24:31], v5
  ds_read_b128 v[48:51], v3 offset:32768
  v_smfmac_f32_16x16x64_bf16 v[44:47], v[16:19], a[32:39], v5
  ds_read_b128 v[52:55], v3 offset:33792
  s_waitcnt lgkmcnt(4)
  v_smfmac_f32_16x16x64_bf16 v[24:27], v[20:23], v[152:159], v5
  ds_read_b128 v[16:19], v1 offset:14336
  v_smfmac_f32_16x16x64_bf16 v[28:31], v[20:23], v[160:167], v5
  v_smfmac_f32_16x16x64_bf16 v[32:35], v[20:23], v[56:63], v5
  ds_read_b128 v[56:59], v3 offset:40960
  ds_read_b128 v[60:63], v3 offset:41984
  s_waitcnt lgkmcnt(5)
  v_smfmac_f32_16x16x64_bf16 v[36:39], v[20:23], v[64:71], v5
  ds_read_b128 v[64:67], v3 offset:49152
  ds_read_b128 v[68:71], v3 offset:50176
  s_waitcnt lgkmcnt(4)
  v_smfmac_f32_16x16x64_bf16 v[24:27], v[16:19], v[168:175], v5
  ds_read_b128 v[20:23], v1 offset:15360
  v_smfmac_f32_16x16x64_bf16 v[28:31], v[16:19], v[176:183], v5
  v_smfmac_f32_16x16x64_bf16 v[32:35], v[16:19], v[48:55], v5
  ds_read_b128 v[48:51], v3 offset:57344
  ds_read_b128 v[52:55], v3 offset:58368
  s_waitcnt lgkmcnt(5)
  v_smfmac_f32_16x16x64_bf16 v[36:39], v[16:19], v[56:63], v5
  ds_read_b128 v[56:59], v4 offset:0
  ds_read_b128 v[60:63], v4 offset:1024
  s_waitcnt lgkmcnt(4)
  v_smfmac_f32_16x16x64_bf16 v[24:27], v[20:23], v[184:191], v5
  ds_read_b128 v[16:19], v1 offset:16384
  v_smfmac_f32_16x16x64_bf16 v[28:31], v[20:23], v[192:199], v5
  v_smfmac_f32_16x16x64_bf16 v[32:35], v[20:23], v[64:71], v5
  ds_read_b128 v[64:67], v1 offset:13312
  s_waitcnt lgkmcnt(4)
  v_smfmac_f32_16x16x64_bf16 v[36:39], v[20:23], v[48:55], v5
  ds_read_b128 v[68:71], v1 offset:14336
  s_waitcnt lgkmcnt(2)
  v_smfmac_f32_16x16x64_bf16 v[24:27], v[16:19], v[200:207], v5
  v_smfmac_f32_16x16x64_bf16 v[28:31], v[16:19], v[208:215], v5
  v_smfmac_f32_16x16x64_bf16 v[32:35], v[16:19], v[56:63], v5
  v_smfmac_f32_16x16x64_bf16 v[36:39], v[16:19], a[104:111], v5
  v_smfmac_f32_16x16x64_bf16 v[40:43], v[16:19], a[88:95], v5
  ds_read_b128 v[48:51], v1 offset:23552
  v_smfmac_f32_16x16x64_bf16 v[44:47], v[16:19], a[96:103], v5
  ds_read_b128 v[52:55], v1 offset:24576
  s_nop 0
  v_add_f32 v24, v24, v26
  v_add_f32 v25, v25, v27
  v_add_f32 v28, v28, v30
  v_add_f32 v29, v29, v31
  v_cvt_pk_bf16_f32 v24, v24, v25
  v_cvt_pk_bf16_f32 v28, v28, v29
  ds_write2_b32 v6, v24, v28 offset0:0 offset1:64
  v_add_f32 v32, v32, v34
  v_add_f32 v33, v33, v35
  v_add_f32 v36, v36, v38
  v_add_f32 v37, v37, v39
  v_cvt_pk_bf16_f32 v14, v32, v33
  v_cvt_pk_bf16_f32 v15, v36, v37
  ds_write2_b32 v7, v14, v14 offset0:0 offset1:1
  ds_write2_b32 v7, v15, v15 offset0:128 offset1:129
  v_smfmac_f32_16x16x64_bf16 v[40:43], v[20:23], a[72:79], v5
  ds_read_b128 v[56:59], v1 offset:25600
  v_smfmac_f32_16x16x64_bf16 v[44:47], v[20:23], a[80:87], v5
  ds_read_b128 v[60:63], v1 offset:26624
  s_waitcnt lgkmcnt(8)
  v_smfmac_f32_16x16x64_bf16 v[40:43], v[64:67], a[40:47], v5
  v_smfmac_f32_16x16x64_bf16 v[44:47], v[64:67], a[48:55], v5
  s_waitcnt lgkmcnt(7)
  v_smfmac_f32_16x16x64_bf16 v[40:43], v[68:71], a[56:63], v5
  v_smfmac_f32_16x16x64_bf16 v[44:47], v[68:71], a[64:71], v5
  s_branch p1j_84
p1w_86:
  ds_read_b128 v[64:67], v2 offset:49152
  ds_read_b128 v[68:71], v2 offset:50176
  s_waitcnt lgkmcnt(4)
  s_cmp_eq_u32 s17, 3
  s_cbranch_scc0 kf_91
  buffer_load_dword v12, off, s[4:7], s82 sc1
kf_91:
  v_smfmac_f32_16x16x64_bf16 v[24:27], v[16:19], v[104:111], v5
  v_smfmac_f32_16x16x64_bf16 v[28:31], v[16:19], v[112:119], v5
  buffer_load_dword v13, v1, s[4:7], s45 offen offset:0 sc1
  v_smfmac_f32_16x16x64_bf16 v[32:35], v[16:19], v[48:55], v5
  ds_read_b128 v[48:51], v2 offset:57344
  v_smfmac_f32_16x16x64_bf16 v[36:39], v[16:19], v[56:63], v5
  ds_read_b128 v[52:55], v2 offset:58368
  v_smfmac_f32_16x16x64_bf16 v[40:43], v[16:19], v[248:255], v5
  ds_read_b128 v[56:59], v2 offset:0
  v_smfmac_f32_16x16x64_bf16 v[44:47], v[16:19], a[0:7], v5
  ds_read_b128 v[60:63], v2 offset:1024
  v_smfmac_f32_16x16x64_bf16 v[24:27], v[20:23], v[120:127], v5
  s_waitcnt lgkmcnt(6)
  s_barrier
  s_cmp_eq_u32 s17, 3
  s_cbranch_scc0 pf_92
  s_mov_b64 exec, 1
  v_mov_b32 v14, s18
  buffer_store_dword v14, off, s[4:7], s99 sc1
  s_mov_b64 exec, -1
pf_92:
  ds_read_b128 v[16:19], v1 offset:8192
  v_smfmac_f32_16x16x64_bf16 v[28:31], v[20:23], v[128:135], v5
  buffer_load_dword v13, v1, s[4:7], s45 offen offset:1024 sc1
  s_waitcnt lgkmcnt(5)
  v_smfmac_f32_16x16x64_bf16 v[32:35], v[20:23], v[64:71], v5
  ds_read_b128 v[64:67], v2 offset:8192
  s_waitcnt lgkmcnt(4)
  v_smfmac_f32_16x16x64_bf16 v[36:39], v[20:23], v[48:55], v5
  ds_read_b128 v[68:71], v2 offset:9216
  v_smfmac_f32_16x16x64_bf16 v[40:43], v[20:23], a[8:15], v5
  ds_read_b128 v[48:51], v2 offset:16384
  v_smfmac_f32_16x16x64_bf16 v[44:47], v[20:23], a[16:23], v5
  ds_read_b128 v[52:55], v2 offset:17408
  s_waitcnt lgkmcnt(4)
  v_smfmac_f32_16x16x64_bf16 v[24:27], v[16:19], v[72:79], v5
  ds_read_b128 v[20:23], v1 offset:9216
  v_smfmac_f32_16x16x64_bf16 v[28:31], v[16:19], v[80:87], v5
  buffer_load_dword v13, v1, s[4:7], s45 offen offset:2048 sc1
  v_smfmac_f32_16x16x64_bf16 v[32:35], v[16:19], v[56:63], v5
  ds_read_b128 v[56:59], v2 offset:24576
  s_waitcnt lgkmcnt(4)
  v_smfmac_f32_16x16x64_bf16 v[36:39], v[16:19], v[64:71], v5
  ds_read_b128 v[60:63], v2 offset:25600
  v_smfmac_f32_16x16x64_bf16 v[40:43], v[16:19], v[216:223], v5
  ds_read_b128 v[64:67], v3 offset:0
  v_smfmac_f32_16x16x64_bf16 v[44:47], v[16:19], v[224:231], v5
  ds_read_b128 v[68:71], v3 offset:1024
  s_waitcnt lgkmcnt(4)
  v_smfmac_f32_16x16x64_bf16 v[24:27], v[20:23], v[88:95], v5
  ds_read_b128 v[16:19], v1 offset:12288
  v_smfmac_f32_16x16x64_bf16 v[28:31], v[20:23], v[96:103], v5
  buffer_load_dword v13, v1, s[4:7], s45 offen offset:3072 sc1
  v_smfmac_f32_16x16x64_bf16 v[32:35], v[20:23], v[48:55], v5
  ds_read_b128 v[48:51], v3 offset:8192
  s_waitcnt lgkmcnt(4)
  v_smfmac_f32_16x16x64_bf16 v[36:39], v[20:23], v[56:63], v5
  ds_read_b128 v[52:55], v3 offset:9216
  v_smfmac_f32_16x16x64_bf16 v[40:43], v[20:23], v[232:239], v5
  ds_read_b128 v[56:59], v3 offset:16384
  v_smfmac_f32_16x16x64_bf16 v[44:47], v[20:23], v[240:247], v5
  ds_read_b128 v[60:63], v3 offset:17408
  s_waitcnt lgkmcnt(4)
  v_smfmac_f32_16x16x64_bf16 v[24:27], v[16:19], v[136:143], v5
  ds_read_b128 v[20:23], v1 offset:13312
  v_smfmac_f32_16x16x64_bf16 v[28:31], v[16:19], v[144:151], v5
  v_smfmac_f32_16x16x64_bf16 v[32:35], v[16:19], v[64:71], v5
  ds_read_b128 v[64:67], v3 offset:24576
  s_waitcnt lgkmcnt(4)
  v_smfmac_f32_16x16x64_bf16 v[36:39], v[16:19], v[48:55], v5
  ds_read_b128 v[68:71], v3 offset:25600
  v_smfmac_f32_16x16x64_bf16 v[40:43], v[16:19], a[24:31], v5
  ds_read_b128 v[48:51], v3 offset:32768
  v_smfmac_f32_16x16x64_bf16 v[44:47], v[16:19], a[32:39], v5
  ds_read_b128 v[52:55], v3 offset:33792
  s_waitcnt lgkmcnt(4)
  v_smfmac_f32_16x16x64_bf16 v[24:27], v[20:23], v[152:159], v5
  ds_read_b128 v[16:19], v1 offset:14336
  v_smfmac_f32_16x16x64_bf16 v[28:31], v[20:23], v[160:167], v5
  v_smfmac_f32_16x16x64_bf16 v[32:35], v[20:23], v[56:63], v5
  ds_read_b128 v[56:59], v3 offset:40960
  ds_read_b128 v[60:63], v3 offset:41984
  s_waitcnt lgkmcnt(5)
  v_smfmac_f32_16x16x64_bf16 v[36:39], v[20:23], v[64:71], v5
  ds_read_b128 v[64:67], v3 offset:49152
  ds_read_b128 v[68:71], v3 offset:50176
  s_waitcnt lgkmcnt(4)
  v_smfmac_f32_16x16x64_bf16 v[24:27], v[16:19], v[168:175], v5
  ds_read_b128 v[20:23], v1 offset:15360
  v_smfmac_f32_16x16x64_bf16 v[28:31], v[16:19], v[176:183], v5
  v_smfmac_f32_16x16x64_bf16 v[32:35], v[16:19], v[48:55], v5
  ds_read_b128 v[48:51], v3 offset:57344
  ds_read_b128 v[52:55], v3 offset:58368
  s_waitcnt lgkmcnt(5)
  v_smfmac_f32_16x16x64_bf16 v[36:39], v[16:19], v[56:63], v5
  ds_read_b128 v[56:59], v4 offset:0
  ds_read_b128 v[60:63], v4 offset:1024
  s_waitcnt lgkmcnt(4)
  v_smfmac_f32_16x16x64_bf16 v[24:27], v[20:23], v[184:191], v5
  ds_read_b128 v[16:19], v1 offset:16384
  v_smfmac_f32_16x16x64_bf16 v[28:31], v[20:23], v[192:199], v5
  v_smfmac_f32_16x16x64_bf16 v[32:35], v[20:23], v[64:71], v5
  ds_read_b128 v[64:67], v1 offset:13312
  s_waitcnt lgkmcnt(4)
  v_smfmac_f32_16x16x64_bf16 v[36:39], v[20:23], v[48:55], v5
  ds_read_b128 v[68:71], v1 offset:14336
  s_waitcnt lgkmcnt(2)
  v_smfmac_f32_16x16x64_bf16 v[24:27], v[16:19], v[200:207], v5
  v_smfmac_f32_16x16x64_bf16 v[28:31], v[16:19], v[208:215], v5
  v_smfmac_f32_16x16x64_bf16 v[32:35], v[16:19], v[56:63], v5
  v_smfmac_f32_16x16x64_bf16 v[36:39], v[16:19], a[104:111], v5
  v_smfmac_f32_16x16x64_bf16 v[40:43], v[16:19], a[88:95], v5
  ds_read_b128 v[48:51], v1 offset:23552
  v_smfmac_f32_16x16x64_bf16 v[44:47], v[16:19], a[96:103], v5
  ds_read_b128 v[52:55], v1 offset:24576
  s_nop 0
  v_add_f32 v24, v24, v26
  v_add_f32 v25, v25, v27
  v_add_f32 v28, v28, v30
  v_add_f32 v29, v29, v31
  v_cvt_pk_bf16_f32 v24, v24, v25
  v_cvt_pk_bf16_f32 v28, v28, v29
  ds_write2_b32 v6, v24, v28 offset0:0 offset1:64
  v_add_f32 v32, v32, v34
  v_add_f32 v33, v33, v35
  v_add_f32 v36, v36, v38
  v_add_f32 v37, v37, v39
  v_cvt_pk_bf16_f32 v14, v32, v33
  v_cvt_pk_bf16_f32 v15, v36, v37
  ds_write2_b32 v7, v14, v14 offset0:0 offset1:1
  ds_write2_b32 v7, v15, v15 offset0:128 offset1:129
  v_smfmac_f32_16x16x64_bf16 v[40:43], v[20:23], a[72:79], v5
  ds_read_b128 v[56:59], v1 offset:25600
  v_smfmac_f32_16x16x64_bf16 v[44:47], v[20:23], a[80:87], v5
  ds_read_b128 v[60:63], v1 offset:26624
  s_waitcnt lgkmcnt(8)
  v_smfmac_f32_16x16x64_bf16 v[40:43], v[64:67], a[40:47], v5
  v_smfmac_f32_16x16x64_bf16 v[44:47], v[64:67], a[48:55], v5
  s_waitcnt lgkmcnt(7)
  v_smfmac_f32_16x16x64_bf16 v[40:43], v[68:71], a[56:63], v5
  v_smfmac_f32_16x16x64_bf16 v[44:47], v[68:71], a[64:71], v5
  s_branch p1j_84
p1w_87:
  ds_read_b128 v[64:67], v3 offset:16384
  ds_read_b128 v[68:71], v3 offset:17408
  s_waitcnt lgkmcnt(4)
  s_cmp_eq_u32 s17, 3
  s_cbranch_scc0 kf_93
  buffer_load_dword v12, off, s[4:7], s82 sc1
kf_93:
  v_smfmac_f32_16x16x64_bf16 v[24:27], v[16:19], v[136:143], v5
  v_smfmac_f32_16x16x64_bf16 v[28:31], v[16:19], v[144:151], v5
  buffer_load_dword v13, v1, s[4:7], s45 offen offset:0 sc1
  v_smfmac_f32_16x16x64_bf16 v[32:35], v[16:19], v[48:55], v5
  ds_read_b128 v[48:51], v3 offset:24576
  v_smfmac_f32_16x16x64_bf16 v[36:39], v[16:19], v[56:63], v5
  ds_read_b128 v[52:55], v3 offset:25600
  v_smfmac_f32_16x16x64_bf16 v[40:43], v[16:19], a[24:31], v5
  ds_read_b128 v[56:59], v2 offset:0
  v_smfmac_f32_16x16x64_bf16 v[44:47], v[16:19], a[32:39], v5
  ds_read_b128 v[60:63], v2 offset:1024
  v_smfmac_f32_16x16x64_bf16 v[24:27], v[20:23], v[152:159], v5
  s_waitcnt lgkmcnt(6)
  s_barrier
  s_cmp_eq_u32 s17, 3
  s_cbranch_scc0 pf_94
  s_mov_b64 exec, 1
  v_mov_b32 v14, s18
  buffer_store_dword v14, off, s[4:7], s99 sc1
  s_mov_b64 exec, -1
pf_94:
  ds_read_b128 v[16:19], v1 offset:8192
  v_smfmac_f32_16x16x64_bf16 v[28:31], v[20:23], v[160:167], v5
  buffer_load_dword v13, v1, s[4:7], s45 offen offset:1024 sc1
  s_waitcnt lgkmcnt(5)
  v_smfmac_f32_16x16x64_bf16 v[32:35], v[20:23], v[64:71], v5
  ds_read_b128 v[64:67], v2 offset:8192
  s_waitcnt lgkmcnt(4)
  v_smfmac_f32_16x16x64_bf16 v[36:39], v[20:23], v[48:55], v5
  ds_read_b128 v[68:71], v2 offset:9216
  v_smfmac_f32_16x16x64_bf16 v[40:43], v[20:23], a[40:47], v5
  ds_read_b128 v[48:51], v2 offset:16384
  v_smfmac_f32_16x16x64_bf16 v[44:47], v[20:23], a[48:55], v5
  ds_read_b128 v[52:55], v2 offset:17408
  s_waitcnt lgkmcnt(4)
  v_smfmac_f32_16x16x64_bf16 v[24:27], v[16:19], v[72:79], v5
  ds_read_b128 v[20:23], v1 offset:9216
  v_smfmac_f32_16x16x64_bf16 v[28:31], v[16:19], v[80:87], v5
  buffer_load_dword v13, v1, s[4:7], s45 offen offset:2048 sc1
  v_smfmac_f32_16x16x64_bf16 v[32:35], v[16:19], v[56:63], v5
  ds_read_b128 v[56:59], v2 offset:24576
  s_waitcnt lgkmcnt(4)
  v_smfmac_f32_16x16x64_bf16 v[36:39], v[16:19], v[64:71], v5
  ds_read_b128 v[60:63], v2 offset:25600
  v_smfmac_f32_16x16x64_bf16 v[40:43], v[16:19], v[216:223], v5
  ds_read_b128 v[64:67], v2 offset:32768
  v_smfmac_f32_16x16x64_bf16 v[44:47], v[16:19], v[224:231], v5
  ds_read_b128 v[68:71], v2 offset:33792
  s_waitcnt lgkmcnt(4)
  v_smfmac_f32_16x16x64_bf16 v[24:27], v[20:23], v[88:95], v5
  ds_read_b128 v[16:19], v1 offset:10240
  v_smfmac_f32_16x16x64_bf16 v[28:31], v[20:23], v[96:103], v5
  buffer_load_dword v13, v1, s[4:7], s45 offen offset:3072 sc1
  v_smfmac_f32_16x16x64_bf16 v[32:35], v[20:23], v[48:55], v5
  ds_read_b128 v[48:51], v2 offset:40960
  s_waitcnt lgkmcnt(4)
  v_smfmac_f32_16x16x64_bf16 v[36:39], v[20:23], v[56:63], v5
  ds_read_b128 v[52:55], v2 offset:41984
  v_smfmac_f32_16x16x64_bf16 v[40:43], v[20:23], v[232:239], v5
  ds_read_b128 v[56:59], v2 offset:49152
  v_smfmac_f32_16x16x64_bf16 v[44:47], v[20:23], v[240:247], v5
  ds_read_b128 v[60:63], v2 offset:50176
  s_waitcnt lgkmcnt(4)
  v_smfmac_f32_16x16x64_bf16 v[24:27], v[16:19], v[104:111], v5
  ds_read_b128 v[20:23], v1 offset:11264
  v_smfmac_f32_16x16x64_bf16 v[28:31], v[16:19], v[112:119], v5
  v_smfmac_f32_16x16x64_bf16 v[32:35], v[16:19], v[64:71], v5
  ds_read_b128 v[64:67], v2 offset:57344
  s_waitcnt lgkmcnt(4)
  v_smfmac_f32_16x16x64_bf16 v[36:39], v[16:19], v[48:55], v5
  ds_read_b128 v[68:71], v2 offset:58368
  v_smfmac_f32_16x16x64_bf16 v[40:43], v[16:19], v[248:255], v5
  ds_read_b128 v[48:51], v3 offset:32768
  v_smfmac_f32_16x16x64_bf16 v[44:47], v[16:19], a[0:7], v5
  ds_read_b128 v[52:55], v3 offset:33792
  s_waitcnt lgkmcnt(4)
  v_smfmac_f32_16x16x64_bf16 v[24:27], v[20:23], v[120:127], v5
  ds_read_b128 v[16:19], v1 offset:14336
  v_smfmac_f32_16x16x64_bf16 v[28:31], v[20:23], v[128:135], v5
  v_smfmac_f32_16x16x64_bf16 v[32:35], v[20:23], v[56:63], v5
  ds_read_b128 v[56:59], v3 offset:40960
  ds_read_b128 v[60:63], v3 offset:41984
  s_waitcnt lgkmcnt(5)
  v_smfmac_f32_16x16x64_bf16 v[36:39], v[20:23], v[64:71], v5
  ds_read_b128 v[64:67], v3 offset:49152
  ds_read_b128 v[68:71], v3 offset:50176
  s_waitcnt lgkmcnt(4)
  v_smfmac_f32_16x16x64_bf16 v[24:27], v[16:19], v[168:175], v5
  ds_read_b128 v[20:23], v1 offset:15360
  v_smfmac_f32_16x16x64_bf16 v[28:31], v[16:19], v[176:183], v5
  v_smfmac_f32_16x16x64_bf16 v[32:35], v[16:19], v[48:55], v5
  ds_read_b128 v[48:51], v3 offset:57344
  ds_read_b128 v[52:55], v3 offset:58368
  s_waitcnt lgkmcnt(5)
  v_smfmac_f32_16x16x64_bf16 v[36:39], v[16:19], v[56:63], v5
  ds_read_b128 v[56:59], v4 offset:0
  ds_read_b128 v[60:63], v4 offset:1024
  s_waitcnt lgkmcnt(4)
  v_smfmac_f32_16x16x64_bf16 v[24:27], v[20:23], v[184:191], v5
  ds_read_b128 v[16:19], v1 offset:16384
  v_smfmac_f32_16x16x64_bf16 v[28:31], v[20:23], v[192:199], v5
  v_smfmac_f32_16x16x64_bf16 v[32:35], v[20:23], v[64:71], v5
  ds_read_b128 v[64:67], v1 offset:11264
  s_waitcnt lgkmcnt(4)
  v_smfmac_f32_16x16x64_bf16 v[36:39], v[20:23], v[48:55], v5
  ds_read_b128 v[68:71], v1 offset:14336
  s_waitcnt lgkmcnt(2)
  v_smfmac_f32_16x16x64_bf16 v[24:27], v[16:19], v[200:207], v5
  v_smfmac_f32_16x16x64_bf16 v[28:31], v[16:19], v[208:215], v5
  v_smfmac_f32_16x16x64_bf16 v[32:35], v[16:19], v[56:63], v5
  v_smfmac_f32_16x16x64_bf16 v[36:39], v[16:19], a[104:111], v5
  v_smfmac_f32_16x16x64_bf16 v[40:43], v[16:19], a[88:95], v5
  ds_read_b128 v[48:51], v1 offset:23552
  v_smfmac_f32_16x16x64_bf16 v[44:47], v[16:19], a[96:103], v5
  ds_read_b128 v[52:55], v1 offset:24576
  s_nop 0
  v_add_f32 v24, v24, v26
  v_add_f32 v25, v25, v27
  v_add_f32 v28, v28, v30
  v_add_f32 v29, v29, v31
  v_cvt_pk_bf16_f32 v24, v24, v25
  v_cvt_pk_bf16_f32 v28, v28, v29
  ds_write2_b32 v6, v24, v28 offset0:0 offset1:64
  v_add_f32 v32, v32, v34
  v_add_f32 v33, v33, v35
  v_add_f32 v36, v36, v38
  v_add_f32 v37, v37, v39
  v_cvt_pk_bf16_f32 v14, v32, v33
  v_cvt_pk_bf16_f32 v15, v36, v37
  ds_write2_b32 v7, v14, v14 offset0:0 offset1:1
  ds_write2_b32 v7, v15, v15 offset0:128 offset1:129
  v_smfmac_f32_16x16x64_bf16 v[40:43], v[20:23], a[72:79], v5
  ds_read_b128 v[56:59], v1 offset:25600
  v_smfmac_f32_16x16x64_bf16 v[44:47], v[20:23], a[80:87], v5
  ds_read_b128 v[60:63], v1 offset:26624
  s_waitcnt lgkmcnt(8)
  v_smfmac_f32_16x16x64_bf16 v[40:43], v[64:67], a[8:15], v5
  v_smfmac_f32_16x16x64_bf16 v[44:47], v[64:67], a[16:23], v5
  s_waitcnt lgkmcnt(7)
  v_smfmac_f32_16x16x64_bf16 v[40:43], v[68:71], a[56:63], v5
  v_smfmac_f32_16x16x64_bf16 v[44:47], v[68:71], a[64:71], v5
  s_branch p1j_84
p1w_88:
  ds_read_b128 v[64:67], v3 offset:49152
  ds_read_b128 v[68:71], v3 offset:50176
  s_waitcnt lgkmcnt(4)
  s_cmp_eq_u32 s17, 3
  s_cbranch_scc0 kf_95
  buffer_load_dword v12, off, s[4:7], s82 sc1
kf_95:
  v_smfmac_f32_16x16x64_bf16 v[24:27], v[16:19], v[168:175], v5
  v_smfmac_f32_16x16x64_bf16 v[28:31], v[16:19], v[176:183], v5
  buffer_load_dword v13, v1, s[4:7], s45 offen offset:0 sc1
  v_smfmac_f32_16x16x64_bf16 v[32:35], v[16:19], v[48:55], v5
  ds_read_b128 v[48:51], v3 offset:57344
  v_smfmac_f32_16x16x64_bf16 v[36:39], v[16:19], v[56:63], v5
  ds_read_b128 v[52:55], v3 offset:58368
  v_smfmac_f32_16x16x64_bf16 v[40:43], v[16:19], a[56:63], v5
  ds_read_b128 v[56:59], v2 offset:0
  v_smfmac_f32_16x16x64_bf16 v[44:47], v[16:19], a[64:71], v5
  ds_read_b128 v[60:63], v2 offset:1024
  v_smfmac_f32_16x16x64_bf16 v[24:27], v[20:23], v[184:191], v5
  s_waitcnt lgkmcnt(6)
  s_barrier
  s_cmp_eq_u32 s17, 3
  s_cbranch_scc0 pf_96
  s_mov_b64 exec, 1
  v_mov_b32 v14, s18
  buffer_store_dword v14, off, s[4:7], s99 sc1
  s_mov_b64 exec, -1
pf_96:
  ds_read_b128 v[16:19], v1 offset:8192
  v_smfmac_f32_16x16x64_bf16 v[28:31], v[20:23], v[192:199], v5
  buffer_load_dword v13, v1, s[4:7], s45 offen offset:1024 sc1
  s_waitcnt lgkmcnt(5)
  v_smfmac_f32_16x16x64_bf16 v[32:35], v[20:23], v[64:71], v5
  ds_read_b128 v[64:67], v2 offset:8192
  s_waitcnt lgkmcnt(4)
  v_smfmac_f32_16x16x64_bf16 v[36:39], v[20:23], v[48:55], v5
  ds_read_b128 v[68:71], v2 offset:9216
  v_smfmac_f32_16x16x64_bf16 v[40:43], v[20:23], a[72:79], v5
  ds_read_b128 v[48:51], v2 offset:16384
  v_smfmac_f32_16x16x64_bf16 v[44:47], v[20:23], a[80:87], v5
  ds_read_b128 v[52:55], v2 offset:17408
  s_waitcnt lgkmcnt(4)
  v_smfmac_f32_16x16x64_bf16 v[24:27], v[16:19], v[72:79], v5
  ds_read_b128 v[20:23], v1 offset:9216
  v_smfmac_f32_16x16x64_bf16 v[28:31], v[16:19], v[80:87], v5
  buffer_load_dword v13, v1, s[4:7], s45 offen offset:2048 sc1
  v_smfmac_f32_16x16x64_bf16 v[32:35], v[16:19], v[56:63], v5
  ds_read_b128 v[56:59], v2 offset:24576
  s_waitcnt lgkmcnt(4)
  v_smfmac_f32_16x16x64_bf16 v[36:39], v[16:19], v[64:71], v5
  ds_read_b128 v[60:63], v2 offset:25600
  v_smfmac_f32_16x16x64_bf16 v[40:43], v[16:19], v[216:223], v5
  ds_read_b128 v[64:67], v2 offset:32768
  v_smfmac_f32_16x16x64_bf16 v[44:47], v[16:19], v[224:231], v5
  ds_read_b128 v[68:71], v2 offset:33792
  s_waitcnt lgkmcnt(4)
  v_smfmac_f32_16x16x64_bf16 v[24:27], v[20:23], v[88:95], v5
  ds_read_b128 v[16:19], v1 offset:10240
  v_smfmac_f32_16x16x64_bf16 v[28:31], v[20:23], v[96:103], v5
  buffer_load_dword v13, v1, s[4:7], s45 offen offset:3072 sc1
  v_smfmac_f32_16x16x64_bf16 v[32:35], v[20:23], v[48:55], v5
  ds_read_b128 v[48:51], v2 offset:40960
  s_waitcnt lgkmcnt(4)
  v_smfmac_f32_16x16x64_bf16 v[36:39], v[20:23], v[56:63], v5
  ds_read_b128 v[52:55], v2 offset:41984
  v_smfmac_f32_16x16x64_bf16 v[40:43], v[20:23], v[232:239], v5
  ds_read_b128 v[56:59], v2 offset:49152
  v_smfmac_f32_16x16x64_bf16 v[44:47], v[20:23], v[240:247], v5
  ds_read_b128 v[60:63], v2 offset:50176
  s_waitcnt lgkmcnt(4)
  v_smfmac_f32_16x16x64_bf16 v[24:27], v[16:19], v[104:111], v5
  ds_read_b128 v[20:23], v1 offset:11264
  v_smfmac_f32_16x16x64_bf16 v[28:31], v[16:19], v[112:119], v5
  v_smfmac_f32_16x16x64_bf16 v[32:35], v[16:19], v[64:71], v5
  ds_read_b128 v[64:67], v2 offset:57344
  s_waitcnt lgkmcnt(4)
  v_smfmac_f32_16x16x64_bf16 v[36:39], v[16:19], v[48:55], v5
  ds_read_b128 v[68:71], v2 offset:58368
  v_smfmac_f32_16x16x64_bf16 v[40:43], v[16:19], v[248:255], v5
  ds_read_b128 v[48:51], v3 offset:0
  v_smfmac_f32_16x16x64_bf16 v[44:47], v[16:19], a[0:7], v5
  ds_read_b128 v[52:55], v3 offset:1024
  s_waitcnt lgkmcnt(4)
  v_smfmac_f32_16x16x64_bf16 v[24:27], v[20:23], v[120:127], v5
  ds_read_b128 v[16:19], v1 offset:12288
  v_smfmac_f32_16x16x64_bf16 v[28:31], v[20:23], v[128:135], v5
  v_smfmac_f32_16x16x64_bf16 v[32:35], v[20:23], v[56:63], v5
  ds_read_b128 v[56:59], v3 offset:8192
  ds_read_b128 v[60:63], v3 offset:9216
  s_waitcnt lgkmcnt(5)
  v_smfmac_f32_16x16x64_bf16 v[36:39], v[20:23], v[64:71], v5
  ds_read_b128 v[64:67], v3 offset:16384
  ds_read_b128 v[68:71], v3 offset:17408
  s_waitcnt lgkmcnt(4)
  v_smfmac_f32_16x16x64_bf16 v[24:27], v[16:19], v[136:143], v5
  ds_read_b128 v[20:23], v1 offset:13312
  v_smfmac_f32_16x16x64_bf16 v[28:31], v[16:19], v[144:151], v5
  v_smfmac_f32_16x16x64_bf16 v[32:35], v[16:19], v[48:55], v5
  ds_read_b128 v[48:51], v3 offset:24576
  ds_read_b128 v[52:55], v3 offset:25600
  s_waitcnt lgkmcnt(5)
  v_smfmac_f32_16x16x64_bf16 v[36:39], v[16:19], v[56:63], v5
  ds_read_b128 v[56:59], v4 offset:0
  ds_read_b128 v[60:63], v4 offset:1024
  s_waitcnt lgkmcnt(4)
  v_smfmac_f32_16x16x64_bf16 v[24:27], v[20:23], v[152:159], v5
  ds_read_b128 v[16:19], v1 offset:16384
  v_smfmac_f32_16x16x64_bf16 v[28:31], v[20:23], v[160:167], v5
  v_smfmac_f32_16x16x64_bf16 v[32:35], v[20:23], v[64:71], v5
  ds_read_b128 v[64:67], v1 offset:11264
  s_waitcnt lgkmcnt(4)
  v_smfmac_f32_16x16x64_bf16 v[36:39], v[20:23], v[48:55], v5
  ds_read_b128 v[68:71], v1 offset:12288
  s_waitcnt lgkmcnt(2)
  v_smfmac_f32_16x16x64_bf16 v[24:27], v[16:19], v[200:207], v5
  v_smfmac_f32_16x16x64_bf16 v[28:31], v[16:19], v[208:215], v5
  v_smfmac_f32_16x16x64_bf16 v[32:35], v[16:19], v[56:63], v5
  v_smfmac_f32_16x16x64_bf16 v[36:39], v[16:19], a[104:111], v5
  v_smfmac_f32_16x16x64_bf16 v[40:43], v[16:19], a[88:95], v5
  ds_read_b128 v[48:51], v1 offset:23552
  v_smfmac_f32_16x16x64_bf16 v[44:47], v[16:19], a[96:103], v5
  ds_read_b128 v[52:55], v1 offset:24576
  s_nop 0
  v_add_f32 v24, v24, v26
  v_add_f32 v25, v25, v27
  v_add_f32 v28, v28, v30
  v_add_f32 v29, v29, v31
  v_cvt_pk_bf16_f32 v24, v24, v25
  v_cvt_pk_bf16_f32 v28, v28, v29
  ds_write2_b32 v6, v24, v28 offset0:0 offset1:64
  v_add_f32 v32, v32, v34
  v_add_f32 v33, v33, v35
  v_add_f32 v36, v36, v38
  v_add_f32 v37, v37, v39
  v_cvt_pk_bf16_f32 v14, v32, v33
  v_cvt_pk_bf16_f32 v15, v36, v37
  ds_write2_b32 v7, v14, v14 offset0:0 offset1:1
  ds_write2_b32 v7, v15, v15 offset0:128 offset1:129
  v_smfmac_f32_16x16x64_bf16 v[40:43], v[20:23], a[40:47], v5
  ds_read_b128 v[56:59], v1 offset:25600
  v_smfmac_f32_16x16x64_bf16 v[44:47], v[20:23], a[48:55], v5
  ds_read_b128 v[60:63], v1 offset:26624
  s_waitcnt lgkmcnt(8)
  v_smfmac_f32_16x16x64_bf16 v[40:43], v[64:67], a[8:15], v5
  v_smfmac_f32_16x16x64_bf16 v[44:47], v[64:67], a[16:23], v5
  s_waitcnt lgkmcnt(7)
  v_smfmac_f32_16x16x64_bf16 v[40:43], v[68:71], a[24:31], v5
  v_smfmac_f32_16x16x64_bf16 v[44:47], v[68:71], a[32:39], v5
p1j_84:
  s_waitcnt lgkmcnt(2)
  s_barrier
  ds_read_b64_tr_b16 v[16:17], v8 offset:0
  ds_read_b64_tr_b16 v[18:19], v8 offset:128
  ds_read_b64_tr_b16 v[20:21], v9 offset:0
  ds_read_b64_tr_b16 v[22:23], v9 offset:256
  ds_read_b64_tr_b16 v[36:37], v8 offset:512
  ds_read_b64_tr_b16 v[38:39], v8 offset:640
  ds_read_b128 v[64:67], v1 offset:27648
  ds_read_b128 v[68:71], v1 offset:28672
  v_add_f32 v40, v40, v42
  v_add_f32 v41, v41, v43
  v_add_f32 v44, v44, v46
  v_add_f32 v45, v45, v47
  v_cvt_pk_bf16_f32 v40, v40, v41
  v_cvt_pk_bf16_f32 v41, v44, v45
  ds_read_b64_tr_b16 v[44:45], v9 offset:1024
  ds_read_b64_tr_b16 v[46:47], v9 offset:1280
  s_waitcnt lgkmcnt(8)
  v_mfma_f32_16x16x32_bf16 v[24:27], v[48:51], v[16:19], 0
  v_mfma_f32_16x16x32_bf16 v[28:31], v[52:55], v[16:19], 0
  s_waitcnt lgkmcnt(6)
  v_mfma_f32_16x16x32_bf16 v[32:35], v[20:23], v[16:19], 0
  buffer_load_dwordx4 v[48:51], v1, s[4:7], s37 offen sc1
  buffer_load_dwordx4 v[52:55], v1, s[4:7], s37 offen offset:1024 sc1
  v_lshrrev_b32 v43, 1, v1
  buffer_store_dwordx2 v[14:15], v43, s[4:7], s38 offen sc1
  buffer_store_dwordx2 v[40:41], v43, s[4:7], s39 offen sc1
  ds_read_b64_tr_b16 v[16:17], v8 offset:1024
  ds_read_b64_tr_b16 v[18:19], v8 offset:1152
  ds_read_b64_tr_b16 v[20:21], v9 offset:2048
  ds_read_b64_tr_b16 v[22:23], v9 offset:2304
  s_waitcnt lgkmcnt(8)
  v_mfma_f32_16x16x32_bf16 v[24:27], v[56:59], v[36:39], v[24:27]
  v_mfma_f32_16x16x32_bf16 v[28:31], v[60:63], v[36:39], v[28:31]
  s_waitcnt lgkmcnt(4)
  v_mfma_f32_16x16x32_bf16 v[32:35], v[44:47], v[36:39], v[32:35]
  ds_read_b128 v[56:59], v1 offset:29696
  ds_read_b128 v[60:63], v1 offset:30720
  ds_read_b64_tr_b16 v[36:37], v8 offset:1536
  ds_read_b64_tr_b16 v[38:39], v8 offset:1664
  ds_read_b64_tr_b16 v[44:45], v9 offset:3072
  ds_read_b64_tr_b16 v[46:47], v9 offset:3328
  s_waitcnt lgkmcnt(8)
  v_mfma_f32_16x16x32_bf16 v[24:27], v[64:67], v[16:19], v[24:27]
  v_mfma_f32_16x16x32_bf16 v[28:31], v[68:71], v[16:19], v[28:31]
  s_waitcnt lgkmcnt(6)
  v_mfma_f32_16x16x32_bf16 v[32:35], v[20:23], v[16:19], v[32:35]
  v_mov_b32 v16, 0x3f803f80
  v_mov_b32 v17, 0x3f803f80
  v_mov_b32 v18, 0x3f803f80
  v_mov_b32 v19, 0x3f803f80
  s_waitcnt lgkmcnt(2)
  v_mfma_f32_16x16x32_bf16 v[24:27], v[56:59], v[36:39], v[24:27]
  v_mov_b32 v21, 0
  v_mfma_f32_16x16x32_bf16 v[28:31], v[60:63], v[36:39], v[28:31]
  v_mov_b32 v22, 0
  s_waitcnt lgkmcnt(0)
  v_mfma_f32_16x16x32_bf16 v[32:35], v[44:47], v[36:39], v[32:35]
  s_nop 2
  v_max3_f32 v42, v24, v25, v26
  s_nop 0
  v_max3_f32 v14, v28, v29, v30
  v_max3_f32 v42, v42, v27, v31
  v_max_f32 v42, v42, v14
  v_max3_f32 v42, v42, v32, v33
  v_mov_b32 v14, v42
  s_nop 1
  v_permlane16_swap_b32 v42, v14
  v_max_f32 v42, v42, v14
  v_mov_b32 v14, v42
  s_nop 1
  v_permlane32_swap_b32 v42, v14
  v_max_f32 v42, v42, v14
  v_mul_f32 v14, s40, v42
  v_pk_fma_f32 v[24:25], v[24:25], s[40:41], v[14:15] op_sel_hi:[1,1,0] neg_lo:[0,0,1] neg_hi:[0,0,1]
  v_pk_fma_f32 v[26:27], v[26:27], s[40:41], v[14:15] op_sel_hi:[1,1,0] neg_lo:[0,0,1] neg_hi:[0,0,1]
  v_pk_fma_f32 v[28:29], v[28:29], s[40:41], v[14:15] op_sel_hi:[1,1,0] neg_lo:[0,0,1] neg_hi:[0,0,1]
  v_pk_fma_f32 v[30:31], v[30:31], s[40:41], v[14:15] op_sel_hi:[1,1,0] neg_lo:[0,0,1] neg_hi:[0,0,1]
  v_pk_fma_f32 v[32:33], v[32:33], s[40:41], v[14:15] op_sel_hi:[1,1,0] neg_lo:[0,0,1] neg_hi:[0,0,1]
  v_exp_f32 v24, v24
  v_exp_f32 v25, v25
  v_exp_f32 v26, v26
  v_exp_f32 v27, v27
  v_exp_f32 v28, v28
  v_exp_f32 v29, v29
  v_exp_f32 v30, v30
  v_exp_f32 v31, v31
  v_exp_f32 v32, v32
  v_exp_f32 v33, v33
  v_cvt_pk_bf16_f32 v56, v24, v25
  v_cvt_pk_bf16_f32 v57, v26, v27
  v_cvt_pk_bf16_f32 v58, v28, v29
  v_cvt_pk_bf16_f32 v59, v30, v31
  v_cvt_pk_bf16_f32 v20, v32, v33
  v_cvt_pk_bf16_f32 v23, v32, v33
  v_mfma_f32_16x16x32_bf16 v[32:35], v[16:19], v[56:59], 0
  s_waitcnt vmcnt(3)
  v_mfma_f32_16x16x32_bf16 v[24:27], v[48:51], v[56:59], 0
  s_waitcnt vmcnt(2)
  v_mfma_f32_16x16x32_bf16 v[28:31], v[52:55], v[56:59], 0
  v_mfma_f32_16x16x16_bf16 v[32:35], v[16:17], v[20:21], v[32:35]
  v_mfma_f32_16x16x16_bf16 v[24:27], v[40:41], v[20:21], v[24:27]
  v_mfma_f32_16x16x16_bf16 v[28:31], v[40:41], v[22:23], v[28:31]
  v_mov_b64 v[36:37], 0
  v_mov_b64 v[38:39], 0
  v_mov_b64 v[40:41], 0
  v_mov_b64 v[42:43], 0
  v_mov_b64 v[44:45], 0
  v_mov_b64 v[46:47], 0
  v_rcp_f32 v13, v32
  v_mov_b64 v[48:49], 0
  v_mul_f32 v24, v13, v24
  v_mul_f32 v25, v13, v25
  v_mul_f32 v26, v13, v26
  v_mul_f32 v27, v13, v27
  v_cvt_pk_bf16_f32 v24, v24, v25
  v_cvt_pk_bf16_f32 v25, v26, v27
  v_mul_f32 v28, v13, v28
  v_mul_f32 v29, v13, v29
  v_mul_f32 v30, v13, v30
  v_mul_f32 v31, v13, v31
  v_cvt_pk_bf16_f32 v26, v28, v29
  v_cvt_pk_bf16_f32 v27, v30, v31
  s_mov_b64 exec, s[42:43]
  ds_write_b128 v10, v[24:27]
  s_mov_b64 exec, -1
  v_mov_b64 v[50:51], 0
  v_mov_b64 v[52:53], 0
  v_mov_b64 v[54:55], 0
  v_mov_b64 v[56:57], 0
  v_mov_b64 v[58:59], 0
  v_mov_b64 v[60:61], 0
  v_mov_b64 v[62:63], 0
  v_mov_b64 v[64:65], 0
  v_mov_b64 v[66:67], 0
  v_mov_b64 v[68:69], 0
  v_mov_b64 v[70:71], 0
  s_waitcnt lgkmcnt(0)
  s_barrier
  ds_read_b128 v[16:19], v1 offset:8192
  ds_read_b128 v[20:23], v1 offset:9216
  s_waitcnt lgkmcnt(1)
  v_smfmac_f32_16x16x64_bf16 v[36:39], v[16:19], a[112:119], v5
  s_waitcnt lgkmcnt(0)
  v_smfmac_f32_16x16x64_bf16 v[36:39], v[20:23], a[120:127], v5
  v_smfmac_f32_16x16x64_bf16 v[40:43], v[16:19], a[128:135], v5
  v_smfmac_f32_16x16x64_bf16 v[40:43], v[20:23], a[136:143], v5
  v_smfmac_f32_16x16x64_bf16 v[44:47], v[16:19], a[144:151], v5
  v_smfmac_f32_16x16x64_bf16 v[44:47], v[20:23], a[152:159], v5
  v_smfmac_f32_16x16x64_bf16 v[48:51], v[16:19], a[160:167], v5
  s_nop 2
  v_add_f32 v36, v36, v38
  v_add_f32 v37, v37, v39
  v_smfmac_f32_16x16x64_bf16 v[48:51], v[20:23], a[168:175], v5
  v_cvt_pk_bf16_f32 v24, v36, v37
  v_or_b32 v24, 1, v24
  v_smfmac_f32_16x16x64_bf16 v[52:55], v[16:19], a[176:183], v5
  v_add_f32 v40, v40, v42
  v_add_f32 v41, v41, v43
  v_smfmac_f32_16x16x64_bf16 v[52:55], v[20:23], a[184:191], v5
  v_cvt_pk_bf16_f32 v25, v40, v41
  v_or_b32 v25, 1, v25
  v_smfmac_f32_16x16x64_bf16 v[56:59], v[16:19], a[192:199], v5
  v_add_f32 v44, v44, v46
  v_add_f32 v45, v45, v47
  v_smfmac_f32_16x16x64_bf16 v[56:59], v[20:23], a[200:207], v5
  v_cvt_pk_bf16_f32 v26, v44, v45
  v_or_b32 v26, 1, v26
  v_smfmac_f32_16x16x64_bf16 v[60:63], v[16:19], a[208:215], v5
  v_add_f32 v48, v48, v50
  v_add_f32 v49, v49, v51
  v_smfmac_f32_16x16x64_bf16 v[60:63], v[20:23], a[216:223], v5
  v_cvt_pk_bf16_f32 v27, v48, v49
  v_or_b32 v27, 1, v27
  v_smfmac_f32_16x16x64_bf16 v[64:67], v[16:19], a[224:231], v5
  buffer_store_dwordx4 v[24:27], v1, s[4:7], s21 offen offset:0 sc1
  v_add_f32 v52, v52, v54
  v_smfmac_f32_16x16x64_bf16 v[64:67], v[20:23], a[232:239], v5
  v_add_f32 v53, v53, v55
  v_cvt_pk_bf16_f32 v28, v52, v53
  v_smfmac_f32_16x16x64_bf16 v[68:71], v[16:19], a[240:247], v5
  v_or_b32 v28, 1, v28
  v_add_f32 v56, v56, v58
  v_smfmac_f32_16x16x64_bf16 v[68:71], v[20:23], a[248:255], v5
  v_add_f32 v57, v57, v59
  v_cvt_pk_bf16_f32 v29, v56, v57
  ds_read_b128 v[16:19], v1 offset:31744
  v_or_b32 v29, 1, v29
  v_add_f32 v60, v60, v62
  v_add_f32 v61, v61, v63
  v_cvt_pk_bf16_f32 v30, v60, v61
  v_or_b32 v30, 1, v30
  v_add_f32 v64, v64, v66
  v_add_f32 v65, v65, v67
  v_cvt_pk_bf16_f32 v31, v64, v65
  v_or_b32 v31, 1, v31
  buffer_store_dwordx4 v[28:31], v1, s[4:7], s21 offen offset:1024 sc1
  v_add_f32 v68, v68, v70
  v_add_f32 v69, v69, v71
  v_cvt_pk_bf16_f32 v32, v68, v69
  v_or_b32 v32, 1, v32
  buffer_store_dword v32, v6, s[4:7], s59 offen sc1
  s_cmp_eq_u32 s25, -1
  s_cbranch_scc1 nored_97
  s_mov_b32 s29, 0
  v_mov_b64 v[24:25], 0
  v_mov_b64 v[26:27], 0
  v_mov_b64 v[28:29], 0
  v_mov_b64 v[30:31], 0
  v_mov_b64 v[32:33], 0
  v_mov_b64 v[34:35], 0
  v_mov_b64 v[36:37], 0
  v_mov_b64 v[38:39], 0
  v_mov_b64 v[40:41], 0
  v_mov_b64 v[42:43], 0
  v_mov_b64 v[44:45], 0
  v_mov_b64 v[46:47], 0
  s_add_u32 s19, s23, s26
  s_add_u32 s20, s22, s26
  s_mov_b32 s58, s23
  s_mov_b32 s27, s22
  s_mov_b32 s22, s23
  s_mov_b32 s23, s24
  s_mov_b32 s24, s27
  s_add_u32 s37, s37, 262144
  s_add_u32 s45, s45, 262144
  s_add_u32 s38, s38, 65536
  s_add_u32 s39, s39, 65536
  s_add_u32 s18, s18, 1
  s_add_u32 s100, s100, 1
  s_cmp_eq_u32 s100, 7
  s_cselect_b32 s100, 0, s100
  s_addc_u32 s101, s101, 0
  s_lshl_b32 s82, s100, 7
  s_add_u32 s82, s82, s81
  v_mov_b64 v[64:65], 0
  v_mov_b64 v[66:67], 0
  s_sleep 4
  buffer_load_dwordx4 v[48:51], v11, s[4:7], s46 offen sc1
  buffer_load_dwordx4 v[52:55], v11, s[4:7], s47 offen sc1
  buffer_load_dwordx4 v[56:59], v11, s[4:7], s48 offen sc1
  buffer_load_dwordx4 v[60:63], v11, s[4:7], s49 offen sc1
  s_waitcnt lgkmcnt(0)
  s_waitcnt vmcnt(3)
  v_mfma_f32_16x16x32_bf16 v[20:23], v[48:51], v[16:19], 0
  v_bitop3_b32 v13, v48, v49, v50 bitop3:0x80
  s_waitcnt vmcnt(2)
  v_mfma_f32_16x16x32_bf16 v[20:23], v[52:55], v[16:19], v[20:23]
  v_bitop3_b32 v13, v13, v51, v52 bitop3:0x80
  v_bitop3_b32 v13, v13, v53, v54 bitop3:0x80
  s_waitcnt vmcnt(1)
  v_mfma_f32_16x16x32_bf16 v[20:23], v[56:59], v[16:19], v[20:23]
  v_bitop3_b32 v13, v13, v55, v56 bitop3:0x80
  v_bitop3_b32 v13, v13, v57, v58 bitop3:0x80
  s_waitcnt vmcnt(0)
  v_mfma_f32_16x16x32_bf16 v[20:23], v[60:63], v[16:19], v[20:23]
  v_bitop3_b32 v13, v13, v59, v60 bitop3:0x80
  v_bitop3_b32 v13, v13, v61, v62 bitop3:0x80
  v_bitop3_b32 v13, v13, v63, v63 bitop3:0x80
  s_add_u32 s29, s29, 1
  v_and_b32 v13, 1, v13
  v_cmp_eq_u32 vcc, 0, v13
  s_cbranch_vccz redok_100
redp_99:
  buffer_load_dwordx4 v[48:51], v11, s[4:7], s46 offen sc1
  buffer_load_dwordx4 v[52:55], v11, s[4:7], s47 offen sc1
  buffer_load_dwordx4 v[56:59], v11, s[4:7], s48 offen sc1
  buffer_load_dwordx4 v[60:63], v11, s[4:7], s49 offen sc1
  s_add_u32 s29, s29, 1
  s_waitcnt vmcnt(3)
  v_mfma_f32_16x16x32_bf16 v[20:23], v[48:51], v[16:19], 0
  v_bitop3_b32 v13, v48, v49, v50 bitop3:0x80
  s_waitcnt vmcnt(2)
  v_mfma_f32_16x16x32_bf16 v[20:23], v[52:55], v[16:19], v[20:23]
  v_bitop3_b32 v13, v13, v51, v52 bitop3:0x80
  v_bitop3_b32 v13, v13, v53, v54 bitop3:0x80
  s_waitcnt vmcnt(1)
  v_mfma_f32_16x16x32_bf16 v[20:23], v[56:59], v[16:19], v[20:23]
  v_bitop3_b32 v13, v13, v55, v56 bitop3:0x80
  v_bitop3_b32 v13, v13, v57, v58 bitop3:0x80
  s_waitcnt vmcnt(0)
  v_mfma_f32_16x16x32_bf16 v[20:23], v[60:63], v[16:19], v[20:23]
  v_bitop3_b32 v13, v13, v59, v60 bitop3:0x80
  v_bitop3_b32 v13, v13, v61, v62 bitop3:0x80
  v_bitop3_b32 v13, v13, v63, v63 bitop3:0x80
  s_nop 0
  v_and_b32 v13, 1, v13
  v_cmp_eq_u32 vcc, 0, v13
  s_cbranch_vccz redok_100
  s_cmp_lg_u32 s44, 0
  s_cbranch_scc1 redok_100_d
  s_cmp_lt_u32 s29, 0x10000
  s_cbranch_scc1 redp_99
  s_mov_b32 s44, 1
redok_100_d:
  s_waitcnt vmcnt(0)
redok_100_m:
  v_mfma_f32_16x16x32_bf16 v[20:23], v[48:51], v[16:19], 0
  v_mfma_f32_16x16x32_bf16 v[20:23], v[52:55], v[16:19], v[20:23]
  v_mfma_f32_16x16x32_bf16 v[20:23], v[56:59], v[16:19], v[20:23]
  v_mfma_f32_16x16x32_bf16 v[20:23], v[60:63], v[16:19], v[20:23]
  s_nop 5
redok_100:
  s_nop 1
  v_permlane32_swap_b32 v20, v21
  v_permlane32_swap_b32 v22, v23
  v_add_f32 v20, v20, v21
  v_add_f32 v22, v22, v23
  v_cvt_pk_bf16_f32 v20, v20, v22
  s_mov_b64 exec, s[42:43]
  buffer_store_dword v20, v12, s[4:7], s19 offen sc1
  v_mov_b32 v22, -1
  buffer_store_dword v22, v12, s[4:7], s20 offen sc1
  s_mov_b64 exec, -1
  s_waitcnt vmcnt(2)
  s_add_u32 s76, s76, s29
  s_branch gat_98
nored_97:
  s_cmp_eq_u32 s17, 3
  s_cbranch_scc0 nkv_101
  s_cmp_lt_u32 s18, 62
  s_cbranch_scc0 nkv_101
  v_readfirstlane_b32 s29, v12
  s_nop 3
  s_cmp_gt_u32 s29, s101
  s_cbranch_scc1 nkv_101
  s_lshl_b32 s27, s100, 7
  s_lshl_b32 s28, s16, 2
  s_add_u32 s27, s27, s28
  s_add_u32 s27, s27, 2162816
  s_mov_b32 s28, 0
  v_mov_b32 v13, 0
kvw_102:
  buffer_load_dword v14, v13, s[4:7], s27 offen sc1
  s_add_u32 s28, s28, 1
  s_waitcnt vmcnt(0)
  v_readfirstlane_b32 s29, v14
  s_nop 3
  s_cmp_gt_u32 s29, s101
  s_cbranch_scc1 kvd_103
  s_sleep 2
  s_cmp_lg_u32 s44, 0
  s_cbranch_scc1 kvd_103
  s_cmp_lt_u32 s28, 0x40000
  s_cbranch_scc1 kvw_102
  s_mov_b32 s44, 1
kvd_103:
nkv_101:
  s_cmp_eq_u32 s17, 3
  s_cbranch_scc0 nkx_104
  s_add_u32 s36, s36, 262144
  s_mov_b32 m0, 154624
  s_add_u32 s29, s36, 4096
  buffer_load_dwordx4 v1, s[4:7], s36 offen offset:0 sc1 lds
  buffer_load_dwordx4 v1, s[4:7], s36 offen offset:1024 sc1 lds
  buffer_load_dwordx4 v1, s[4:7], s36 offen offset:2048 sc1 lds
  buffer_load_dwordx4 v1, s[4:7], s36 offen offset:3072 sc1 lds
  s_mov_b32 m0, 158720
  s_nop 0
  buffer_load_dwordx4 v1, s[4:7], s29 offen offset:0 sc1 lds
  buffer_load_dwordx4 v1, s[4:7], s29 offen offset:1024 sc1 lds
  buffer_load_dwordx4 v1, s[4:7], s29 offen offset:2048 sc1 lds
  buffer_load_dwordx4 v1, s[4:7], s29 offen offset:3072 sc1 lds
nkx_104:
  v_mov_b64 v[24:25], 0
  v_mov_b64 v[26:27], 0
  v_mov_b64 v[28:29], 0
  v_mov_b64 v[30:31], 0
  v_mov_b64 v[32:33], 0
  v_mov_b64 v[34:35], 0
  v_mov_b64 v[36:37], 0
  v_mov_b64 v[38:39], 0
  v_mov_b64 v[40:41], 0
  v_mov_b64 v[42:43], 0
  v_mov_b64 v[44:45], 0
  v_mov_b64 v[46:47], 0
  s_add_u32 s19, s23, s26
  s_add_u32 s20, s22, s26
  s_mov_b32 s58, s23
  s_mov_b32 s27, s22
  s_mov_b32 s22, s23
  s_mov_b32 s23, s24
  s_mov_b32 s24, s27
  s_add_u32 s37, s37, 262144
  s_add_u32 s45, s45, 262144
  s_add_u32 s38, s38, 65536
  s_add_u32 s39, s39, 65536
  s_add_u32 s18, s18, 1
  s_add_u32 s100, s100, 1
  s_cmp_eq_u32 s100, 7
  s_cselect_b32 s100, 0, s100
  s_addc_u32 s101, s101, 0
  s_lshl_b32 s82, s100, 7
  s_add_u32 s82, s82, s81
  v_mov_b64 v[64:65], 0
  v_mov_b64 v[66:67], 0
gat_98:
  s_lshl_b32 s27, s17, 15
  v_add_u32 v15, s27, v2
  ds_read_b128 v[48:51], v15 offset:0
  ds_read_b128 v[52:55], v15 offset:1024
  ds_read_b128 v[56:59], v15 offset:8192
  ds_read_b128 v[60:63], v15 offset:9216
  s_barrier
  s_mov_b32 s29, 0
  s_add_u32 s28, s58, 8192
  s_sleep 3
  buffer_load_dwordx4 v[16:19], v4, s[4:7], s58 offen sc1
  buffer_load_dwordx4 v[20:23], v4, s[4:7], s58 offen offset:1024 sc1
  s_cmp_eq_u32 s17, 3
  s_cbranch_scc0 gat3_109
  buffer_load_dwordx4 v[64:67], v1, s[4:7], s28 offen sc1
gat3_109:
  s_add_u32 s29, s29, 1
  s_waitcnt vmcnt(0)
  v_max3_u32 v13, v16, v17, v18
  v_max3_u32 v14, v20, v21, v22
  v_max3_u32 v13, v13, v19, v23
  v_max3_u32 v14, v14, v64, v65
  v_max3_u32 v13, v13, v66, v67
  v_max_u32 v13, v13, v14
  v_cmp_eq_u32 vcc, -1, v13
  s_cbranch_vccz gatok_106
gatp_105:
  buffer_load_dwordx4 v[16:19], v4, s[4:7], s58 offen sc1
  buffer_load_dwordx4 v[20:23], v4, s[4:7], s58 offen offset:1024 sc1
  s_cmp_eq_u32 s17, 3
  s_cbranch_scc0 gat3_110
  buffer_load_dwordx4 v[64:67], v1, s[4:7], s28 offen sc1
gat3_110:
  s_add_u32 s29, s29, 1
  s_waitcnt vmcnt(0)
  v_max3_u32 v13, v16, v17, v18
  v_max3_u32 v14, v20, v21, v22
  v_max3_u32 v13, v13, v19, v23
  v_max3_u32 v14, v14, v64, v65
  v_max3_u32 v13, v13, v66, v67
  v_max_u32 v13, v13, v14
  v_cmp_eq_u32 vcc, -1, v13
  s_cbranch_vccz gatok_106
  s_cmp_lg_u32 s44, 0
  s_cbranch_scc1 gatok_106
  s_cmp_lt_u32 s29, 0x10000
  s_cbranch_scc1 gatp_105
  s_mov_b32 s44, 1
gatok_106:
  ds_write_b128 v4, v[16:19] offset:8192
  ds_write_b128 v4, v[20:23] offset:9216
  s_cmp_eq_u32 s17, 3
  s_cbranch_scc0 gat3b_111
  ds_write_b128 v1, v[64:67] offset:16384
gat3b_111:
  s_add_u32 s77, s77, s29
  s_cmp_eq_u32 s17, 1
  s_cbranch_scc1 p1w_114
  s_cmp_eq_u32 s17, 2
  s_cbranch_scc1 p1w_115
  s_cmp_eq_u32 s17, 3
  s_cbranch_scc1 p1w_116
  ds_read_b128 v[64:67], v2 offset:16384
  ds_read_b128 v[68:71], v2 offset:17408
  s_waitcnt lgkmcnt(4)
  s_cmp_eq_u32 s17, 3
  s_cbranch_scc0 kf_117
  buffer_load_dword v12, off, s[4:7], s82 sc1
kf_117:
  v_smfmac_f32_16x16x64_bf16 v[24:27], v[16:19], v[72:79], v5
  v_smfmac_f32_16x16x64_bf16 v[28:31], v[16:19], v[80:87], v5
  buffer_load_dword v13, v1, s[4:7], s45 offen offset:0 sc1
  v_smfmac_f32_16x16x64_bf16 v[32:35], v[16:19], v[48:55], v5
  ds_read_b128 v[48:51], v2 offset:24576
  v_smfmac_f32_16x16x64_bf16 v[36:39], v[16:19], v[56:63], v5
  ds_read_b128 v[52:55], v2 offset:25600
  v_smfmac_f32_16x16x64_bf16 v[40:43], v[16:19], v[216:223], v5
  ds_read_b128 v[56:59], v2 offset:32768
  v_smfmac_f32_16x16x64_bf16 v[44:47], v[16:19], v[224:231], v5
  ds_read_b128 v[60:63], v2 offset:33792
  v_smfmac_f32_16x16x64_bf16 v[24:27], v[20:23], v[88:95], v5
  s_waitcnt lgkmcnt(6)
  s_barrier
  s_cmp_eq_u32 s17, 3
  s_cbranch_scc0 pf_118
  s_mov_b64 exec, 1
  v_mov_b32 v14, s18
  buffer_store_dword v14, off, s[4:7], s99 sc1
  s_mov_b64 exec, -1
pf_118:
  ds_read_b128 v[16:19], v1 offset:10240
  v_smfmac_f32_16x16x64_bf16 v[28:31], v[20:23], v[96:103], v5
  buffer_load_dword v13, v1, s[4:7], s45 offen offset:1024 sc1
  s_waitcnt lgkmcnt(5)
  v_smfmac_f32_16x16x64_bf16 v[32:35], v[20:23], v[64:71], v5
  ds_read_b128 v[64:67], v2 offset:40960
  s_waitcnt lgkmcnt(4)
  v_smfmac_f32_16x16x64_bf16 v[36:39], v[20:23], v[48:55], v5
  ds_read_b128 v[68:71], v2 offset:41984
  v_smfmac_f32_16x16x64_bf16 v[40:43], v[20:23], v[232:239], v5
  ds_read_b128 v[48:51], v2 offset:49152
  v_smfmac_f32_16x16x64_bf16 v[44:47], v[20:23], v[240:247], v5
  ds_read_b128 v[52:55], v2 offset:50176
  s_waitcnt lgkmcnt(4)
  v_smfmac_f32_16x16x64_bf16 v[24:27], v[16:19], v[104:111], v5
  ds_read_b128 v[20:23], v1 offset:11264
  v_smfmac_f32_16x16x64_bf16 v[28:31], v[16:19], v[112:119], v5
  buffer_load_dword v13, v1, s[4:7], s45 offen offset:2048 sc1
  v_smfmac_f32_16x16x64_bf16 v[32:35], v[16:19], v[56:63], v5
  ds_read_b128 v[56:59], v2 offset:57344
  s_waitcnt lgkmcnt(4)
  v_smfmac_f32_16x16x64_bf16 v[36:39], v[16:19], v[64:71], v5
  ds_read_b128 v[60:63], v2 offset:58368
  v_smfmac_f32_16x16x64_bf16 v[40:43], v[16:19], v[248:255], v5
  ds_read_b128 v[64:67], v3 offset:0
  v_smfmac_f32_16x16x64_bf16 v[44:47], v[16:19], a[0:7], v5
  ds_read_b128 v[68:71], v3 offset:1024
  s_waitcnt lgkmcnt(4)
  v_smfmac_f32_16x16x64_bf16 v[24:27], v[20:23], v[120:127], v5
  ds_read_b128 v[16:19], v1 offset:12288
  v_smfmac_f32_16x16x64_bf16 v[28:31], v[20:23], v[128:135], v5
  buffer_load_dword v13, v1, s[4:7], s45 offen offset:3072 sc1
  v_smfmac_f32_16x16x64_bf16 v[32:35], v[20:23], v[48:55], v5
  ds_read_b128 v[48:51], v3 offset:8192
  s_waitcnt lgkmcnt(4)
  v_smfmac_f32_16x16x64_bf16 v[36:39], v[20:23], v[56:63], v5
  ds_read_b128 v[52:55], v3 offset:9216
  v_smfmac_f32_16x16x64_bf16 v[40:43], v[20:23], a[8:15], v5
  ds_read_b128 v[56:59], v3 offset:16384
  v_smfmac_f32_16x16x64_bf16 v[44:47], v[20:23], a[16:23], v5
  ds_read_b128 v[60:63], v3 offset:17408
  s_waitcnt lgkmcnt(4)
  v_smfmac_f32_16x16x64_bf16 v[24:27], v[16:19], v[136:143], v5
  ds_read_b128 v[20:23], v1 offset:13312
  v_smfmac_f32_16x16x64_bf16 v[28:31], v[16:19], v[144:151], v5
  v_smfmac_f32_16x16x64_bf16 v[32:35], v[16:19], v[64:71], v5
  ds_read_b128 v[64:67], v3 offset:24576
  s_waitcnt lgkmcnt(4)
  v_smfmac_f32_16x16x64_bf16 v[36:39], v[16:19], v[48:55], v5
  ds_read_b128 v[68:71], v3 offset:25600
  v_smfmac_f32_16x16x64_bf16 v[40:43], v[16:19], a[24:31], v5
  ds_read_b128 v[48:51], v3 offset:32768
  v_smfmac_f32_16x16x64_bf16 v[44:47], v[16:19], a[32:39], v5
  ds_read_b128 v[52:55], v3 offset:33792
  s_waitcnt lgkmcnt(4)
  v_smfmac_f32_16x16x64_bf16 v[24:27], v[20:23], v[152:159], v5
  ds_read_b128 v[16:19], v1 offset:14336
  v_smfmac_f32_16x16x64_bf16 v[28:31], v[20:23], v[160:167], v5
  v_smfmac_f32_16x16x64_bf16 v[32:35], v[20:23], v[56:63], v5
  ds_read_b128 v[56:59], v3 offset:40960
  ds_read_b128 v[60:63], v3 offset:41984
  s_waitcnt lgkmcnt(5)
  v_smfmac_f32_16x16x64_bf16 v[36:39], v[20:23], v[64:71], v5
  ds_read_b128 v[64:67], v3 offset:49152
  ds_read_b128 v[68:71], v3 offset:50176
  s_waitcnt lgkmcnt(4)
  v_smfmac_f32_16x16x64_bf16 v[24:27], v[16:19], v[168:175], v5
  ds_read_b128 v[20:23], v1 offset:15360
  v_smfmac_f32_16x16x64_bf16 v[28:31], v[16:19], v[176:183], v5
  v_smfmac_f32_16x16x64_bf16 v[32:35], v[16:19], v[48:55], v5
  ds_read_b128 v[48:51], v3 offset:57344
  ds_read_b128 v[52:55], v3 offset:58368
  s_waitcnt lgkmcnt(5)
  v_smfmac_f32_16x16x64_bf16 v[36:39], v[16:19], v[56:63], v5
  ds_read_b128 v[56:59], v4 offset:0
  ds_read_b128 v[60:63], v4 offset:1024
  s_waitcnt lgkmcnt(4)
  v_smfmac_f32_16x16x64_bf16 v[24:27], v[20:23], v[184:191], v5
  ds_read_b128 v[16:19], v1 offset:16384
  v_smfmac_f32_16x16x64_bf16 v[28:31], v[20:23], v[192:199], v5
  v_smfmac_f32_16x16x64_bf16 v[32:35], v[20:23], v[64:71], v5
  ds_read_b128 v[64:67], v1 offset:13312
  s_waitcnt lgkmcnt(4)
  v_smfmac_f32_16x16x64_bf16 v[36:39], v[20:23], v[48:55], v5
  ds_read_b128 v[68:71], v1 offset:14336
  s_waitcnt lgkmcnt(2)
  v_smfmac_f32_16x16x64_bf16 v[24:27], v[16:19], v[200:207], v5
  v_smfmac_f32_16x16x64_bf16 v[28:31], v[16:19], v[208:215], v5
  v_smfmac_f32_16x16x64_bf16 v[32:35], v[16:19], v[56:63], v5
  v_smfmac_f32_16x16x64_bf16 v[36:39], v[16:19], a[104:111], v5
  v_smfmac_f32_16x16x64_bf16 v[40:43], v[16:19], a[88:95], v5
  ds_read_b128 v[48:51], v1 offset:23552
  v_smfmac_f32_16x16x64_bf16 v[44:47], v[16:19], a[96:103], v5
  ds_read_b128 v[52:55], v1 offset:24576
  s_nop 0
  v_add_f32 v24, v24, v26
  v_add_f32 v25, v25, v27
  v_add_f32 v28, v28, v30
  v_add_f32 v29, v29, v31
  v_cvt_pk_bf16_f32 v24, v24, v25
  v_cvt_pk_bf16_f32 v28, v28, v29
  ds_write2_b32 v6, v24, v28 offset0:0 offset1:64
  v_add_f32 v32, v32, v34
  v_add_f32 v33, v33, v35
  v_add_f32 v36, v36, v38
  v_add_f32 v37, v37, v39
  v_cvt_pk_bf16_f32 v14, v32, v33
  v_cvt_pk_bf16_f32 v15, v36, v37
  ds_write2_b32 v7, v14, v14 offset0:0 offset1:1
  ds_write2_b32 v7, v15, v15 offset0:128 offset1:129
  v_smfmac_f32_16x16x64_bf16 v[40:43], v[20:23], a[72:79], v5
  ds_read_b128 v[56:59], v1 offset:25600
  v_smfmac_f32_16x16x64_bf16 v[44:47], v[20:23], a[80:87], v5
  ds_read_b128 v[60:63], v1 offset:26624
  s_waitcnt lgkmcnt(8)
  v_smfmac_f32_16x16x64_bf16 v[40:43], v[64:67], a[40:47], v5
  v_smfmac_f32_16x16x64_bf16 v[44:47], v[64:67], a[48:55], v5
  s_waitcnt lgkmcnt(7)
  v_smfmac_f32_16x16x64_bf16 v[40:43], v[68:71], a[56:63], v5
  v_smfmac_f32_16x16x64_bf16 v[44:47], v[68:71], a[64:71], v5
  s_branch p1j_112
p1w_114:
  ds_read_b128 v[64:67], v2 offset:49152
  ds_read_b128 v[68:71], v2 offset:50176
  s_waitcnt lgkmcnt(4)
  s_cmp_eq_u32 s17, 3
  s_cbranch_scc0 kf_119
  buffer_load_dword v12, off, s[4:7], s82 sc1
kf_119:
  v_smfmac_f32_16x16x64_bf16 v[24:27], v[16:19], v[104:111], v5
  v_smfmac_f32_16x16x64_bf16 v[28:31], v[16:19], v[112:119], v5
  buffer_load_dword v13, v1, s[4:7], s45 offen offset:0 sc1
  v_smfmac_f32_16x16x64_bf16 v[32:35], v[16:19], v[48:55], v5
  ds_read_b128 v[48:51], v2 offset:57344
  v_smfmac_f32_16x16x64_bf16 v[36:39], v[16:19], v[56:63], v5
  ds_read_b128 v[52:55], v2 offset:58368
  v_smfmac_f32_16x16x64_bf16 v[40:43], v[16:19], v[248:255], v5
  ds_read_b128 v[56:59], v2 offset:0
  v_smfmac_f32_16x16x64_bf16 v[44:47], v[16:19], a[0:7], v5
  ds_read_b128 v[60:63], v2 offset:1024
  v_smfmac_f32_16x16x64_bf16 v[24:27], v[20:23], v[120:127], v5
  s_waitcnt lgkmcnt(6)
  s_barrier
  s_cmp_eq_u32 s17, 3
  s_cbranch_scc0 pf_120
  s_mov_b64 exec, 1
  v_mov_b32 v14, s18
  buffer_store_dword v14, off, s[4:7], s99 sc1
  s_mov_b64 exec, -1
pf_120:
  ds_read_b128 v[16:19], v1 offset:8192
  v_smfmac_f32_16x16x64_bf16 v[28:31], v[20:23], v[128:135], v5
  buffer_load_dword v13, v1, s[4:7], s45 offen offset:1024 sc1
  s_waitcnt lgkmcnt(5)
  v_smfmac_f32_16x16x64_bf16 v[32:35], v[20:23], v[64:71], v5
  ds_read_b128 v[64:67], v2 offset:8192
  s_waitcnt lgkmcnt(4)
  v_smfmac_f32_16x16x64_bf16 v[36:39], v[20:23], v[48:55], v5
  ds_read_b128 v[68:71], v2 offset:9216
  v_smfmac_f32_16x16x64_bf16 v[40:43], v[20:23], a[8:15], v5
  ds_read_b128 v[48:51], v2 offset:16384
  v_smfmac_f32_16x16x64_bf16 v[44:47], v[20:23], a[16:23], v5
  ds_read_b128 v[52:55], v2 offset:17408
  s_waitcnt lgkmcnt(4)
  v_smfmac_f32_16x16x64_bf16 v[24:27], v[16:19], v[72:79], v5
  ds_read_b128 v[20:23], v1 offset:9216
  v_smfmac_f32_16x16x64_bf16 v[28:31], v[16:19], v[80:87], v5
  buffer_load_dword v13, v1, s[4:7], s45 offen offset:2048 sc1
  v_smfmac_f32_16x16x64_bf16 v[32:35], v[16:19], v[56:63], v5
  ds_read_b128 v[56:59], v2 offset:24576
  s_waitcnt lgkmcnt(4)
  v_smfmac_f32_16x16x64_bf16 v[36:39], v[16:19], v[64:71], v5
  ds_read_b128 v[60:63], v2 offset:25600
  v_smfmac_f32_16x16x64_bf16 v[40:43], v[16:19], v[216:223], v5
  ds_read_b128 v[64:67], v3 offset:0
  v_smfmac_f32_16x16x64_bf16 v[44:47], v[16:19], v[224:231], v5
  ds_read_b128 v[68:71], v3 offset:1024
  s_waitcnt lgkmcnt(4)
  v_smfmac_f32_16x16x64_bf16 v[24:27], v[20:23], v[88:95], v5
  ds_read_b128 v[16:19], v1 offset:12288
  v_smfmac_f32_16x16x64_bf16 v[28:31], v[20:23], v[96:103], v5
  buffer_load_dword v13, v1, s[4:7], s45 offen offset:3072 sc1
  v_smfmac_f32_16x16x64_bf16 v[32:35], v[20:23], v[48:55], v5
  ds_read_b128 v[48:51], v3 offset:8192
  s_waitcnt lgkmcnt(4)
  v_smfmac_f32_16x16x64_bf16 v[36:39], v[20:23], v[56:63], v5
  ds_read_b128 v[52:55], v3 offset:9216
  v_smfmac_f32_16x16x64_bf16 v[40:43], v[20:23], v[232:239], v5
  ds_read_b128 v[56:59], v3 offset:16384
  v_smfmac_f32_16x16x64_bf16 v[44:47], v[20:23], v[240:247], v5
  ds_read_b128 v[60:63], v3 offset:17408
  s_waitcnt lgkmcnt(4)
  v_smfmac_f32_16x16x64_bf16 v[24:27], v[16:19], v[136:143], v5
  ds_read_b128 v[20:23], v1 offset:13312
  v_smfmac_f32_16x16x64_bf16 v[28:31], v[16:19], v[144:151], v5
  v_smfmac_f32_16x16x64_bf16 v[32:35], v[16:19], v[64:71], v5
  ds_read_b128 v[64:67], v3 offset:24576
  s_waitcnt lgkmcnt(4)
  v_smfmac_f32_16x16x64_bf16 v[36:39], v[16:19], v[48:55], v5
  ds_read_b128 v[68:71], v3 offset:25600
  v_smfmac_f32_16x16x64_bf16 v[40:43], v[16:19], a[24:31], v5
  ds_read_b128 v[48:51], v3 offset:32768
  v_smfmac_f32_16x16x64_bf16 v[44:47], v[16:19], a[32:39], v5
  ds_read_b128 v[52:55], v3 offset:33792
  s_waitcnt lgkmcnt(4)
  v_smfmac_f32_16x16x64_bf16 v[24:27], v[20:23], v[152:159], v5
  ds_read_b128 v[16:19], v1 offset:14336
  v_smfmac_f32_16x16x64_bf16 v[28:31], v[20:23], v[160:167], v5
  v_smfmac_f32_16x16x64_bf16 v[32:35], v[20:23], v[56:63], v5
  ds_read_b128 v[56:59], v3 offset:40960
  ds_read_b128 v[60:63], v3 offset:41984
  s_waitcnt lgkmcnt(5)
  v_smfmac_f32_16x16x64_bf16 v[36:39], v[20:23], v[64:71], v5
  ds_read_b128 v[64:67], v3 offset:49152
  ds_read_b128 v[68:71], v3 offset:50176
  s_waitcnt lgkmcnt(4)
  v_smfmac_f32_16x16x64_bf16 v[24:27], v[16:19], v[168:175], v5
  ds_read_b128 v[20:23], v1 offset:15360
  v_smfmac_f32_16x16x64_bf16 v[28:31], v[16:19], v[176:183], v5
  v_smfmac_f32_16x16x64_bf16 v[32:35], v[16:19], v[48:55], v5
  ds_read_b128 v[48:51], v3 offset:57344
  ds_read_b128 v[52:55], v3 offset:58368
  s_waitcnt lgkmcnt(5)
  v_smfmac_f32_16x16x64_bf16 v[36:39], v[16:19], v[56:63], v5
  ds_read_b128 v[56:59], v4 offset:0
  ds_read_b128 v[60:63], v4 offset:1024
  s_waitcnt lgkmcnt(4)
  v_smfmac_f32_16x16x64_bf16 v[24:27], v[20:23], v[184:191], v5
  ds_read_b128 v[16:19], v1 offset:16384
  v_smfmac_f32_16x16x64_bf16 v[28:31], v[20:23], v[192:199], v5
  v_smfmac_f32_16x16x64_bf16 v[32:35], v[20:23], v[64:71], v5
  ds_read_b128 v[64:67], v1 offset:13312
  s_waitcnt lgkmcnt(4)
  v_smfmac_f32_16x16x64_bf16 v[36:39], v[20:23], v[48:55], v5
  ds_read_b128 v[68:71], v1 offset:14336
  s_waitcnt lgkmcnt(2)
  v_smfmac_f32_16x16x64_bf16 v[24:27], v[16:19], v[200:207], v5
  v_smfmac_f32_16x16x64_bf16 v[28:31], v[16:19], v[208:215], v5
  v_smfmac_f32_16x16x64_bf16 v[32:35], v[16:19], v[56:63], v5
  v_smfmac_f32_16x16x64_bf16 v[36:39], v[16:19], a[104:111], v5
  v_smfmac_f32_16x16x64_bf16 v[40:43], v[16:19], a[88:95], v5
  ds_read_b128 v[48:51], v1 offset:23552
  v_smfmac_f32_16x16x64_bf16 v[44:47], v[16:19], a[96:103], v5
  ds_read_b128 v[52:55], v1 offset:24576
  s_nop 0
  v_add_f32 v24, v24, v26
  v_add_f32 v25, v25, v27
  v_add_f32 v28, v28, v30
  v_add_f32 v29, v29, v31
  v_cvt_pk_bf16_f32 v24, v24, v25
  v_cvt_pk_bf16_f32 v28, v28, v29
  ds_write2_b32 v6, v24, v28 offset0:0 offset1:64
  v_add_f32 v32, v32, v34
  v_add_f32 v33, v33, v35
  v_add_f32 v36, v36, v38
  v_add_f32 v37, v37, v39
  v_cvt_pk_bf16_f32 v14, v32, v33
  v_cvt_pk_bf16_f32 v15, v36, v37
  ds_write2_b32 v7, v14, v14 offset0:0 offset1:1
  ds_write2_b32 v7, v15, v15 offset0:128 offset1:129
  v_smfmac_f32_16x16x64_bf16 v[40:43], v[20:23], a[72:79], v5
  ds_read_b128 v[56:59], v1 offset:25600
  v_smfmac_f32_16x16x64_bf16 v[44:47], v[20:23], a[80:87], v5
  ds_read_b128 v[60:63], v1 offset:26624
  s_waitcnt lgkmcnt(8)
  v_smfmac_f32_16x16x64_bf16 v[40:43], v[64:67], a[40:47], v5
  v_smfmac_f32_16x16x64_bf16 v[44:47], v[64:67], a[48:55], v5
  s_waitcnt lgkmcnt(7)
  v_smfmac_f32_16x16x64_bf16 v[40:43], v[68:71], a[56:63], v5
  v_smfmac_f32_16x16x64_bf16 v[44:47], v[68:71], a[64:71], v5
  s_branch p1j_112
p1w_115:
  ds_read_b128 v[64:67], v3 offset:16384
  ds_read_b128 v[68:71], v3 offset:17408
  s_waitcnt lgkmcnt(4)
  s_cmp_eq_u32 s17, 3
  s_cbranch_scc0 kf_121
  buffer_load_dword v12, off, s[4:7], s82 sc1
kf_121:
  v_smfmac_f32_16x16x64_bf16 v[24:27], v[16:19], v[136:143], v5
  v_smfmac_f32_16x16x64_bf16 v[28:31], v[16:19], v[144:151], v5
  buffer_load_dword v13, v1, s[4:7], s45 offen offset:0 sc1
  v_smfmac_f32_16x16x64_bf16 v[32:35], v[16:19], v[48:55], v5
  ds_read_b128 v[48:51], v3 offset:24576
  v_smfmac_f32_16x16x64_bf16 v[36:39], v[16:19], v[56:63], v5
  ds_read_b128 v[52:55], v3 offset:25600
  v_smfmac_f32_16x16x64_bf16 v[40:43], v[16:19], a[24:31], v5
  ds_read_b128 v[56:59], v2 offset:0
  v_smfmac_f32_16x16x64_bf16 v[44:47], v[16:19], a[32:39], v5
  ds_read_b128 v[60:63], v2 offset:1024
  v_smfmac_f32_16x16x64_bf16 v[24:27], v[20:23], v[152:159], v5
  s_waitcnt lgkmcnt(6)
  s_barrier
  s_cmp_eq_u32 s17, 3
  s_cbranch_scc0 pf_122
  s_mov_b64 exec, 1
  v_mov_b32 v14, s18
  buffer_store_dword v14, off, s[4:7], s99 sc1
  s_mov_b64 exec, -1
pf_122:
  ds_read_b128 v[16:19], v1 offset:8192
  v_smfmac_f32_16x16x64_bf16 v[28:31], v[20:23], v[160:167], v5
  buffer_load_dword v13, v1, s[4:7], s45 offen offset:1024 sc1
  s_waitcnt lgkmcnt(5)
  v_smfmac_f32_16x16x64_bf16 v[32:35], v[20:23], v[64:71], v5
  ds_read_b128 v[64:67], v2 offset:8192
  s_waitcnt lgkmcnt(4)
  v_smfmac_f32_16x16x64_bf16 v[36:39], v[20:23], v[48:55], v5
  ds_read_b128 v[68:71], v2 offset:9216
  v_smfmac_f32_16x16x64_bf16 v[40:43], v[20:23], a[40:47], v5
  ds_read_b128 v[48:51], v2 offset:16384
  v_smfmac_f32_16x16x64_bf16 v[44:47], v[20:23], a[48:55], v5
  ds_read_b128 v[52:55], v2 offset:17408
  s_waitcnt lgkmcnt(4)
  v_smfmac_f32_16x16x64_bf16 v[24:27], v[16:19], v[72:79], v5
  ds_read_b128 v[20:23], v1 offset:9216
  v_smfmac_f32_16x16x64_bf16 v[28:31], v[16:19], v[80:87], v5
  buffer_load_dword v13, v1, s[4:7], s45 offen offset:2048 sc1
  v_smfmac_f32_16x16x64_bf16 v[32:35], v[16:19], v[56:63], v5
  ds_read_b128 v[56:59], v2 offset:24576
  s_waitcnt lgkmcnt(4)
  v_smfmac_f32_16x16x64_bf16 v[36:39], v[16:19], v[64:71], v5
  ds_read_b128 v[60:63], v2 offset:25600
  v_smfmac_f32_16x16x64_bf16 v[40:43], v[16:19], v[216:223], v5
  ds_read_b128 v[64:67], v2 offset:32768
  v_smfmac_f32_16x16x64_bf16 v[44:47], v[16:19], v[224:231], v5
  ds_read_b128 v[68:71], v2 offset:33792
  s_waitcnt lgkmcnt(4)
  v_smfmac_f32_16x16x64_bf16 v[24:27], v[20:23], v[88:95], v5
  ds_read_b128 v[16:19], v1 offset:10240
  v_smfmac_f32_16x16x64_bf16 v[28:31], v[20:23], v[96:103], v5
  buffer_load_dword v13, v1, s[4:7], s45 offen offset:3072 sc1
  v_smfmac_f32_16x16x64_bf16 v[32:35], v[20:23], v[48:55], v5
  ds_read_b128 v[48:51], v2 offset:40960
  s_waitcnt lgkmcnt(4)
  v_smfmac_f32_16x16x64_bf16 v[36:39], v[20:23], v[56:63], v5
  ds_read_b128 v[52:55], v2 offset:41984
  v_smfmac_f32_16x16x64_bf16 v[40:43], v[20:23], v[232:239], v5
  ds_read_b128 v[56:59], v2 offset:49152
  v_smfmac_f32_16x16x64_bf16 v[44:47], v[20:23], v[240:247], v5
  ds_read_b128 v[60:63], v2 offset:50176
  s_waitcnt lgkmcnt(4)
  v_smfmac_f32_16x16x64_bf16 v[24:27], v[16:19], v[104:111], v5
  ds_read_b128 v[20:23], v1 offset:11264
  v_smfmac_f32_16x16x64_bf16 v[28:31], v[16:19], v[112:119], v5
  v_smfmac_f32_16x16x64_bf16 v[32:35], v[16:19], v[64:71], v5
  ds_read_b128 v[64:67], v2 offset:57344
  s_waitcnt lgkmcnt(4)
  v_smfmac_f32_16x16x64_bf16 v[36:39], v[16:19], v[48:55], v5
  ds_read_b128 v[68:71], v2 offset:58368
  v_smfmac_f32_16x16x64_bf16 v[40:43], v[16:19], v[248:255], v5
  ds_read_b128 v[48:51], v3 offset:32768
  v_smfmac_f32_16x16x64_bf16 v[44:47], v[16:19], a[0:7], v5
  ds_read_b128 v[52:55], v3 offset:33792
  s_waitcnt lgkmcnt(4)
  v_smfmac_f32_16x16x64_bf16 v[24:27], v[20:23], v[120:127], v5
  ds_read_b128 v[16:19], v1 offset:14336
  v_smfmac_f32_16x16x64_bf16 v[28:31], v[20:23], v[128:135], v5
  v_smfmac_f32_16x16x64_bf16 v[32:35], v[20:23], v[56:63], v5
  ds_read_b128 v[56:59], v3 offset:40960
  ds_read_b128 v[60:63], v3 offset:41984
  s_waitcnt lgkmcnt(5)
  v_smfmac_f32_16x16x64_bf16 v[36:39], v[20:23], v[64:71], v5
  ds_read_b128 v[64:67], v3 offset:49152
  ds_read_b128 v[68:71], v3 offset:50176
  s_waitcnt lgkmcnt(4)
  v_smfmac_f32_16x16x64_bf16 v[24:27], v[16:19], v[168:175], v5
  ds_read_b128 v[20:23], v1 offset:15360
  v_smfmac_f32_16x16x64_bf16 v[28:31], v[16:19], v[176:183], v5
  v_smfmac_f32_16x16x64_bf16 v[32:35], v[16:19], v[48:55], v5
  ds_read_b128 v[48:51], v3 offset:57344
  ds_read_b128 v[52:55], v3 offset:58368
  s_waitcnt lgkmcnt(5)
  v_smfmac_f32_16x16x64_bf16 v[36:39], v[16:19], v[56:63], v5
  ds_read_b128 v[56:59], v4 offset:0
  ds_read_b128 v[60:63], v4 offset:1024
  s_waitcnt lgkmcnt(4)
  v_smfmac_f32_16x16x64_bf16 v[24:27], v[20:23], v[184:191], v5
  ds_read_b128 v[16:19], v1 offset:16384
  v_smfmac_f32_16x16x64_bf16 v[28:31], v[20:23], v[192:199], v5
  v_smfmac_f32_16x16x64_bf16 v[32:35], v[20:23], v[64:71], v5
  ds_read_b128 v[64:67], v1 offset:11264
  s_waitcnt lgkmcnt(4)
  v_smfmac_f32_16x16x64_bf16 v[36:39], v[20:23], v[48:55], v5
  ds_read_b128 v[68:71], v1 offset:14336
  s_waitcnt lgkmcnt(2)
  v_smfmac_f32_16x16x64_bf16 v[24:27], v[16:19], v[200:207], v5
  v_smfmac_f32_16x16x64_bf16 v[28:31], v[16:19], v[208:215], v5
  v_smfmac_f32_16x16x64_bf16 v[32:35], v[16:19], v[56:63], v5
  v_smfmac_f32_16x16x64_bf16 v[36:39], v[16:19], a[104:111], v5
  v_smfmac_f32_16x16x64_bf16 v[40:43], v[16:19], a[88:95], v5
  ds_read_b128 v[48:51], v1 offset:23552
  v_smfmac_f32_16x16x64_bf16 v[44:47], v[16:19], a[96:103], v5
  ds_read_b128 v[52:55], v1 offset:24576
  s_nop 0
  v_add_f32 v24, v24, v26
  v_add_f32 v25, v25, v27
  v_add_f32 v28, v28, v30
  v_add_f32 v29, v29, v31
  v_cvt_pk_bf16_f32 v24, v24, v25
  v_cvt_pk_bf16_f32 v28, v28, v29
  ds_write2_b32 v6, v24, v28 offset0:0 offset1:64
  v_add_f32 v32, v32, v34
  v_add_f32 v33, v33, v35
  v_add_f32 v36, v36, v38
  v_add_f32 v37, v37, v39
  v_cvt_pk_bf16_f32 v14, v32, v33
  v_cvt_pk_bf16_f32 v15, v36, v37
  ds_write2_b32 v7, v14, v14 offset0:0 offset1:1
  ds_write2_b32 v7, v15, v15 offset0:128 offset1:129
  v_smfmac_f32_16x16x64_bf16 v[40:43], v[20:23], a[72:79], v5
  ds_read_b128 v[56:59], v1 offset:25600
  v_smfmac_f32_16x16x64_bf16 v[44:47], v[20:23], a[80:87], v5
  ds_read_b128 v[60:63], v1 offset:26624
  s_waitcnt lgkmcnt(8)
  v_smfmac_f32_16x16x64_bf16 v[40:43], v[64:67], a[8:15], v5
  v_smfmac_f32_16x16x64_bf16 v[44:47], v[64:67], a[16:23], v5
  s_waitcnt lgkmcnt(7)
  v_smfmac_f32_16x16x64_bf16 v[40:43], v[68:71], a[56:63], v5
  v_smfmac_f32_16x16x64_bf16 v[44:47], v[68:71], a[64:71], v5
  s_branch p1j_112
p1w_116:
  ds_read_b128 v[64:67], v3 offset:49152
  ds_read_b128 v[68:71], v3 offset:50176
  s_waitcnt lgkmcnt(4)
  s_cmp_eq_u32 s17, 3
  s_cbranch_scc0 kf_123
  buffer_load_dword v12, off, s[4:7], s82 sc1
kf_123:
  v_smfmac_f32_16x16x64_bf16 v[24:27], v[16:19], v[168:175], v5
  v_smfmac_f32_16x16x64_bf16 v[28:31], v[16:19], v[176:183], v5
  buffer_load_dword v13, v1, s[4:7], s45 offen offset:0 sc1
  v_smfmac_f32_16x16x64_bf16 v[32:35], v[16:19], v[48:55], v5
  ds_read_b128 v[48:51], v3 offset:57344
  v_smfmac_f32_16x16x64_bf16 v[36:39], v[16:19], v[56:63], v5
  ds_read_b128 v[52:55], v3 offset:58368
  v_smfmac_f32_16x16x64_bf16 v[40:43], v[16:19], a[56:63], v5
  ds_read_b128 v[56:59], v2 offset:0
  v_smfmac_f32_16x16x64_bf16 v[44:47], v[16:19], a[64:71], v5
  ds_read_b128 v[60:63], v2 offset:1024
  v_smfmac_f32_16x16x64_bf16 v[24:27], v[20:23], v[184:191], v5
  s_waitcnt lgkmcnt(6)
  s_barrier
  s_cmp_eq_u32 s17, 3
  s_cbranch_scc0 pf_124
  s_mov_b64 exec, 1
  v_mov_b32 v14, s18
  buffer_store_dword v14, off, s[4:7], s99 sc1
  s_mov_b64 exec, -1
pf_124:
  ds_read_b128 v[16:19], v1 offset:8192
  v_smfmac_f32_16x16x64_bf16 v[28:31], v[20:23], v[192:199], v5
  buffer_load_dword v13, v1, s[4:7], s45 offen offset:1024 sc1
  s_waitcnt lgkmcnt(5)
  v_smfmac_f32_16x16x64_bf16 v[32:35], v[20:23], v[64:71], v5
  ds_read_b128 v[64:67], v2 offset:8192
  s_waitcnt lgkmcnt(4)
  v_smfmac_f32_16x16x64_bf16 v[36:39], v[20:23], v[48:55], v5
  ds_read_b128 v[68:71], v2 offset:9216
  v_smfmac_f32_16x16x64_bf16 v[40:43], v[20:23], a[72:79], v5
  ds_read_b128 v[48:51], v2 offset:16384
  v_smfmac_f32_16x16x64_bf16 v[44:47], v[20:23], a[80:87], v5
  ds_read_b128 v[52:55], v2 offset:17408
  s_waitcnt lgkmcnt(4)
  v_smfmac_f32_16x16x64_bf16 v[24:27], v[16:19], v[72:79], v5
  ds_read_b128 v[20:23], v1 offset:9216
  v_smfmac_f32_16x16x64_bf16 v[28:31], v[16:19], v[80:87], v5
  buffer_load_dword v13, v1, s[4:7], s45 offen offset:2048 sc1
  v_smfmac_f32_16x16x64_bf16 v[32:35], v[16:19], v[56:63], v5
  ds_read_b128 v[56:59], v2 offset:24576
  s_waitcnt lgkmcnt(4)
  v_smfmac_f32_16x16x64_bf16 v[36:39], v[16:19], v[64:71], v5
  ds_read_b128 v[60:63], v2 offset:25600
  v_smfmac_f32_16x16x64_bf16 v[40:43], v[16:19], v[216:223], v5
  ds_read_b128 v[64:67], v2 offset:32768
  v_smfmac_f32_16x16x64_bf16 v[44:47], v[16:19], v[224:231], v5
  ds_read_b128 v[68:71], v2 offset:33792
  s_waitcnt lgkmcnt(4)
  v_smfmac_f32_16x16x64_bf16 v[24:27], v[20:23], v[88:95], v5
  ds_read_b128 v[16:19], v1 offset:10240
  v_smfmac_f32_16x16x64_bf16 v[28:31], v[20:23], v[96:103], v5
  buffer_load_dword v13, v1, s[4:7], s45 offen offset:3072 sc1
  v_smfmac_f32_16x16x64_bf16 v[32:35], v[20:23], v[48:55], v5
  ds_read_b128 v[48:51], v2 offset:40960
  s_waitcnt lgkmcnt(4)
  v_smfmac_f32_16x16x64_bf16 v[36:39], v[20:23], v[56:63], v5
  ds_read_b128 v[52:55], v2 offset:41984
  v_smfmac_f32_16x16x64_bf16 v[40:43], v[20:23], v[232:239], v5
  ds_read_b128 v[56:59], v2 offset:49152
  v_smfmac_f32_16x16x64_bf16 v[44:47], v[20:23], v[240:247], v5
  ds_read_b128 v[60:63], v2 offset:50176
  s_waitcnt lgkmcnt(4)
  v_smfmac_f32_16x16x64_bf16 v[24:27], v[16:19], v[104:111], v5
  ds_read_b128 v[20:23], v1 offset:11264
  v_smfmac_f32_16x16x64_bf16 v[28:31], v[16:19], v[112:119], v5
  v_smfmac_f32_16x16x64_bf16 v[32:35], v[16:19], v[64:71], v5
  ds_read_b128 v[64:67], v2 offset:57344
  s_waitcnt lgkmcnt(4)
  v_smfmac_f32_16x16x64_bf16 v[36:39], v[16:19], v[48:55], v5
  ds_read_b128 v[68:71], v2 offset:58368
  v_smfmac_f32_16x16x64_bf16 v[40:43], v[16:19], v[248:255], v5
  ds_read_b128 v[48:51], v3 offset:0
  v_smfmac_f32_16x16x64_bf16 v[44:47], v[16:19], a[0:7], v5
  ds_read_b128 v[52:55], v3 offset:1024
  s_waitcnt lgkmcnt(4)
  v_smfmac_f32_16x16x64_bf16 v[24:27], v[20:23], v[120:127], v5
  ds_read_b128 v[16:19], v1 offset:12288
  v_smfmac_f32_16x16x64_bf16 v[28:31], v[20:23], v[128:135], v5
  v_smfmac_f32_16x16x64_bf16 v[32:35], v[20:23], v[56:63], v5
  ds_read_b128 v[56:59], v3 offset:8192
  ds_read_b128 v[60:63], v3 offset:9216
  s_waitcnt lgkmcnt(5)
  v_smfmac_f32_16x16x64_bf16 v[36:39], v[20:23], v[64:71], v5
  ds_read_b128 v[64:67], v3 offset:16384
  ds_read_b128 v[68:71], v3 offset:17408
  s_waitcnt lgkmcnt(4)
  v_smfmac_f32_16x16x64_bf16 v[24:27], v[16:19], v[136:143], v5
  ds_read_b128 v[20:23], v1 offset:13312
  v_smfmac_f32_16x16x64_bf16 v[28:31], v[16:19], v[144:151], v5
  v_smfmac_f32_16x16x64_bf16 v[32:35], v[16:19], v[48:55], v5
  ds_read_b128 v[48:51], v3 offset:24576
  ds_read_b128 v[52:55], v3 offset:25600
  s_waitcnt lgkmcnt(5)
  v_smfmac_f32_16x16x64_bf16 v[36:39], v[16:19], v[56:63], v5
  ds_read_b128 v[56:59], v4 offset:0
  ds_read_b128 v[60:63], v4 offset:1024
  s_waitcnt lgkmcnt(4)
  v_smfmac_f32_16x16x64_bf16 v[24:27], v[20:23], v[152:159], v5
  ds_read_b128 v[16:19], v1 offset:16384
  v_smfmac_f32_16x16x64_bf16 v[28:31], v[20:23], v[160:167], v5
  v_smfmac_f32_16x16x64_bf16 v[32:35], v[20:23], v[64:71], v5
  ds_read_b128 v[64:67], v1 offset:11264
  s_waitcnt lgkmcnt(4)
  v_smfmac_f32_16x16x64_bf16 v[36:39], v[20:23], v[48:55], v5
  ds_read_b128 v[68:71], v1 offset:12288
  s_waitcnt lgkmcnt(2)
  v_smfmac_f32_16x16x64_bf16 v[24:27], v[16:19], v[200:207], v5
  v_smfmac_f32_16x16x64_bf16 v[28:31], v[16:19], v[208:215], v5
  v_smfmac_f32_16x16x64_bf16 v[32:35], v[16:19], v[56:63], v5
  v_smfmac_f32_16x16x64_bf16 v[36:39], v[16:19], a[104:111], v5
  v_smfmac_f32_16x16x64_bf16 v[40:43], v[16:19], a[88:95], v5
  ds_read_b128 v[48:51], v1 offset:23552
  v_smfmac_f32_16x16x64_bf16 v[44:47], v[16:19], a[96:103], v5
  ds_read_b128 v[52:55], v1 offset:24576
  s_nop 0
  v_add_f32 v24, v24, v26
  v_add_f32 v25, v25, v27
  v_add_f32 v28, v28, v30
  v_add_f32 v29, v29, v31
  v_cvt_pk_bf16_f32 v24, v24, v25
  v_cvt_pk_bf16_f32 v28, v28, v29
  ds_write2_b32 v6, v24, v28 offset0:0 offset1:64
  v_add_f32 v32, v32, v34
  v_add_f32 v33, v33, v35
  v_add_f32 v36, v36, v38
  v_add_f32 v37, v37, v39
  v_cvt_pk_bf16_f32 v14, v32, v33
  v_cvt_pk_bf16_f32 v15, v36, v37
  ds_write2_b32 v7, v14, v14 offset0:0 offset1:1
  ds_write2_b32 v7, v15, v15 offset0:128 offset1:129
  v_smfmac_f32_16x16x64_bf16 v[40:43], v[20:23], a[40:47], v5
  ds_read_b128 v[56:59], v1 offset:25600
  v_smfmac_f32_16x16x64_bf16 v[44:47], v[20:23], a[48:55], v5
  ds_read_b128 v[60:63], v1 offset:26624
  s_waitcnt lgkmcnt(8)
  v_smfmac_f32_16x16x64_bf16 v[40:43], v[64:67], a[8:15], v5
  v_smfmac_f32_16x16x64_bf16 v[44:47], v[64:67], a[16:23], v5
  s_waitcnt lgkmcnt(7)
  v_smfmac_f32_16x16x64_bf16 v[40:43], v[68:71], a[24:31], v5
  v_smfmac_f32_16x16x64_bf16 v[44:47], v[68:71], a[32:39], v5
p1j_112:
  s_waitcnt lgkmcnt(2)
  s_barrier
  ds_read_b64_tr_b16 v[16:17], v8 offset:0
  ds_read_b64_tr_b16 v[18:19], v8 offset:128
  ds_read_b64_tr_b16 v[20:21], v9 offset:0
  ds_read_b64_tr_b16 v[22:23], v9 offset:256
  ds_read_b64_tr_b16 v[36:37], v8 offset:512
  ds_read_b64_tr_b16 v[38:39], v8 offset:640
  ds_read_b128 v[64:67], v1 offset:27648
  ds_read_b128 v[68:71], v1 offset:28672
  v_add_f32 v40, v40, v42
  v_add_f32 v41, v41, v43
  v_add_f32 v44, v44, v46
  v_add_f32 v45, v45, v47
  v_cvt_pk_bf16_f32 v40, v40, v41
  v_cvt_pk_bf16_f32 v41, v44, v45
  ds_read_b64_tr_b16 v[44:45], v9 offset:1024
  ds_read_b64_tr_b16 v[46:47], v9 offset:1280
  s_waitcnt lgkmcnt(8)
  v_mfma_f32_16x16x32_bf16 v[24:27], v[48:51], v[16:19], 0
  v_mfma_f32_16x16x32_bf16 v[28:31], v[52:55], v[16:19], 0
  s_waitcnt lgkmcnt(6)
  v_mfma_f32_16x16x32_bf16 v[32:35], v[20:23], v[16:19], 0
  buffer_load_dwordx4 v[48:51], v1, s[4:7], s37 offen sc1
  buffer_load_dwordx4 v[52:55], v1, s[4:7], s37 offen offset:1024 sc1
  v_lshrrev_b32 v43, 1, v1
  buffer_store_dwordx2 v[14:15], v43, s[4:7], s38 offen sc1
  buffer_store_dwordx2 v[40:41], v43, s[4:7], s39 offen sc1
  s_cmp_eq_u32 s18, 63
  s_cbranch_scc1 ch_last_s
  ds_read_b64_tr_b16 v[16:17], v8 offset:1024
  ds_read_b64_tr_b16 v[18:19], v8 offset:1152
  ds_read_b64_tr_b16 v[20:21], v9 offset:2048
  ds_read_b64_tr_b16 v[22:23], v9 offset:2304
  s_waitcnt lgkmcnt(8)
  v_mfma_f32_16x16x32_bf16 v[24:27], v[56:59], v[36:39], v[24:27]
  v_mfma_f32_16x16x32_bf16 v[28:31], v[60:63], v[36:39], v[28:31]
  s_waitcnt lgkmcnt(4)
  v_mfma_f32_16x16x32_bf16 v[32:35], v[44:47], v[36:39], v[32:35]
  ds_read_b128 v[56:59], v1 offset:29696
  ds_read_b128 v[60:63], v1 offset:30720
  ds_read_b64_tr_b16 v[36:37], v8 offset:1536
  ds_read_b64_tr_b16 v[38:39], v8 offset:1664
  ds_read_b64_tr_b16 v[44:45], v9 offset:3072
  ds_read_b64_tr_b16 v[46:47], v9 offset:3328
  s_waitcnt lgkmcnt(8)
  v_mfma_f32_16x16x32_bf16 v[24:27], v[64:67], v[16:19], v[24:27]
  v_mfma_f32_16x16x32_bf16 v[28:31], v[68:71], v[16:19], v[28:31]
  s_waitcnt lgkmcnt(6)
  v_mfma_f32_16x16x32_bf16 v[32:35], v[20:23], v[16:19], v[32:35]
  v_mov_b32 v16, 0x3f803f80
  v_mov_b32 v17, 0x3f803f80
  v_mov_b32 v18, 0x3f803f80
  v_mov_b32 v19, 0x3f803f80
  s_waitcnt lgkmcnt(2)
  v_mfma_f32_16x16x32_bf16 v[24:27], v[56:59], v[36:39], v[24:27]
  v_mov_b32 v21, 0
  v_mfma_f32_16x16x32_bf16 v[28:31], v[60:63], v[36:39], v[28:31]
  v_mov_b32 v22, 0
  s_waitcnt lgkmcnt(0)
  v_mfma_f32_16x16x32_bf16 v[32:35], v[44:47], v[36:39], v[32:35]
  s_nop 2
  v_max3_f32 v42, v24, v25, v26
  s_nop 0
  v_max3_f32 v14, v28, v29, v30
  v_max3_f32 v42, v42, v27, v31
  v_max_f32 v42, v42, v14
  v_max3_f32 v42, v42, v32, v33
  v_mov_b32 v14, v42
  s_nop 1
  v_permlane16_swap_b32 v42, v14
  v_max_f32 v42, v42, v14
  v_mov_b32 v14, v42
  s_nop 1
  v_permlane32_swap_b32 v42, v14
  v_max_f32 v42, v42, v14
  v_mul_f32 v14, s40, v42
  v_pk_fma_f32 v[24:25], v[24:25], s[40:41], v[14:15] op_sel_hi:[1,1,0] neg_lo:[0,0,1] neg_hi:[0,0,1]
  v_pk_fma_f32 v[26:27], v[26:27], s[40:41], v[14:15] op_sel_hi:[1,1,0] neg_lo:[0,0,1] neg_hi:[0,0,1]
  v_pk_fma_f32 v[28:29], v[28:29], s[40:41], v[14:15] op_sel_hi:[1,1,0] neg_lo:[0,0,1] neg_hi:[0,0,1]
  v_pk_fma_f32 v[30:31], v[30:31], s[40:41], v[14:15] op_sel_hi:[1,1,0] neg_lo:[0,0,1] neg_hi:[0,0,1]
  v_pk_fma_f32 v[32:33], v[32:33], s[40:41], v[14:15] op_sel_hi:[1,1,0] neg_lo:[0,0,1] neg_hi:[0,0,1]
  v_exp_f32 v24, v24
  v_exp_f32 v25, v25
  v_exp_f32 v26, v26
  v_exp_f32 v27, v27
  v_exp_f32 v28, v28
  v_exp_f32 v29, v29
  v_exp_f32 v30, v30
  v_exp_f32 v31, v31
  v_exp_f32 v32, v32
  v_exp_f32 v33, v33
  v_cvt_pk_bf16_f32 v56, v24, v25
  v_cvt_pk_bf16_f32 v57, v26, v27
  v_cvt_pk_bf16_f32 v58, v28, v29
  v_cvt_pk_bf16_f32 v59, v30, v31
  v_cvt_pk_bf16_f32 v20, v32, v33
  v_cvt_pk_bf16_f32 v23, v32, v33
  v_mfma_f32_16x16x32_bf16 v[32:35], v[16:19], v[56:59], 0
  s_waitcnt vmcnt(3)
  v_mfma_f32_16x16x32_bf16 v[24:27], v[48:51], v[56:59], 0
  s_waitcnt vmcnt(2)
  v_mfma_f32_16x16x32_bf16 v[28:31], v[52:55], v[56:59], 0
  v_mfma_f32_16x16x16_bf16 v[32:35], v[16:17], v[20:21], v[32:35]
  v_mfma_f32_16x16x16_bf16 v[24:27], v[40:41], v[20:21], v[24:27]
  v_mfma_f32_16x16x16_bf16 v[28:31], v[40:41], v[22:23], v[28:31]
  v_mov_b64 v[36:37], 0
  v_mov_b64 v[38:39], 0
  v_mov_b64 v[40:41], 0
  v_mov_b64 v[42:43], 0
  v_mov_b64 v[44:45], 0
  v_mov_b64 v[46:47], 0
  v_rcp_f32 v13, v32
  v_mov_b64 v[48:49], 0
  v_mul_f32 v24, v13, v24
  v_mul_f32 v25, v13, v25
  v_mul_f32 v26, v13, v26
  v_mul_f32 v27, v13, v27
  v_cvt_pk_bf16_f32 v24, v24, v25
  v_cvt_pk_bf16_f32 v25, v26, v27
  v_mul_f32 v28, v13, v28
  v_mul_f32 v29, v13, v29
  v_mul_f32 v30, v13, v30
  v_mul_f32 v31, v13, v31
  v_cvt_pk_bf16_f32 v26, v28, v29
  v_cvt_pk_bf16_f32 v27, v30, v31
  s_mov_b64 exec, s[42:43]
  ds_write_b128 v10, v[24:27]
  s_mov_b64 exec, -1
  v_mov_b64 v[50:51], 0
  v_mov_b64 v[52:53], 0
  v_mov_b64 v[54:55], 0
  v_mov_b64 v[56:57], 0
  v_mov_b64 v[58:59], 0
  v_mov_b64 v[60:61], 0
  v_mov_b64 v[62:63], 0
  v_mov_b64 v[64:65], 0
  v_mov_b64 v[66:67], 0
  v_mov_b64 v[68:69], 0
  v_mov_b64 v[70:71], 0
  s_waitcnt lgkmcnt(0)
  s_barrier
  ds_read_b128 v[16:19], v1 offset:8192
  ds_read_b128 v[20:23], v1 offset:9216
  s_waitcnt lgkmcnt(1)
  v_smfmac_f32_16x16x64_bf16 v[36:39], v[16:19], a[112:119], v5
  s_waitcnt lgkmcnt(0)
  v_smfmac_f32_16x16x64_bf16 v[36:39], v[20:23], a[120:127], v5
  v_smfmac_f32_16x16x64_bf16 v[40:43], v[16:19], a[128:135], v5
  v_smfmac_f32_16x16x64_bf16 v[40:43], v[20:23], a[136:143], v5
  v_smfmac_f32_16x16x64_bf16 v[44:47], v[16:19], a[144:151], v5
  v_smfmac_f32_16x16x64_bf16 v[44:47], v[20:23], a[152:159], v5
  v_smfmac_f32_16x16x64_bf16 v[48:51], v[16:19], a[160:167], v5
  s_nop 2
  v_add_f32 v36, v36, v38
  v_add_f32 v37, v37, v39
  v_smfmac_f32_16x16x64_bf16 v[48:51], v[20:23], a[168:175], v5
  v_cvt_pk_bf16_f32 v24, v36, v37
  v_and_b32 v24, -2, v24
  v_smfmac_f32_16x16x64_bf16 v[52:55], v[16:19], a[176:183], v5
  v_add_f32 v40, v40, v42
  v_add_f32 v41, v41, v43
  v_smfmac_f32_16x16x64_bf16 v[52:55], v[20:23], a[184:191], v5
  v_cvt_pk_bf16_f32 v25, v40, v41
  v_and_b32 v25, -2, v25
  v_smfmac_f32_16x16x64_bf16 v[56:59], v[16:19], a[192:199], v5
  v_add_f32 v44, v44, v46
  v_add_f32 v45, v45, v47
  v_smfmac_f32_16x16x64_bf16 v[56:59], v[20:23], a[200:207], v5
  v_cvt_pk_bf16_f32 v26, v44, v45
  v_and_b32 v26, -2, v26
  v_smfmac_f32_16x16x64_bf16 v[60:63], v[16:19], a[208:215], v5
  v_add_f32 v48, v48, v50
  v_add_f32 v49, v49, v51
  v_smfmac_f32_16x16x64_bf16 v[60:63], v[20:23], a[216:223], v5
  v_cvt_pk_bf16_f32 v27, v48, v49
  v_and_b32 v27, -2, v27
  v_smfmac_f32_16x16x64_bf16 v[64:67], v[16:19], a[224:231], v5
  buffer_store_dwordx4 v[24:27], v1, s[4:7], s21 offen offset:0 sc1
  v_add_f32 v52, v52, v54
  v_smfmac_f32_16x16x64_bf16 v[64:67], v[20:23], a[232:239], v5
  v_add_f32 v53, v53, v55
  v_cvt_pk_bf16_f32 v28, v52, v53
  v_smfmac_f32_16x16x64_bf16 v[68:71], v[16:19], a[240:247], v5
  v_and_b32 v28, -2, v28
  v_add_f32 v56, v56, v58
  v_smfmac_f32_16x16x64_bf16 v[68:71], v[20:23], a[248:255], v5
  v_add_f32 v57, v57, v59
  v_cvt_pk_bf16_f32 v29, v56, v57
  ds_read_b128 v[16:19], v1 offset:31744
  v_and_b32 v29, -2, v29
  v_add_f32 v60, v60, v62
  v_add_f32 v61, v61, v63
  v_cvt_pk_bf16_f32 v30, v60, v61
  v_and_b32 v30, -2, v30
  v_add_f32 v64, v64, v66
  v_add_f32 v65, v65, v67
  v_cvt_pk_bf16_f32 v31, v64, v65
  v_and_b32 v31, -2, v31
  buffer_store_dwordx4 v[28:31], v1, s[4:7], s21 offen offset:1024 sc1
  v_add_f32 v68, v68, v70
  v_add_f32 v69, v69, v71
  v_cvt_pk_bf16_f32 v32, v68, v69
  v_and_b32 v32, -2, v32
  buffer_store_dword v32, v6, s[4:7], s59 offen sc1
  s_cmp_eq_u32 s25, -1
  s_cbranch_scc1 nored_125
  s_mov_b32 s29, 0
  v_mov_b64 v[24:25], 0
  v_mov_b64 v[26:27], 0
  v_mov_b64 v[28:29], 0
  v_mov_b64 v[30:31], 0
  v_mov_b64 v[32:33], 0
  v_mov_b64 v[34:35], 0
  v_mov_b64 v[36:37], 0
  v_mov_b64 v[38:39], 0
  v_mov_b64 v[40:41], 0
  v_mov_b64 v[42:43], 0
  v_mov_b64 v[44:45], 0
  v_mov_b64 v[46:47], 0
  s_add_u32 s19, s23, s26
  s_add_u32 s20, s22, s26
  s_mov_b32 s58, s23
  s_mov_b32 s27, s22
  s_mov_b32 s22, s23
  s_mov_b32 s23, s24
  s_mov_b32 s24, s27
  s_add_u32 s37, s37, 262144
  s_add_u32 s45, s45, 262144
  s_add_u32 s38, s38, 65536
  s_add_u32 s39, s39, 65536
  s_add_u32 s18, s18, 1
  s_add_u32 s100, s100, 1
  s_cmp_eq_u32 s100, 7
  s_cselect_b32 s100, 0, s100
  s_addc_u32 s101, s101, 0
  s_lshl_b32 s82, s100, 7
  s_add_u32 s82, s82, s81
  v_mov_b64 v[64:65], 0
  v_mov_b64 v[66:67], 0
  s_sleep 4
  buffer_load_dwordx4 v[48:51], v11, s[4:7], s46 offen sc1
  buffer_load_dwordx4 v[52:55], v11, s[4:7], s47 offen sc1
  buffer_load_dwordx4 v[56:59], v11, s[4:7], s48 offen sc1
  buffer_load_dwordx4 v[60:63], v11, s[4:7], s49 offen sc1
  s_waitcnt lgkmcnt(0)
  s_waitcnt vmcnt(3)
  v_mfma_f32_16x16x32_bf16 v[20:23], v[48:51], v[16:19], 0
  v_bitop3_b32 v13, v48, v49, v50 bitop3:0xfe
  s_waitcnt vmcnt(2)
  v_mfma_f32_16x16x32_bf16 v[20:23], v[52:55], v[16:19], v[20:23]
  v_bitop3_b32 v13, v13, v51, v52 bitop3:0xfe
  v_bitop3_b32 v13, v13, v53, v54 bitop3:0xfe
  s_waitcnt vmcnt(1)
  v_mfma_f32_16x16x32_bf16 v[20:23], v[56:59], v[16:19], v[20:23]
  v_bitop3_b32 v13, v13, v55, v56 bitop3:0xfe
  v_bitop3_b32 v13, v13, v57, v58 bitop3:0xfe
  s_waitcnt vmcnt(0)
  v_mfma_f32_16x16x32_bf16 v[20:23], v[60:63], v[16:19], v[20:23]
  v_bitop3_b32 v13, v13, v59, v60 bitop3:0xfe
  v_bitop3_b32 v13, v13, v61, v62 bitop3:0xfe
  v_bitop3_b32 v13, v13, v63, v63 bitop3:0xfe
  s_add_u32 s29, s29, 1
  v_and_b32 v13, 1, v13
  v_cmp_ne_u32 vcc, 0, v13
  s_cbranch_vccz redok_128
redp_127:
  buffer_load_dwordx4 v[48:51], v11, s[4:7], s46 offen sc1
  buffer_load_dwordx4 v[52:55], v11, s[4:7], s47 offen sc1
  buffer_load_dwordx4 v[56:59], v11, s[4:7], s48 offen sc1
  buffer_load_dwordx4 v[60:63], v11, s[4:7], s49 offen sc1
  s_add_u32 s29, s29, 1
  s_waitcnt vmcnt(3)
  v_mfma_f32_16x16x32_bf16 v[20:23], v[48:51], v[16:19], 0
  v_bitop3_b32 v13, v48, v49, v50 bitop3:0xfe
  s_waitcnt vmcnt(2)
  v_mfma_f32_16x16x32_bf16 v[20:23], v[52:55], v[16:19], v[20:23]
  v_bitop3_b32 v13, v13, v51, v52 bitop3:0xfe
  v_bitop3_b32 v13, v13, v53, v54 bitop3:0xfe
  s_waitcnt vmcnt(1)
  v_mfma_f32_16x16x32_bf16 v[20:23], v[56:59], v[16:19], v[20:23]
  v_bitop3_b32 v13, v13, v55, v56 bitop3:0xfe
  v_bitop3_b32 v13, v13, v57, v58 bitop3:0xfe
  s_waitcnt vmcnt(0)
  v_mfma_f32_16x16x32_bf16 v[20:23], v[60:63], v[16:19], v[20:23]
  v_bitop3_b32 v13, v13, v59, v60 bitop3:0xfe
  v_bitop3_b32 v13, v13, v61, v62 bitop3:0xfe
  v_bitop3_b32 v13, v13, v63, v63 bitop3:0xfe
  s_nop 0
  v_and_b32 v13, 1, v13
  v_cmp_ne_u32 vcc, 0, v13
  s_cbranch_vccz redok_128
  s_cmp_lg_u32 s44, 0
  s_cbranch_scc1 redok_128_d
  s_cmp_lt_u32 s29, 0x10000
  s_cbranch_scc1 redp_127
  s_mov_b32 s44, 1
redok_128_d:
  s_waitcnt vmcnt(0)
redok_128_m:
  v_mfma_f32_16x16x32_bf16 v[20:23], v[48:51], v[16:19], 0
  v_mfma_f32_16x16x32_bf16 v[20:23], v[52:55], v[16:19], v[20:23]
  v_mfma_f32_16x16x32_bf16 v[20:23], v[56:59], v[16:19], v[20:23]
  v_mfma_f32_16x16x32_bf16 v[20:23], v[60:63], v[16:19], v[20:23]
  s_nop 5
redok_128:
  s_nop 1
  v_permlane32_swap_b32 v20, v21
  v_permlane32_swap_b32 v22, v23
  v_add_f32 v20, v20, v21
  v_add_f32 v22, v22, v23
  v_cvt_pk_bf16_f32 v20, v20, v22
  s_mov_b64 exec, s[42:43]
  buffer_store_dword v20, v12, s[4:7], s19 offen sc1
  v_mov_b32 v22, -1
  buffer_store_dword v22, v12, s[4:7], s20 offen sc1
  s_mov_b64 exec, -1
  s_waitcnt vmcnt(2)
  s_add_u32 s76, s76, s29
  s_branch gat_126
nored_125:
  s_cmp_eq_u32 s17, 3
  s_cbranch_scc0 nkv_129
  s_cmp_lt_u32 s18, 62
  s_cbranch_scc0 nkv_129
  v_readfirstlane_b32 s29, v12
  s_nop 3
  s_cmp_gt_u32 s29, s101
  s_cbranch_scc1 nkv_129
  s_lshl_b32 s27, s100, 7
  s_lshl_b32 s28, s16, 2
  s_add_u32 s27, s27, s28
  s_add_u32 s27, s27, 2162816
  s_mov_b32 s28, 0
  v_mov_b32 v13, 0
kvw_130:
  buffer_load_dword v14, v13, s[4:7], s27 offen sc1
  s_add_u32 s28, s28, 1
  s_waitcnt vmcnt(0)
  v_readfirstlane_b32 s29, v14
  s_nop 3
  s_cmp_gt_u32 s29, s101
  s_cbranch_scc1 kvd_131
  s_sleep 2
  s_cmp_lg_u32 s44, 0
  s_cbranch_scc1 kvd_131
  s_cmp_lt_u32 s28, 0x40000
  s_cbranch_scc1 kvw_130
  s_mov_b32 s44, 1
kvd_131:
nkv_129:
  s_cmp_eq_u32 s17, 3
  s_cbranch_scc0 nkx_132
  s_add_u32 s36, s36, 262144
  s_mov_b32 m0, 154624
  s_add_u32 s29, s36, 4096
  buffer_load_dwordx4 v1, s[4:7], s36 offen offset:0 sc1 lds
  buffer_load_dwordx4 v1, s[4:7], s36 offen offset:1024 sc1 lds
  buffer_load_dwordx4 v1, s[4:7], s36 offen offset:2048 sc1 lds
  buffer_load_dwordx4 v1, s[4:7], s36 offen offset:3072 sc1 lds
  s_mov_b32 m0, 158720
  s_nop 0
  buffer_load_dwordx4 v1, s[4:7], s29 offen offset:0 sc1 lds
  buffer_load_dwordx4 v1, s[4:7], s29 offen offset:1024 sc1 lds
  buffer_load_dwordx4 v1, s[4:7], s29 offen offset:2048 sc1 lds
  buffer_load_dwordx4 v1, s[4:7], s29 offen offset:3072 sc1 lds
nkx_132:
  v_mov_b64 v[24:25], 0
  v_mov_b64 v[26:27], 0
  v_mov_b64 v[28:29], 0
  v_mov_b64 v[30:31], 0
  v_mov_b64 v[32:33], 0
  v_mov_b64 v[34:35], 0
  v_mov_b64 v[36:37], 0
  v_mov_b64 v[38:39], 0
  v_mov_b64 v[40:41], 0
  v_mov_b64 v[42:43], 0
  v_mov_b64 v[44:45], 0
  v_mov_b64 v[46:47], 0
  s_add_u32 s19, s23, s26
  s_add_u32 s20, s22, s26
  s_mov_b32 s58, s23
  s_mov_b32 s27, s22
  s_mov_b32 s22, s23
  s_mov_b32 s23, s24
  s_mov_b32 s24, s27
  s_add_u32 s37, s37, 262144
  s_add_u32 s45, s45, 262144
  s_add_u32 s38, s38, 65536
  s_add_u32 s39, s39, 65536
  s_add_u32 s18, s18, 1
  s_add_u32 s100, s100, 1
  s_cmp_eq_u32 s100, 7
  s_cselect_b32 s100, 0, s100
  s_addc_u32 s101, s101, 0
  s_lshl_b32 s82, s100, 7
  s_add_u32 s82, s82, s81
  v_mov_b64 v[64:65], 0
  v_mov_b64 v[66:67], 0
gat_126:
  s_lshl_b32 s27, s17, 15
  v_add_u32 v15, s27, v2
  ds_read_b128 v[48:51], v15 offset:0
  ds_read_b128 v[52:55], v15 offset:1024
  ds_read_b128 v[56:59], v15 offset:8192
  ds_read_b128 v[60:63], v15 offset:9216
  s_barrier
  s_mov_b32 s29, 0
  s_add_u32 s28, s58, 8192
  s_sleep 3
  buffer_load_dwordx4 v[16:19], v4, s[4:7], s58 offen sc1
  buffer_load_dwordx4 v[20:23], v4, s[4:7], s58 offen offset:1024 sc1
  s_cmp_eq_u32 s17, 3
  s_cbranch_scc0 gat3_137
  buffer_load_dwordx4 v[64:67], v1, s[4:7], s28 offen sc1
gat3_137:
  s_add_u32 s29, s29, 1
  s_waitcnt vmcnt(0)
  v_max3_u32 v13, v16, v17, v18
  v_max3_u32 v14, v20, v21, v22
  v_max3_u32 v13, v13, v19, v23
  v_max3_u32 v14, v14, v64, v65
  v_max3_u32 v13, v13, v66, v67
  v_max_u32 v13, v13, v14
  v_cmp_eq_u32 vcc, -1, v13
  s_cbranch_vccz gatok_134
gatp_133:
  buffer_load_dwordx4 v[16:19], v4, s[4:7], s58 offen sc1
  buffer_load_dwordx4 v[20:23], v4, s[4:7], s58 offen offset:1024 sc1
  s_cmp_eq_u32 s17, 3
  s_cbranch_scc0 gat3_138
  buffer_load_dwordx4 v[64:67], v1, s[4:7], s28 offen sc1
gat3_138:
  s_add_u32 s29, s29, 1
  s_waitcnt vmcnt(0)
  v_max3_u32 v13, v16, v17, v18
  v_max3_u32 v14, v20, v21, v22
  v_max3_u32 v13, v13, v19, v23
  v_max3_u32 v14, v14, v64, v65
  v_max3_u32 v13, v13, v66, v67
  v_max_u32 v13, v13, v14
  v_cmp_eq_u32 vcc, -1, v13
  s_cbranch_vccz gatok_134
  s_cmp_lg_u32 s44, 0
  s_cbranch_scc1 gatok_134
  s_cmp_lt_u32 s29, 0x10000
  s_cbranch_scc1 gatp_133
  s_mov_b32 s44, 1
gatok_134:
  ds_write_b128 v4, v[16:19] offset:8192
  ds_write_b128 v4, v[20:23] offset:9216
  s_cmp_eq_u32 s17, 3
  s_cbranch_scc0 gat3b_139
  ds_write_b128 v1, v[64:67] offset:16384
gat3b_139:
  s_add_u32 s77, s77, s29
  s_cmp_lt_u32 s18, 64
  s_cbranch_scc1 ch_loop_s
ch_last_s:
  s_waitcnt vmcnt(0) lgkmcnt(0)
  s_barrier
  s_cmp_eq_u32 s17, 3
  s_cbranch_scc0 pfl_140
  s_mov_b64 exec, 1
  v_mov_b32 v13, 0
  v_mov_b32 v14, 64
  buffer_store_dword v14, v13, s[4:7], s99 offen sc1
  s_mov_b64 exec, -1
pfl_140:
ch_done:
  s_waitcnt vmcnt(0) lgkmcnt(0)
  s_branch k_end
k_worker:
  s_sub_u32 s18, s3, 1
  s_cmp_eq_u32 s18, 0
  s_cselect_b32 s21, 10, 9
  s_mov_b32 s22, 1
  s_mov_b32 s53, s3
  s_mov_b32 s44, 0
  s_getpc_b64 s[30:31]
  s_add_u32 s30, s30, worker_tab@rel32@lo+4
  s_addc_u32 s31, s31, worker_tab@rel32@hi+12
  v_mov_b32 v2, 192
  v_mul_u32_u24 v2, v2, v0
  global_load_dword v3, v2, s[30:31] offset:4
  global_load_dword v4, v2, s[30:31] offset:8
  s_waitcnt vmcnt(0)
  s_lshl_b32 s23, s18, 8
  s_lshl_b32 s24, s16, 2
  s_add_u32 s23, s23, s24
  s_add_u32 s23, s23, 2170880
  v_mov_b32 v60, 0
  buffer_store_dword v60, v60, s[4:7], s23 offen sc1
  buffer_store_dword v60, v60, s[4:7], s23 offen offset:128 sc1
  s_cmp_eq_u32 s18, 0
  s_cbranch_scc0 ftc_141
  v_mov_b64 v[8:9], -1
  v_mov_b64 v[10:11], -1
  v_lshlrev_b32 v12, 3, v0
  s_add_u32 s23, s16, 2016
  s_lshl_b32 s23, s23, 11
  s_add_u32 s24, s23, 37748736
  buffer_store_dwordx2 v[8:9], v12, s[4:7], s24 offen sc1
  s_add_u32 s24, s23, 46137344
  buffer_store_dwordx2 v[8:9], v12, s[4:7], s24 offen sc1
  v_lshlrev_b32 v12, 4, v0
  s_mul_i32 s23, s16, 36864
  s_add_u32 s23, s23, 83623936
  buffer_store_dwordx4 v[8:11], v12, s[4:7], s23 offen sc1
  s_add_u32 s23, s23, 4096
  buffer_store_dwordx4 v[8:11], v12, s[4:7], s23 offen sc1
  s_add_u32 s23, s23, 4096
  buffer_store_dwordx4 v[8:11], v12, s[4:7], s23 offen sc1
  s_add_u32 s23, s23, 4096
  buffer_store_dwordx4 v[8:11], v12, s[4:7], s23 offen sc1
  s_add_u32 s23, s23, 4096
  buffer_store_dwordx4 v[8:11], v12, s[4:7], s23 offen sc1
  s_add_u32 s23, s23, 4096
  buffer_store_dwordx4 v[8:11], v12, s[4:7], s23 offen sc1
  s_add_u32 s23, s23, 4096
  buffer_store_dwordx4 v[8:11], v12, s[4:7], s23 offen sc1
  s_add_u32 s23, s23, 4096
  buffer_store_dwordx4 v[8:11], v12, s[4:7], s23 offen sc1
  s_add_u32 s23, s23, 4096
  buffer_store_dwordx4 v[8:11], v12, s[4:7], s23 offen sc1
ftc_141:
  s_lshl_b32 s23, s17, 5
  s_add_u32 s23, s23, s16
  s_lshl_b32 s24, s21, 2
  s_cmp_lt_u32 s23, s24
  s_cbranch_scc0 lnd_142
  s_lshr_b32 s24, s23, 2
  s_mul_i32 s24, s24, 7
  s_add_u32 s24, s24, s18
  s_and_b32 s25, s23, 3
  s_lshl_b32 s26, s24, 2
  s_add_u32 s26, s26, s25
  s_mul_i32 s36, s26, 9216
  s_mul_i32 s37, s24, 36864
  s_lshl_b32 s25, s25, 7
  s_add_u32 s37, s37, s25
  s_load_dwordx2 s[32:33], s[0:1], 0
  s_waitcnt lgkmcnt(0)
  s_mov_b32 s8, s32
  s_and_b32 s9, s33, 0xffff
  s_mov_b32 s10, 2359296
  s_mov_b32 s11, 0x20000
  buffer_load_dwordx4 v[64:67], v3, s[8:11], s36 offen offset:0
  buffer_load_dwordx4 v[68:71], v3, s[8:11], s36 offen offset:128
  buffer_load_dwordx4 v[72:75], v3, s[8:11], s36 offen offset:256
  buffer_load_dwordx4 v[76:79], v3, s[8:11], s36 offen offset:384
  buffer_load_dwordx4 v[80:83], v3, s[8:11], s36 offen offset:512
  buffer_load_dwordx4 v[84:87], v3, s[8:11], s36 offen offset:640
  buffer_load_dwordx4 v[88:91], v3, s[8:11], s36 offen offset:768
  buffer_load_dwordx4 v[92:95], v3, s[8:11], s36 offen offset:896
  buffer_load_dwordx4 v[96:99], v3, s[8:11], s36 offen offset:1024
  s_mov_b32 s38, 0xffff0000
  s_waitcnt vmcnt(8)
  v_lshlrev_b32 v100, 16, v64
  v_and_b32 v101, s38, v64
  v_lshlrev_b32 v102, 16, v65
  v_and_b32 v103, s38, v65
  v_lshlrev_b32 v104, 16, v66
  v_and_b32 v105, s38, v66
  v_lshlrev_b32 v106, 16, v67
  v_and_b32 v107, s38, v67
  s_waitcnt vmcnt(7)
  v_lshlrev_b32 v108, 16, v68
  v_and_b32 v109, s38, v68
  v_lshlrev_b32 v110, 16, v69
  v_and_b32 v111, s38, v69
  v_lshlrev_b32 v112, 16, v70
  v_and_b32 v113, s38, v70
  v_lshlrev_b32 v114, 16, v71
  v_and_b32 v115, s38, v71
  s_waitcnt vmcnt(6)
  v_lshlrev_b32 v116, 16, v72
  v_and_b32 v117, s38, v72
  v_lshlrev_b32 v118, 16, v73
  v_and_b32 v119, s38, v73
  v_lshlrev_b32 v120, 16, v74
  v_and_b32 v121, s38, v74
  v_lshlrev_b32 v122, 16, v75
  v_and_b32 v123, s38, v75
  s_waitcnt vmcnt(5)
  v_lshlrev_b32 v124, 16, v76
  v_and_b32 v125, s38, v76
  v_lshlrev_b32 v126, 16, v77
  v_and_b32 v127, s38, v77
  v_lshlrev_b32 v128, 16, v78
  v_and_b32 v129, s38, v78
  v_lshlrev_b32 v130, 16, v79
  v_and_b32 v131, s38, v79
  s_waitcnt vmcnt(4)
  v_lshlrev_b32 v132, 16, v80
  v_and_b32 v133, s38, v80
  v_lshlrev_b32 v134, 16, v81
  v_and_b32 v135, s38, v81
  v_lshlrev_b32 v136, 16, v82
  v_and_b32 v137, s38, v82
  v_lshlrev_b32 v138, 16, v83
  v_and_b32 v139, s38, v83
  s_waitcnt vmcnt(3)
  v_lshlrev_b32 v140, 16, v84
  v_and_b32 v141, s38, v84
  v_lshlrev_b32 v142, 16, v85
  v_and_b32 v143, s38, v85
  v_lshlrev_b32 v144, 16, v86
  v_and_b32 v145, s38, v86
  v_lshlrev_b32 v146, 16, v87
  v_and_b32 v147, s38, v87
  s_waitcnt vmcnt(2)
  v_lshlrev_b32 v148, 16, v88
  v_and_b32 v149, s38, v88
  v_lshlrev_b32 v150, 16, v89
  v_and_b32 v151, s38, v89
  v_lshlrev_b32 v152, 16, v90
  v_and_b32 v153, s38, v90
  v_lshlrev_b32 v154, 16, v91
  v_and_b32 v155, s38, v91
  s_waitcnt vmcnt(1)
  v_lshlrev_b32 v156, 16, v92
  v_and_b32 v157, s38, v92
  v_lshlrev_b32 v158, 16, v93
  v_and_b32 v159, s38, v93
  v_lshlrev_b32 v160, 16, v94
  v_and_b32 v161, s38, v94
  v_lshlrev_b32 v162, 16, v95
  v_and_b32 v163, s38, v95
  s_waitcnt vmcnt(0)
  v_lshlrev_b32 v164, 16, v96
  v_and_b32 v165, s38, v96
  v_lshlrev_b32 v166, 16, v97
  v_and_b32 v167, s38, v97
  v_lshlrev_b32 v168, 16, v98
  v_and_b32 v169, s38, v98
  v_lshlrev_b32 v170, 16, v99
  v_and_b32 v171, s38, v99
  v_mov_b32 v10, v100
  v_mov_b32 v11, v101
  v_mov_b32 v12, v102
  v_mov_b32 v13, v103
  v_add_f32 v10, v10, v104
  v_add_f32 v11, v11, v105
  v_add_f32 v12, v12, v106
  v_add_f32 v13, v13, v107
  v_add_f32 v10, v10, v108
  v_add_f32 v11, v11, v109
  v_add_f32 v12, v12, v110
  v_add_f32 v13, v13, v111
  v_add_f32 v10, v10, v112
  v_add_f32 v11, v11, v113
  v_add_f32 v12, v12, v114
  v_add_f32 v13, v13, v115
  v_add_f32 v10, v10, v116
  v_add_f32 v11, v11, v117
  v_add_f32 v12, v12, v118
  v_add_f32 v13, v13, v119
  v_add_f32 v10, v10, v120
  v_add_f32 v11, v11, v121
  v_add_f32 v12, v12, v122
  v_add_f32 v13, v13, v123
  v_add_f32 v10, v10, v124
  v_add_f32 v11, v11, v125
  v_add_f32 v12, v12, v126
  v_add_f32 v13, v13, v127
  v_add_f32 v10, v10, v128
  v_add_f32 v11, v11, v129
  v_add_f32 v12, v12, v130
  v_add_f32 v13, v13, v131
  v_add_f32 v10, v10, v132
  v_add_f32 v11, v11, v133
  v_add_f32 v12, v12, v134
  v_add_f32 v13, v13, v135
  v_add_f32 v10, v10, v136
  v_add_f32 v11, v11, v137
  v_add_f32 v12, v12, v138
  v_add_f32 v13, v13, v139
  v_add_f32 v10, v10, v140
  v_add_f32 v11, v11, v141
  v_add_f32 v12, v12, v142
  v_add_f32 v13, v13, v143
  v_add_f32 v10, v10, v144
  v_add_f32 v11, v11, v145
  v_add_f32 v12, v12, v146
  v_add_f32 v13, v13, v147
  v_add_f32 v10, v10, v148
  v_add_f32 v11, v11, v149
  v_add_f32 v12, v12, v150
  v_add_f32 v13, v13, v151
  v_add_f32 v10, v10, v152
  v_add_f32 v11, v11, v153
  v_add_f32 v12, v12, v154
  v_add_f32 v13, v13, v155
  v_add_f32 v10, v10, v156
  v_add_f32 v11, v11, v157
  v_add_f32 v12, v12, v158
  v_add_f32 v13, v13, v159
  v_add_f32 v10, v10, v160
  v_add_f32 v11, v11, v161
  v_add_f32 v12, v12, v162
  v_add_f32 v13, v13, v163
  v_add_f32 v10, v10, v164
  v_add_f32 v11, v11, v165
  v_add_f32 v12, v12, v166
  v_add_f32 v13, v13, v167
  v_add_f32 v10, v10, v168
  v_add_f32 v11, v11, v169
  v_add_f32 v12, v12, v170
  v_add_f32 v13, v13, v171
  v_add_f32 v10, v10, v11
  v_add_f32 v12, v12, v13
  v_add_f32 v10, v10, v12
  s_nop 1
  v_add_f32_dpp v10, v10, v10 quad_perm:[1,0,3,2] row_mask:0xf bank_mask:0xf
  s_nop 1
  v_add_f32_dpp v10, v10, v10 quad_perm:[2,3,0,1] row_mask:0xf bank_mask:0xf
  s_nop 1
  v_add_f32_dpp v10, v10, v10 row_half_mirror row_mask:0xf bank_mask:0xf
  v_mul_f32 v10, 0x3ae38e39, v10
  v_mov_b32 v11, 0
  v_mov_b32 v12, 0
  v_mov_b32 v13, 0
  v_mov_b32 v14, 0
  v_sub_f32 v15, v100, v10
  v_fmac_f32 v11, v15, v15
  v_sub_f32 v15, v101, v10
  v_fmac_f32 v12, v15, v15
  v_sub_f32 v15, v102, v10
  v_fmac_f32 v13, v15, v15
  v_sub_f32 v15, v103, v10
  v_fmac_f32 v14, v15, v15
  v_sub_f32 v15, v104, v10
  v_fmac_f32 v11, v15, v15
  v_sub_f32 v15, v105, v10
  v_fmac_f32 v12, v15, v15
  v_sub_f32 v15, v106, v10
  v_fmac_f32 v13, v15, v15
  v_sub_f32 v15, v107, v10
  v_fmac_f32 v14, v15, v15
  v_sub_f32 v15, v108, v10
  v_fmac_f32 v11, v15, v15
  v_sub_f32 v15, v109, v10
  v_fmac_f32 v12, v15, v15
  v_sub_f32 v15, v110, v10
  v_fmac_f32 v13, v15, v15
  v_sub_f32 v15, v111, v10
  v_fmac_f32 v14, v15, v15
  v_sub_f32 v15, v112, v10
  v_fmac_f32 v11, v15, v15
  v_sub_f32 v15, v113, v10
  v_fmac_f32 v12, v15, v15
  v_sub_f32 v15, v114, v10
  v_fmac_f32 v13, v15, v15
  v_sub_f32 v15, v115, v10
  v_fmac_f32 v14, v15, v15
  v_sub_f32 v15, v116, v10
  v_fmac_f32 v11, v15, v15
  v_sub_f32 v15, v117, v10
  v_fmac_f32 v12, v15, v15
  v_sub_f32 v15, v118, v10
  v_fmac_f32 v13, v15, v15
  v_sub_f32 v15, v119, v10
  v_fmac_f32 v14, v15, v15
  v_sub_f32 v15, v120, v10
  v_fmac_f32 v11, v15, v15
  v_sub_f32 v15, v121, v10
  v_fmac_f32 v12, v15, v15
  v_sub_f32 v15, v122, v10
  v_fmac_f32 v13, v15, v15
  v_sub_f32 v15, v123, v10
  v_fmac_f32 v14, v15, v15
  v_sub_f32 v15, v124, v10
  v_fmac_f32 v11, v15, v15
  v_sub_f32 v15, v125, v10
  v_fmac_f32 v12, v15, v15
  v_sub_f32 v15, v126, v10
  v_fmac_f32 v13, v15, v15
  v_sub_f32 v15, v127, v10
  v_fmac_f32 v14, v15, v15
  v_sub_f32 v15, v128, v10
  v_fmac_f32 v11, v15, v15
  v_sub_f32 v15, v129, v10
  v_fmac_f32 v12, v15, v15
  v_sub_f32 v15, v130, v10
  v_fmac_f32 v13, v15, v15
  v_sub_f32 v15, v131, v10
  v_fmac_f32 v14, v15, v15
  v_sub_f32 v15, v132, v10
  v_fmac_f32 v11, v15, v15
  v_sub_f32 v15, v133, v10
  v_fmac_f32 v12, v15, v15
  v_sub_f32 v15, v134, v10
  v_fmac_f32 v13, v15, v15
  v_sub_f32 v15, v135, v10
  v_fmac_f32 v14, v15, v15
  v_sub_f32 v15, v136, v10
  v_fmac_f32 v11, v15, v15
  v_sub_f32 v15, v137, v10
  v_fmac_f32 v12, v15, v15
  v_sub_f32 v15, v138, v10
  v_fmac_f32 v13, v15, v15
  v_sub_f32 v15, v139, v10
  v_fmac_f32 v14, v15, v15
  v_sub_f32 v15, v140, v10
  v_fmac_f32 v11, v15, v15
  v_sub_f32 v15, v141, v10
  v_fmac_f32 v12, v15, v15
  v_sub_f32 v15, v142, v10
  v_fmac_f32 v13, v15, v15
  v_sub_f32 v15, v143, v10
  v_fmac_f32 v14, v15, v15
  v_sub_f32 v15, v144, v10
  v_fmac_f32 v11, v15, v15
  v_sub_f32 v15, v145, v10
  v_fmac_f32 v12, v15, v15
  v_sub_f32 v15, v146, v10
  v_fmac_f32 v13, v15, v15
  v_sub_f32 v15, v147, v10
  v_fmac_f32 v14, v15, v15
  v_sub_f32 v15, v148, v10
  v_fmac_f32 v11, v15, v15
  v_sub_f32 v15, v149, v10
  v_fmac_f32 v12, v15, v15
  v_sub_f32 v15, v150, v10
  v_fmac_f32 v13, v15, v15
  v_sub_f32 v15, v151, v10
  v_fmac_f32 v14, v15, v15
  v_sub_f32 v15, v152, v10
  v_fmac_f32 v11, v15, v15
  v_sub_f32 v15, v153, v10
  v_fmac_f32 v12, v15, v15
  v_sub_f32 v15, v154, v10
  v_fmac_f32 v13, v15, v15
  v_sub_f32 v15, v155, v10
  v_fmac_f32 v14, v15, v15
  v_sub_f32 v15, v156, v10
  v_fmac_f32 v11, v15, v15
  v_sub_f32 v15, v157, v10
  v_fmac_f32 v12, v15, v15
  v_sub_f32 v15, v158, v10
  v_fmac_f32 v13, v15, v15
  v_sub_f32 v15, v159, v10
  v_fmac_f32 v14, v15, v15
  v_sub_f32 v15, v160, v10
  v_fmac_f32 v11, v15, v15
  v_sub_f32 v15, v161, v10
  v_fmac_f32 v12, v15, v15
  v_sub_f32 v15, v162, v10
  v_fmac_f32 v13, v15, v15
  v_sub_f32 v15, v163, v10
  v_fmac_f32 v14, v15, v15
  v_sub_f32 v15, v164, v10
  v_fmac_f32 v11, v15, v15
  v_sub_f32 v15, v165, v10
  v_fmac_f32 v12, v15, v15
  v_sub_f32 v15, v166, v10
  v_fmac_f32 v13, v15, v15
  v_sub_f32 v15, v167, v10
  v_fmac_f32 v14, v15, v15
  v_sub_f32 v15, v168, v10
  v_fmac_f32 v11, v15, v15
  v_sub_f32 v15, v169, v10
  v_fmac_f32 v12, v15, v15
  v_sub_f32 v15, v170, v10
  v_fmac_f32 v13, v15, v15
  v_sub_f32 v15, v171, v10
  v_fmac_f32 v14, v15, v15
  v_add_f32 v11, v11, v12
  v_add_f32 v13, v13, v14
  v_add_f32 v11, v11, v13
  s_nop 1
  v_add_f32_dpp v11, v11, v11 quad_perm:[1,0,3,2] row_mask:0xf bank_mask:0xf
  s_nop 1
  v_add_f32_dpp v11, v11, v11 quad_perm:[2,3,0,1] row_mask:0xf bank_mask:0xf
  s_nop 1
  v_add_f32_dpp v11, v11, v11 row_half_mirror row_mask:0xf bank_mask:0xf
  v_mul_f32 v11, 0x3ae38e39, v11
  v_cvt_pk_bf16_f32 v10, v10, v11
  v_and_b32 v11, s38, v10
  v_lshlrev_b32 v10, 16, v10
  v_add_f32 v11, 0x3727c5ac, v11
  v_cvt_pk_bf16_f32 v11, v11, v11
  v_and_b32 v11, s38, v11
  v_sqrt_f32 v11, v11
  s_nop 0
  v_cvt_pk_bf16_f32 v11, v11, v11
  v_and_b32 v11, s38, v11
  v_rcp_f32 v11, v11
  v_sub_f32 v100, v100, v10
  v_sub_f32 v101, v101, v10
  v_cvt_pk_bf16_f32 v15, v100, v101
  v_lshlrev_b32 v100, 16, v15
  v_and_b32 v101, s38, v15
  v_mul_f32 v100, v11, v100
  v_mul_f32 v101, v11, v101
  v_cvt_pk_bf16_f32 v64, v100, v101
  v_sub_f32 v102, v102, v10
  v_sub_f32 v103, v103, v10
  v_cvt_pk_bf16_f32 v15, v102, v103
  v_lshlrev_b32 v102, 16, v15
  v_and_b32 v103, s38, v15
  v_mul_f32 v102, v11, v102
  v_mul_f32 v103, v11, v103
  v_cvt_pk_bf16_f32 v65, v102, v103
  v_sub_f32 v104, v104, v10
  v_sub_f32 v105, v105, v10
  v_cvt_pk_bf16_f32 v15, v104, v105
  v_lshlrev_b32 v104, 16, v15
  v_and_b32 v105, s38, v15
  v_mul_f32 v104, v11, v104
  v_mul_f32 v105, v11, v105
  v_cvt_pk_bf16_f32 v66, v104, v105
  v_sub_f32 v106, v106, v10
  v_sub_f32 v107, v107, v10
  v_cvt_pk_bf16_f32 v15, v106, v107
  v_lshlrev_b32 v106, 16, v15
  v_and_b32 v107, s38, v15
  v_mul_f32 v106, v11, v106
  v_mul_f32 v107, v11, v107
  v_cvt_pk_bf16_f32 v67, v106, v107
  v_sub_f32 v108, v108, v10
  v_sub_f32 v109, v109, v10
  v_cvt_pk_bf16_f32 v15, v108, v109
  v_lshlrev_b32 v108, 16, v15
  v_and_b32 v109, s38, v15
  v_mul_f32 v108, v11, v108
  v_mul_f32 v109, v11, v109
  v_cvt_pk_bf16_f32 v68, v108, v109
  v_sub_f32 v110, v110, v10
  v_sub_f32 v111, v111, v10
  v_cvt_pk_bf16_f32 v15, v110, v111
  v_lshlrev_b32 v110, 16, v15
  v_and_b32 v111, s38, v15
  v_mul_f32 v110, v11, v110
  v_mul_f32 v111, v11, v111
  v_cvt_pk_bf16_f32 v69, v110, v111
  v_sub_f32 v112, v112, v10
  v_sub_f32 v113, v113, v10
  v_cvt_pk_bf16_f32 v15, v112, v113
  v_lshlrev_b32 v112, 16, v15
  v_and_b32 v113, s38, v15
  v_mul_f32 v112, v11, v112
  v_mul_f32 v113, v11, v113
  v_cvt_pk_bf16_f32 v70, v112, v113
  v_sub_f32 v114, v114, v10
  v_sub_f32 v115, v115, v10
  v_cvt_pk_bf16_f32 v15, v114, v115
  v_lshlrev_b32 v114, 16, v15
  v_and_b32 v115, s38, v15
  v_mul_f32 v114, v11, v114
  v_mul_f32 v115, v11, v115
  v_cvt_pk_bf16_f32 v71, v114, v115
  v_sub_f32 v116, v116, v10
  v_sub_f32 v117, v117, v10
  v_cvt_pk_bf16_f32 v15, v116, v117
  v_lshlrev_b32 v116, 16, v15
  v_and_b32 v117, s38, v15
  v_mul_f32 v116, v11, v116
  v_mul_f32 v117, v11, v117
  v_cvt_pk_bf16_f32 v72, v116, v117
  v_sub_f32 v118, v118, v10
  v_sub_f32 v119, v119, v10
  v_cvt_pk_bf16_f32 v15, v118, v119
  v_lshlrev_b32 v118, 16, v15
  v_and_b32 v119, s38, v15
  v_mul_f32 v118, v11, v118
  v_mul_f32 v119, v11, v119
  v_cvt_pk_bf16_f32 v73, v118, v119
  v_sub_f32 v120, v120, v10
  v_sub_f32 v121, v121, v10
  v_cvt_pk_bf16_f32 v15, v120, v121
  v_lshlrev_b32 v120, 16, v15
  v_and_b32 v121, s38, v15
  v_mul_f32 v120, v11, v120
  v_mul_f32 v121, v11, v121
  v_cvt_pk_bf16_f32 v74, v120, v121
  v_sub_f32 v122, v122, v10
  v_sub_f32 v123, v123, v10
  v_cvt_pk_bf16_f32 v15, v122, v123
  v_lshlrev_b32 v122, 16, v15
  v_and_b32 v123, s38, v15
  v_mul_f32 v122, v11, v122
  v_mul_f32 v123, v11, v123
  v_cvt_pk_bf16_f32 v75, v122, v123
  v_sub_f32 v124, v124, v10
  v_sub_f32 v125, v125, v10
  v_cvt_pk_bf16_f32 v15, v124, v125
  v_lshlrev_b32 v124, 16, v15
  v_and_b32 v125, s38, v15
  v_mul_f32 v124, v11, v124
  v_mul_f32 v125, v11, v125
  v_cvt_pk_bf16_f32 v76, v124, v125
  v_sub_f32 v126, v126, v10
  v_sub_f32 v127, v127, v10
  v_cvt_pk_bf16_f32 v15, v126, v127
  v_lshlrev_b32 v126, 16, v15
  v_and_b32 v127, s38, v15
  v_mul_f32 v126, v11, v126
  v_mul_f32 v127, v11, v127
  v_cvt_pk_bf16_f32 v77, v126, v127
  v_sub_f32 v128, v128, v10
  v_sub_f32 v129, v129, v10
  v_cvt_pk_bf16_f32 v15, v128, v129
  v_lshlrev_b32 v128, 16, v15
  v_and_b32 v129, s38, v15
  v_mul_f32 v128, v11, v128
  v_mul_f32 v129, v11, v129
  v_cvt_pk_bf16_f32 v78, v128, v129
  v_sub_f32 v130, v130, v10
  v_sub_f32 v131, v131, v10
  v_cvt_pk_bf16_f32 v15, v130, v131
  v_lshlrev_b32 v130, 16, v15
  v_and_b32 v131, s38, v15
  v_mul_f32 v130, v11, v130
  v_mul_f32 v131, v11, v131
  v_cvt_pk_bf16_f32 v79, v130, v131
  v_sub_f32 v132, v132, v10
  v_sub_f32 v133, v133, v10
  v_cvt_pk_bf16_f32 v15, v132, v133
  v_lshlrev_b32 v132, 16, v15
  v_and_b32 v133, s38, v15
  v_mul_f32 v132, v11, v132
  v_mul_f32 v133, v11, v133
  v_cvt_pk_bf16_f32 v80, v132, v133
  v_sub_f32 v134, v134, v10
  v_sub_f32 v135, v135, v10
  v_cvt_pk_bf16_f32 v15, v134, v135
  v_lshlrev_b32 v134, 16, v15
  v_and_b32 v135, s38, v15
  v_mul_f32 v134, v11, v134
  v_mul_f32 v135, v11, v135
  v_cvt_pk_bf16_f32 v81, v134, v135
  v_sub_f32 v136, v136, v10
  v_sub_f32 v137, v137, v10
  v_cvt_pk_bf16_f32 v15, v136, v137
  v_lshlrev_b32 v136, 16, v15
  v_and_b32 v137, s38, v15
  v_mul_f32 v136, v11, v136
  v_mul_f32 v137, v11, v137
  v_cvt_pk_bf16_f32 v82, v136, v137
  v_sub_f32 v138, v138, v10
  v_sub_f32 v139, v139, v10
  v_cvt_pk_bf16_f32 v15, v138, v139
  v_lshlrev_b32 v138, 16, v15
  v_and_b32 v139, s38, v15
  v_mul_f32 v138, v11, v138
  v_mul_f32 v139, v11, v139
  v_cvt_pk_bf16_f32 v83, v138, v139
  v_sub_f32 v140, v140, v10
  v_sub_f32 v141, v141, v10
  v_cvt_pk_bf16_f32 v15, v140, v141
  v_lshlrev_b32 v140, 16, v15
  v_and_b32 v141, s38, v15
  v_mul_f32 v140, v11, v140
  v_mul_f32 v141, v11, v141
  v_cvt_pk_bf16_f32 v84, v140, v141
  v_sub_f32 v142, v142, v10
  v_sub_f32 v143, v143, v10
  v_cvt_pk_bf16_f32 v15, v142, v143
  v_lshlrev_b32 v142, 16, v15
  v_and_b32 v143, s38, v15
  v_mul_f32 v142, v11, v142
  v_mul_f32 v143, v11, v143
  v_cvt_pk_bf16_f32 v85, v142, v143
  v_sub_f32 v144, v144, v10
  v_sub_f32 v145, v145, v10
  v_cvt_pk_bf16_f32 v15, v144, v145
  v_lshlrev_b32 v144, 16, v15
  v_and_b32 v145, s38, v15
  v_mul_f32 v144, v11, v144
  v_mul_f32 v145, v11, v145
  v_cvt_pk_bf16_f32 v86, v144, v145
  v_sub_f32 v146, v146, v10
  v_sub_f32 v147, v147, v10
  v_cvt_pk_bf16_f32 v15, v146, v147
  v_lshlrev_b32 v146, 16, v15
  v_and_b32 v147, s38, v15
  v_mul_f32 v146, v11, v146
  v_mul_f32 v147, v11, v147
  v_cvt_pk_bf16_f32 v87, v146, v147
  v_sub_f32 v148, v148, v10
  v_sub_f32 v149, v149, v10
  v_cvt_pk_bf16_f32 v15, v148, v149
  v_lshlrev_b32 v148, 16, v15
  v_and_b32 v149, s38, v15
  v_mul_f32 v148, v11, v148
  v_mul_f32 v149, v11, v149
  v_cvt_pk_bf16_f32 v88, v148, v149
  v_sub_f32 v150, v150, v10
  v_sub_f32 v151, v151, v10
  v_cvt_pk_bf16_f32 v15, v150, v151
  v_lshlrev_b32 v150, 16, v15
  v_and_b32 v151, s38, v15
  v_mul_f32 v150, v11, v150
  v_mul_f32 v151, v11, v151
  v_cvt_pk_bf16_f32 v89, v150, v151
  v_sub_f32 v152, v152, v10
  v_sub_f32 v153, v153, v10
  v_cvt_pk_bf16_f32 v15, v152, v153
  v_lshlrev_b32 v152, 16, v15
  v_and_b32 v153, s38, v15
  v_mul_f32 v152, v11, v152
  v_mul_f32 v153, v11, v153
  v_cvt_pk_bf16_f32 v90, v152, v153
  v_sub_f32 v154, v154, v10
  v_sub_f32 v155, v155, v10
  v_cvt_pk_bf16_f32 v15, v154, v155
  v_lshlrev_b32 v154, 16, v15
  v_and_b32 v155, s38, v15
  v_mul_f32 v154, v11, v154
  v_mul_f32 v155, v11, v155
  v_cvt_pk_bf16_f32 v91, v154, v155
  v_sub_f32 v156, v156, v10
  v_sub_f32 v157, v157, v10
  v_cvt_pk_bf16_f32 v15, v156, v157
  v_lshlrev_b32 v156, 16, v15
  v_and_b32 v157, s38, v15
  v_mul_f32 v156, v11, v156
  v_mul_f32 v157, v11, v157
  v_cvt_pk_bf16_f32 v92, v156, v157
  v_sub_f32 v158, v158, v10
  v_sub_f32 v159, v159, v10
  v_cvt_pk_bf16_f32 v15, v158, v159
  v_lshlrev_b32 v158, 16, v15
  v_and_b32 v159, s38, v15
  v_mul_f32 v158, v11, v158
  v_mul_f32 v159, v11, v159
  v_cvt_pk_bf16_f32 v93, v158, v159
  v_sub_f32 v160, v160, v10
  v_sub_f32 v161, v161, v10
  v_cvt_pk_bf16_f32 v15, v160, v161
  v_lshlrev_b32 v160, 16, v15
  v_and_b32 v161, s38, v15
  v_mul_f32 v160, v11, v160
  v_mul_f32 v161, v11, v161
  v_cvt_pk_bf16_f32 v94, v160, v161
  v_sub_f32 v162, v162, v10
  v_sub_f32 v163, v163, v10
  v_cvt_pk_bf16_f32 v15, v162, v163
  v_lshlrev_b32 v162, 16, v15
  v_and_b32 v163, s38, v15
  v_mul_f32 v162, v11, v162
  v_mul_f32 v163, v11, v163
  v_cvt_pk_bf16_f32 v95, v162, v163
  v_sub_f32 v164, v164, v10
  v_sub_f32 v165, v165, v10
  v_cvt_pk_bf16_f32 v15, v164, v165
  v_lshlrev_b32 v164, 16, v15
  v_and_b32 v165, s38, v15
  v_mul_f32 v164, v11, v164
  v_mul_f32 v165, v11, v165
  v_cvt_pk_bf16_f32 v96, v164, v165
  v_sub_f32 v166, v166, v10
  v_sub_f32 v167, v167, v10
  v_cvt_pk_bf16_f32 v15, v166, v167
  v_lshlrev_b32 v166, 16, v15
  v_and_b32 v167, s38, v15
  v_mul_f32 v166, v11, v166
  v_mul_f32 v167, v11, v167
  v_cvt_pk_bf16_f32 v97, v166, v167
  v_sub_f32 v168, v168, v10
  v_sub_f32 v169, v169, v10
  v_cvt_pk_bf16_f32 v15, v168, v169
  v_lshlrev_b32 v168, 16, v15
  v_and_b32 v169, s38, v15
  v_mul_f32 v168, v11, v168
  v_mul_f32 v169, v11, v169
  v_cvt_pk_bf16_f32 v98, v168, v169
  v_sub_f32 v170, v170, v10
  v_sub_f32 v171, v171, v10
  v_cvt_pk_bf16_f32 v15, v170, v171
  v_lshlrev_b32 v170, 16, v15
  v_and_b32 v171, s38, v15
  v_mul_f32 v170, v11, v170
  v_mul_f32 v171, v11, v171
  v_cvt_pk_bf16_f32 v99, v170, v171
  s_add_u32 s23, s37, 54525952
  buffer_store_dwordx4 v[64:67], v4, s[4:7], s23 offen sc1
  s_add_u32 s23, s37, 54530048
  buffer_store_dwordx4 v[68:71], v4, s[4:7], s23 offen sc1
  s_add_u32 s23, s37, 54534144
  buffer_store_dwordx4 v[72:75], v4, s[4:7], s23 offen sc1
  s_add_u32 s23, s37, 54538240
  buffer_store_dwordx4 v[76:79], v4, s[4:7], s23 offen sc1
  s_add_u32 s23, s37, 54542336
  buffer_store_dwordx4 v[80:83], v4, s[4:7], s23 offen sc1
  s_add_u32 s23, s37, 54546432
  buffer_store_dwordx4 v[84:87], v4, s[4:7], s23 offen sc1
  s_add_u32 s23, s37, 54550528
  buffer_store_dwordx4 v[88:91], v4, s[4:7], s23 offen sc1
  s_add_u32 s23, s37, 54554624
  buffer_store_dwordx4 v[92:95], v4, s[4:7], s23 offen sc1
  s_add_u32 s23, s37, 54558720
  buffer_store_dwordx4 v[96:99], v4, s[4:7], s23 offen sc1
  s_nop 1
  v_lshlrev_b32 v100, 16, v64
  v_and_b32 v101, s38, v64
  v_lshlrev_b32 v102, 16, v65
  v_and_b32 v103, s38, v65
  v_lshlrev_b32 v104, 16, v66
  v_and_b32 v105, s38, v66
  v_lshlrev_b32 v106, 16, v67
  v_and_b32 v107, s38, v67
  v_lshlrev_b32 v108, 16, v68
  v_and_b32 v109, s38, v68
  v_lshlrev_b32 v110, 16, v69
  v_and_b32 v111, s38, v69
  v_lshlrev_b32 v112, 16, v70
  v_and_b32 v113, s38, v70
  v_lshlrev_b32 v114, 16, v71
  v_and_b32 v115, s38, v71
  v_lshlrev_b32 v116, 16, v72
  v_and_b32 v117, s38, v72
  v_lshlrev_b32 v118, 16, v73
  v_and_b32 v119, s38, v73
  v_lshlrev_b32 v120, 16, v74
  v_and_b32 v121, s38, v74
  v_lshlrev_b32 v122, 16, v75
  v_and_b32 v123, s38, v75
  v_lshlrev_b32 v124, 16, v76
  v_and_b32 v125, s38, v76
  v_lshlrev_b32 v126, 16, v77
  v_and_b32 v127, s38, v77
  v_lshlrev_b32 v128, 16, v78
  v_and_b32 v129, s38, v78
  v_lshlrev_b32 v130, 16, v79
  v_and_b32 v131, s38, v79
  v_lshlrev_b32 v132, 16, v80
  v_and_b32 v133, s38, v80
  v_lshlrev_b32 v134, 16, v81
  v_and_b32 v135, s38, v81
  v_lshlrev_b32 v136, 16, v82
  v_and_b32 v137, s38, v82
  v_lshlrev_b32 v138, 16, v83
  v_and_b32 v139, s38, v83
  v_lshlrev_b32 v140, 16, v84
  v_and_b32 v141, s38, v84
  v_lshlrev_b32 v142, 16, v85
  v_and_b32 v143, s38, v85
  v_lshlrev_b32 v144, 16, v86
  v_and_b32 v145, s38, v86
  v_lshlrev_b32 v146, 16, v87
  v_and_b32 v147, s38, v87
  v_lshlrev_b32 v148, 16, v88
  v_and_b32 v149, s38, v88
  v_lshlrev_b32 v150, 16, v89
  v_and_b32 v151, s38, v89
  v_lshlrev_b32 v152, 16, v90
  v_and_b32 v153, s38, v90
  v_lshlrev_b32 v154, 16, v91
  v_and_b32 v155, s38, v91
  v_lshlrev_b32 v156, 16, v92
  v_and_b32 v157, s38, v92
  v_lshlrev_b32 v158, 16, v93
  v_and_b32 v159, s38, v93
  v_lshlrev_b32 v160, 16, v94
  v_and_b32 v161, s38, v94
  v_lshlrev_b32 v162, 16, v95
  v_and_b32 v163, s38, v95
  v_lshlrev_b32 v164, 16, v96
  v_and_b32 v165, s38, v96
  v_lshlrev_b32 v166, 16, v97
  v_and_b32 v167, s38, v97
  v_lshlrev_b32 v168, 16, v98
  v_and_b32 v169, s38, v98
  v_lshlrev_b32 v170, 16, v99
  v_and_b32 v171, s38, v99
  v_mov_b32 v10, v100
  v_mov_b32 v11, v101
  v_mov_b32 v12, v102
  v_mov_b32 v13, v103
  v_add_f32 v10, v10, v104
  v_add_f32 v11, v11, v105
  v_add_f32 v12, v12, v106
  v_add_f32 v13, v13, v107
  v_add_f32 v10, v10, v108
  v_add_f32 v11, v11, v109
  v_add_f32 v12, v12, v110
  v_add_f32 v13, v13, v111
  v_add_f32 v10, v10, v112
  v_add_f32 v11, v11, v113
  v_add_f32 v12, v12, v114
  v_add_f32 v13, v13, v115
  v_add_f32 v10, v10, v116
  v_add_f32 v11, v11, v117
  v_add_f32 v12, v12, v118
  v_add_f32 v13, v13, v119
  v_add_f32 v10, v10, v120
  v_add_f32 v11, v11, v121
  v_add_f32 v12, v12, v122
  v_add_f32 v13, v13, v123
  v_add_f32 v10, v10, v124
  v_add_f32 v11, v11, v125
  v_add_f32 v12, v12, v126
  v_add_f32 v13, v13, v127
  v_add_f32 v10, v10, v128
  v_add_f32 v11, v11, v129
  v_add_f32 v12, v12, v130
  v_add_f32 v13, v13, v131
  v_add_f32 v10, v10, v132
  v_add_f32 v11, v11, v133
  v_add_f32 v12, v12, v134
  v_add_f32 v13, v13, v135
  v_add_f32 v10, v10, v136
  v_add_f32 v11, v11, v137
  v_add_f32 v12, v12, v138
  v_add_f32 v13, v13, v139
  v_add_f32 v10, v10, v140
  v_add_f32 v11, v11, v141
  v_add_f32 v12, v12, v142
  v_add_f32 v13, v13, v143
  v_add_f32 v10, v10, v144
  v_add_f32 v11, v11, v145
  v_add_f32 v12, v12, v146
  v_add_f32 v13, v13, v147
  v_add_f32 v10, v10, v148
  v_add_f32 v11, v11, v149
  v_add_f32 v12, v12, v150
  v_add_f32 v13, v13, v151
  v_add_f32 v10, v10, v152
  v_add_f32 v11, v11, v153
  v_add_f32 v12, v12, v154
  v_add_f32 v13, v13, v155
  v_add_f32 v10, v10, v156
  v_add_f32 v11, v11, v157
  v_add_f32 v12, v12, v158
  v_add_f32 v13, v13, v159
  v_add_f32 v10, v10, v160
  v_add_f32 v11, v11, v161
  v_add_f32 v12, v12, v162
  v_add_f32 v13, v13, v163
  v_add_f32 v10, v10, v164
  v_add_f32 v11, v11, v165
  v_add_f32 v12, v12, v166
  v_add_f32 v13, v13, v167
  v_add_f32 v10, v10, v168
  v_add_f32 v11, v11, v169
  v_add_f32 v12, v12, v170
  v_add_f32 v13, v13, v171
  v_add_f32 v10, v10, v11
  v_add_f32 v12, v12, v13
  v_add_f32 v10, v10, v12
  s_nop 1
  v_add_f32_dpp v10, v10, v10 quad_perm:[1,0,3,2] row_mask:0xf bank_mask:0xf
  s_nop 1
  v_add_f32_dpp v10, v10, v10 quad_perm:[2,3,0,1] row_mask:0xf bank_mask:0xf
  s_nop 1
  v_add_f32_dpp v10, v10, v10 row_half_mirror row_mask:0xf bank_mask:0xf
  v_mul_f32 v10, 0x3ae38e39, v10
  v_mov_b32 v11, 0
  v_mov_b32 v12, 0
  v_mov_b32 v13, 0
  v_mov_b32 v14, 0
  v_sub_f32 v15, v100, v10
  v_fmac_f32 v11, v15, v15
  v_sub_f32 v15, v101, v10
  v_fmac_f32 v12, v15, v15
  v_sub_f32 v15, v102, v10
  v_fmac_f32 v13, v15, v15
  v_sub_f32 v15, v103, v10
  v_fmac_f32 v14, v15, v15
  v_sub_f32 v15, v104, v10
  v_fmac_f32 v11, v15, v15
  v_sub_f32 v15, v105, v10
  v_fmac_f32 v12, v15, v15
  v_sub_f32 v15, v106, v10
  v_fmac_f32 v13, v15, v15
  v_sub_f32 v15, v107, v10
  v_fmac_f32 v14, v15, v15
  v_sub_f32 v15, v108, v10
  v_fmac_f32 v11, v15, v15
  v_sub_f32 v15, v109, v10
  v_fmac_f32 v12, v15, v15
  v_sub_f32 v15, v110, v10
  v_fmac_f32 v13, v15, v15
  v_sub_f32 v15, v111, v10
  v_fmac_f32 v14, v15, v15
  v_sub_f32 v15, v112, v10
  v_fmac_f32 v11, v15, v15
  v_sub_f32 v15, v113, v10
  v_fmac_f32 v12, v15, v15
  v_sub_f32 v15, v114, v10
  v_fmac_f32 v13, v15, v15
  v_sub_f32 v15, v115, v10
  v_fmac_f32 v14, v15, v15
  v_sub_f32 v15, v116, v10
  v_fmac_f32 v11, v15, v15
  v_sub_f32 v15, v117, v10
  v_fmac_f32 v12, v15, v15
  v_sub_f32 v15, v118, v10
  v_fmac_f32 v13, v15, v15
  v_sub_f32 v15, v119, v10
  v_fmac_f32 v14, v15, v15
  v_sub_f32 v15, v120, v10
  v_fmac_f32 v11, v15, v15
  v_sub_f32 v15, v121, v10
  v_fmac_f32 v12, v15, v15
  v_sub_f32 v15, v122, v10
  v_fmac_f32 v13, v15, v15
  v_sub_f32 v15, v123, v10
  v_fmac_f32 v14, v15, v15
  v_sub_f32 v15, v124, v10
  v_fmac_f32 v11, v15, v15
  v_sub_f32 v15, v125, v10
  v_fmac_f32 v12, v15, v15
  v_sub_f32 v15, v126, v10
  v_fmac_f32 v13, v15, v15
  v_sub_f32 v15, v127, v10
  v_fmac_f32 v14, v15, v15
  v_sub_f32 v15, v128, v10
  v_fmac_f32 v11, v15, v15
  v_sub_f32 v15, v129, v10
  v_fmac_f32 v12, v15, v15
  v_sub_f32 v15, v130, v10
  v_fmac_f32 v13, v15, v15
  v_sub_f32 v15, v131, v10
  v_fmac_f32 v14, v15, v15
  v_sub_f32 v15, v132, v10
  v_fmac_f32 v11, v15, v15
  v_sub_f32 v15, v133, v10
  v_fmac_f32 v12, v15, v15
  v_sub_f32 v15, v134, v10
  v_fmac_f32 v13, v15, v15
  v_sub_f32 v15, v135, v10
  v_fmac_f32 v14, v15, v15
  v_sub_f32 v15, v136, v10
  v_fmac_f32 v11, v15, v15
  v_sub_f32 v15, v137, v10
  v_fmac_f32 v12, v15, v15
  v_sub_f32 v15, v138, v10
  v_fmac_f32 v13, v15, v15
  v_sub_f32 v15, v139, v10
  v_fmac_f32 v14, v15, v15
  v_sub_f32 v15, v140, v10
  v_fmac_f32 v11, v15, v15
  v_sub_f32 v15, v141, v10
  v_fmac_f32 v12, v15, v15
  v_sub_f32 v15, v142, v10
  v_fmac_f32 v13, v15, v15
  v_sub_f32 v15, v143, v10
  v_fmac_f32 v14, v15, v15
  v_sub_f32 v15, v144, v10
  v_fmac_f32 v11, v15, v15
  v_sub_f32 v15, v145, v10
  v_fmac_f32 v12, v15, v15
  v_sub_f32 v15, v146, v10
  v_fmac_f32 v13, v15, v15
  v_sub_f32 v15, v147, v10
  v_fmac_f32 v14, v15, v15
  v_sub_f32 v15, v148, v10
  v_fmac_f32 v11, v15, v15
  v_sub_f32 v15, v149, v10
  v_fmac_f32 v12, v15, v15
  v_sub_f32 v15, v150, v10
  v_fmac_f32 v13, v15, v15
  v_sub_f32 v15, v151, v10
  v_fmac_f32 v14, v15, v15
  v_sub_f32 v15, v152, v10
  v_fmac_f32 v11, v15, v15
  v_sub_f32 v15, v153, v10
  v_fmac_f32 v12, v15, v15
  v_sub_f32 v15, v154, v10
  v_fmac_f32 v13, v15, v15
  v_sub_f32 v15, v155, v10
  v_fmac_f32 v14, v15, v15
  v_sub_f32 v15, v156, v10
  v_fmac_f32 v11, v15, v15
  v_sub_f32 v15, v157, v10
  v_fmac_f32 v12, v15, v15
  v_sub_f32 v15, v158, v10
  v_fmac_f32 v13, v15, v15
  v_sub_f32 v15, v159, v10
  v_fmac_f32 v14, v15, v15
  v_sub_f32 v15, v160, v10
  v_fmac_f32 v11, v15, v15
  v_sub_f32 v15, v161, v10
  v_fmac_f32 v12, v15, v15
  v_sub_f32 v15, v162, v10
  v_fmac_f32 v13, v15, v15
  v_sub_f32 v15, v163, v10
  v_fmac_f32 v14, v15, v15
  v_sub_f32 v15, v164, v10
  v_fmac_f32 v11, v15, v15
  v_sub_f32 v15, v165, v10
  v_fmac_f32 v12, v15, v15
  v_sub_f32 v15, v166, v10
  v_fmac_f32 v13, v15, v15
  v_sub_f32 v15, v167, v10
  v_fmac_f32 v14, v15, v15
  v_sub_f32 v15, v168, v10
  v_fmac_f32 v11, v15, v15
  v_sub_f32 v15, v169, v10
  v_fmac_f32 v12, v15, v15
  v_sub_f32 v15, v170, v10
  v_fmac_f32 v13, v15, v15
  v_sub_f32 v15, v171, v10
  v_fmac_f32 v14, v15, v15
  v_add_f32 v11, v11, v12
  v_add_f32 v13, v13, v14
  v_add_f32 v11, v11, v13
  s_nop 1
  v_add_f32_dpp v11, v11, v11 quad_perm:[1,0,3,2] row_mask:0xf bank_mask:0xf
  s_nop 1
  v_add_f32_dpp v11, v11, v11 quad_perm:[2,3,0,1] row_mask:0xf bank_mask:0xf
  s_nop 1
  v_add_f32_dpp v11, v11, v11 row_half_mirror row_mask:0xf bank_mask:0xf
  v_mul_f32 v11, 0x3ae38e39, v11
  v_cvt_pk_bf16_f32 v10, v10, v11
  v_and_b32 v11, s38, v10
  v_lshlrev_b32 v10, 16, v10
  v_add_f32 v11, 0x3727c5ac, v11
  v_cvt_pk_bf16_f32 v11, v11, v11
  v_and_b32 v11, s38, v11
  v_sqrt_f32 v11, v11
  s_nop 0
  v_cvt_pk_bf16_f32 v11, v11, v11
  v_and_b32 v11, s38, v11
  v_rcp_f32 v11, v11
  v_sub_f32 v100, v100, v10
  v_sub_f32 v101, v101, v10
  v_cvt_pk_bf16_f32 v15, v100, v101
  v_lshlrev_b32 v100, 16, v15
  v_and_b32 v101, s38, v15
  v_mul_f32 v100, v11, v100
  v_mul_f32 v101, v11, v101
  v_cvt_pk_bf16_f32 v64, v100, v101
  v_sub_f32 v102, v102, v10
  v_sub_f32 v103, v103, v10
  v_cvt_pk_bf16_f32 v15, v102, v103
  v_lshlrev_b32 v102, 16, v15
  v_and_b32 v103, s38, v15
  v_mul_f32 v102, v11, v102
  v_mul_f32 v103, v11, v103
  v_cvt_pk_bf16_f32 v65, v102, v103
  v_sub_f32 v104, v104, v10
  v_sub_f32 v105, v105, v10
  v_cvt_pk_bf16_f32 v15, v104, v105
  v_lshlrev_b32 v104, 16, v15
  v_and_b32 v105, s38, v15
  v_mul_f32 v104, v11, v104
  v_mul_f32 v105, v11, v105
  v_cvt_pk_bf16_f32 v66, v104, v105
  v_sub_f32 v106, v106, v10
  v_sub_f32 v107, v107, v10
  v_cvt_pk_bf16_f32 v15, v106, v107
  v_lshlrev_b32 v106, 16, v15
  v_and_b32 v107, s38, v15
  v_mul_f32 v106, v11, v106
  v_mul_f32 v107, v11, v107
  v_cvt_pk_bf16_f32 v67, v106, v107
  v_sub_f32 v108, v108, v10
  v_sub_f32 v109, v109, v10
  v_cvt_pk_bf16_f32 v15, v108, v109
  v_lshlrev_b32 v108, 16, v15
  v_and_b32 v109, s38, v15
  v_mul_f32 v108, v11, v108
  v_mul_f32 v109, v11, v109
  v_cvt_pk_bf16_f32 v68, v108, v109
  v_sub_f32 v110, v110, v10
  v_sub_f32 v111, v111, v10
  v_cvt_pk_bf16_f32 v15, v110, v111
  v_lshlrev_b32 v110, 16, v15
  v_and_b32 v111, s38, v15
  v_mul_f32 v110, v11, v110
  v_mul_f32 v111, v11, v111
  v_cvt_pk_bf16_f32 v69, v110, v111
  v_sub_f32 v112, v112, v10
  v_sub_f32 v113, v113, v10
  v_cvt_pk_bf16_f32 v15, v112, v113
  v_lshlrev_b32 v112, 16, v15
  v_and_b32 v113, s38, v15
  v_mul_f32 v112, v11, v112
  v_mul_f32 v113, v11, v113
  v_cvt_pk_bf16_f32 v70, v112, v113
  v_sub_f32 v114, v114, v10
  v_sub_f32 v115, v115, v10
  v_cvt_pk_bf16_f32 v15, v114, v115
  v_lshlrev_b32 v114, 16, v15
  v_and_b32 v115, s38, v15
  v_mul_f32 v114, v11, v114
  v_mul_f32 v115, v11, v115
  v_cvt_pk_bf16_f32 v71, v114, v115
  v_sub_f32 v116, v116, v10
  v_sub_f32 v117, v117, v10
  v_cvt_pk_bf16_f32 v15, v116, v117
  v_lshlrev_b32 v116, 16, v15
  v_and_b32 v117, s38, v15
  v_mul_f32 v116, v11, v116
  v_mul_f32 v117, v11, v117
  v_cvt_pk_bf16_f32 v72, v116, v117
  v_sub_f32 v118, v118, v10
  v_sub_f32 v119, v119, v10
  v_cvt_pk_bf16_f32 v15, v118, v119
  v_lshlrev_b32 v118, 16, v15
  v_and_b32 v119, s38, v15
  v_mul_f32 v118, v11, v118
  v_mul_f32 v119, v11, v119
  v_cvt_pk_bf16_f32 v73, v118, v119
  v_sub_f32 v120, v120, v10
  v_sub_f32 v121, v121, v10
  v_cvt_pk_bf16_f32 v15, v120, v121
  v_lshlrev_b32 v120, 16, v15
  v_and_b32 v121, s38, v15
  v_mul_f32 v120, v11, v120
  v_mul_f32 v121, v11, v121
  v_cvt_pk_bf16_f32 v74, v120, v121
  v_sub_f32 v122, v122, v10
  v_sub_f32 v123, v123, v10
  v_cvt_pk_bf16_f32 v15, v122, v123
  v_lshlrev_b32 v122, 16, v15
  v_and_b32 v123, s38, v15
  v_mul_f32 v122, v11, v122
  v_mul_f32 v123, v11, v123
  v_cvt_pk_bf16_f32 v75, v122, v123
  v_sub_f32 v124, v124, v10
  v_sub_f32 v125, v125, v10
  v_cvt_pk_bf16_f32 v15, v124, v125
  v_lshlrev_b32 v124, 16, v15
  v_and_b32 v125, s38, v15
  v_mul_f32 v124, v11, v124
  v_mul_f32 v125, v11, v125
  v_cvt_pk_bf16_f32 v76, v124, v125
  v_sub_f32 v126, v126, v10
  v_sub_f32 v127, v127, v10
  v_cvt_pk_bf16_f32 v15, v126, v127
  v_lshlrev_b32 v126, 16, v15
  v_and_b32 v127, s38, v15
  v_mul_f32 v126, v11, v126
  v_mul_f32 v127, v11, v127
  v_cvt_pk_bf16_f32 v77, v126, v127
  v_sub_f32 v128, v128, v10
  v_sub_f32 v129, v129, v10
  v_cvt_pk_bf16_f32 v15, v128, v129
  v_lshlrev_b32 v128, 16, v15
  v_and_b32 v129, s38, v15
  v_mul_f32 v128, v11, v128
  v_mul_f32 v129, v11, v129
  v_cvt_pk_bf16_f32 v78, v128, v129
  v_sub_f32 v130, v130, v10
  v_sub_f32 v131, v131, v10
  v_cvt_pk_bf16_f32 v15, v130, v131
  v_lshlrev_b32 v130, 16, v15
  v_and_b32 v131, s38, v15
  v_mul_f32 v130, v11, v130
  v_mul_f32 v131, v11, v131
  v_cvt_pk_bf16_f32 v79, v130, v131
  v_sub_f32 v132, v132, v10
  v_sub_f32 v133, v133, v10
  v_cvt_pk_bf16_f32 v15, v132, v133
  v_lshlrev_b32 v132, 16, v15
  v_and_b32 v133, s38, v15
  v_mul_f32 v132, v11, v132
  v_mul_f32 v133, v11, v133
  v_cvt_pk_bf16_f32 v80, v132, v133
  v_sub_f32 v134, v134, v10
  v_sub_f32 v135, v135, v10
  v_cvt_pk_bf16_f32 v15, v134, v135
  v_lshlrev_b32 v134, 16, v15
  v_and_b32 v135, s38, v15
  v_mul_f32 v134, v11, v134
  v_mul_f32 v135, v11, v135
  v_cvt_pk_bf16_f32 v81, v134, v135
  v_sub_f32 v136, v136, v10
  v_sub_f32 v137, v137, v10
  v_cvt_pk_bf16_f32 v15, v136, v137
  v_lshlrev_b32 v136, 16, v15
  v_and_b32 v137, s38, v15
  v_mul_f32 v136, v11, v136
  v_mul_f32 v137, v11, v137
  v_cvt_pk_bf16_f32 v82, v136, v137
  v_sub_f32 v138, v138, v10
  v_sub_f32 v139, v139, v10
  v_cvt_pk_bf16_f32 v15, v138, v139
  v_lshlrev_b32 v138, 16, v15
  v_and_b32 v139, s38, v15
  v_mul_f32 v138, v11, v138
  v_mul_f32 v139, v11, v139
  v_cvt_pk_bf16_f32 v83, v138, v139
  v_sub_f32 v140, v140, v10
  v_sub_f32 v141, v141, v10
  v_cvt_pk_bf16_f32 v15, v140, v141
  v_lshlrev_b32 v140, 16, v15
  v_and_b32 v141, s38, v15
  v_mul_f32 v140, v11, v140
  v_mul_f32 v141, v11, v141
  v_cvt_pk_bf16_f32 v84, v140, v141
  v_sub_f32 v142, v142, v10
  v_sub_f32 v143, v143, v10
  v_cvt_pk_bf16_f32 v15, v142, v143
  v_lshlrev_b32 v142, 16, v15
  v_and_b32 v143, s38, v15
  v_mul_f32 v142, v11, v142
  v_mul_f32 v143, v11, v143
  v_cvt_pk_bf16_f32 v85, v142, v143
  v_sub_f32 v144, v144, v10
  v_sub_f32 v145, v145, v10
  v_cvt_pk_bf16_f32 v15, v144, v145
  v_lshlrev_b32 v144, 16, v15
  v_and_b32 v145, s38, v15
  v_mul_f32 v144, v11, v144
  v_mul_f32 v145, v11, v145
  v_cvt_pk_bf16_f32 v86, v144, v145
  v_sub_f32 v146, v146, v10
  v_sub_f32 v147, v147, v10
  v_cvt_pk_bf16_f32 v15, v146, v147
  v_lshlrev_b32 v146, 16, v15
  v_and_b32 v147, s38, v15
  v_mul_f32 v146, v11, v146
  v_mul_f32 v147, v11, v147
  v_cvt_pk_bf16_f32 v87, v146, v147
  v_sub_f32 v148, v148, v10
  v_sub_f32 v149, v149, v10
  v_cvt_pk_bf16_f32 v15, v148, v149
  v_lshlrev_b32 v148, 16, v15
  v_and_b32 v149, s38, v15
  v_mul_f32 v148, v11, v148
  v_mul_f32 v149, v11, v149
  v_cvt_pk_bf16_f32 v88, v148, v149
  v_sub_f32 v150, v150, v10
  v_sub_f32 v151, v151, v10
  v_cvt_pk_bf16_f32 v15, v150, v151
  v_lshlrev_b32 v150, 16, v15
  v_and_b32 v151, s38, v15
  v_mul_f32 v150, v11, v150
  v_mul_f32 v151, v11, v151
  v_cvt_pk_bf16_f32 v89, v150, v151
  v_sub_f32 v152, v152, v10
  v_sub_f32 v153, v153, v10
  v_cvt_pk_bf16_f32 v15, v152, v153
  v_lshlrev_b32 v152, 16, v15
  v_and_b32 v153, s38, v15
  v_mul_f32 v152, v11, v152
  v_mul_f32 v153, v11, v153
  v_cvt_pk_bf16_f32 v90, v152, v153
  v_sub_f32 v154, v154, v10
  v_sub_f32 v155, v155, v10
  v_cvt_pk_bf16_f32 v15, v154, v155
  v_lshlrev_b32 v154, 16, v15
  v_and_b32 v155, s38, v15
  v_mul_f32 v154, v11, v154
  v_mul_f32 v155, v11, v155
  v_cvt_pk_bf16_f32 v91, v154, v155
  v_sub_f32 v156, v156, v10
  v_sub_f32 v157, v157, v10
  v_cvt_pk_bf16_f32 v15, v156, v157
  v_lshlrev_b32 v156, 16, v15
  v_and_b32 v157, s38, v15
  v_mul_f32 v156, v11, v156
  v_mul_f32 v157, v11, v157
  v_cvt_pk_bf16_f32 v92, v156, v157
  v_sub_f32 v158, v158, v10
  v_sub_f32 v159, v159, v10
  v_cvt_pk_bf16_f32 v15, v158, v159
  v_lshlrev_b32 v158, 16, v15
  v_and_b32 v159, s38, v15
  v_mul_f32 v158, v11, v158
  v_mul_f32 v159, v11, v159
  v_cvt_pk_bf16_f32 v93, v158, v159
  v_sub_f32 v160, v160, v10
  v_sub_f32 v161, v161, v10
  v_cvt_pk_bf16_f32 v15, v160, v161
  v_lshlrev_b32 v160, 16, v15
  v_and_b32 v161, s38, v15
  v_mul_f32 v160, v11, v160
  v_mul_f32 v161, v11, v161
  v_cvt_pk_bf16_f32 v94, v160, v161
  v_sub_f32 v162, v162, v10
  v_sub_f32 v163, v163, v10
  v_cvt_pk_bf16_f32 v15, v162, v163
  v_lshlrev_b32 v162, 16, v15
  v_and_b32 v163, s38, v15
  v_mul_f32 v162, v11, v162
  v_mul_f32 v163, v11, v163
  v_cvt_pk_bf16_f32 v95, v162, v163
  v_sub_f32 v164, v164, v10
  v_sub_f32 v165, v165, v10
  v_cvt_pk_bf16_f32 v15, v164, v165
  v_lshlrev_b32 v164, 16, v15
  v_and_b32 v165, s38, v15
  v_mul_f32 v164, v11, v164
  v_mul_f32 v165, v11, v165
  v_cvt_pk_bf16_f32 v96, v164, v165
  v_sub_f32 v166, v166, v10
  v_sub_f32 v167, v167, v10
  v_cvt_pk_bf16_f32 v15, v166, v167
  v_lshlrev_b32 v166, 16, v15
  v_and_b32 v167, s38, v15
  v_mul_f32 v166, v11, v166
  v_mul_f32 v167, v11, v167
  v_cvt_pk_bf16_f32 v97, v166, v167
  v_sub_f32 v168, v168, v10
  v_sub_f32 v169, v169, v10
  v_cvt_pk_bf16_f32 v15, v168, v169
  v_lshlrev_b32 v168, 16, v15
  v_and_b32 v169, s38, v15
  v_mul_f32 v168, v11, v168
  v_mul_f32 v169, v11, v169
  v_cvt_pk_bf16_f32 v98, v168, v169
  v_sub_f32 v170, v170, v10
  v_sub_f32 v171, v171, v10
  v_cvt_pk_bf16_f32 v15, v170, v171
  v_lshlrev_b32 v170, 16, v15
  v_and_b32 v171, s38, v15
  v_mul_f32 v170, v11, v170
  v_mul_f32 v171, v11, v171
  v_cvt_pk_bf16_f32 v99, v170, v171
  s_add_u32 s23, s37, 57671680
  buffer_store_dwordx4 v[64:67], v4, s[4:7], s23 offen sc1
  s_add_u32 s23, s37, 57675776
  buffer_store_dwordx4 v[68:71], v4, s[4:7], s23 offen sc1
  s_add_u32 s23, s37, 57679872
  buffer_store_dwordx4 v[72:75], v4, s[4:7], s23 offen sc1
  s_add_u32 s23, s37, 57683968
  buffer_store_dwordx4 v[76:79], v4, s[4:7], s23 offen sc1
  s_add_u32 s23, s37, 57688064
  buffer_store_dwordx4 v[80:83], v4, s[4:7], s23 offen sc1
  s_add_u32 s23, s37, 57692160
  buffer_store_dwordx4 v[84:87], v4, s[4:7], s23 offen sc1
  s_add_u32 s23, s37, 57696256
  buffer_store_dwordx4 v[88:91], v4, s[4:7], s23 offen sc1
  s_add_u32 s23, s37, 57700352
  buffer_store_dwordx4 v[92:95], v4, s[4:7], s23 offen sc1
  s_add_u32 s23, s37, 57704448
  buffer_store_dwordx4 v[96:99], v4, s[4:7], s23 offen sc1
  s_waitcnt vmcnt(0)
lnd_142:
  s_waitcnt vmcnt(0)
  s_barrier
  s_cmp_eq_u32 s17, 0
  s_cbranch_scc0 wda_143
  s_add_u32 s23, s18, 16
  s_lshl_b32 s23, s23, 2
  s_mov_b64 exec, 1
  v_mov_b32 v60, s23
  v_mov_b32 v61, 1
  global_atomic_add v60, v61, s[14:15]
  s_mov_b64 exec, -1
wda_143:
  s_lshl_b32 s23, s18, 5
  s_add_u32 s23, s23, s16
  s_mul_i32 s50, s23, 9363
  s_lshr_b32 s50, s50, 16
  s_mul_i32 s24, s50, 7
  s_sub_u32 s51, s23, s24
  s_cmp_eq_u32 s51, 0
  s_cselect_b32 s52, 10, 9
  v_mov_b32 v2, 192
  v_mul_u32_u24 v2, v2, v0
  global_load_dword v3, v2, s[30:31] offset:0
  global_load_dword v4, v2, s[30:31] offset:12
  global_load_dword v5, v2, s[30:31] offset:16
  global_load_dword v6, v2, s[30:31] offset:20
  global_load_dword v7, v2, s[30:31] offset:60
  s_waitcnt vmcnt(0)
  s_load_dwordx2 s[32:33], s[0:1], 24
  s_load_dwordx2 s[34:35], s[0:1], 32
  s_waitcnt lgkmcnt(0)
  s_cmp_lt_u32 s17, 2
  s_cselect_b32 s8, s32, s34
  s_cselect_b32 s9, s33, s35
  s_and_b32 s9, s9, 0xffff
  s_mov_b32 s10, 4718592
  s_mov_b32 s11, 0x20000
  s_and_b32 s23, s17, 1
  s_mul_i32 s23, s23, 131072
  s_lshl_b32 s36, s50, 8
  s_add_u32 s36, s36, s23
  s_lshl_b32 s42, s17, 12
  s_add_u32 s43, s36, 0
  s_add_u32 m0, s42, 0
  s_nop 0
  buffer_load_dwordx4 v4, s[8:11], s43 offen lds
  s_add_u32 s43, s36, 32768
  s_add_u32 m0, s42, 1024
  s_nop 0
  buffer_load_dwordx4 v4, s[8:11], s43 offen lds
  s_add_u32 s43, s36, 65536
  s_add_u32 m0, s42, 2048
  s_nop 0
  buffer_load_dwordx4 v4, s[8:11], s43 offen lds
  s_add_u32 s43, s36, 98304
  s_add_u32 m0, s42, 3072
  s_nop 0
  buffer_load_dwordx4 v4, s[8:11], s43 offen lds
  s_add_u32 s43, s36, 262144
  s_add_u32 m0, s42, 16384
  s_nop 0
  buffer_load_dwordx4 v4, s[8:11], s43 offen lds
  s_add_u32 s43, s36, 294912
  s_add_u32 m0, s42, 17408
  s_nop 0
  buffer_load_dwordx4 v4, s[8:11], s43 offen lds
  s_add_u32 s43, s36, 327680
  s_add_u32 m0, s42, 18432
  s_nop 0
  buffer_load_dwordx4 v4, s[8:11], s43 offen lds
  s_add_u32 s43, s36, 360448
  s_add_u32 m0, s42, 19456
  s_nop 0
  buffer_load_dwordx4 v4, s[8:11], s43 offen lds
  s_add_u32 s43, s36, 524288
  s_add_u32 m0, s42, 32768
  s_nop 0
  buffer_load_dwordx4 v4, s[8:11], s43 offen lds
  s_add_u32 s43, s36, 557056
  s_add_u32 m0, s42, 33792
  s_nop 0
  buffer_load_dwordx4 v4, s[8:11], s43 offen lds
  s_add_u32 s43, s36, 589824
  s_add_u32 m0, s42, 34816
  s_nop 0
  buffer_load_dwordx4 v4, s[8:11], s43 offen lds
  s_add_u32 s43, s36, 622592
  s_add_u32 m0, s42, 35840
  s_nop 0
  buffer_load_dwordx4 v4, s[8:11], s43 offen lds
  s_add_u32 s43, s36, 786432
  s_add_u32 m0, s42, 49152
  s_nop 0
  buffer_load_dwordx4 v4, s[8:11], s43 offen lds
  s_add_u32 s43, s36, 819200
  s_add_u32 m0, s42, 50176
  s_nop 0
  buffer_load_dwordx4 v4, s[8:11], s43 offen lds
  s_add_u32 s43, s36, 851968
  s_add_u32 m0, s42, 51200
  s_nop 0
  buffer_load_dwordx4 v4, s[8:11], s43 offen lds
  s_add_u32 s43, s36, 884736
  s_add_u32 m0, s42, 52224
  s_nop 0
  buffer_load_dwordx4 v4, s[8:11], s43 offen lds
  s_add_u32 s43, s36, 1048576
  s_add_u32 m0, s42, 65536
  s_nop 0
  buffer_load_dwordx4 v4, s[8:11], s43 offen lds
  s_add_u32 s43, s36, 1081344
  s_add_u32 m0, s42, 66560
  s_nop 0
  buffer_load_dwordx4 v4, s[8:11], s43 offen lds
  s_add_u32 s43, s36, 1114112
  s_add_u32 m0, s42, 67584
  s_nop 0
  buffer_load_dwordx4 v4, s[8:11], s43 offen lds
  s_add_u32 s43, s36, 1146880
  s_add_u32 m0, s42, 68608
  s_nop 0
  buffer_load_dwordx4 v4, s[8:11], s43 offen lds
  s_add_u32 s43, s36, 1310720
  s_add_u32 m0, s42, 81920
  s_nop 0
  buffer_load_dwordx4 v4, s[8:11], s43 offen lds
  s_add_u32 s43, s36, 1343488
  s_add_u32 m0, s42, 82944
  s_nop 0
  buffer_load_dwordx4 v4, s[8:11], s43 offen lds
  s_add_u32 s43, s36, 1376256
  s_add_u32 m0, s42, 83968
  s_nop 0
  buffer_load_dwordx4 v4, s[8:11], s43 offen lds
  s_add_u32 s43, s36, 1409024
  s_add_u32 m0, s42, 84992
  s_nop 0
  buffer_load_dwordx4 v4, s[8:11], s43 offen lds
  s_waitcnt vmcnt(20) lgkmcnt(0)
  s_barrier
  v_add_u32 v60, 0, v5
  ds_read_b64_tr_b16 a[0:1], v60 offset:0
  ds_read_b64_tr_b16 a[2:3], v60 offset:1024
  v_add_u32 v61, 0, v6
  ds_read_b64_tr_b16 a[4:5], v61 offset:0
  ds_read_b64_tr_b16 a[6:7], v61 offset:1024
  ds_read_b64_tr_b16 a[8:9], v60 offset:4096
  ds_read_b64_tr_b16 a[10:11], v60 offset:5120
  ds_read_b64_tr_b16 a[12:13], v61 offset:4096
  ds_read_b64_tr_b16 a[14:15], v61 offset:5120
  s_waitcnt vmcnt(16) lgkmcnt(0)
  s_barrier
  s_add_u32 s43, s36, 1572864
  s_add_u32 m0, s42, 98304
  s_nop 0
  buffer_load_dwordx4 v4, s[8:11], s43 offen lds
  s_add_u32 s43, s36, 1605632
  s_add_u32 m0, s42, 99328
  s_nop 0
  buffer_load_dwordx4 v4, s[8:11], s43 offen lds
  s_add_u32 s43, s36, 1638400
  s_add_u32 m0, s42, 100352
  s_nop 0
  buffer_load_dwordx4 v4, s[8:11], s43 offen lds
  s_add_u32 s43, s36, 1671168
  s_add_u32 m0, s42, 101376
  s_nop 0
  buffer_load_dwordx4 v4, s[8:11], s43 offen lds
  v_add_u32 v60, 16384, v5
  ds_read_b64_tr_b16 a[16:17], v60 offset:0
  ds_read_b64_tr_b16 a[18:19], v60 offset:1024
  v_add_u32 v61, 16384, v6
  ds_read_b64_tr_b16 a[20:21], v61 offset:0
  ds_read_b64_tr_b16 a[22:23], v61 offset:1024
  ds_read_b64_tr_b16 a[24:25], v60 offset:4096
  ds_read_b64_tr_b16 a[26:27], v60 offset:5120
  ds_read_b64_tr_b16 a[28:29], v61 offset:4096
  ds_read_b64_tr_b16 a[30:31], v61 offset:5120
  s_waitcnt vmcnt(16) lgkmcnt(0)
  s_barrier
  s_add_u32 s43, s36, 1835008
  s_add_u32 m0, s42, 114688
  s_nop 0
  buffer_load_dwordx4 v4, s[8:11], s43 offen lds
  s_add_u32 s43, s36, 1867776
  s_add_u32 m0, s42, 115712
  s_nop 0
  buffer_load_dwordx4 v4, s[8:11], s43 offen lds
  s_add_u32 s43, s36, 1900544
  s_add_u32 m0, s42, 116736
  s_nop 0
  buffer_load_dwordx4 v4, s[8:11], s43 offen lds
  s_add_u32 s43, s36, 1933312
  s_add_u32 m0, s42, 117760
  s_nop 0
  buffer_load_dwordx4 v4, s[8:11], s43 offen lds
  v_add_u32 v60, 32768, v5
  ds_read_b64_tr_b16 a[32:33], v60 offset:0
  ds_read_b64_tr_b16 a[34:35], v60 offset:1024
  v_add_u32 v61, 32768, v6
  ds_read_b64_tr_b16 a[36:37], v61 offset:0
  ds_read_b64_tr_b16 a[38:39], v61 offset:1024
  ds_read_b64_tr_b16 a[40:41], v60 offset:4096
  ds_read_b64_tr_b16 a[42:43], v60 offset:5120
  ds_read_b64_tr_b16 a[44:45], v61 offset:4096
  ds_read_b64_tr_b16 a[46:47], v61 offset:5120
  s_waitcnt vmcnt(16) lgkmcnt(0)
  s_barrier
  s_add_u32 s43, s36, 2097152
  s_add_u32 m0, s42, 131072
  s_nop 0
  buffer_load_dwordx4 v4, s[8:11], s43 offen lds
  s_add_u32 s43, s36, 2129920
  s_add_u32 m0, s42, 132096
  s_nop 0
  buffer_load_dwordx4 v4, s[8:11], s43 offen lds
  s_add_u32 s43, s36, 2162688
  s_add_u32 m0, s42, 133120
  s_nop 0
  buffer_load_dwordx4 v4, s[8:11], s43 offen lds
  s_add_u32 s43, s36, 2195456
  s_add_u32 m0, s42, 134144
  s_nop 0
  buffer_load_dwordx4 v4, s[8:11], s43 offen lds
  v_add_u32 v60, 49152, v5
  ds_read_b64_tr_b16 a[48:49], v60 offset:0
  ds_read_b64_tr_b16 a[50:51], v60 offset:1024
  v_add_u32 v61, 49152, v6
  ds_read_b64_tr_b16 a[52:53], v61 offset:0
  ds_read_b64_tr_b16 a[54:55], v61 offset:1024
  ds_read_b64_tr_b16 a[56:57], v60 offset:4096
  ds_read_b64_tr_b16 a[58:59], v60 offset:5120
  ds_read_b64_tr_b16 a[60:61], v61 offset:4096
  ds_read_b64_tr_b16 a[62:63], v61 offset:5120
  s_waitcnt vmcnt(16) lgkmcnt(0)
  s_barrier
  s_add_u32 s43, s36, 2359296
  s_add_u32 m0, s42, 0
  s_nop 0
  buffer_load_dwordx4 v4, s[8:11], s43 offen lds
  s_add_u32 s43, s36, 2392064
  s_add_u32 m0, s42, 1024
  s_nop 0
  buffer_load_dwordx4 v4, s[8:11], s43 offen lds
  s_add_u32 s43, s36, 2424832
  s_add_u32 m0, s42, 2048
  s_nop 0
  buffer_load_dwordx4 v4, s[8:11], s43 offen lds
  s_add_u32 s43, s36, 2457600
  s_add_u32 m0, s42, 3072
  s_nop 0
  buffer_load_dwordx4 v4, s[8:11], s43 offen lds
  v_add_u32 v60, 65536, v5
  ds_read_b64_tr_b16 a[64:65], v60 offset:0
  ds_read_b64_tr_b16 a[66:67], v60 offset:1024
  v_add_u32 v61, 65536, v6
  ds_read_b64_tr_b16 a[68:69], v61 offset:0
  ds_read_b64_tr_b16 a[70:71], v61 offset:1024
  ds_read_b64_tr_b16 a[72:73], v60 offset:4096
  ds_read_b64_tr_b16 a[74:75], v60 offset:5120
  ds_read_b64_tr_b16 a[76:77], v61 offset:4096
  ds_read_b64_tr_b16 a[78:79], v61 offset:5120
  s_waitcnt vmcnt(16) lgkmcnt(0)
  s_barrier
  s_add_u32 s43, s36, 2621440
  s_add_u32 m0, s42, 16384
  s_nop 0
  buffer_load_dwordx4 v4, s[8:11], s43 offen lds
  s_add_u32 s43, s36, 2654208
  s_add_u32 m0, s42, 17408
  s_nop 0
  buffer_load_dwordx4 v4, s[8:11], s43 offen lds
  s_add_u32 s43, s36, 2686976
  s_add_u32 m0, s42, 18432
  s_nop 0
  buffer_load_dwordx4 v4, s[8:11], s43 offen lds
  s_add_u32 s43, s36, 2719744
  s_add_u32 m0, s42, 19456
  s_nop 0
  buffer_load_dwordx4 v4, s[8:11], s43 offen lds
  v_add_u32 v60, 81920, v5
  ds_read_b64_tr_b16 a[80:81], v60 offset:0
  ds_read_b64_tr_b16 a[82:83], v60 offset:1024
  v_add_u32 v61, 81920, v6
  ds_read_b64_tr_b16 a[84:85], v61 offset:0
  ds_read_b64_tr_b16 a[86:87], v61 offset:1024
  ds_read_b64_tr_b16 a[88:89], v60 offset:4096
  ds_read_b64_tr_b16 a[90:91], v60 offset:5120
  ds_read_b64_tr_b16 a[92:93], v61 offset:4096
  ds_read_b64_tr_b16 a[94:95], v61 offset:5120
  s_waitcnt vmcnt(16) lgkmcnt(0)
  s_barrier
  s_add_u32 s43, s36, 2883584
  s_add_u32 m0, s42, 32768
  s_nop 0
  buffer_load_dwordx4 v4, s[8:11], s43 offen lds
  s_add_u32 s43, s36, 2916352
  s_add_u32 m0, s42, 33792
  s_nop 0
  buffer_load_dwordx4 v4, s[8:11], s43 offen lds
  s_add_u32 s43, s36, 2949120
  s_add_u32 m0, s42, 34816
  s_nop 0
  buffer_load_dwordx4 v4, s[8:11], s43 offen lds
  s_add_u32 s43, s36, 2981888
  s_add_u32 m0, s42, 35840
  s_nop 0
  buffer_load_dwordx4 v4, s[8:11], s43 offen lds
  v_add_u32 v60, 98304, v5
  ds_read_b64_tr_b16 a[96:97], v60 offset:0
  ds_read_b64_tr_b16 a[98:99], v60 offset:1024
  v_add_u32 v61, 98304, v6
  ds_read_b64_tr_b16 a[100:101], v61 offset:0
  ds_read_b64_tr_b16 a[102:103], v61 offset:1024
  ds_read_b64_tr_b16 a[104:105], v60 offset:4096
  ds_read_b64_tr_b16 a[106:107], v60 offset:5120
  ds_read_b64_tr_b16 a[108:109], v61 offset:4096
  ds_read_b64_tr_b16 a[110:111], v61 offset:5120
  s_waitcnt vmcnt(16) lgkmcnt(0)
  s_barrier
  s_add_u32 s43, s36, 3145728
  s_add_u32 m0, s42, 49152
  s_nop 0
  buffer_load_dwordx4 v4, s[8:11], s43 offen lds
  s_add_u32 s43, s36, 3178496
  s_add_u32 m0, s42, 50176
  s_nop 0
  buffer_load_dwordx4 v4, s[8:11], s43 offen lds
  s_add_u32 s43, s36, 3211264
  s_add_u32 m0, s42, 51200
  s_nop 0
  buffer_load_dwordx4 v4, s[8:11], s43 offen lds
  s_add_u32 s43, s36, 3244032
  s_add_u32 m0, s42, 52224
  s_nop 0
  buffer_load_dwordx4 v4, s[8:11], s43 offen lds
  v_add_u32 v60, 114688, v5
  ds_read_b64_tr_b16 a[112:113], v60 offset:0
  ds_read_b64_tr_b16 a[114:115], v60 offset:1024
  v_add_u32 v61, 114688, v6
  ds_read_b64_tr_b16 a[116:117], v61 offset:0
  ds_read_b64_tr_b16 a[118:119], v61 offset:1024
  ds_read_b64_tr_b16 a[120:121], v60 offset:4096
  ds_read_b64_tr_b16 a[122:123], v60 offset:5120
  ds_read_b64_tr_b16 a[124:125], v61 offset:4096
  ds_read_b64_tr_b16 a[126:127], v61 offset:5120
  s_waitcnt vmcnt(16) lgkmcnt(0)
  s_barrier
  s_add_u32 s43, s36, 3407872
  s_add_u32 m0, s42, 65536
  s_nop 0
  buffer_load_dwordx4 v4, s[8:11], s43 offen lds
  s_add_u32 s43, s36, 3440640
  s_add_u32 m0, s42, 66560
  s_nop 0
  buffer_load_dwordx4 v4, s[8:11], s43 offen lds
  s_add_u32 s43, s36, 3473408
  s_add_u32 m0, s42, 67584
  s_nop 0
  buffer_load_dwordx4 v4, s[8:11], s43 offen lds
  s_add_u32 s43, s36, 3506176
  s_add_u32 m0, s42, 68608
  s_nop 0
  buffer_load_dwordx4 v4, s[8:11], s43 offen lds
  v_add_u32 v60, 131072, v5
  ds_read_b64_tr_b16 a[128:129], v60 offset:0
  ds_read_b64_tr_b16 a[130:131], v60 offset:1024
  v_add_u32 v61, 131072, v6
  ds_read_b64_tr_b16 a[132:133], v61 offset:0
  ds_read_b64_tr_b16 a[134:135], v61 offset:1024
  ds_read_b64_tr_b16 a[136:137], v60 offset:4096
  ds_read_b64_tr_b16 a[138:139], v60 offset:5120
  ds_read_b64_tr_b16 a[140:141], v61 offset:4096
  ds_read_b64_tr_b16 a[142:143], v61 offset:5120
  s_waitcnt vmcnt(16) lgkmcnt(0)
  s_barrier
  s_add_u32 s43, s36, 3670016
  s_add_u32 m0, s42, 81920
  s_nop 0
  buffer_load_dwordx4 v4, s[8:11], s43 offen lds
  s_add_u32 s43, s36, 3702784
  s_add_u32 m0, s42, 82944
  s_nop 0
  buffer_load_dwordx4 v4, s[8:11], s43 offen lds
  s_add_u32 s43, s36, 3735552
  s_add_u32 m0, s42, 83968
  s_nop 0
  buffer_load_dwordx4 v4, s[8:11], s43 offen lds
  s_add_u32 s43, s36, 3768320
  s_add_u32 m0, s42, 84992
  s_nop 0
  buffer_load_dwordx4 v4, s[8:11], s43 offen lds
  v_add_u32 v60, 0, v5
  ds_read_b64_tr_b16 a[144:145], v60 offset:0
  ds_read_b64_tr_b16 a[146:147], v60 offset:1024
  v_add_u32 v61, 0, v6
  ds_read_b64_tr_b16 a[148:149], v61 offset:0
  ds_read_b64_tr_b16 a[150:151], v61 offset:1024
  ds_read_b64_tr_b16 a[152:153], v60 offset:4096
  ds_read_b64_tr_b16 a[154:155], v60 offset:5120
  ds_read_b64_tr_b16 a[156:157], v61 offset:4096
  ds_read_b64_tr_b16 a[158:159], v61 offset:5120
  s_waitcnt vmcnt(16) lgkmcnt(0)
  s_barrier
  s_add_u32 s43, s36, 3932160
  s_add_u32 m0, s42, 98304
  s_nop 0
  buffer_load_dwordx4 v4, s[8:11], s43 offen lds
  s_add_u32 s43, s36, 3964928
  s_add_u32 m0, s42, 99328
  s_nop 0
  buffer_load_dwordx4 v4, s[8:11], s43 offen lds
  s_add_u32 s43, s36, 3997696
  s_add_u32 m0, s42, 100352
  s_nop 0
  buffer_load_dwordx4 v4, s[8:11], s43 offen lds
  s_add_u32 s43, s36, 4030464
  s_add_u32 m0, s42, 101376
  s_nop 0
  buffer_load_dwordx4 v4, s[8:11], s43 offen lds
  v_add_u32 v60, 16384, v5
  ds_read_b64_tr_b16 a[160:161], v60 offset:0
  ds_read_b64_tr_b16 a[162:163], v60 offset:1024
  v_add_u32 v61, 16384, v6
  ds_read_b64_tr_b16 a[164:165], v61 offset:0
  ds_read_b64_tr_b16 a[166:167], v61 offset:1024
  ds_read_b64_tr_b16 a[168:169], v60 offset:4096
  ds_read_b64_tr_b16 a[170:171], v60 offset:5120
  ds_read_b64_tr_b16 a[172:173], v61 offset:4096
  ds_read_b64_tr_b16 a[174:175], v61 offset:5120
  s_waitcnt vmcnt(16) lgkmcnt(0)
  s_barrier
  s_add_u32 s43, s36, 4194304
  s_add_u32 m0, s42, 114688
  s_nop 0
  buffer_load_dwordx4 v4, s[8:11], s43 offen lds
  s_add_u32 s43, s36, 4227072
  s_add_u32 m0, s42, 115712
  s_nop 0
  buffer_load_dwordx4 v4, s[8:11], s43 offen lds
  s_add_u32 s43, s36, 4259840
  s_add_u32 m0, s42, 116736
  s_nop 0
  buffer_load_dwordx4 v4, s[8:11], s43 offen lds
  s_add_u32 s43, s36, 4292608
  s_add_u32 m0, s42, 117760
  s_nop 0
  buffer_load_dwordx4 v4, s[8:11], s43 offen lds
  v_add_u32 v60, 32768, v5
  ds_read_b64_tr_b16 a[176:177], v60 offset:0
  ds_read_b64_tr_b16 a[178:179], v60 offset:1024
  v_add_u32 v61, 32768, v6
  ds_read_b64_tr_b16 a[180:181], v61 offset:0
  ds_read_b64_tr_b16 a[182:183], v61 offset:1024
  ds_read_b64_tr_b16 a[184:185], v60 offset:4096
  ds_read_b64_tr_b16 a[186:187], v60 offset:5120
  ds_read_b64_tr_b16 a[188:189], v61 offset:4096
  ds_read_b64_tr_b16 a[190:191], v61 offset:5120
  s_waitcnt vmcnt(16) lgkmcnt(0)
  s_barrier
  s_add_u32 s43, s36, 4456448
  s_add_u32 m0, s42, 131072
  s_nop 0
  buffer_load_dwordx4 v4, s[8:11], s43 offen lds
  s_add_u32 s43, s36, 4489216
  s_add_u32 m0, s42, 132096
  s_nop 0
  buffer_load_dwordx4 v4, s[8:11], s43 offen lds
  s_add_u32 s43, s36, 4521984
  s_add_u32 m0, s42, 133120
  s_nop 0
  buffer_load_dwordx4 v4, s[8:11], s43 offen lds
  s_add_u32 s43, s36, 4554752
  s_add_u32 m0, s42, 134144
  s_nop 0
  buffer_load_dwordx4 v4, s[8:11], s43 offen lds
  v_add_u32 v60, 49152, v5
  ds_read_b64_tr_b16 a[192:193], v60 offset:0
  ds_read_b64_tr_b16 a[194:195], v60 offset:1024
  v_add_u32 v61, 49152, v6
  ds_read_b64_tr_b16 a[196:197], v61 offset:0
  ds_read_b64_tr_b16 a[198:199], v61 offset:1024
  ds_read_b64_tr_b16 a[200:201], v60 offset:4096
  ds_read_b64_tr_b16 a[202:203], v60 offset:5120
  ds_read_b64_tr_b16 a[204:205], v61 offset:4096
  ds_read_b64_tr_b16 a[206:207], v61 offset:5120
  s_waitcnt vmcnt(16) lgkmcnt(0)
  s_barrier
  v_add_u32 v60, 65536, v5
  ds_read_b64_tr_b16 a[208:209], v60 offset:0
  ds_read_b64_tr_b16 a[210:211], v60 offset:1024
  v_add_u32 v61, 65536, v6
  ds_read_b64_tr_b16 a[212:213], v61 offset:0
  ds_read_b64_tr_b16 a[214:215], v61 offset:1024
  ds_read_b64_tr_b16 a[216:217], v60 offset:4096
  ds_read_b64_tr_b16 a[218:219], v60 offset:5120
  ds_read_b64_tr_b16 a[220:221], v61 offset:4096
  ds_read_b64_tr_b16 a[222:223], v61 offset:5120
  s_waitcnt vmcnt(12) lgkmcnt(0)
  s_barrier
  v_add_u32 v60, 81920, v5
  ds_read_b64_tr_b16 a[224:225], v60 offset:0
  ds_read_b64_tr_b16 a[226:227], v60 offset:1024
  v_add_u32 v61, 81920, v6
  ds_read_b64_tr_b16 a[228:229], v61 offset:0
  ds_read_b64_tr_b16 a[230:231], v61 offset:1024
  ds_read_b64_tr_b16 a[232:233], v60 offset:4096
  ds_read_b64_tr_b16 a[234:235], v60 offset:5120
  ds_read_b64_tr_b16 a[236:237], v61 offset:4096
  ds_read_b64_tr_b16 a[238:239], v61 offset:5120
  s_waitcnt vmcnt(8) lgkmcnt(0)
  s_barrier
  v_add_u32 v60, 98304, v5
  ds_read_b64_tr_b16 a[240:241], v60 offset:0
  ds_read_b64_tr_b16 a[242:243], v60 offset:1024
  v_add_u32 v61, 98304, v6
  ds_read_b64_tr_b16 a[244:245], v61 offset:0
  ds_read_b64_tr_b16 a[246:247], v61 offset:1024
  ds_read_b64_tr_b16 a[248:249], v60 offset:4096
  ds_read_b64_tr_b16 a[250:251], v60 offset:5120
  ds_read_b64_tr_b16 a[252:253], v61 offset:4096
  ds_read_b64_tr_b16 a[254:255], v61 offset:5120
  s_waitcnt vmcnt(4) lgkmcnt(0)
  s_barrier
  v_add_u32 v60, 114688, v5
  ds_read_b64_tr_b16 v[224:225], v60 offset:0
  ds_read_b64_tr_b16 v[226:227], v60 offset:1024
  v_add_u32 v61, 114688, v6
  ds_read_b64_tr_b16 v[228:229], v61 offset:0
  ds_read_b64_tr_b16 v[230:231], v61 offset:1024
  ds_read_b64_tr_b16 v[232:233], v60 offset:4096
  ds_read_b64_tr_b16 v[234:235], v60 offset:5120
  ds_read_b64_tr_b16 v[236:237], v61 offset:4096
  ds_read_b64_tr_b16 v[238:239], v61 offset:5120
  s_waitcnt vmcnt(0) lgkmcnt(0)
  s_barrier
  v_add_u32 v60, 131072, v5
  ds_read_b64_tr_b16 v[240:241], v60 offset:0
  ds_read_b64_tr_b16 v[242:243], v60 offset:1024
  v_add_u32 v61, 131072, v6
  ds_read_b64_tr_b16 v[244:245], v61 offset:0
  ds_read_b64_tr_b16 v[246:247], v61 offset:1024
  ds_read_b64_tr_b16 v[248:249], v60 offset:4096
  ds_read_b64_tr_b16 v[250:251], v60 offset:5120
  ds_read_b64_tr_b16 v[252:253], v61 offset:4096
  ds_read_b64_tr_b16 v[254:255], v61 offset:5120
  s_waitcnt lgkmcnt(0)
  s_barrier
  s_cmp_eq_u32 s17, 0
  s_cbranch_scc0 wds_146
  s_add_u32 s23, s51, 16
  s_lshl_b32 s23, s23, 2
  v_mov_b32 v60, s23
  s_mov_b32 s25, 32
  s_mov_b32 s23, 0
wdw_144:
  global_load_dword v61, v60, s[14:15] sc1
  s_add_u32 s23, s23, 1
  s_waitcnt vmcnt(0)
  v_readfirstlane_b32 s24, v61
  s_nop 3
  s_cmp_ge_u32 s24, s25
  s_cbranch_scc1 wdd_145
  s_sleep 2
  s_cmp_lg_u32 s44, 0
  s_cbranch_scc1 wdd_145
  s_cmp_lt_u32 s23, 0x40000
  s_cbranch_scc1 wdw_144
  s_mov_b32 s44, 1
wdd_145:
wds_146:
  s_barrier
  s_cmp_eq_u32 s17, 0
  s_cbranch_scc0 wds_149
  s_mov_b32 s23, 9
  s_lshl_b32 s23, s23, 2
  v_mov_b32 v60, s23
  s_mov_b32 s25, 32
  s_mov_b32 s23, 0
wdw_147:
  global_load_dword v61, v60, s[14:15] sc1
  s_add_u32 s23, s23, 1
  s_waitcnt vmcnt(0)
  v_readfirstlane_b32 s24, v61
  s_nop 3
  s_cmp_ge_u32 s24, s25
  s_cbranch_scc1 wdd_148
  s_sleep 2
  s_cmp_lg_u32 s44, 0
  s_cbranch_scc1 wdd_148
  s_cmp_lt_u32 s23, 0x40000
  s_cbranch_scc1 wdw_147
  s_mov_b32 s44, 1
wdd_148:
wds_149:
  s_barrier
  s_mov_b32 s19, 0
  s_mov_b32 s20, s51
  s_mov_b32 s37, 22528
  s_mul_i32 s23, s20, 36864
  s_mul_i32 s24, s17, 9216
  s_add_u32 s23, s23, s24
  s_add_u32 s23, s23, 54525952
  s_add_u32 s24, s24, s37
  s_add_u32 m0, s24, 0
  s_nop 0
  buffer_load_dwordx4 v3, s[4:7], s23 offen offset:0 sc1 lds
  s_add_u32 m0, s24, 0
  s_nop 0
  buffer_load_dwordx4 v3, s[4:7], s23 offen offset:1024 sc1 lds
  s_add_u32 m0, s24, 0
  s_nop 0
  buffer_load_dwordx4 v3, s[4:7], s23 offen offset:2048 sc1 lds
  s_add_u32 m0, s24, 0
  s_nop 0
  buffer_load_dwordx4 v3, s[4:7], s23 offen offset:3072 sc1 lds
  s_add_u32 m0, s24, 4096
  s_add_u32 s23, s23, 4096
  buffer_load_dwordx4 v3, s[4:7], s23 offen offset:0 sc1 lds
  s_add_u32 m0, s24, 4096
  s_nop 0
  buffer_load_dwordx4 v3, s[4:7], s23 offen offset:1024 sc1 lds
  s_add_u32 m0, s24, 4096
  s_nop 0
  buffer_load_dwordx4 v3, s[4:7], s23 offen offset:2048 sc1 lds
  s_add_u32 m0, s24, 4096
  s_nop 0
  buffer_load_dwordx4 v3, s[4:7], s23 offen offset:3072 sc1 lds
  s_add_u32 m0, s24, 8192
  s_add_u32 s23, s23, 4096
  buffer_load_dwordx4 v3, s[4:7], s23 offen offset:0 sc1 lds
  v_add_u32 v8, 22528, v3
  s_lshl_b32 s38, s51, 7
  s_lshl_b32 s23, s50, 2
  s_add_u32 s38, s38, s23
  s_add_u32 s38, s38, 2162816
pa_loop_150:
  s_waitcnt vmcnt(0)
  s_barrier
  s_cmp_eq_u32 s19, 0
  s_cbranch_scc1 pa_fl_154
  s_cmp_eq_u32 s17, 0
  s_cbranch_scc0 pa_fl_154
  s_mov_b64 exec, 1
  v_mov_b32 v60, 0
  v_mov_b32 v61, s19
  buffer_store_dword v61, v60, s[4:7], s38 offen sc1
  s_mov_b64 exec, -1
pa_fl_154:
  s_add_u32 s39, s19, 1
  s_cmp_lt_u32 s39, s52
  s_cbranch_scc0 pa_nn_151
  s_add_u32 s39, s20, 7
  s_xor_b32 s25, s37, 45056
  s_mul_i32 s23, s39, 36864
  s_mul_i32 s24, s17, 9216
  s_add_u32 s23, s23, s24
  s_add_u32 s23, s23, 54525952
  s_add_u32 s24, s24, s25
  s_add_u32 m0, s24, 0
  s_nop 0
  buffer_load_dwordx4 v3, s[4:7], s23 offen offset:0 sc1 lds
  s_add_u32 m0, s24, 0
  s_nop 0
  buffer_load_dwordx4 v3, s[4:7], s23 offen offset:1024 sc1 lds
  s_add_u32 m0, s24, 0
  s_nop 0
  buffer_load_dwordx4 v3, s[4:7], s23 offen offset:2048 sc1 lds
  s_add_u32 m0, s24, 0
  s_nop 0
  buffer_load_dwordx4 v3, s[4:7], s23 offen offset:3072 sc1 lds
  s_add_u32 m0, s24, 4096
  s_add_u32 s23, s23, 4096
  buffer_load_dwordx4 v3, s[4:7], s23 offen offset:0 sc1 lds
  s_add_u32 m0, s24, 4096
  s_nop 0
  buffer_load_dwordx4 v3, s[4:7], s23 offen offset:1024 sc1 lds
  s_add_u32 m0, s24, 4096
  s_nop 0
  buffer_load_dwordx4 v3, s[4:7], s23 offen offset:2048 sc1 lds
  s_add_u32 m0, s24, 4096
  s_nop 0
  buffer_load_dwordx4 v3, s[4:7], s23 offen offset:3072 sc1 lds
  s_add_u32 m0, s24, 8192
  s_add_u32 s23, s23, 4096
  buffer_load_dwordx4 v3, s[4:7], s23 offen offset:0 sc1 lds
pa_nn_151:
  s_cmp_lt_u32 s17, 2
  s_cbranch_scc0 pa_v_152
  ds_read_b128 v[96:99], v8 offset:0
  ds_read_b128 v[100:103], v8 offset:1024
  ds_read_b128 v[104:107], v8 offset:2048
  ds_read_b128 v[108:111], v8 offset:3072
  s_waitcnt lgkmcnt(3)
  v_mfma_f32_32x32x16_bf16 v[64:79], a[0:3], v[96:99], 0
  v_mfma_f32_32x32x16_bf16 v[80:95], a[4:7], v[96:99], 0
  ds_read_b128 v[96:99], v8 offset:4096
  s_waitcnt lgkmcnt(3)
  v_mfma_f32_32x32x16_bf16 v[64:79], a[8:11], v[100:103], v[64:79]
  v_mfma_f32_32x32x16_bf16 v[80:95], a[12:15], v[100:103], v[80:95]
  ds_read_b128 v[100:103], v8 offset:5120
  s_waitcnt lgkmcnt(3)
  v_mfma_f32_32x32x16_bf16 v[64:79], a[16:19], v[104:107], v[64:79]
  v_mfma_f32_32x32x16_bf16 v[80:95], a[20:23], v[104:107], v[80:95]
  ds_read_b128 v[104:107], v8 offset:6144
  s_waitcnt lgkmcnt(3)
  v_mfma_f32_32x32x16_bf16 v[64:79], a[24:27], v[108:111], v[64:79]
  v_mfma_f32_32x32x16_bf16 v[80:95], a[28:31], v[108:111], v[80:95]
  ds_read_b128 v[108:111], v8 offset:7168
  s_waitcnt lgkmcnt(3)
  v_mfma_f32_32x32x16_bf16 v[64:79], a[32:35], v[96:99], v[64:79]
  v_mfma_f32_32x32x16_bf16 v[80:95], a[36:39], v[96:99], v[80:95]
  ds_read_b128 v[96:99], v8 offset:8192
  s_waitcnt lgkmcnt(3)
  v_mfma_f32_32x32x16_bf16 v[64:79], a[40:43], v[100:103], v[64:79]
  v_mfma_f32_32x32x16_bf16 v[80:95], a[44:47], v[100:103], v[80:95]
  ds_read_b128 v[100:103], v8 offset:9216
  s_waitcnt lgkmcnt(3)
  v_mfma_f32_32x32x16_bf16 v[64:79], a[48:51], v[104:107], v[64:79]
  v_mfma_f32_32x32x16_bf16 v[80:95], a[52:55], v[104:107], v[80:95]
  ds_read_b128 v[104:107], v8 offset:10240
  s_waitcnt lgkmcnt(3)
  v_mfma_f32_32x32x16_bf16 v[64:79], a[56:59], v[108:111], v[64:79]
  v_mfma_f32_32x32x16_bf16 v[80:95], a[60:63], v[108:111], v[80:95]
  ds_read_b128 v[108:111], v8 offset:11264
  s_waitcnt lgkmcnt(3)
  v_mfma_f32_32x32x16_bf16 v[64:79], a[64:67], v[96:99], v[64:79]
  v_mfma_f32_32x32x16_bf16 v[80:95], a[68:71], v[96:99], v[80:95]
  ds_read_b128 v[96:99], v8 offset:12288
  s_waitcnt lgkmcnt(3)
  v_mfma_f32_32x32x16_bf16 v[64:79], a[72:75], v[100:103], v[64:79]
  v_mfma_f32_32x32x16_bf16 v[80:95], a[76:79], v[100:103], v[80:95]
  ds_read_b128 v[100:103], v8 offset:13312
  s_waitcnt lgkmcnt(3)
  v_mfma_f32_32x32x16_bf16 v[64:79], a[80:83], v[104:107], v[64:79]
  v_mfma_f32_32x32x16_bf16 v[80:95], a[84:87], v[104:107], v[80:95]
  ds_read_b128 v[104:107], v8 offset:14336
  s_waitcnt lgkmcnt(3)
  v_mfma_f32_32x32x16_bf16 v[64:79], a[88:91], v[108:111], v[64:79]
  v_mfma_f32_32x32x16_bf16 v[80:95], a[92:95], v[108:111], v[80:95]
  ds_read_b128 v[108:111], v8 offset:15360
  s_waitcnt lgkmcnt(3)
  v_mfma_f32_32x32x16_bf16 v[64:79], a[96:99], v[96:99], v[64:79]
  v_mfma_f32_32x32x16_bf16 v[80:95], a[100:103], v[96:99], v[80:95]
  ds_read_b128 v[96:99], v8 offset:16384
  s_waitcnt lgkmcnt(3)
  v_mfma_f32_32x32x16_bf16 v[64:79], a[104:107], v[100:103], v[64:79]
  v_mfma_f32_32x32x16_bf16 v[80:95], a[108:111], v[100:103], v[80:95]
  ds_read_b128 v[100:103], v8 offset:17408
  s_waitcnt lgkmcnt(3)
  v_mfma_f32_32x32x16_bf16 v[64:79], a[112:115], v[104:107], v[64:79]
  v_mfma_f32_32x32x16_bf16 v[80:95], a[116:119], v[104:107], v[80:95]
  ds_read_b128 v[104:107], v8 offset:18432
  s_waitcnt lgkmcnt(3)
  v_mfma_f32_32x32x16_bf16 v[64:79], a[120:123], v[108:111], v[64:79]
  v_mfma_f32_32x32x16_bf16 v[80:95], a[124:127], v[108:111], v[80:95]
  ds_read_b128 v[108:111], v8 offset:19456
  s_waitcnt lgkmcnt(3)
  v_mfma_f32_32x32x16_bf16 v[64:79], a[128:131], v[96:99], v[64:79]
  v_mfma_f32_32x32x16_bf16 v[80:95], a[132:135], v[96:99], v[80:95]
  ds_read_b128 v[96:99], v8 offset:20480
  s_waitcnt lgkmcnt(3)
  v_mfma_f32_32x32x16_bf16 v[64:79], a[136:139], v[100:103], v[64:79]
  v_mfma_f32_32x32x16_bf16 v[80:95], a[140:143], v[100:103], v[80:95]
  ds_read_b128 v[100:103], v8 offset:21504
  s_waitcnt lgkmcnt(3)
  v_mfma_f32_32x32x16_bf16 v[64:79], a[144:147], v[104:107], v[64:79]
  v_mfma_f32_32x32x16_bf16 v[80:95], a[148:151], v[104:107], v[80:95]
  ds_read_b128 v[104:107], v8 offset:22528
  s_waitcnt lgkmcnt(3)
  v_mfma_f32_32x32x16_bf16 v[64:79], a[152:155], v[108:111], v[64:79]
  v_mfma_f32_32x32x16_bf16 v[80:95], a[156:159], v[108:111], v[80:95]
  ds_read_b128 v[108:111], v8 offset:23552
  s_waitcnt lgkmcnt(3)
  v_mfma_f32_32x32x16_bf16 v[64:79], a[160:163], v[96:99], v[64:79]
  v_mfma_f32_32x32x16_bf16 v[80:95], a[164:167], v[96:99], v[80:95]
  ds_read_b128 v[96:99], v8 offset:24576
  s_waitcnt lgkmcnt(3)
  v_mfma_f32_32x32x16_bf16 v[64:79], a[168:171], v[100:103], v[64:79]
  v_mfma_f32_32x32x16_bf16 v[80:95], a[172:175], v[100:103], v[80:95]
  ds_read_b128 v[100:103], v8 offset:25600
  s_waitcnt lgkmcnt(3)
  v_mfma_f32_32x32x16_bf16 v[64:79], a[176:179], v[104:107], v[64:79]
  v_mfma_f32_32x32x16_bf16 v[80:95], a[180:183], v[104:107], v[80:95]
  ds_read_b128 v[104:107], v8 offset:26624
  s_waitcnt lgkmcnt(3)
  v_mfma_f32_32x32x16_bf16 v[64:79], a[184:187], v[108:111], v[64:79]
  v_mfma_f32_32x32x16_bf16 v[80:95], a[188:191], v[108:111], v[80:95]
  ds_read_b128 v[108:111], v8 offset:27648
  s_waitcnt lgkmcnt(3)
  v_mfma_f32_32x32x16_bf16 v[64:79], a[192:195], v[96:99], v[64:79]
  v_mfma_f32_32x32x16_bf16 v[80:95], a[196:199], v[96:99], v[80:95]
  ds_read_b128 v[96:99], v8 offset:28672
  s_waitcnt lgkmcnt(3)
  v_mfma_f32_32x32x16_bf16 v[64:79], a[200:203], v[100:103], v[64:79]
  v_mfma_f32_32x32x16_bf16 v[80:95], a[204:207], v[100:103], v[80:95]
  ds_read_b128 v[100:103], v8 offset:29696
  s_waitcnt lgkmcnt(3)
  v_mfma_f32_32x32x16_bf16 v[64:79], a[208:211], v[104:107], v[64:79]
  v_mfma_f32_32x32x16_bf16 v[80:95], a[212:215], v[104:107], v[80:95]
  ds_read_b128 v[104:107], v8 offset:30720
  s_waitcnt lgkmcnt(3)
  v_mfma_f32_32x32x16_bf16 v[64:79], a[216:219], v[108:111], v[64:79]
  v_mfma_f32_32x32x16_bf16 v[80:95], a[220:223], v[108:111], v[80:95]
  ds_read_b128 v[108:111], v8 offset:31744
  s_waitcnt lgkmcnt(3)
  v_mfma_f32_32x32x16_bf16 v[64:79], a[224:227], v[96:99], v[64:79]
  v_mfma_f32_32x32x16_bf16 v[80:95], a[228:231], v[96:99], v[80:95]
  ds_read_b128 v[96:99], v8 offset:32768
  s_waitcnt lgkmcnt(3)
  v_mfma_f32_32x32x16_bf16 v[64:79], a[232:235], v[100:103], v[64:79]
  v_mfma_f32_32x32x16_bf16 v[80:95], a[236:239], v[100:103], v[80:95]
  ds_read_b128 v[100:103], v8 offset:33792
  s_waitcnt lgkmcnt(3)
  v_mfma_f32_32x32x16_bf16 v[64:79], a[240:243], v[104:107], v[64:79]
  v_mfma_f32_32x32x16_bf16 v[80:95], a[244:247], v[104:107], v[80:95]
  ds_read_b128 v[104:107], v8 offset:34816
  s_waitcnt lgkmcnt(3)
  v_mfma_f32_32x32x16_bf16 v[64:79], a[248:251], v[108:111], v[64:79]
  v_mfma_f32_32x32x16_bf16 v[80:95], a[252:255], v[108:111], v[80:95]
  ds_read_b128 v[108:111], v8 offset:35840
  s_waitcnt lgkmcnt(3)
  v_mfma_f32_32x32x16_bf16 v[64:79], v[224:227], v[96:99], v[64:79]
  v_mfma_f32_32x32x16_bf16 v[80:95], v[228:231], v[96:99], v[80:95]
  s_waitcnt lgkmcnt(2)
  v_mfma_f32_32x32x16_bf16 v[64:79], v[232:235], v[100:103], v[64:79]
  v_mfma_f32_32x32x16_bf16 v[80:95], v[236:239], v[100:103], v[80:95]
  s_waitcnt lgkmcnt(1)
  v_mfma_f32_32x32x16_bf16 v[64:79], v[240:243], v[104:107], v[64:79]
  v_mfma_f32_32x32x16_bf16 v[80:95], v[244:247], v[104:107], v[80:95]
  s_waitcnt lgkmcnt(0)
  v_mfma_f32_32x32x16_bf16 v[64:79], v[248:251], v[108:111], v[64:79]
  v_mfma_f32_32x32x16_bf16 v[80:95], v[252:255], v[108:111], v[80:95]
  s_branch pa_e_153
pa_v_152:
  ds_read_b128 v[96:99], v8 offset:0
  ds_read_b128 v[100:103], v8 offset:1024
  ds_read_b128 v[104:107], v8 offset:2048
  ds_read_b128 v[108:111], v8 offset:3072
  s_waitcnt lgkmcnt(3)
  v_mfma_f32_32x32x16_bf16 v[64:79], v[96:99], a[0:3], 0
  v_mfma_f32_32x32x16_bf16 v[80:95], v[96:99], a[4:7], 0
  ds_read_b128 v[96:99], v8 offset:4096
  s_waitcnt lgkmcnt(3)
  v_mfma_f32_32x32x16_bf16 v[64:79], v[100:103], a[8:11], v[64:79]
  v_mfma_f32_32x32x16_bf16 v[80:95], v[100:103], a[12:15], v[80:95]
  ds_read_b128 v[100:103], v8 offset:5120
  s_waitcnt lgkmcnt(3)
  v_mfma_f32_32x32x16_bf16 v[64:79], v[104:107], a[16:19], v[64:79]
  v_mfma_f32_32x32x16_bf16 v[80:95], v[104:107], a[20:23], v[80:95]
  ds_read_b128 v[104:107], v8 offset:6144
  s_waitcnt lgkmcnt(3)
  v_mfma_f32_32x32x16_bf16 v[64:79], v[108:111], a[24:27], v[64:79]
  v_mfma_f32_32x32x16_bf16 v[80:95], v[108:111], a[28:31], v[80:95]
  ds_read_b128 v[108:111], v8 offset:7168
  s_waitcnt lgkmcnt(3)
  v_mfma_f32_32x32x16_bf16 v[64:79], v[96:99], a[32:35], v[64:79]
  v_mfma_f32_32x32x16_bf16 v[80:95], v[96:99], a[36:39], v[80:95]
  ds_read_b128 v[96:99], v8 offset:8192
  s_waitcnt lgkmcnt(3)
  v_mfma_f32_32x32x16_bf16 v[64:79], v[100:103], a[40:43], v[64:79]
  v_mfma_f32_32x32x16_bf16 v[80:95], v[100:103], a[44:47], v[80:95]
  ds_read_b128 v[100:103], v8 offset:9216
  s_waitcnt lgkmcnt(3)
  v_mfma_f32_32x32x16_bf16 v[64:79], v[104:107], a[48:51], v[64:79]
  v_mfma_f32_32x32x16_bf16 v[80:95], v[104:107], a[52:55], v[80:95]
  ds_read_b128 v[104:107], v8 offset:10240
  s_waitcnt lgkmcnt(3)
  v_mfma_f32_32x32x16_bf16 v[64:79], v[108:111], a[56:59], v[64:79]
  v_mfma_f32_32x32x16_bf16 v[80:95], v[108:111], a[60:63], v[80:95]
  ds_read_b128 v[108:111], v8 offset:11264
  s_waitcnt lgkmcnt(3)
  v_mfma_f32_32x32x16_bf16 v[64:79], v[96:99], a[64:67], v[64:79]
  v_mfma_f32_32x32x16_bf16 v[80:95], v[96:99], a[68:71], v[80:95]
  ds_read_b128 v[96:99], v8 offset:12288
  s_waitcnt lgkmcnt(3)
  v_mfma_f32_32x32x16_bf16 v[64:79], v[100:103], a[72:75], v[64:79]
  v_mfma_f32_32x32x16_bf16 v[80:95], v[100:103], a[76:79], v[80:95]
  ds_read_b128 v[100:103], v8 offset:13312
  s_waitcnt lgkmcnt(3)
  v_mfma_f32_32x32x16_bf16 v[64:79], v[104:107], a[80:83], v[64:79]
  v_mfma_f32_32x32x16_bf16 v[80:95], v[104:107], a[84:87], v[80:95]
  ds_read_b128 v[104:107], v8 offset:14336
  s_waitcnt lgkmcnt(3)
  v_mfma_f32_32x32x16_bf16 v[64:79], v[108:111], a[88:91], v[64:79]
  v_mfma_f32_32x32x16_bf16 v[80:95], v[108:111], a[92:95], v[80:95]
  ds_read_b128 v[108:111], v8 offset:15360
  s_waitcnt lgkmcnt(3)
  v_mfma_f32_32x32x16_bf16 v[64:79], v[96:99], a[96:99], v[64:79]
  v_mfma_f32_32x32x16_bf16 v[80:95], v[96:99], a[100:103], v[80:95]
  ds_read_b128 v[96:99], v8 offset:16384
  s_waitcnt lgkmcnt(3)
  v_mfma_f32_32x32x16_bf16 v[64:79], v[100:103], a[104:107], v[64:79]
  v_mfma_f32_32x32x16_bf16 v[80:95], v[100:103], a[108:111], v[80:95]
  ds_read_b128 v[100:103], v8 offset:17408
  s_waitcnt lgkmcnt(3)
  v_mfma_f32_32x32x16_bf16 v[64:79], v[104:107], a[112:115], v[64:79]
  v_mfma_f32_32x32x16_bf16 v[80:95], v[104:107], a[116:119], v[80:95]
  ds_read_b128 v[104:107], v8 offset:18432
  s_waitcnt lgkmcnt(3)
  v_mfma_f32_32x32x16_bf16 v[64:79], v[108:111], a[120:123], v[64:79]
  v_mfma_f32_32x32x16_bf16 v[80:95], v[108:111], a[124:127], v[80:95]
  ds_read_b128 v[108:111], v8 offset:19456
  s_waitcnt lgkmcnt(3)
  v_mfma_f32_32x32x16_bf16 v[64:79], v[96:99], a[128:131], v[64:79]
  v_mfma_f32_32x32x16_bf16 v[80:95], v[96:99], a[132:135], v[80:95]
  ds_read_b128 v[96:99], v8 offset:20480
  s_waitcnt lgkmcnt(3)
  v_mfma_f32_32x32x16_bf16 v[64:79], v[100:103], a[136:139], v[64:79]
  v_mfma_f32_32x32x16_bf16 v[80:95], v[100:103], a[140:143], v[80:95]
  ds_read_b128 v[100:103], v8 offset:21504
  s_waitcnt lgkmcnt(3)
  v_mfma_f32_32x32x16_bf16 v[64:79], v[104:107], a[144:147], v[64:79]
  v_mfma_f32_32x32x16_bf16 v[80:95], v[104:107], a[148:151], v[80:95]
  ds_read_b128 v[104:107], v8 offset:22528
  s_waitcnt lgkmcnt(3)
  v_mfma_f32_32x32x16_bf16 v[64:79], v[108:111], a[152:155], v[64:79]
  v_mfma_f32_32x32x16_bf16 v[80:95], v[108:111], a[156:159], v[80:95]
  ds_read_b128 v[108:111], v8 offset:23552
  s_waitcnt lgkmcnt(3)
  v_mfma_f32_32x32x16_bf16 v[64:79], v[96:99], a[160:163], v[64:79]
  v_mfma_f32_32x32x16_bf16 v[80:95], v[96:99], a[164:167], v[80:95]
  ds_read_b128 v[96:99], v8 offset:24576
  s_waitcnt lgkmcnt(3)
  v_mfma_f32_32x32x16_bf16 v[64:79], v[100:103], a[168:171], v[64:79]
  v_mfma_f32_32x32x16_bf16 v[80:95], v[100:103], a[172:175], v[80:95]
  ds_read_b128 v[100:103], v8 offset:25600
  s_waitcnt lgkmcnt(3)
  v_mfma_f32_32x32x16_bf16 v[64:79], v[104:107], a[176:179], v[64:79]
  v_mfma_f32_32x32x16_bf16 v[80:95], v[104:107], a[180:183], v[80:95]
  ds_read_b128 v[104:107], v8 offset:26624
  s_waitcnt lgkmcnt(3)
  v_mfma_f32_32x32x16_bf16 v[64:79], v[108:111], a[184:187], v[64:79]
  v_mfma_f32_32x32x16_bf16 v[80:95], v[108:111], a[188:191], v[80:95]
  ds_read_b128 v[108:111], v8 offset:27648
  s_waitcnt lgkmcnt(3)
  v_mfma_f32_32x32x16_bf16 v[64:79], v[96:99], a[192:195], v[64:79]
  v_mfma_f32_32x32x16_bf16 v[80:95], v[96:99], a[196:199], v[80:95]
  ds_read_b128 v[96:99], v8 offset:28672
  s_waitcnt lgkmcnt(3)
  v_mfma_f32_32x32x16_bf16 v[64:79], v[100:103], a[200:203], v[64:79]
  v_mfma_f32_32x32x16_bf16 v[80:95], v[100:103], a[204:207], v[80:95]
  ds_read_b128 v[100:103], v8 offset:29696
  s_waitcnt lgkmcnt(3)
  v_mfma_f32_32x32x16_bf16 v[64:79], v[104:107], a[208:211], v[64:79]
  v_mfma_f32_32x32x16_bf16 v[80:95], v[104:107], a[212:215], v[80:95]
  ds_read_b128 v[104:107], v8 offset:30720
  s_waitcnt lgkmcnt(3)
  v_mfma_f32_32x32x16_bf16 v[64:79], v[108:111], a[216:219], v[64:79]
  v_mfma_f32_32x32x16_bf16 v[80:95], v[108:111], a[220:223], v[80:95]
  ds_read_b128 v[108:111], v8 offset:31744
  s_waitcnt lgkmcnt(3)
  v_mfma_f32_32x32x16_bf16 v[64:79], v[96:99], a[224:227], v[64:79]
  v_mfma_f32_32x32x16_bf16 v[80:95], v[96:99], a[228:231], v[80:95]
  ds_read_b128 v[96:99], v8 offset:32768
  s_waitcnt lgkmcnt(3)
  v_mfma_f32_32x32x16_bf16 v[64:79], v[100:103], a[232:235], v[64:79]
  v_mfma_f32_32x32x16_bf16 v[80:95], v[100:103], a[236:239], v[80:95]
  ds_read_b128 v[100:103], v8 offset:33792
  s_waitcnt lgkmcnt(3)
  v_mfma_f32_32x32x16_bf16 v[64:79], v[104:107], a[240:243], v[64:79]
  v_mfma_f32_32x32x16_bf16 v[80:95], v[104:107], a[244:247], v[80:95]
  ds_read_b128 v[104:107], v8 offset:34816
  s_waitcnt lgkmcnt(3)
  v_mfma_f32_32x32x16_bf16 v[64:79], v[108:111], a[248:251], v[64:79]
  v_mfma_f32_32x32x16_bf16 v[80:95], v[108:111], a[252:255], v[80:95]
  ds_read_b128 v[108:111], v8 offset:35840
  s_waitcnt lgkmcnt(3)
  v_mfma_f32_32x32x16_bf16 v[64:79], v[96:99], v[224:227], v[64:79]
  v_mfma_f32_32x32x16_bf16 v[80:95], v[96:99], v[228:231], v[80:95]
  s_waitcnt lgkmcnt(2)
  v_mfma_f32_32x32x16_bf16 v[64:79], v[100:103], v[232:235], v[64:79]
  v_mfma_f32_32x32x16_bf16 v[80:95], v[100:103], v[236:239], v[80:95]
  s_waitcnt lgkmcnt(1)
  v_mfma_f32_32x32x16_bf16 v[64:79], v[104:107], v[240:243], v[64:79]
  v_mfma_f32_32x32x16_bf16 v[80:95], v[104:107], v[244:247], v[80:95]
  s_waitcnt lgkmcnt(0)
  v_mfma_f32_32x32x16_bf16 v[64:79], v[108:111], v[248:251], v[64:79]
  v_mfma_f32_32x32x16_bf16 v[80:95], v[108:111], v[252:255], v[80:95]
pa_e_153:
  s_nop 15
  s_lshl_b32 s23, s20, 5
  s_add_u32 s23, s23, s50
  s_lshl_b32 s23, s23, 13
  s_cmp_lt_u32 s17, 2
  s_cselect_b32 s24, 0, 16777216
  s_add_u32 s23, s23, s24
  s_add_u32 s23, s23, 4194304
  v_cvt_pk_bf16_f32 v112, v64, v65
  v_cvt_pk_bf16_f32 v113, v66, v67
  v_cvt_pk_bf16_f32 v114, v68, v69
  v_cvt_pk_bf16_f32 v115, v70, v71
  buffer_store_dwordx4 v[112:115], v7, s[4:7], s23 offen offset:0 sc1
  v_cvt_pk_bf16_f32 v116, v72, v73
  v_cvt_pk_bf16_f32 v117, v74, v75
  v_cvt_pk_bf16_f32 v118, v76, v77
  v_cvt_pk_bf16_f32 v119, v78, v79
  buffer_store_dwordx4 v[116:119], v7, s[4:7], s23 offen offset:512 sc1
  v_cvt_pk_bf16_f32 v120, v80, v81
  v_cvt_pk_bf16_f32 v121, v82, v83
  v_cvt_pk_bf16_f32 v122, v84, v85
  v_cvt_pk_bf16_f32 v123, v86, v87
  buffer_store_dwordx4 v[120:123], v7, s[4:7], s23 offen offset:2048 sc1
  v_cvt_pk_bf16_f32 v124, v88, v89
  v_cvt_pk_bf16_f32 v125, v90, v91
  v_cvt_pk_bf16_f32 v126, v92, v93
  v_cvt_pk_bf16_f32 v127, v94, v95
  buffer_store_dwordx4 v[124:127], v7, s[4:7], s23 offen offset:2560 sc1
  s_xor_b32 s37, s37, 45056
  v_add_u32 v8, s37, v3
  s_add_u32 s20, s20, 7
  s_add_u32 s19, s19, 1
  s_cmp_lt_u32 s19, s52
  s_cbranch_scc1 pa_loop_150
  s_waitcnt vmcnt(0)
  s_barrier
  s_cmp_eq_u32 s17, 0
  s_cbranch_scc0 pa_fl_155
  s_mov_b64 exec, 1
  v_mov_b32 v60, 0
  v_mov_b32 v61, s19
  buffer_store_dword v61, v60, s[4:7], s38 offen sc1
  s_mov_b64 exec, -1
pa_fl_155:
  v_mov_b32 v2, 192
  v_mul_u32_u24 v2, v2, v0
  global_load_dword v3, v2, s[30:31] offset:0
  global_load_dword v4, v2, s[30:31] offset:28
  global_load_dword v5, v2, s[30:31] offset:32
  global_load_dword v6, v2, s[30:31] offset:36
  global_load_dword v7, v2, s[30:31] offset:40
  global_load_dword v8, v2, s[30:31] offset:44
  global_load_dword v9, v2, s[30:31] offset:48
  global_load_dword v10, v2, s[30:31] offset:52
  global_load_dword v11, v2, s[30:31] offset:56
  global_load_dword v12, v2, s[30:31] offset:68
  global_load_dword v13, v2, s[30:31] offset:72
  global_load_dword v14, v2, s[30:31] offset:88
  global_load_dword v15, v2, s[30:31] offset:92
  global_load_dword v16, v2, s[30:31] offset:96
  global_load_dword v17, v2, s[30:31] offset:100
  global_load_dword v18, v2, s[30:31] offset:104
  global_load_dword v19, v2, s[30:31] offset:108
  global_load_dword v20, v2, s[30:31] offset:112
  global_load_dword v21, v2, s[30:31] offset:116
  global_load_dword v22, v2, s[30:31] offset:120
  global_load_dword v23, v2, s[30:31] offset:124
  global_load_dword v24, v2, s[30:31] offset:160
  global_load_dword v25, v2, s[30:31] offset:164
  global_load_dword v26, v2, s[30:31] offset:168
  global_load_dword v27, v2, s[30:31] offset:172
  s_waitcnt vmcnt(0)
  v_lshrrev_b32 v28, 8, v3
  v_and_b32 v28, 1, v28
  v_lshlrev_b32 v29, 3, v28
  v_lshlrev_b32 v28, 5, v28
  s_load_dwordx2 s[32:33], s[0:1], 64
  s_waitcnt lgkmcnt(0)
  s_mov_b32 s8, s32
  s_and_b32 s9, s33, 0xffff
  s_mov_b32 s10, 5308416
  s_mov_b32 s11, 0x20000
  s_mul_i32 s36, s16, 288
  s_mul_i32 s23, s17, 36864
  s_add_u32 s37, s36, s23
  s_mul_i32 s23, s17, 1474560
  s_add_u32 s38, s36, s23
  s_add_u32 s38, s38, 256
  s_lshl_b32 s42, s17, 10
  s_mul_i32 s45, s17, 5120
  s_add_u32 s43, s37, 0
  s_add_u32 m0, s42, 0
  s_nop 0
  buffer_load_dwordx4 v4, s[8:11], s43 offen lds
  s_add_u32 s43, s37, 147456
  s_add_u32 m0, s42, 4096
  s_nop 0
  buffer_load_dwordx4 v4, s[8:11], s43 offen lds
  s_add_u32 s43, s37, 294912
  s_add_u32 m0, s42, 8192
  s_nop 0
  buffer_load_dwordx4 v4, s[8:11], s43 offen lds
  s_add_u32 s43, s37, 442368
  s_add_u32 m0, s42, 12288
  s_nop 0
  buffer_load_dwordx4 v4, s[8:11], s43 offen lds
  s_add_u32 s43, s37, 589824
  s_add_u32 m0, s42, 16384
  s_nop 0
  buffer_load_dwordx4 v4, s[8:11], s43 offen lds
  s_add_u32 s43, s37, 737280
  s_add_u32 m0, s42, 20480
  s_nop 0
  buffer_load_dwordx4 v4, s[8:11], s43 offen lds
  s_add_u32 s43, s37, 884736
  s_add_u32 m0, s42, 24576
  s_nop 0
  buffer_load_dwordx4 v4, s[8:11], s43 offen lds
  s_add_u32 s43, s37, 1032192
  s_add_u32 m0, s42, 28672
  s_nop 0
  buffer_load_dwordx4 v4, s[8:11], s43 offen lds
  s_add_u32 s43, s37, 1179648
  s_add_u32 m0, s42, 32768
  s_nop 0
  buffer_load_dwordx4 v4, s[8:11], s43 offen lds
  s_add_u32 s43, s37, 1327104
  s_add_u32 m0, s42, 36864
  s_nop 0
  buffer_load_dwordx4 v4, s[8:11], s43 offen lds
  s_add_u32 s43, s37, 1474560
  s_add_u32 m0, s42, 40960
  s_nop 0
  buffer_load_dwordx4 v4, s[8:11], s43 offen lds
  s_add_u32 s43, s37, 1622016
  s_add_u32 m0, s42, 45056
  s_nop 0
  buffer_load_dwordx4 v4, s[8:11], s43 offen lds
  s_add_u32 s43, s37, 1769472
  s_add_u32 m0, s42, 49152
  s_nop 0
  buffer_load_dwordx4 v4, s[8:11], s43 offen lds
  s_add_u32 s43, s37, 1916928
  s_add_u32 m0, s42, 53248
  s_nop 0
  buffer_load_dwordx4 v4, s[8:11], s43 offen lds
  s_add_u32 s43, s37, 2064384
  s_add_u32 m0, s42, 57344
  s_nop 0
  buffer_load_dwordx4 v4, s[8:11], s43 offen lds
  s_add_u32 s43, s37, 2211840
  s_add_u32 m0, s42, 61440
  s_nop 0
  buffer_load_dwordx4 v4, s[8:11], s43 offen lds
  s_add_u32 s43, s37, 2359296
  s_add_u32 m0, s42, 65536
  s_nop 0
  buffer_load_dwordx4 v4, s[8:11], s43 offen lds
  s_add_u32 s43, s37, 2506752
  s_add_u32 m0, s42, 69632
  s_nop 0
  buffer_load_dwordx4 v4, s[8:11], s43 offen lds
  s_add_u32 s43, s37, 2654208
  s_add_u32 m0, s42, 73728
  s_nop 0
  buffer_load_dwordx4 v4, s[8:11], s43 offen lds
  s_add_u32 s43, s37, 2801664
  s_add_u32 m0, s42, 77824
  s_nop 0
  buffer_load_dwordx4 v4, s[8:11], s43 offen lds
  s_add_u32 s43, s37, 2949120
  s_add_u32 m0, s42, 81920
  s_nop 0
  buffer_load_dwordx4 v4, s[8:11], s43 offen lds
  s_add_u32 s43, s37, 3096576
  s_add_u32 m0, s42, 86016
  s_nop 0
  buffer_load_dwordx4 v4, s[8:11], s43 offen lds
  s_add_u32 s43, s37, 3244032
  s_add_u32 m0, s42, 90112
  s_nop 0
  buffer_load_dwordx4 v4, s[8:11], s43 offen lds
  s_add_u32 s43, s37, 3391488
  s_add_u32 m0, s42, 94208
  s_nop 0
  buffer_load_dwordx4 v4, s[8:11], s43 offen lds
  s_waitcnt vmcnt(20) lgkmcnt(0)
  s_barrier
  v_add_u32 v60, 0, v6
  ds_read_b64_tr_b16 a[0:1], v60 offset:0
  ds_read_b64_tr_b16 a[2:3], v60 offset:1024
  v_add_u32 v61, 0, v7
  ds_read_b64_tr_b16 a[72:73], v61 offset:0
  ds_read_b64_tr_b16 a[74:75], v61 offset:1024
  ds_read_b64_tr_b16 a[4:5], v60 offset:8192
  ds_read_b64_tr_b16 a[6:7], v60 offset:9216
  ds_read_b64_tr_b16 a[76:77], v61 offset:8192
  ds_read_b64_tr_b16 a[78:79], v61 offset:9216
  s_waitcnt vmcnt(16) lgkmcnt(0)
  s_barrier
  s_add_u32 s43, s37, 3538944
  s_add_u32 m0, s42, 98304
  s_nop 0
  buffer_load_dwordx4 v4, s[8:11], s43 offen lds
  s_add_u32 s43, s37, 3686400
  s_add_u32 m0, s42, 102400
  s_nop 0
  buffer_load_dwordx4 v4, s[8:11], s43 offen lds
  s_add_u32 s43, s37, 3833856
  s_add_u32 m0, s42, 106496
  s_nop 0
  buffer_load_dwordx4 v4, s[8:11], s43 offen lds
  s_add_u32 s43, s37, 3981312
  s_add_u32 m0, s42, 110592
  s_nop 0
  buffer_load_dwordx4 v4, s[8:11], s43 offen lds
  v_add_u32 v60, 16384, v6
  ds_read_b64_tr_b16 a[8:9], v60 offset:0
  ds_read_b64_tr_b16 a[10:11], v60 offset:1024
  v_add_u32 v61, 16384, v7
  ds_read_b64_tr_b16 a[80:81], v61 offset:0
  ds_read_b64_tr_b16 a[82:83], v61 offset:1024
  ds_read_b64_tr_b16 a[12:13], v60 offset:8192
  ds_read_b64_tr_b16 a[14:15], v60 offset:9216
  ds_read_b64_tr_b16 a[84:85], v61 offset:8192
  ds_read_b64_tr_b16 a[86:87], v61 offset:9216
  s_waitcnt vmcnt(16) lgkmcnt(0)
  s_barrier
  s_add_u32 s43, s37, 4128768
  s_add_u32 m0, s42, 114688
  s_nop 0
  buffer_load_dwordx4 v4, s[8:11], s43 offen lds
  s_add_u32 s43, s37, 4276224
  s_add_u32 m0, s42, 118784
  s_nop 0
  buffer_load_dwordx4 v4, s[8:11], s43 offen lds
  s_add_u32 s43, s37, 4423680
  s_add_u32 m0, s42, 122880
  s_nop 0
  buffer_load_dwordx4 v4, s[8:11], s43 offen lds
  s_add_u32 s43, s37, 4571136
  s_add_u32 m0, s42, 126976
  s_nop 0
  buffer_load_dwordx4 v4, s[8:11], s43 offen lds
  v_add_u32 v60, 32768, v6
  ds_read_b64_tr_b16 a[16:17], v60 offset:0
  ds_read_b64_tr_b16 a[18:19], v60 offset:1024
  v_add_u32 v61, 32768, v7
  ds_read_b64_tr_b16 a[88:89], v61 offset:0
  ds_read_b64_tr_b16 a[90:91], v61 offset:1024
  ds_read_b64_tr_b16 a[20:21], v60 offset:8192
  ds_read_b64_tr_b16 a[22:23], v60 offset:9216
  ds_read_b64_tr_b16 a[92:93], v61 offset:8192
  ds_read_b64_tr_b16 a[94:95], v61 offset:9216
  s_waitcnt vmcnt(16) lgkmcnt(0)
  s_barrier
  s_add_u32 s43, s37, 4718592
  s_add_u32 m0, s42, 131072
  s_nop 0
  buffer_load_dwordx4 v4, s[8:11], s43 offen lds
  s_add_u32 s43, s37, 4866048
  s_add_u32 m0, s42, 135168
  s_nop 0
  buffer_load_dwordx4 v4, s[8:11], s43 offen lds
  s_add_u32 s43, s37, 5013504
  s_add_u32 m0, s42, 139264
  s_nop 0
  buffer_load_dwordx4 v4, s[8:11], s43 offen lds
  s_add_u32 s43, s37, 5160960
  s_add_u32 m0, s42, 143360
  s_nop 0
  buffer_load_dwordx4 v4, s[8:11], s43 offen lds
  v_add_u32 v60, 49152, v6
  ds_read_b64_tr_b16 a[24:25], v60 offset:0
  ds_read_b64_tr_b16 a[26:27], v60 offset:1024
  v_add_u32 v61, 49152, v7
  ds_read_b64_tr_b16 a[96:97], v61 offset:0
  ds_read_b64_tr_b16 a[98:99], v61 offset:1024
  ds_read_b64_tr_b16 a[28:29], v60 offset:8192
  ds_read_b64_tr_b16 a[30:31], v60 offset:9216
  ds_read_b64_tr_b16 a[100:101], v61 offset:8192
  ds_read_b64_tr_b16 a[102:103], v61 offset:9216
  s_waitcnt vmcnt(16) lgkmcnt(0)
  s_barrier
  s_add_u32 s43, s38, 0
  s_add_u32 m0, s45, 0
  s_nop 0
  buffer_load_dwordx4 v5, s[8:11], s43 offen lds
  s_add_u32 s43, s38, 294912
  s_add_u32 m0, s45, 1024
  s_nop 0
  buffer_load_dwordx4 v5, s[8:11], s43 offen lds
  s_add_u32 s43, s38, 589824
  s_add_u32 m0, s45, 2048
  s_nop 0
  buffer_load_dwordx4 v5, s[8:11], s43 offen lds
  s_add_u32 s43, s38, 884736
  s_add_u32 m0, s45, 3072
  s_nop 0
  buffer_load_dwordx4 v5, s[8:11], s43 offen lds
  s_add_u32 s43, s38, 1179648
  s_add_u32 m0, s45, 4096
  s_nop 0
  buffer_load_dwordx4 v5, s[8:11], s43 offen lds
  v_add_u32 v60, 65536, v6
  ds_read_b64_tr_b16 a[32:33], v60 offset:0
  ds_read_b64_tr_b16 a[34:35], v60 offset:1024
  v_add_u32 v61, 65536, v7
  ds_read_b64_tr_b16 a[104:105], v61 offset:0
  ds_read_b64_tr_b16 a[106:107], v61 offset:1024
  ds_read_b64_tr_b16 a[36:37], v60 offset:8192
  ds_read_b64_tr_b16 a[38:39], v60 offset:9216
  ds_read_b64_tr_b16 a[108:109], v61 offset:8192
  ds_read_b64_tr_b16 a[110:111], v61 offset:9216
  s_waitcnt vmcnt(17) lgkmcnt(0)
  s_barrier
  v_add_u32 v60, 81920, v6
  ds_read_b64_tr_b16 a[40:41], v60 offset:0
  ds_read_b64_tr_b16 a[42:43], v60 offset:1024
  v_add_u32 v61, 81920, v7
  ds_read_b64_tr_b16 a[112:113], v61 offset:0
  ds_read_b64_tr_b16 a[114:115], v61 offset:1024
  ds_read_b64_tr_b16 a[44:45], v60 offset:8192
  ds_read_b64_tr_b16 a[46:47], v60 offset:9216
  ds_read_b64_tr_b16 a[116:117], v61 offset:8192
  ds_read_b64_tr_b16 a[118:119], v61 offset:9216
  s_waitcnt vmcnt(13) lgkmcnt(0)
  s_barrier
  v_add_u32 v60, 98304, v6
  ds_read_b64_tr_b16 a[48:49], v60 offset:0
  ds_read_b64_tr_b16 a[50:51], v60 offset:1024
  v_add_u32 v61, 98304, v7
  ds_read_b64_tr_b16 a[120:121], v61 offset:0
  ds_read_b64_tr_b16 a[122:123], v61 offset:1024
  ds_read_b64_tr_b16 a[52:53], v60 offset:8192
  ds_read_b64_tr_b16 a[54:55], v60 offset:9216
  ds_read_b64_tr_b16 a[124:125], v61 offset:8192
  ds_read_b64_tr_b16 a[126:127], v61 offset:9216
  s_waitcnt vmcnt(9) lgkmcnt(0)
  s_barrier
  v_add_u32 v60, 114688, v6
  ds_read_b64_tr_b16 a[56:57], v60 offset:0
  ds_read_b64_tr_b16 a[58:59], v60 offset:1024
  v_add_u32 v61, 114688, v7
  ds_read_b64_tr_b16 a[128:129], v61 offset:0
  ds_read_b64_tr_b16 a[130:131], v61 offset:1024
  ds_read_b64_tr_b16 a[60:61], v60 offset:8192
  ds_read_b64_tr_b16 a[62:63], v60 offset:9216
  ds_read_b64_tr_b16 a[132:133], v61 offset:8192
  ds_read_b64_tr_b16 a[134:135], v61 offset:9216
  s_waitcnt vmcnt(5) lgkmcnt(0)
  s_barrier
  v_add_u32 v60, 131072, v6
  ds_read_b64_tr_b16 a[64:65], v60 offset:0
  ds_read_b64_tr_b16 a[66:67], v60 offset:1024
  v_add_u32 v61, 131072, v7
  ds_read_b64_tr_b16 a[136:137], v61 offset:0
  ds_read_b64_tr_b16 a[138:139], v61 offset:1024
  ds_read_b64_tr_b16 a[68:69], v60 offset:8192
  ds_read_b64_tr_b16 a[70:71], v60 offset:9216
  ds_read_b64_tr_b16 a[140:141], v61 offset:8192
  ds_read_b64_tr_b16 a[142:143], v61 offset:9216
  s_waitcnt vmcnt(0) lgkmcnt(0)
  s_barrier
  v_add_u32 v60, 0, v8
  ds_read_b64_tr_b16 a[144:145], v60 offset:0
  ds_read_b64_tr_b16 a[146:147], v60 offset:128
  ds_read_b64_tr_b16 a[148:149], v60 offset:1024
  ds_read_b64_tr_b16 a[150:151], v60 offset:1152
  ds_read_b64_tr_b16 a[152:153], v60 offset:2048
  ds_read_b64_tr_b16 a[154:155], v60 offset:2176
  ds_read_b64_tr_b16 a[156:157], v60 offset:3072
  ds_read_b64_tr_b16 a[158:159], v60 offset:3200
  ds_read_b64_tr_b16 a[160:161], v60 offset:4096
  ds_read_b64_tr_b16 a[162:163], v60 offset:4224
  ds_read_b64_tr_b16 a[164:165], v60 offset:5120
  ds_read_b64_tr_b16 a[166:167], v60 offset:5248
  ds_read_b64_tr_b16 a[168:169], v60 offset:6144
  ds_read_b64_tr_b16 a[170:171], v60 offset:6272
  ds_read_b64_tr_b16 a[172:173], v60 offset:7168
  ds_read_b64_tr_b16 a[174:175], v60 offset:7296
  ds_read_b64_tr_b16 a[176:177], v60 offset:8192
  ds_read_b64_tr_b16 a[178:179], v60 offset:8320
  ds_read_b64_tr_b16 a[180:181], v60 offset:9216
  ds_read_b64_tr_b16 a[182:183], v60 offset:9344
  ds_read_b64_tr_b16 a[184:185], v60 offset:10240
  ds_read_b64_tr_b16 a[186:187], v60 offset:10368
  ds_read_b64_tr_b16 a[188:189], v60 offset:11264
  ds_read_b64_tr_b16 a[190:191], v60 offset:11392
  ds_read_b64_tr_b16 a[192:193], v60 offset:12288
  ds_read_b64_tr_b16 a[194:195], v60 offset:12416
  ds_read_b64_tr_b16 a[196:197], v60 offset:13312
  ds_read_b64_tr_b16 a[198:199], v60 offset:13440
  ds_read_b64_tr_b16 a[200:201], v60 offset:14336
  ds_read_b64_tr_b16 a[202:203], v60 offset:14464
  ds_read_b64_tr_b16 a[204:205], v60 offset:15360
  ds_read_b64_tr_b16 a[206:207], v60 offset:15488
  ds_read_b64_tr_b16 a[208:209], v60 offset:16384
  ds_read_b64_tr_b16 a[210:211], v60 offset:16512
  ds_read_b64_tr_b16 a[212:213], v60 offset:17408
  ds_read_b64_tr_b16 a[214:215], v60 offset:17536
  s_waitcnt lgkmcnt(0)
  s_barrier
  s_load_dwordx2 s[32:33], s[0:1], 80
  s_waitcnt lgkmcnt(0)
  s_mov_b32 s8, s32
  s_and_b32 s9, s33, 0xffff
  s_mov_b32 s10, 5308416
  s_mov_b32 s11, 0x20000
  s_mul_i32 s36, s16, 144
  s_lshl_b32 s23, s17, 2
  s_add_u32 s36, s36, s23
  s_mul_i32 s37, s36, 1152
  s_add_u32 s43, s37, 0
  s_add_u32 m0, s42, 0
  s_nop 0
  buffer_load_dwordx4 v9, s[8:11], s43 offen lds
  s_add_u32 s43, s37, 18432
  s_add_u32 m0, s42, 4096
  s_nop 0
  buffer_load_dwordx4 v9, s[8:11], s43 offen lds
  s_add_u32 s43, s37, 36864
  s_add_u32 m0, s42, 8192
  s_nop 0
  buffer_load_dwordx4 v9, s[8:11], s43 offen lds
  s_add_u32 s43, s37, 55296
  s_add_u32 m0, s42, 12288
  s_nop 0
  buffer_load_dwordx4 v9, s[8:11], s43 offen lds
  s_add_u32 s43, s37, 73728
  s_add_u32 m0, s42, 16384
  s_nop 0
  buffer_load_dwordx4 v9, s[8:11], s43 offen lds
  s_add_u32 s43, s37, 92160
  s_add_u32 m0, s42, 20480
  s_nop 0
  buffer_load_dwordx4 v9, s[8:11], s43 offen lds
  s_add_u32 s43, s37, 110592
  s_add_u32 m0, s42, 24576
  s_nop 0
  buffer_load_dwordx4 v9, s[8:11], s43 offen lds
  s_add_u32 s43, s37, 129024
  s_add_u32 m0, s42, 28672
  s_nop 0
  buffer_load_dwordx4 v9, s[8:11], s43 offen lds
  s_add_u32 s43, s37, 147456
  s_add_u32 m0, s42, 32768
  s_nop 0
  buffer_load_dwordx4 v9, s[8:11], s43 offen lds
  s_add_u32 s43, s37, 64
  s_add_u32 m0, s42, 49152
  s_nop 0
  buffer_load_dwordx4 v9, s[8:11], s43 offen lds
  s_add_u32 s43, s37, 18496
  s_add_u32 m0, s42, 53248
  s_nop 0
  buffer_load_dwordx4 v9, s[8:11], s43 offen lds
  s_add_u32 s43, s37, 36928
  s_add_u32 m0, s42, 57344
  s_nop 0
  buffer_load_dwordx4 v9, s[8:11], s43 offen lds
  s_add_u32 s43, s37, 55360
  s_add_u32 m0, s42, 61440
  s_nop 0
  buffer_load_dwordx4 v9, s[8:11], s43 offen lds
  s_add_u32 s43, s37, 73792
  s_add_u32 m0, s42, 65536
  s_nop 0
  buffer_load_dwordx4 v9, s[8:11], s43 offen lds
  s_add_u32 s43, s37, 92224
  s_add_u32 m0, s42, 69632
  s_nop 0
  buffer_load_dwordx4 v9, s[8:11], s43 offen lds
  s_add_u32 s43, s37, 110656
  s_add_u32 m0, s42, 73728
  s_nop 0
  buffer_load_dwordx4 v9, s[8:11], s43 offen lds
  s_add_u32 s43, s37, 129088
  s_add_u32 m0, s42, 77824
  s_nop 0
  buffer_load_dwordx4 v9, s[8:11], s43 offen lds
  s_add_u32 s43, s37, 147520
  s_add_u32 m0, s42, 81920
  s_nop 0
  buffer_load_dwordx4 v9, s[8:11], s43 offen lds
  s_waitcnt vmcnt(14) lgkmcnt(0)
  s_barrier
  v_add_u32 v60, 0, v10
  ds_read_b64_tr_b16 a[216:217], v60 offset:0
  ds_read_b64_tr_b16 a[218:219], v60 offset:4096
  v_add_u32 v61, 0, v11
  ds_read_b64_tr_b16 a[232:233], v61 offset:0
  ds_read_b64_tr_b16 a[234:235], v61 offset:4096
  ds_read_b64_tr_b16 a[220:221], v60 offset:8192
  ds_read_b64_tr_b16 a[222:223], v60 offset:12288
  ds_read_b64_tr_b16 a[236:237], v61 offset:8192
  ds_read_b64_tr_b16 a[238:239], v61 offset:12288
  s_waitcnt vmcnt(10) lgkmcnt(0)
  s_barrier
  s_add_u32 s43, s37, 128
  s_add_u32 m0, s42, 98304
  s_nop 0
  buffer_load_dwordx4 v9, s[8:11], s43 offen lds
  s_add_u32 s43, s37, 18560
  s_add_u32 m0, s42, 102400
  s_nop 0
  buffer_load_dwordx4 v9, s[8:11], s43 offen lds
  s_add_u32 s43, s37, 36992
  s_add_u32 m0, s42, 106496
  s_nop 0
  buffer_load_dwordx4 v9, s[8:11], s43 offen lds
  s_add_u32 s43, s37, 55424
  s_add_u32 m0, s42, 110592
  s_nop 0
  buffer_load_dwordx4 v9, s[8:11], s43 offen lds
  v_add_u32 v60, 16384, v10
  ds_read_b64_tr_b16 a[224:225], v60 offset:0
  ds_read_b64_tr_b16 a[226:227], v60 offset:4096
  v_add_u32 v61, 16384, v11
  ds_read_b64_tr_b16 a[240:241], v61 offset:0
  ds_read_b64_tr_b16 a[242:243], v61 offset:4096
  ds_read_b64_tr_b16 a[228:229], v60 offset:8192
  ds_read_b64_tr_b16 a[230:231], v60 offset:12288
  ds_read_b64_tr_b16 a[244:245], v61 offset:8192
  ds_read_b64_tr_b16 a[246:247], v61 offset:12288
  s_waitcnt vmcnt(13) lgkmcnt(0)
  s_barrier
  s_add_u32 s43, s37, 73856
  s_add_u32 m0, s42, 114688
  s_nop 0
  buffer_load_dwordx4 v9, s[8:11], s43 offen lds
  s_add_u32 s43, s37, 92288
  s_add_u32 m0, s42, 118784
  s_nop 0
  buffer_load_dwordx4 v9, s[8:11], s43 offen lds
  s_add_u32 s43, s37, 110720
  s_add_u32 m0, s42, 122880
  s_nop 0
  buffer_load_dwordx4 v9, s[8:11], s43 offen lds
  s_add_u32 s43, s37, 129152
  s_add_u32 m0, s42, 126976
  s_nop 0
  buffer_load_dwordx4 v9, s[8:11], s43 offen lds
  v_add_u32 v60, 32768, v10
  ds_read_b64_tr_b16 v[238:239], v60 offset:0
  v_add_u32 v61, 32768, v11
  ds_read_b64_tr_b16 v[240:241], v61 offset:0
  s_waitcnt vmcnt(13) lgkmcnt(0)
  s_barrier
  s_add_u32 s43, s37, 147584
  s_add_u32 m0, s42, 131072
  s_nop 0
  buffer_load_dwordx4 v9, s[8:11], s43 offen lds
  v_add_u32 v60, 49152, v10
  ds_read_b64_tr_b16 a[248:249], v60 offset:0
  ds_read_b64_tr_b16 a[250:251], v60 offset:4096
  v_add_u32 v61, 49152, v11
  ds_read_b64_tr_b16 v[142:143], v61 offset:0
  ds_read_b64_tr_b16 v[144:145], v61 offset:4096
  ds_read_b64_tr_b16 a[252:253], v60 offset:8192
  ds_read_b64_tr_b16 a[254:255], v60 offset:12288
  ds_read_b64_tr_b16 v[146:147], v61 offset:8192
  ds_read_b64_tr_b16 v[148:149], v61 offset:12288
  s_waitcnt vmcnt(10) lgkmcnt(0)
  s_barrier
  s_add_u32 s43, s37, 192
  s_add_u32 m0, s42, 0
  s_nop 0
  buffer_load_dwordx4 v9, s[8:11], s43 offen lds
  s_add_u32 s43, s37, 18624
  s_add_u32 m0, s42, 4096
  s_nop 0
  buffer_load_dwordx4 v9, s[8:11], s43 offen lds
  s_add_u32 s43, s37, 37056
  s_add_u32 m0, s42, 8192
  s_nop 0
  buffer_load_dwordx4 v9, s[8:11], s43 offen lds
  s_add_u32 s43, s37, 55488
  s_add_u32 m0, s42, 12288
  s_nop 0
  buffer_load_dwordx4 v9, s[8:11], s43 offen lds
  v_add_u32 v60, 65536, v10
  ds_read_b64_tr_b16 v[134:135], v60 offset:0
  ds_read_b64_tr_b16 v[136:137], v60 offset:4096
  v_add_u32 v61, 65536, v11
  ds_read_b64_tr_b16 v[150:151], v61 offset:0
  ds_read_b64_tr_b16 v[152:153], v61 offset:4096
  ds_read_b64_tr_b16 v[138:139], v60 offset:8192
  ds_read_b64_tr_b16 v[140:141], v60 offset:12288
  ds_read_b64_tr_b16 v[154:155], v61 offset:8192
  ds_read_b64_tr_b16 v[156:157], v61 offset:12288
  s_waitcnt vmcnt(13) lgkmcnt(0)
  s_barrier
  s_add_u32 s43, s37, 73920
  s_add_u32 m0, s42, 16384
  s_nop 0
  buffer_load_dwordx4 v9, s[8:11], s43 offen lds
  s_add_u32 s43, s37, 92352
  s_add_u32 m0, s42, 20480
  s_nop 0
  buffer_load_dwordx4 v9, s[8:11], s43 offen lds
  s_add_u32 s43, s37, 110784
  s_add_u32 m0, s42, 24576
  s_nop 0
  buffer_load_dwordx4 v9, s[8:11], s43 offen lds
  s_add_u32 s43, s37, 129216
  s_add_u32 m0, s42, 28672
  s_nop 0
  buffer_load_dwordx4 v9, s[8:11], s43 offen lds
  v_add_u32 v60, 81920, v10
  ds_read_b64_tr_b16 v[242:243], v60 offset:0
  v_add_u32 v61, 81920, v11
  ds_read_b64_tr_b16 v[244:245], v61 offset:0
  s_waitcnt vmcnt(13) lgkmcnt(0)
  s_barrier
  s_add_u32 s43, s37, 147648
  s_add_u32 m0, s42, 32768
  s_nop 0
  buffer_load_dwordx4 v9, s[8:11], s43 offen lds
  v_add_u32 v60, 98304, v10
  ds_read_b64_tr_b16 v[158:159], v60 offset:0
  ds_read_b64_tr_b16 v[160:161], v60 offset:4096
  v_add_u32 v61, 98304, v11
  ds_read_b64_tr_b16 v[174:175], v61 offset:0
  ds_read_b64_tr_b16 v[176:177], v61 offset:4096
  ds_read_b64_tr_b16 v[162:163], v60 offset:8192
  ds_read_b64_tr_b16 v[164:165], v60 offset:12288
  ds_read_b64_tr_b16 v[178:179], v61 offset:8192
  ds_read_b64_tr_b16 v[180:181], v61 offset:12288
  s_waitcnt vmcnt(10) lgkmcnt(0)
  s_barrier
  s_add_u32 s43, s37, 256
  s_add_u32 m0, s42, 49152
  s_nop 0
  buffer_load_dwordx4 v9, s[8:11], s43 offen lds
  s_add_u32 s43, s37, 18688
  s_add_u32 m0, s42, 53248
  s_nop 0
  buffer_load_dwordx4 v9, s[8:11], s43 offen lds
  s_add_u32 s43, s37, 37120
  s_add_u32 m0, s42, 57344
  s_nop 0
  buffer_load_dwordx4 v9, s[8:11], s43 offen lds
  s_add_u32 s43, s37, 55552
  s_add_u32 m0, s42, 61440
  s_nop 0
  buffer_load_dwordx4 v9, s[8:11], s43 offen lds
  v_add_u32 v60, 114688, v10
  ds_read_b64_tr_b16 v[166:167], v60 offset:0
  ds_read_b64_tr_b16 v[168:169], v60 offset:4096
  v_add_u32 v61, 114688, v11
  ds_read_b64_tr_b16 v[182:183], v61 offset:0
  ds_read_b64_tr_b16 v[184:185], v61 offset:4096
  ds_read_b64_tr_b16 v[170:171], v60 offset:8192
  ds_read_b64_tr_b16 v[172:173], v60 offset:12288
  ds_read_b64_tr_b16 v[186:187], v61 offset:8192
  ds_read_b64_tr_b16 v[188:189], v61 offset:12288
  s_waitcnt vmcnt(13) lgkmcnt(0)
  s_barrier
  s_add_u32 s43, s37, 73984
  s_add_u32 m0, s42, 65536
  s_nop 0
  buffer_load_dwordx4 v9, s[8:11], s43 offen lds
  s_add_u32 s43, s37, 92416
  s_add_u32 m0, s42, 69632
  s_nop 0
  buffer_load_dwordx4 v9, s[8:11], s43 offen lds
  s_add_u32 s43, s37, 110848
  s_add_u32 m0, s42, 73728
  s_nop 0
  buffer_load_dwordx4 v9, s[8:11], s43 offen lds
  s_add_u32 s43, s37, 129280
  s_add_u32 m0, s42, 77824
  s_nop 0
  buffer_load_dwordx4 v9, s[8:11], s43 offen lds
  v_add_u32 v60, 131072, v10
  ds_read_b64_tr_b16 v[246:247], v60 offset:0
  v_add_u32 v61, 131072, v11
  ds_read_b64_tr_b16 v[248:249], v61 offset:0
  s_waitcnt vmcnt(13) lgkmcnt(0)
  s_barrier
  s_add_u32 s43, s37, 147712
  s_add_u32 m0, s42, 81920
  s_nop 0
  buffer_load_dwordx4 v9, s[8:11], s43 offen lds
  v_add_u32 v60, 0, v10
  ds_read_b64_tr_b16 v[190:191], v60 offset:0
  ds_read_b64_tr_b16 v[192:193], v60 offset:4096
  v_add_u32 v61, 0, v11
  ds_read_b64_tr_b16 v[206:207], v61 offset:0
  ds_read_b64_tr_b16 v[208:209], v61 offset:4096
  ds_read_b64_tr_b16 v[194:195], v60 offset:8192
  ds_read_b64_tr_b16 v[196:197], v60 offset:12288
  ds_read_b64_tr_b16 v[210:211], v61 offset:8192
  ds_read_b64_tr_b16 v[212:213], v61 offset:12288
  s_waitcnt vmcnt(10) lgkmcnt(0)
  s_barrier
  v_add_u32 v60, 16384, v10
  ds_read_b64_tr_b16 v[198:199], v60 offset:0
  ds_read_b64_tr_b16 v[200:201], v60 offset:4096
  v_add_u32 v61, 16384, v11
  ds_read_b64_tr_b16 v[214:215], v61 offset:0
  ds_read_b64_tr_b16 v[216:217], v61 offset:4096
  ds_read_b64_tr_b16 v[202:203], v60 offset:8192
  ds_read_b64_tr_b16 v[204:205], v60 offset:12288
  ds_read_b64_tr_b16 v[218:219], v61 offset:8192
  ds_read_b64_tr_b16 v[220:221], v61 offset:12288
  s_waitcnt vmcnt(9) lgkmcnt(0)
  s_barrier
  v_add_u32 v60, 32768, v10
  ds_read_b64_tr_b16 v[250:251], v60 offset:0
  v_add_u32 v61, 32768, v11
  ds_read_b64_tr_b16 v[252:253], v61 offset:0
  s_waitcnt vmcnt(5) lgkmcnt(0)
  s_barrier
  v_add_u32 v60, 49152, v10
  ds_read_b64_tr_b16 v[222:223], v60 offset:0
  ds_read_b64_tr_b16 v[224:225], v60 offset:4096
  ds_read_b64_tr_b16 v[226:227], v60 offset:8192
  ds_read_b64_tr_b16 v[228:229], v60 offset:12288
  s_waitcnt vmcnt(1) lgkmcnt(0)
  s_barrier
  v_add_u32 v60, 65536, v10
  ds_read_b64_tr_b16 v[230:231], v60 offset:0
  ds_read_b64_tr_b16 v[232:233], v60 offset:4096
  ds_read_b64_tr_b16 v[234:235], v60 offset:8192
  ds_read_b64_tr_b16 v[236:237], v60 offset:12288
  s_waitcnt vmcnt(0) lgkmcnt(0)
  s_barrier
  v_add_u32 v60, 81920, v10
  ds_read_b64_tr_b16 v[254:255], v60 offset:0
  s_waitcnt lgkmcnt(0)
  s_barrier
  s_load_dwordx2 s[32:33], s[0:1], 72
  s_load_dwordx2 s[34:35], s[0:1], 88
  s_waitcnt lgkmcnt(0)
  s_mul_i32 s23, s16, 288
  s_lshl_b32 s24, s17, 6
  s_add_u32 s24, s24, s23
  v_add_u32 v60, s24, v18
  global_load_dwordx2 v[44:45], v60, s[32:33]
  global_load_dwordx2 v[46:47], v60, s[32:33] offset:32
  s_add_u32 s23, s23, 256
  v_add_u32 v60, s23, v18
  global_load_dwordx2 v[48:49], v60, s[32:33]
  s_mov_b32 s23, 0xffff0000
  s_waitcnt vmcnt(2)
  v_lshlrev_b32 v30, 16, v44
  v_and_b32 v31, s23, v44
  v_lshlrev_b32 v32, 16, v45
  v_and_b32 v33, s23, v45
  s_waitcnt vmcnt(1)
  v_lshlrev_b32 v34, 16, v46
  v_and_b32 v35, s23, v46
  v_lshlrev_b32 v36, 16, v47
  v_and_b32 v37, s23, v47
  s_waitcnt vmcnt(0)
  v_lshlrev_b32 v38, 16, v48
  v_and_b32 v39, s23, v48
  v_lshlrev_b32 v40, 16, v49
  v_and_b32 v41, s23, v49
  s_cmp_eq_u32 s17, 0
  s_cbranch_scc0 wds_158
  s_add_u32 s23, s18, 16
  s_lshl_b32 s23, s23, 2
  v_mov_b32 v60, s23
  s_mov_b32 s25, 32
  s_mov_b32 s23, 0
wdw_156:
  global_load_dword v61, v60, s[14:15] sc1
  s_add_u32 s23, s23, 1
  s_waitcnt vmcnt(0)
  v_readfirstlane_b32 s24, v61
  s_nop 3
  s_cmp_ge_u32 s24, s25
  s_cbranch_scc1 wdd_157
  s_sleep 2
  s_cmp_lg_u32 s44, 0
  s_cbranch_scc1 wdd_157
  s_cmp_lt_u32 s23, 0x40000
  s_cbranch_scc1 wdw_156
  s_mov_b32 s44, 1
wdd_157:
wds_158:
  s_barrier
  s_lshl_b32 s23, s53, 2
  v_mov_b32 v60, s23
  global_load_dword v61, v60, s[14:15] sc1
  s_waitcnt vmcnt(0)
  v_readfirstlane_b32 s23, v61
  s_nop 3
  s_cmp_lt_u32 s23, 32
  s_cselect_b32 s22, 1, 0
  s_load_dwordx2 s[32:33], s[0:1], 0
  s_waitcnt lgkmcnt(0)
  s_mov_b32 s8, s32
  s_and_b32 s9, s33, 0xffff
  s_mov_b32 s10, 2359296
  s_mov_b32 s11, 0x20000
  s_mov_b32 s46, -1
  s_mov_b32 s47, 0
  s_mov_b32 s19, 0
  s_mov_b32 s20, s18
  s_mov_b32 s37, 22528
  s_mul_i32 s23, s20, 36864
  s_mul_i32 s24, s17, 9216
  s_add_u32 s23, s23, s24
  s_add_u32 s23, s23, 57671680
  s_add_u32 s24, s24, s37
  s_add_u32 m0, s24, 0
  s_nop 0
  buffer_load_dwordx4 v3, s[4:7], s23 offen offset:0 sc1 lds
  s_add_u32 m0, s24, 0
  s_nop 0
  buffer_load_dwordx4 v3, s[4:7], s23 offen offset:1024 sc1 lds
  s_add_u32 m0, s24, 0
  s_nop 0
  buffer_load_dwordx4 v3, s[4:7], s23 offen offset:2048 sc1 lds
  s_add_u32 m0, s24, 0
  s_nop 0
  buffer_load_dwordx4 v3, s[4:7], s23 offen offset:3072 sc1 lds
  s_add_u32 m0, s24, 4096
  s_add_u32 s23, s23, 4096
  buffer_load_dwordx4 v3, s[4:7], s23 offen offset:0 sc1 lds
  s_add_u32 m0, s24, 4096
  s_nop 0
  buffer_load_dwordx4 v3, s[4:7], s23 offen offset:1024 sc1 lds
  s_add_u32 m0, s24, 4096
  s_nop 0
  buffer_load_dwordx4 v3, s[4:7], s23 offen offset:2048 sc1 lds
  s_add_u32 m0, s24, 4096
  s_nop 0
  buffer_load_dwordx4 v3, s[4:7], s23 offen offset:3072 sc1 lds
  s_add_u32 m0, s24, 8192
  s_add_u32 s23, s23, 4096
  buffer_load_dwordx4 v3, s[4:7], s23 offen offset:0 sc1 lds
pc_loop_159:
  v_add_u32 v42, s37, v19
  v_add_u32 v43, s37, v20
  s_waitcnt vmcnt(0)
  s_barrier
  s_add_u32 s39, s19, 1
  s_cmp_lt_u32 s39, s21
  s_cbranch_scc0 pc_nn_160
  s_add_u32 s39, s20, 7
  s_xor_b32 s25, s37, 45056
  s_mul_i32 s23, s39, 36864
  s_mul_i32 s24, s17, 9216
  s_add_u32 s23, s23, s24
  s_add_u32 s23, s23, 57671680
  s_add_u32 s24, s24, s25
  s_add_u32 m0, s24, 0
  s_nop 0
  buffer_load_dwordx4 v3, s[4:7], s23 offen offset:0 sc1 lds
  s_add_u32 m0, s24, 0
  s_nop 0
  buffer_load_dwordx4 v3, s[4:7], s23 offen offset:1024 sc1 lds
  s_add_u32 m0, s24, 0
  s_nop 0
  buffer_load_dwordx4 v3, s[4:7], s23 offen offset:2048 sc1 lds
  s_add_u32 m0, s24, 0
  s_nop 0
  buffer_load_dwordx4 v3, s[4:7], s23 offen offset:3072 sc1 lds
  s_add_u32 m0, s24, 4096
  s_add_u32 s23, s23, 4096
  buffer_load_dwordx4 v3, s[4:7], s23 offen offset:0 sc1 lds
  s_add_u32 m0, s24, 4096
  s_nop 0
  buffer_load_dwordx4 v3, s[4:7], s23 offen offset:1024 sc1 lds
  s_add_u32 m0, s24, 4096
  s_nop 0
  buffer_load_dwordx4 v3, s[4:7], s23 offen offset:2048 sc1 lds
  s_add_u32 m0, s24, 4096
  s_nop 0
  buffer_load_dwordx4 v3, s[4:7], s23 offen offset:3072 sc1 lds
  s_add_u32 m0, s24, 8192
  s_add_u32 s23, s23, 4096
  buffer_load_dwordx4 v3, s[4:7], s23 offen offset:0 sc1 lds
pc_nn_160:
  ds_read_b128 v[64:67], v42 offset:0
  ds_read_b128 v[68:71], v42 offset:256
  ds_read_b128 v[72:75], v43 offset:0
  ds_read_b128 v[76:79], v42 offset:2048
  ds_read_b128 v[80:83], v42 offset:2304
  ds_read_b128 v[84:87], v43 offset:2048
  ds_read_b128 v[88:91], v42 offset:4096
  ds_read_b128 v[92:95], v42 offset:4352
  ds_read_b128 v[96:99], v43 offset:4096
  s_waitcnt lgkmcnt(8)
  v_mfma_f32_16x16x32_bf16 v[44:47], a[0:3], v[64:67], 0
  s_waitcnt lgkmcnt(7)
  v_mfma_f32_16x16x32_bf16 v[48:51], a[0:3], v[68:71], 0
  v_mfma_f32_16x16x32_bf16 v[52:55], a[72:75], v[64:67], 0
  v_mfma_f32_16x16x32_bf16 v[56:59], a[72:75], v[68:71], 0
  s_waitcnt lgkmcnt(6)
  v_mfma_f32_16x16x32_bf16 v[60:63], a[144:147], v[72:75], 0
  ds_read_b128 v[64:67], v42 offset:6144
  ds_read_b128 v[68:71], v42 offset:6400
  ds_read_b128 v[72:75], v43 offset:6144
  s_waitcnt lgkmcnt(8)
  v_mfma_f32_16x16x32_bf16 v[44:47], a[4:7], v[76:79], v[44:47]
  s_waitcnt lgkmcnt(7)
  v_mfma_f32_16x16x32_bf16 v[48:51], a[4:7], v[80:83], v[48:51]
  v_mfma_f32_16x16x32_bf16 v[52:55], a[76:79], v[76:79], v[52:55]
  v_mfma_f32_16x16x32_bf16 v[56:59], a[76:79], v[80:83], v[56:59]
  s_waitcnt lgkmcnt(6)
  v_mfma_f32_16x16x32_bf16 v[60:63], a[148:151], v[84:87], v[60:63]
  ds_read_b128 v[76:79], v42 offset:8192
  ds_read_b128 v[80:83], v42 offset:8448
  ds_read_b128 v[84:87], v43 offset:8192
  s_waitcnt lgkmcnt(8)
  v_mfma_f32_16x16x32_bf16 v[44:47], a[8:11], v[88:91], v[44:47]
  s_waitcnt lgkmcnt(7)
  v_mfma_f32_16x16x32_bf16 v[48:51], a[8:11], v[92:95], v[48:51]
  v_mfma_f32_16x16x32_bf16 v[52:55], a[80:83], v[88:91], v[52:55]
  v_mfma_f32_16x16x32_bf16 v[56:59], a[80:83], v[92:95], v[56:59]
  s_waitcnt lgkmcnt(6)
  v_mfma_f32_16x16x32_bf16 v[60:63], a[152:155], v[96:99], v[60:63]
  ds_read_b128 v[88:91], v42 offset:10240
  ds_read_b128 v[92:95], v42 offset:10496
  ds_read_b128 v[96:99], v43 offset:10240
  s_waitcnt lgkmcnt(8)
  v_mfma_f32_16x16x32_bf16 v[44:47], a[12:15], v[64:67], v[44:47]
  s_waitcnt lgkmcnt(7)
  v_mfma_f32_16x16x32_bf16 v[48:51], a[12:15], v[68:71], v[48:51]
  v_mfma_f32_16x16x32_bf16 v[52:55], a[84:87], v[64:67], v[52:55]
  v_mfma_f32_16x16x32_bf16 v[56:59], a[84:87], v[68:71], v[56:59]
  s_waitcnt lgkmcnt(6)
  v_mfma_f32_16x16x32_bf16 v[60:63], a[156:159], v[72:75], v[60:63]
  ds_read_b128 v[64:67], v42 offset:12288
  ds_read_b128 v[68:71], v42 offset:12544
  ds_read_b128 v[72:75], v43 offset:12288
  s_waitcnt lgkmcnt(8)
  v_mfma_f32_16x16x32_bf16 v[44:47], a[16:19], v[76:79], v[44:47]
  s_waitcnt lgkmcnt(7)
  v_mfma_f32_16x16x32_bf16 v[48:51], a[16:19], v[80:83], v[48:51]
  v_mfma_f32_16x16x32_bf16 v[52:55], a[88:91], v[76:79], v[52:55]
  v_mfma_f32_16x16x32_bf16 v[56:59], a[88:91], v[80:83], v[56:59]
  s_waitcnt lgkmcnt(6)
  v_mfma_f32_16x16x32_bf16 v[60:63], a[160:163], v[84:87], v[60:63]
  ds_read_b128 v[76:79], v42 offset:14336
  ds_read_b128 v[80:83], v42 offset:14592
  ds_read_b128 v[84:87], v43 offset:14336
  s_waitcnt lgkmcnt(8)
  v_mfma_f32_16x16x32_bf16 v[44:47], a[20:23], v[88:91], v[44:47]
  s_waitcnt lgkmcnt(7)
  v_mfma_f32_16x16x32_bf16 v[48:51], a[20:23], v[92:95], v[48:51]
  v_mfma_f32_16x16x32_bf16 v[52:55], a[92:95], v[88:91], v[52:55]
  v_mfma_f32_16x16x32_bf16 v[56:59], a[92:95], v[92:95], v[56:59]
  s_waitcnt lgkmcnt(6)
  v_mfma_f32_16x16x32_bf16 v[60:63], a[164:167], v[96:99], v[60:63]
  ds_read_b128 v[88:91], v42 offset:16384
  ds_read_b128 v[92:95], v42 offset:16640
  ds_read_b128 v[96:99], v43 offset:16384
  s_waitcnt lgkmcnt(8)
  v_mfma_f32_16x16x32_bf16 v[44:47], a[24:27], v[64:67], v[44:47]
  s_waitcnt lgkmcnt(7)
  v_mfma_f32_16x16x32_bf16 v[48:51], a[24:27], v[68:71], v[48:51]
  v_mfma_f32_16x16x32_bf16 v[52:55], a[96:99], v[64:67], v[52:55]
  v_mfma_f32_16x16x32_bf16 v[56:59], a[96:99], v[68:71], v[56:59]
  s_waitcnt lgkmcnt(6)
  v_mfma_f32_16x16x32_bf16 v[60:63], a[168:171], v[72:75], v[60:63]
  ds_read_b128 v[64:67], v42 offset:18432
  ds_read_b128 v[68:71], v42 offset:18688
  ds_read_b128 v[72:75], v43 offset:18432
  s_waitcnt lgkmcnt(8)
  v_mfma_f32_16x16x32_bf16 v[44:47], a[28:31], v[76:79], v[44:47]
  s_waitcnt lgkmcnt(7)
  v_mfma_f32_16x16x32_bf16 v[48:51], a[28:31], v[80:83], v[48:51]
  v_mfma_f32_16x16x32_bf16 v[52:55], a[100:103], v[76:79], v[52:55]
  v_mfma_f32_16x16x32_bf16 v[56:59], a[100:103], v[80:83], v[56:59]
  s_waitcnt lgkmcnt(6)
  v_mfma_f32_16x16x32_bf16 v[60:63], a[172:175], v[84:87], v[60:63]
  ds_read_b128 v[76:79], v42 offset:20480
  ds_read_b128 v[80:83], v42 offset:20736
  ds_read_b128 v[84:87], v43 offset:20480
  s_waitcnt lgkmcnt(8)
  v_mfma_f32_16x16x32_bf16 v[44:47], a[32:35], v[88:91], v[44:47]
  s_waitcnt lgkmcnt(7)
  v_mfma_f32_16x16x32_bf16 v[48:51], a[32:35], v[92:95], v[48:51]
  v_mfma_f32_16x16x32_bf16 v[52:55], a[104:107], v[88:91], v[52:55]
  v_mfma_f32_16x16x32_bf16 v[56:59], a[104:107], v[92:95], v[56:59]
  s_waitcnt lgkmcnt(6)
  v_mfma_f32_16x16x32_bf16 v[60:63], a[176:179], v[96:99], v[60:63]
  ds_read_b128 v[88:91], v42 offset:22528
  ds_read_b128 v[92:95], v42 offset:22784
  ds_read_b128 v[96:99], v43 offset:22528
  s_waitcnt lgkmcnt(8)
  v_mfma_f32_16x16x32_bf16 v[44:47], a[36:39], v[64:67], v[44:47]
  s_waitcnt lgkmcnt(7)
  v_mfma_f32_16x16x32_bf16 v[48:51], a[36:39], v[68:71], v[48:51]
  v_mfma_f32_16x16x32_bf16 v[52:55], a[108:111], v[64:67], v[52:55]
  v_mfma_f32_16x16x32_bf16 v[56:59], a[108:111], v[68:71], v[56:59]
  s_waitcnt lgkmcnt(6)
  v_mfma_f32_16x16x32_bf16 v[60:63], a[180:183], v[72:75], v[60:63]
  ds_read_b128 v[64:67], v42 offset:24576
  ds_read_b128 v[68:71], v42 offset:24832
  ds_read_b128 v[72:75], v43 offset:24576
  s_waitcnt lgkmcnt(8)
  v_mfma_f32_16x16x32_bf16 v[44:47], a[40:43], v[76:79], v[44:47]
  s_waitcnt lgkmcnt(7)
  v_mfma_f32_16x16x32_bf16 v[48:51], a[40:43], v[80:83], v[48:51]
  v_mfma_f32_16x16x32_bf16 v[52:55], a[112:115], v[76:79], v[52:55]
  v_mfma_f32_16x16x32_bf16 v[56:59], a[112:115], v[80:83], v[56:59]
  s_waitcnt lgkmcnt(6)
  v_mfma_f32_16x16x32_bf16 v[60:63], a[184:187], v[84:87], v[60:63]
  ds_read_b128 v[76:79], v42 offset:26624
  ds_read_b128 v[80:83], v42 offset:26880
  ds_read_b128 v[84:87], v43 offset:26624
  s_waitcnt lgkmcnt(8)
  v_mfma_f32_16x16x32_bf16 v[44:47], a[44:47], v[88:91], v[44:47]
  s_waitcnt lgkmcnt(7)
  v_mfma_f32_16x16x32_bf16 v[48:51], a[44:47], v[92:95], v[48:51]
  v_mfma_f32_16x16x32_bf16 v[52:55], a[116:119], v[88:91], v[52:55]
  v_mfma_f32_16x16x32_bf16 v[56:59], a[116:119], v[92:95], v[56:59]
  s_waitcnt lgkmcnt(6)
  v_mfma_f32_16x16x32_bf16 v[60:63], a[188:191], v[96:99], v[60:63]
  ds_read_b128 v[88:91], v42 offset:28672
  ds_read_b128 v[92:95], v42 offset:28928
  ds_read_b128 v[96:99], v43 offset:28672
  s_waitcnt lgkmcnt(8)
  v_mfma_f32_16x16x32_bf16 v[44:47], a[48:51], v[64:67], v[44:47]
  s_waitcnt lgkmcnt(7)
  v_mfma_f32_16x16x32_bf16 v[48:51], a[48:51], v[68:71], v[48:51]
  v_mfma_f32_16x16x32_bf16 v[52:55], a[120:123], v[64:67], v[52:55]
  v_mfma_f32_16x16x32_bf16 v[56:59], a[120:123], v[68:71], v[56:59]
  s_waitcnt lgkmcnt(6)
  v_mfma_f32_16x16x32_bf16 v[60:63], a[192:195], v[72:75], v[60:63]
  ds_read_b128 v[64:67], v42 offset:30720
  ds_read_b128 v[68:71], v42 offset:30976
  ds_read_b128 v[72:75], v43 offset:30720
  s_waitcnt lgkmcnt(8)
  v_mfma_f32_16x16x32_bf16 v[44:47], a[52:55], v[76:79], v[44:47]
  s_waitcnt lgkmcnt(7)
  v_mfma_f32_16x16x32_bf16 v[48:51], a[52:55], v[80:83], v[48:51]
  v_mfma_f32_16x16x32_bf16 v[52:55], a[124:127], v[76:79], v[52:55]
  v_mfma_f32_16x16x32_bf16 v[56:59], a[124:127], v[80:83], v[56:59]
  s_waitcnt lgkmcnt(6)
  v_mfma_f32_16x16x32_bf16 v[60:63], a[196:199], v[84:87], v[60:63]
  ds_read_b128 v[76:79], v42 offset:32768
  ds_read_b128 v[80:83], v42 offset:33024
  ds_read_b128 v[84:87], v43 offset:32768
  s_waitcnt lgkmcnt(8)
  v_mfma_f32_16x16x32_bf16 v[44:47], a[56:59], v[88:91], v[44:47]
  s_waitcnt lgkmcnt(7)
  v_mfma_f32_16x16x32_bf16 v[48:51], a[56:59], v[92:95], v[48:51]
  v_mfma_f32_16x16x32_bf16 v[52:55], a[128:131], v[88:91], v[52:55]
  v_mfma_f32_16x16x32_bf16 v[56:59], a[128:131], v[92:95], v[56:59]
  s_waitcnt lgkmcnt(6)
  v_mfma_f32_16x16x32_bf16 v[60:63], a[200:203], v[96:99], v[60:63]
  ds_read_b128 v[88:91], v42 offset:34816
  ds_read_b128 v[92:95], v42 offset:35072
  ds_read_b128 v[96:99], v43 offset:34816
  s_waitcnt lgkmcnt(8)
  v_mfma_f32_16x16x32_bf16 v[44:47], a[60:63], v[64:67], v[44:47]
  s_waitcnt lgkmcnt(7)
  v_mfma_f32_16x16x32_bf16 v[48:51], a[60:63], v[68:71], v[48:51]
  v_mfma_f32_16x16x32_bf16 v[52:55], a[132:135], v[64:67], v[52:55]
  v_mfma_f32_16x16x32_bf16 v[56:59], a[132:135], v[68:71], v[56:59]
  s_waitcnt lgkmcnt(6)
  v_mfma_f32_16x16x32_bf16 v[60:63], a[204:207], v[72:75], v[60:63]
  s_waitcnt lgkmcnt(5)
  v_mfma_f32_16x16x32_bf16 v[44:47], a[64:67], v[76:79], v[44:47]
  s_waitcnt lgkmcnt(4)
  v_mfma_f32_16x16x32_bf16 v[48:51], a[64:67], v[80:83], v[48:51]
  v_mfma_f32_16x16x32_bf16 v[52:55], a[136:139], v[76:79], v[52:55]
  v_mfma_f32_16x16x32_bf16 v[56:59], a[136:139], v[80:83], v[56:59]
  s_waitcnt lgkmcnt(3)
  v_mfma_f32_16x16x32_bf16 v[60:63], a[208:211], v[84:87], v[60:63]
  s_waitcnt lgkmcnt(2)
  v_mfma_f32_16x16x32_bf16 v[44:47], a[68:71], v[88:91], v[44:47]
  s_waitcnt lgkmcnt(1)
  v_mfma_f32_16x16x32_bf16 v[48:51], a[68:71], v[92:95], v[48:51]
  v_mfma_f32_16x16x32_bf16 v[52:55], a[140:143], v[88:91], v[52:55]
  v_mfma_f32_16x16x32_bf16 v[56:59], a[140:143], v[92:95], v[56:59]
  s_waitcnt lgkmcnt(0)
  v_mfma_f32_16x16x32_bf16 v[60:63], a[212:215], v[96:99], v[60:63]
  s_mov_b32 s23, 0xc0135761
  s_mov_b32 s24, 0xbdd2d3e8
  v_mov_b32 v100, s23
  v_add_f32 v44, v44, v30
  v_mul_f32 v64, v44, v44
  v_fma_f32 v64, v64, s24, v100
  v_mul_f32 v64, v64, v44
  v_add_f32 v45, v45, v31
  v_mul_f32 v65, v45, v45
  v_fma_f32 v65, v65, s24, v100
  v_mul_f32 v65, v65, v45
  v_add_f32 v46, v46, v32
  v_mul_f32 v66, v46, v46
  v_fma_f32 v66, v66, s24, v100
  v_mul_f32 v66, v66, v46
  v_add_f32 v47, v47, v33
  v_mul_f32 v67, v47, v47
  v_fma_f32 v67, v67, s24, v100
  v_mul_f32 v67, v67, v47
  v_exp_f32 v64, v64
  v_exp_f32 v65, v65
  v_exp_f32 v66, v66
  v_exp_f32 v67, v67
  v_add_f32 v64, 1.0, v64
  v_add_f32 v65, 1.0, v65
  v_add_f32 v66, 1.0, v66
  v_add_f32 v67, 1.0, v67
  v_rcp_f32 v64, v64
  v_rcp_f32 v65, v65
  v_rcp_f32 v66, v66
  v_rcp_f32 v67, v67
  v_mul_f32 v44, v44, v64
  v_mul_f32 v45, v45, v65
  v_mul_f32 v46, v46, v66
  v_mul_f32 v47, v47, v67
  v_add_f32 v48, v48, v30
  v_mul_f32 v68, v48, v48
  v_fma_f32 v68, v68, s24, v100
  v_mul_f32 v68, v68, v48
  v_add_f32 v49, v49, v31
  v_mul_f32 v69, v49, v49
  v_fma_f32 v69, v69, s24, v100
  v_mul_f32 v69, v69, v49
  v_add_f32 v50, v50, v32
  v_mul_f32 v70, v50, v50
  v_fma_f32 v70, v70, s24, v100
  v_mul_f32 v70, v70, v50
  v_add_f32 v51, v51, v33
  v_mul_f32 v71, v51, v51
  v_fma_f32 v71, v71, s24, v100
  v_mul_f32 v71, v71, v51
  v_exp_f32 v68, v68
  v_exp_f32 v69, v69
  v_exp_f32 v70, v70
  v_exp_f32 v71, v71
  v_add_f32 v68, 1.0, v68
  v_add_f32 v69, 1.0, v69
  v_add_f32 v70, 1.0, v70
  v_add_f32 v71, 1.0, v71
  v_rcp_f32 v68, v68
  v_rcp_f32 v69, v69
  v_rcp_f32 v70, v70
  v_rcp_f32 v71, v71
  v_mul_f32 v48, v48, v68
  v_mul_f32 v49, v49, v69
  v_mul_f32 v50, v50, v70
  v_mul_f32 v51, v51, v71
  v_add_f32 v52, v52, v34
  v_mul_f32 v72, v52, v52
  v_fma_f32 v72, v72, s24, v100
  v_mul_f32 v72, v72, v52
  v_add_f32 v53, v53, v35
  v_mul_f32 v73, v53, v53
  v_fma_f32 v73, v73, s24, v100
  v_mul_f32 v73, v73, v53
  v_add_f32 v54, v54, v36
  v_mul_f32 v74, v54, v54
  v_fma_f32 v74, v74, s24, v100
  v_mul_f32 v74, v74, v54
  v_add_f32 v55, v55, v37
  v_mul_f32 v75, v55, v55
  v_fma_f32 v75, v75, s24, v100
  v_mul_f32 v75, v75, v55
  v_exp_f32 v72, v72
  v_exp_f32 v73, v73
  v_exp_f32 v74, v74
  v_exp_f32 v75, v75
  v_add_f32 v72, 1.0, v72
  v_add_f32 v73, 1.0, v73
  v_add_f32 v74, 1.0, v74
  v_add_f32 v75, 1.0, v75
  v_rcp_f32 v72, v72
  v_rcp_f32 v73, v73
  v_rcp_f32 v74, v74
  v_rcp_f32 v75, v75
  v_mul_f32 v52, v52, v72
  v_mul_f32 v53, v53, v73
  v_mul_f32 v54, v54, v74
  v_mul_f32 v55, v55, v75
  v_add_f32 v56, v56, v34
  v_mul_f32 v76, v56, v56
  v_fma_f32 v76, v76, s24, v100
  v_mul_f32 v76, v76, v56
  v_add_f32 v57, v57, v35
  v_mul_f32 v77, v57, v57
  v_fma_f32 v77, v77, s24, v100
  v_mul_f32 v77, v77, v57
  v_add_f32 v58, v58, v36
  v_mul_f32 v78, v58, v58
  v_fma_f32 v78, v78, s24, v100
  v_mul_f32 v78, v78, v58
  v_add_f32 v59, v59, v37
  v_mul_f32 v79, v59, v59
  v_fma_f32 v79, v79, s24, v100
  v_mul_f32 v79, v79, v59
  v_exp_f32 v76, v76
  v_exp_f32 v77, v77
  v_exp_f32 v78, v78
  v_exp_f32 v79, v79
  v_add_f32 v76, 1.0, v76
  v_add_f32 v77, 1.0, v77
  v_add_f32 v78, 1.0, v78
  v_add_f32 v79, 1.0, v79
  v_rcp_f32 v76, v76
  v_rcp_f32 v77, v77
  v_rcp_f32 v78, v78
  v_rcp_f32 v79, v79
  v_mul_f32 v56, v56, v76
  v_mul_f32 v57, v57, v77
  v_mul_f32 v58, v58, v78
  v_mul_f32 v59, v59, v79
  v_add_f32 v60, v60, v38
  v_mul_f32 v80, v60, v60
  v_fma_f32 v80, v80, s24, v100
  v_mul_f32 v80, v80, v60
  v_add_f32 v61, v61, v39
  v_mul_f32 v81, v61, v61
  v_fma_f32 v81, v81, s24, v100
  v_mul_f32 v81, v81, v61
  v_add_f32 v62, v62, v40
  v_mul_f32 v82, v62, v62
  v_fma_f32 v82, v82, s24, v100
  v_mul_f32 v82, v82, v62
  v_add_f32 v63, v63, v41
  v_mul_f32 v83, v63, v63
  v_fma_f32 v83, v83, s24, v100
  v_mul_f32 v83, v83, v63
  v_exp_f32 v80, v80
  v_exp_f32 v81, v81
  v_exp_f32 v82, v82
  v_exp_f32 v83, v83
  v_add_f32 v80, 1.0, v80
  v_add_f32 v81, 1.0, v81
  v_add_f32 v82, 1.0, v82
  v_add_f32 v83, 1.0, v83
  v_rcp_f32 v80, v80
  v_rcp_f32 v81, v81
  v_rcp_f32 v82, v82
  v_rcp_f32 v83, v83
  v_mul_f32 v60, v60, v80
  v_mul_f32 v61, v61, v81
  v_mul_f32 v62, v62, v82
  v_mul_f32 v63, v63, v83
  v_cvt_pk_bf16_f32 v88, v44, v45
  v_cvt_pk_bf16_f32 v89, v46, v47
  v_cvt_pk_bf16_f32 v90, v52, v53
  v_cvt_pk_bf16_f32 v91, v54, v55
  ds_write_b128 v12, v[88:91] offset:0
  v_cvt_pk_bf16_f32 v92, v48, v49
  v_cvt_pk_bf16_f32 v93, v50, v51
  v_cvt_pk_bf16_f32 v94, v56, v57
  v_cvt_pk_bf16_f32 v95, v58, v59
  ds_write_b128 v12, v[92:95] offset:4096
  v_cvt_pk_bf16_f32 v96, v60, v61
  v_cvt_pk_bf16_f32 v97, v62, v63
  ds_write_b64 v13, v[96:97]
  s_waitcnt lgkmcnt(0)
  s_barrier
  s_mul_i32 s36, s18, 2359296
  s_and_b32 s23, s19, 1
  s_mul_i32 s23, s23, 1179648
  s_add_u32 s36, s36, s23
  s_add_u32 s36, s36, 67108864
  s_mul_i32 s38, s16, 36864
  s_mul_i32 s23, s17, 9216
  s_add_u32 s38, s38, s23
  s_add_u32 s38, s38, s36
  ds_read_b128 v[84:87], v3 offset:8192
  ds_read_b128 v[88:91], v3 offset:9216
  ds_read_b128 v[92:95], v3 offset:10240
  ds_read_b128 v[96:99], v3 offset:11264
  ds_read_b64 v[100:101], v23 offset:16384
  ds_read_b128 v[114:117], v3 offset:12288
  ds_read_b128 v[118:121], v3 offset:13312
  ds_read_b128 v[122:125], v3 offset:14336
  ds_read_b128 v[126:129], v3 offset:15360
  ds_read_b64 v[130:131], v23 offset:16896
  s_add_u32 s58, s38, 4608
  s_add_u32 s59, s38, 4096
  s_add_u32 s60, s58, 4096
  s_cmp_eq_u32 s22, 0
  s_cbranch_scc0 g2s_161
  s_waitcnt lgkmcnt(9)
  v_mfma_f32_16x16x32_bf16 v[44:47], a[216:219], v[84:87], 0
  v_mfma_f32_16x16x32_bf16 v[48:51], a[232:235], v[84:87], 0
  s_waitcnt lgkmcnt(8)
  v_mfma_f32_16x16x32_bf16 v[44:47], a[220:223], v[88:91], v[44:47]
  v_mfma_f32_16x16x32_bf16 v[48:51], a[236:239], v[88:91], v[48:51]
  s_waitcnt lgkmcnt(7)
  v_mfma_f32_16x16x32_bf16 v[44:47], a[224:227], v[92:95], v[44:47]
  v_mfma_f32_16x16x32_bf16 v[48:51], a[240:243], v[92:95], v[48:51]
  s_waitcnt lgkmcnt(6)
  v_mfma_f32_16x16x32_bf16 v[44:47], a[228:231], v[96:99], v[44:47]
  v_mfma_f32_16x16x32_bf16 v[48:51], a[244:247], v[96:99], v[48:51]
  v_mfma_f32_16x16x32_bf16 v[52:55], a[248:251], v[84:87], 0
  v_mfma_f32_16x16x32_bf16 v[56:59], v[142:145], v[84:87], 0
  s_waitcnt lgkmcnt(5)
  v_mfma_f32_16x16x16_bf16 v[44:47], v[238:239], v[100:101], v[44:47]
  v_mfma_f32_16x16x16_bf16 v[48:51], v[240:241], v[100:101], v[48:51]
  s_nop 6
  v_cvt_pk_bf16_f32 v104, v44, v45
  v_cvt_pk_bf16_f32 v105, v46, v47
  v_mfma_f32_16x16x32_bf16 v[52:55], a[252:255], v[88:91], v[52:55]
  v_cvt_pk_bf16_f32 v106, v48, v49
  v_cvt_pk_bf16_f32 v107, v50, v51
  v_mfma_f32_16x16x32_bf16 v[56:59], v[146:149], v[88:91], v[56:59]
  buffer_store_dwordx4 v[104:107], v3, s[4:7], s38 offen offset:0
  v_mfma_f32_16x16x32_bf16 v[52:55], v[134:137], v[92:95], v[52:55]
  v_mfma_f32_16x16x32_bf16 v[56:59], v[150:153], v[92:95], v[56:59]
  v_mfma_f32_16x16x32_bf16 v[52:55], v[138:141], v[96:99], v[52:55]
  v_mfma_f32_16x16x32_bf16 v[56:59], v[154:157], v[96:99], v[56:59]
  v_mfma_f32_16x16x32_bf16 v[60:63], v[158:161], v[84:87], 0
  v_mfma_f32_16x16x32_bf16 v[64:67], v[174:177], v[84:87], 0
  v_mfma_f32_16x16x16_bf16 v[52:55], v[242:243], v[100:101], v[52:55]
  v_mfma_f32_16x16x16_bf16 v[56:59], v[244:245], v[100:101], v[56:59]
  s_nop 6
  v_cvt_pk_bf16_f32 v108, v52, v53
  v_cvt_pk_bf16_f32 v109, v54, v55
  v_mfma_f32_16x16x32_bf16 v[60:63], v[162:165], v[88:91], v[60:63]
  v_cvt_pk_bf16_f32 v110, v56, v57
  v_cvt_pk_bf16_f32 v111, v58, v59
  v_mfma_f32_16x16x32_bf16 v[64:67], v[178:181], v[88:91], v[64:67]
  buffer_store_dwordx4 v[108:111], v3, s[4:7], s38 offen offset:1024
  v_mfma_f32_16x16x32_bf16 v[60:63], v[166:169], v[92:95], v[60:63]
  v_mfma_f32_16x16x32_bf16 v[64:67], v[182:185], v[92:95], v[64:67]
  v_mfma_f32_16x16x32_bf16 v[60:63], v[170:173], v[96:99], v[60:63]
  v_mfma_f32_16x16x32_bf16 v[64:67], v[186:189], v[96:99], v[64:67]
  v_mfma_f32_16x16x32_bf16 v[68:71], v[190:193], v[84:87], 0
  v_mfma_f32_16x16x32_bf16 v[72:75], v[206:209], v[84:87], 0
  v_mfma_f32_16x16x16_bf16 v[60:63], v[246:247], v[100:101], v[60:63]
  v_mfma_f32_16x16x16_bf16 v[64:67], v[248:249], v[100:101], v[64:67]
  s_nop 6
  v_cvt_pk_bf16_f32 v104, v60, v61
  v_cvt_pk_bf16_f32 v105, v62, v63
  v_mfma_f32_16x16x32_bf16 v[68:71], v[194:197], v[88:91], v[68:71]
  v_cvt_pk_bf16_f32 v106, v64, v65
  v_cvt_pk_bf16_f32 v107, v66, v67
  v_mfma_f32_16x16x32_bf16 v[72:75], v[210:213], v[88:91], v[72:75]
  buffer_store_dwordx4 v[104:107], v3, s[4:7], s38 offen offset:2048
  v_mfma_f32_16x16x32_bf16 v[68:71], v[198:201], v[92:95], v[68:71]
  v_mfma_f32_16x16x32_bf16 v[72:75], v[214:217], v[92:95], v[72:75]
  v_mfma_f32_16x16x32_bf16 v[68:71], v[202:205], v[96:99], v[68:71]
  v_mfma_f32_16x16x32_bf16 v[72:75], v[218:221], v[96:99], v[72:75]
  v_mfma_f32_16x16x32_bf16 v[76:79], v[222:225], v[84:87], 0
  v_mfma_f32_16x16x32_bf16 v[76:79], v[226:229], v[88:91], v[76:79]
  v_mfma_f32_16x16x16_bf16 v[68:71], v[250:251], v[100:101], v[68:71]
  v_mfma_f32_16x16x16_bf16 v[72:75], v[252:253], v[100:101], v[72:75]
  s_nop 6
  v_cvt_pk_bf16_f32 v108, v68, v69
  v_cvt_pk_bf16_f32 v109, v70, v71
  v_mfma_f32_16x16x32_bf16 v[76:79], v[230:233], v[92:95], v[76:79]
  v_cvt_pk_bf16_f32 v110, v72, v73
  v_cvt_pk_bf16_f32 v111, v74, v75
  v_mfma_f32_16x16x32_bf16 v[76:79], v[234:237], v[96:99], v[76:79]
  buffer_store_dwordx4 v[108:111], v3, s[4:7], s38 offen offset:3072
  s_waitcnt lgkmcnt(4)
  v_mfma_f32_16x16x32_bf16 v[44:47], a[216:219], v[114:117], 0
  v_mfma_f32_16x16x32_bf16 v[48:51], a[232:235], v[114:117], 0
  v_mfma_f32_16x16x16_bf16 v[76:79], v[254:255], v[100:101], v[76:79]
  s_nop 7
  v_cvt_pk_bf16_f32 v112, v76, v77
  v_cvt_pk_bf16_f32 v113, v78, v79
  s_waitcnt lgkmcnt(3)
  v_mfma_f32_16x16x32_bf16 v[44:47], a[220:223], v[118:121], v[44:47]
  buffer_store_dwordx2 v[112:113], v17, s[4:7], s59 offen
  v_mfma_f32_16x16x32_bf16 v[48:51], a[236:239], v[118:121], v[48:51]
  s_waitcnt lgkmcnt(2)
  v_mfma_f32_16x16x32_bf16 v[44:47], a[224:227], v[122:125], v[44:47]
  v_mfma_f32_16x16x32_bf16 v[48:51], a[240:243], v[122:125], v[48:51]
  s_waitcnt lgkmcnt(1)
  v_mfma_f32_16x16x32_bf16 v[44:47], a[228:231], v[126:129], v[44:47]
  v_mfma_f32_16x16x32_bf16 v[48:51], a[244:247], v[126:129], v[48:51]
  v_mfma_f32_16x16x32_bf16 v[52:55], a[248:251], v[114:117], 0
  v_mfma_f32_16x16x32_bf16 v[56:59], v[142:145], v[114:117], 0
  s_waitcnt lgkmcnt(0)
  v_mfma_f32_16x16x16_bf16 v[44:47], v[238:239], v[130:131], v[44:47]
  v_mfma_f32_16x16x16_bf16 v[48:51], v[240:241], v[130:131], v[48:51]
  s_nop 6
  v_cvt_pk_bf16_f32 v108, v44, v45
  v_cvt_pk_bf16_f32 v109, v46, v47
  v_mfma_f32_16x16x32_bf16 v[52:55], a[252:255], v[118:121], v[52:55]
  v_cvt_pk_bf16_f32 v110, v48, v49
  v_cvt_pk_bf16_f32 v111, v50, v51
  v_mfma_f32_16x16x32_bf16 v[56:59], v[146:149], v[118:121], v[56:59]
  buffer_store_dwordx4 v[108:111], v3, s[4:7], s58 offen offset:0
  v_mfma_f32_16x16x32_bf16 v[52:55], v[134:137], v[122:125], v[52:55]
  v_mfma_f32_16x16x32_bf16 v[56:59], v[150:153], v[122:125], v[56:59]
  v_mfma_f32_16x16x32_bf16 v[52:55], v[138:141], v[126:129], v[52:55]
  v_mfma_f32_16x16x32_bf16 v[56:59], v[154:157], v[126:129], v[56:59]
  v_mfma_f32_16x16x32_bf16 v[60:63], v[158:161], v[114:117], 0
  v_mfma_f32_16x16x32_bf16 v[64:67], v[174:177], v[114:117], 0
  v_mfma_f32_16x16x16_bf16 v[52:55], v[242:243], v[130:131], v[52:55]
  v_mfma_f32_16x16x16_bf16 v[56:59], v[244:245], v[130:131], v[56:59]
  s_nop 6
  v_cvt_pk_bf16_f32 v104, v52, v53
  v_cvt_pk_bf16_f32 v105, v54, v55
  v_mfma_f32_16x16x32_bf16 v[60:63], v[162:165], v[118:121], v[60:63]
  v_cvt_pk_bf16_f32 v106, v56, v57
  v_cvt_pk_bf16_f32 v107, v58, v59
  v_mfma_f32_16x16x32_bf16 v[64:67], v[178:181], v[118:121], v[64:67]
  buffer_store_dwordx4 v[104:107], v3, s[4:7], s58 offen offset:1024
  v_mfma_f32_16x16x32_bf16 v[60:63], v[166:169], v[122:125], v[60:63]
  v_mfma_f32_16x16x32_bf16 v[64:67], v[182:185], v[122:125], v[64:67]
  v_mfma_f32_16x16x32_bf16 v[60:63], v[170:173], v[126:129], v[60:63]
  v_mfma_f32_16x16x32_bf16 v[64:67], v[186:189], v[126:129], v[64:67]
  v_mfma_f32_16x16x32_bf16 v[68:71], v[190:193], v[114:117], 0
  v_mfma_f32_16x16x32_bf16 v[72:75], v[206:209], v[114:117], 0
  v_mfma_f32_16x16x16_bf16 v[60:63], v[246:247], v[130:131], v[60:63]
  v_mfma_f32_16x16x16_bf16 v[64:67], v[248:249], v[130:131], v[64:67]
  s_nop 6
  v_cvt_pk_bf16_f32 v108, v60, v61
  v_cvt_pk_bf16_f32 v109, v62, v63
  v_mfma_f32_16x16x32_bf16 v[68:71], v[194:197], v[118:121], v[68:71]
  v_cvt_pk_bf16_f32 v110, v64, v65
  v_cvt_pk_bf16_f32 v111, v66, v67
  v_mfma_f32_16x16x32_bf16 v[72:75], v[210:213], v[118:121], v[72:75]
  buffer_store_dwordx4 v[108:111], v3, s[4:7], s58 offen offset:2048
  v_mfma_f32_16x16x32_bf16 v[68:71], v[198:201], v[122:125], v[68:71]
  v_mfma_f32_16x16x32_bf16 v[72:75], v[214:217], v[122:125], v[72:75]
  v_mfma_f32_16x16x32_bf16 v[68:71], v[202:205], v[126:129], v[68:71]
  v_mfma_f32_16x16x32_bf16 v[72:75], v[218:221], v[126:129], v[72:75]
  v_mfma_f32_16x16x32_bf16 v[76:79], v[222:225], v[114:117], 0
  v_mfma_f32_16x16x32_bf16 v[76:79], v[226:229], v[118:121], v[76:79]
  v_mfma_f32_16x16x16_bf16 v[68:71], v[250:251], v[130:131], v[68:71]
  v_mfma_f32_16x16x16_bf16 v[72:75], v[252:253], v[130:131], v[72:75]
  s_nop 6
  v_cvt_pk_bf16_f32 v104, v68, v69
  v_cvt_pk_bf16_f32 v105, v70, v71
  v_mfma_f32_16x16x32_bf16 v[76:79], v[230:233], v[122:125], v[76:79]
  v_cvt_pk_bf16_f32 v106, v72, v73
  v_cvt_pk_bf16_f32 v107, v74, v75
  v_mfma_f32_16x16x32_bf16 v[76:79], v[234:237], v[126:129], v[76:79]
  buffer_store_dwordx4 v[104:107], v3, s[4:7], s58 offen offset:3072
  s_nop 7
  v_mfma_f32_16x16x16_bf16 v[76:79], v[254:255], v[130:131], v[76:79]
  s_nop 7
  v_cvt_pk_bf16_f32 v112, v76, v77
  v_cvt_pk_bf16_f32 v113, v78, v79
  buffer_store_dwordx2 v[112:113], v17, s[4:7], s60 offen
  s_branch g2e_162
g2s_161:
  s_waitcnt lgkmcnt(9)
  v_mfma_f32_16x16x32_bf16 v[44:47], a[216:219], v[84:87], 0
  v_mfma_f32_16x16x32_bf16 v[48:51], a[232:235], v[84:87], 0
  s_waitcnt lgkmcnt(8)
  v_mfma_f32_16x16x32_bf16 v[44:47], a[220:223], v[88:91], v[44:47]
  v_mfma_f32_16x16x32_bf16 v[48:51], a[236:239], v[88:91], v[48:51]
  s_waitcnt lgkmcnt(7)
  v_mfma_f32_16x16x32_bf16 v[44:47], a[224:227], v[92:95], v[44:47]
  v_mfma_f32_16x16x32_bf16 v[48:51], a[240:243], v[92:95], v[48:51]
  s_waitcnt lgkmcnt(6)
  v_mfma_f32_16x16x32_bf16 v[44:47], a[228:231], v[96:99], v[44:47]
  v_mfma_f32_16x16x32_bf16 v[48:51], a[244:247], v[96:99], v[48:51]
  v_mfma_f32_16x16x32_bf16 v[52:55], a[248:251], v[84:87], 0
  v_mfma_f32_16x16x32_bf16 v[56:59], v[142:145], v[84:87], 0
  s_waitcnt lgkmcnt(5)
  v_mfma_f32_16x16x16_bf16 v[44:47], v[238:239], v[100:101], v[44:47]
  v_mfma_f32_16x16x16_bf16 v[48:51], v[240:241], v[100:101], v[48:51]
  s_nop 6
  v_cvt_pk_bf16_f32 v104, v44, v45
  v_cvt_pk_bf16_f32 v105, v46, v47
  v_mfma_f32_16x16x32_bf16 v[52:55], a[252:255], v[88:91], v[52:55]
  v_cvt_pk_bf16_f32 v106, v48, v49
  v_cvt_pk_bf16_f32 v107, v50, v51
  v_mfma_f32_16x16x32_bf16 v[56:59], v[146:149], v[88:91], v[56:59]
  buffer_store_dwordx4 v[104:107], v3, s[4:7], s38 offen offset:0 sc1
  v_mfma_f32_16x16x32_bf16 v[52:55], v[134:137], v[92:95], v[52:55]
  v_mfma_f32_16x16x32_bf16 v[56:59], v[150:153], v[92:95], v[56:59]
  v_mfma_f32_16x16x32_bf16 v[52:55], v[138:141], v[96:99], v[52:55]
  v_mfma_f32_16x16x32_bf16 v[56:59], v[154:157], v[96:99], v[56:59]
  v_mfma_f32_16x16x32_bf16 v[60:63], v[158:161], v[84:87], 0
  v_mfma_f32_16x16x32_bf16 v[64:67], v[174:177], v[84:87], 0
  v_mfma_f32_16x16x16_bf16 v[52:55], v[242:243], v[100:101], v[52:55]
  v_mfma_f32_16x16x16_bf16 v[56:59], v[244:245], v[100:101], v[56:59]
  s_nop 6
  v_cvt_pk_bf16_f32 v108, v52, v53
  v_cvt_pk_bf16_f32 v109, v54, v55
  v_mfma_f32_16x16x32_bf16 v[60:63], v[162:165], v[88:91], v[60:63]
  v_cvt_pk_bf16_f32 v110, v56, v57
  v_cvt_pk_bf16_f32 v111, v58, v59
  v_mfma_f32_16x16x32_bf16 v[64:67], v[178:181], v[88:91], v[64:67]
  buffer_store_dwordx4 v[108:111], v3, s[4:7], s38 offen offset:1024 sc1
  v_mfma_f32_16x16x32_bf16 v[60:63], v[166:169], v[92:95], v[60:63]
  v_mfma_f32_16x16x32_bf16 v[64:67], v[182:185], v[92:95], v[64:67]
  v_mfma_f32_16x16x32_bf16 v[60:63], v[170:173], v[96:99], v[60:63]
  v_mfma_f32_16x16x32_bf16 v[64:67], v[186:189], v[96:99], v[64:67]
  v_mfma_f32_16x16x32_bf16 v[68:71], v[190:193], v[84:87], 0
  v_mfma_f32_16x16x32_bf16 v[72:75], v[206:209], v[84:87], 0
  v_mfma_f32_16x16x16_bf16 v[60:63], v[246:247], v[100:101], v[60:63]
  v_mfma_f32_16x16x16_bf16 v[64:67], v[248:249], v[100:101], v[64:67]
  s_nop 6
  v_cvt_pk_bf16_f32 v104, v60, v61
  v_cvt_pk_bf16_f32 v105, v62, v63
  v_mfma_f32_16x16x32_bf16 v[68:71], v[194:197], v[88:91], v[68:71]
  v_cvt_pk_bf16_f32 v106, v64, v65
  v_cvt_pk_bf16_f32 v107, v66, v67
  v_mfma_f32_16x16x32_bf16 v[72:75], v[210:213], v[88:91], v[72:75]
  buffer_store_dwordx4 v[104:107], v3, s[4:7], s38 offen offset:2048 sc1
  v_mfma_f32_16x16x32_bf16 v[68:71], v[198:201], v[92:95], v[68:71]
  v_mfma_f32_16x16x32_bf16 v[72:75], v[214:217], v[92:95], v[72:75]
  v_mfma_f32_16x16x32_bf16 v[68:71], v[202:205], v[96:99], v[68:71]
  v_mfma_f32_16x16x32_bf16 v[72:75], v[218:221], v[96:99], v[72:75]
  v_mfma_f32_16x16x32_bf16 v[76:79], v[222:225], v[84:87], 0
  v_mfma_f32_16x16x32_bf16 v[76:79], v[226:229], v[88:91], v[76:79]
  v_mfma_f32_16x16x16_bf16 v[68:71], v[250:251], v[100:101], v[68:71]
  v_mfma_f32_16x16x16_bf16 v[72:75], v[252:253], v[100:101], v[72:75]
  s_nop 6
  v_cvt_pk_bf16_f32 v108, v68, v69
  v_cvt_pk_bf16_f32 v109, v70, v71
  v_mfma_f32_16x16x32_bf16 v[76:79], v[230:233], v[92:95], v[76:79]
  v_cvt_pk_bf16_f32 v110, v72, v73
  v_cvt_pk_bf16_f32 v111, v74, v75
  v_mfma_f32_16x16x32_bf16 v[76:79], v[234:237], v[96:99], v[76:79]
  buffer_store_dwordx4 v[108:111], v3, s[4:7], s38 offen offset:3072 sc1
  s_waitcnt lgkmcnt(4)
  v_mfma_f32_16x16x32_bf16 v[44:47], a[216:219], v[114:117], 0
  v_mfma_f32_16x16x32_bf16 v[48:51], a[232:235], v[114:117], 0
  v_mfma_f32_16x16x16_bf16 v[76:79], v[254:255], v[100:101], v[76:79]
  s_nop 7
  v_cvt_pk_bf16_f32 v112, v76, v77
  v_cvt_pk_bf16_f32 v113, v78, v79
  s_waitcnt lgkmcnt(3)
  v_mfma_f32_16x16x32_bf16 v[44:47], a[220:223], v[118:121], v[44:47]
  buffer_store_dwordx2 v[112:113], v17, s[4:7], s59 offen sc1
  v_mfma_f32_16x16x32_bf16 v[48:51], a[236:239], v[118:121], v[48:51]
  s_waitcnt lgkmcnt(2)
  v_mfma_f32_16x16x32_bf16 v[44:47], a[224:227], v[122:125], v[44:47]
  v_mfma_f32_16x16x32_bf16 v[48:51], a[240:243], v[122:125], v[48:51]
  s_waitcnt lgkmcnt(1)
  v_mfma_f32_16x16x32_bf16 v[44:47], a[228:231], v[126:129], v[44:47]
  v_mfma_f32_16x16x32_bf16 v[48:51], a[244:247], v[126:129], v[48:51]
  v_mfma_f32_16x16x32_bf16 v[52:55], a[248:251], v[114:117], 0
  v_mfma_f32_16x16x32_bf16 v[56:59], v[142:145], v[114:117], 0
  s_waitcnt lgkmcnt(0)
  v_mfma_f32_16x16x16_bf16 v[44:47], v[238:239], v[130:131], v[44:47]
  v_mfma_f32_16x16x16_bf16 v[48:51], v[240:241], v[130:131], v[48:51]
  s_nop 6
  v_cvt_pk_bf16_f32 v108, v44, v45
  v_cvt_pk_bf16_f32 v109, v46, v47
  v_mfma_f32_16x16x32_bf16 v[52:55], a[252:255], v[118:121], v[52:55]
  v_cvt_pk_bf16_f32 v110, v48, v49
  v_cvt_pk_bf16_f32 v111, v50, v51
  v_mfma_f32_16x16x32_bf16 v[56:59], v[146:149], v[118:121], v[56:59]
  buffer_store_dwordx4 v[108:111], v3, s[4:7], s58 offen offset:0 sc1
  v_mfma_f32_16x16x32_bf16 v[52:55], v[134:137], v[122:125], v[52:55]
  v_mfma_f32_16x16x32_bf16 v[56:59], v[150:153], v[122:125], v[56:59]
  v_mfma_f32_16x16x32_bf16 v[52:55], v[138:141], v[126:129], v[52:55]
  v_mfma_f32_16x16x32_bf16 v[56:59], v[154:157], v[126:129], v[56:59]
  v_mfma_f32_16x16x32_bf16 v[60:63], v[158:161], v[114:117], 0
  v_mfma_f32_16x16x32_bf16 v[64:67], v[174:177], v[114:117], 0
  v_mfma_f32_16x16x16_bf16 v[52:55], v[242:243], v[130:131], v[52:55]
  v_mfma_f32_16x16x16_bf16 v[56:59], v[244:245], v[130:131], v[56:59]
  s_nop 6
  v_cvt_pk_bf16_f32 v104, v52, v53
  v_cvt_pk_bf16_f32 v105, v54, v55
  v_mfma_f32_16x16x32_bf16 v[60:63], v[162:165], v[118:121], v[60:63]
  v_cvt_pk_bf16_f32 v106, v56, v57
  v_cvt_pk_bf16_f32 v107, v58, v59
  v_mfma_f32_16x16x32_bf16 v[64:67], v[178:181], v[118:121], v[64:67]
  buffer_store_dwordx4 v[104:107], v3, s[4:7], s58 offen offset:1024 sc1
  v_mfma_f32_16x16x32_bf16 v[60:63], v[166:169], v[122:125], v[60:63]
  v_mfma_f32_16x16x32_bf16 v[64:67], v[182:185], v[122:125], v[64:67]
  v_mfma_f32_16x16x32_bf16 v[60:63], v[170:173], v[126:129], v[60:63]
  v_mfma_f32_16x16x32_bf16 v[64:67], v[186:189], v[126:129], v[64:67]
  v_mfma_f32_16x16x32_bf16 v[68:71], v[190:193], v[114:117], 0
  v_mfma_f32_16x16x32_bf16 v[72:75], v[206:209], v[114:117], 0
  v_mfma_f32_16x16x16_bf16 v[60:63], v[246:247], v[130:131], v[60:63]
  v_mfma_f32_16x16x16_bf16 v[64:67], v[248:249], v[130:131], v[64:67]
  s_nop 6
  v_cvt_pk_bf16_f32 v108, v60, v61
  v_cvt_pk_bf16_f32 v109, v62, v63
  v_mfma_f32_16x16x32_bf16 v[68:71], v[194:197], v[118:121], v[68:71]
  v_cvt_pk_bf16_f32 v110, v64, v65
  v_cvt_pk_bf16_f32 v111, v66, v67
  v_mfma_f32_16x16x32_bf16 v[72:75], v[210:213], v[118:121], v[72:75]
  buffer_store_dwordx4 v[108:111], v3, s[4:7], s58 offen offset:2048 sc1
  v_mfma_f32_16x16x32_bf16 v[68:71], v[198:201], v[122:125], v[68:71]
  v_mfma_f32_16x16x32_bf16 v[72:75], v[214:217], v[122:125], v[72:75]
  v_mfma_f32_16x16x32_bf16 v[68:71], v[202:205], v[126:129], v[68:71]
  v_mfma_f32_16x16x32_bf16 v[72:75], v[218:221], v[126:129], v[72:75]
  v_mfma_f32_16x16x32_bf16 v[76:79], v[222:225], v[114:117], 0
  v_mfma_f32_16x16x32_bf16 v[76:79], v[226:229], v[118:121], v[76:79]
  v_mfma_f32_16x16x16_bf16 v[68:71], v[250:251], v[130:131], v[68:71]
  v_mfma_f32_16x16x16_bf16 v[72:75], v[252:253], v[130:131], v[72:75]
  s_nop 6
  v_cvt_pk_bf16_f32 v104, v68, v69
  v_cvt_pk_bf16_f32 v105, v70, v71
  v_mfma_f32_16x16x32_bf16 v[76:79], v[230:233], v[122:125], v[76:79]
  v_cvt_pk_bf16_f32 v106, v72, v73
  v_cvt_pk_bf16_f32 v107, v74, v75
  v_mfma_f32_16x16x32_bf16 v[76:79], v[234:237], v[126:129], v[76:79]
  buffer_store_dwordx4 v[104:107], v3, s[4:7], s58 offen offset:3072 sc1
  s_nop 7
  v_mfma_f32_16x16x16_bf16 v[76:79], v[254:255], v[130:131], v[76:79]
  s_nop 7
  v_cvt_pk_bf16_f32 v112, v76, v77
  v_cvt_pk_bf16_f32 v113, v78, v79
  buffer_store_dwordx2 v[112:113], v17, s[4:7], s60 offen sc1
g2e_162:
  s_waitcnt vmcnt(0)
  s_barrier
  s_cmp_eq_u32 s17, 0
  s_cbranch_scc0 gs_164
  s_lshl_b32 s23, s18, 8
  s_add_u32 s23, s23, 2170880
  s_add_u32 s25, s19, 1
  s_lshl_b32 s24, s16, 2
  s_mov_b64 exec, 1
  v_mov_b32 v60, s24
  v_mov_b32 v61, s25
  s_cmp_eq_u32 s22, 0
  s_cbranch_scc0 ms_167
  buffer_store_dword v61, v60, s[4:7], s23 offen
  s_branch me_168
ms_167:
  buffer_store_dword v61, v60, s[4:7], s23 offen sc1
me_168:
  s_mov_b64 exec, -1
  v_mbcnt_lo_u32_b32 v60, -1, 0
  v_mbcnt_hi_u32_b32 v60, -1, v60
  v_and_b32 v60, 31, v60
  v_lshlrev_b32 v60, 2, v60
  s_mov_b32 s24, 0
gsp_165:
  buffer_load_dword v61, v60, s[4:7], s23 offen sc1
  s_add_u32 s24, s24, 1
  s_waitcnt vmcnt(0)
  v_cmp_gt_u32 vcc, s25, v61
  s_cbranch_vccz gsd_166
  s_cmp_lg_u32 s44, 0
  s_cbranch_scc1 gsd_166
  s_cmp_lt_u32 s24, 0x100000
  s_cbranch_scc1 gsp_165
  s_mov_b32 s44, 1
gsd_166:
gs_164:
  s_barrier
  s_lshr_b32 s23, s16, 3
  s_bfe_u32 s24, s16, 0x10002
  s_and_b32 s25, s16, 3
  s_mul_i32 s26, s23, 9216
  s_mul_i32 s27, s24, 4608
  s_add_u32 s26, s26, s27
  s_lshl_b32 s27, s25, 10
  s_add_u32 s26, s26, s27
  s_lshl_b32 s27, s17, 8
  s_add_u32 s26, s26, s27
  s_mul_i32 s28, s23, 288
  s_lshl_b32 s27, s25, 6
  s_add_u32 s28, s28, s27
  s_lshl_b32 s27, s17, 3
  s_add_u32 s28, s28, s27
  s_lshl_b32 s27, s20, 5
  s_lshl_b32 s24, s24, 4
  s_add_u32 s27, s27, s24
  s_mul_i32 s27, s27, 1152
  s_add_u32 s27, s27, s28
  s_add_u32 s26, s26, s36
  s_lshl_b32 s25, s27, 1
  s_add_u32 s25, s25, 60817408
  buffer_load_dwordx2 v[80:81], v15, s[8:11], s27 offen
  v_add_u32 v86, s28, v28
  global_load_dwordx2 v[84:85], v86, s[34:35]
  s_mov_b32 s57, s26
  buffer_load_dwordx4 v[44:47], v14, s[4:7], s57 offen sc1
  s_add_u32 s57, s57, 147456
  buffer_load_dwordx4 v[48:51], v14, s[4:7], s57 offen sc1
  s_add_u32 s57, s57, 147456
  buffer_load_dwordx4 v[52:55], v14, s[4:7], s57 offen sc1
  s_add_u32 s57, s57, 147456
  buffer_load_dwordx4 v[56:59], v14, s[4:7], s57 offen sc1
  s_add_u32 s57, s57, 147456
  buffer_load_dwordx4 v[60:63], v14, s[4:7], s57 offen sc1
  s_add_u32 s57, s57, 147456
  buffer_load_dwordx4 v[64:67], v14, s[4:7], s57 offen sc1
  s_add_u32 s57, s57, 147456
  buffer_load_dwordx4 v[68:71], v14, s[4:7], s57 offen sc1
  s_add_u32 s57, s57, 147456
  buffer_load_dwordx4 v[72:75], v14, s[4:7], s57 offen sc1
  s_waitcnt vmcnt(7)
  v_mfma_f32_16x16x32_bf16 v[76:79], v[24:27], v[44:47], 0
  s_waitcnt vmcnt(6)
  v_mfma_f32_16x16x32_bf16 v[76:79], v[24:27], v[48:51], v[76:79]
  s_waitcnt vmcnt(5)
  v_mfma_f32_16x16x32_bf16 v[76:79], v[24:27], v[52:55], v[76:79]
  s_waitcnt vmcnt(4)
  v_mfma_f32_16x16x32_bf16 v[76:79], v[24:27], v[56:59], v[76:79]
  s_waitcnt vmcnt(3)
  v_mfma_f32_16x16x32_bf16 v[76:79], v[24:27], v[60:63], v[76:79]
  s_waitcnt vmcnt(2)
  v_mfma_f32_16x16x32_bf16 v[76:79], v[24:27], v[64:67], v[76:79]
  s_waitcnt vmcnt(1)
  v_mfma_f32_16x16x32_bf16 v[76:79], v[24:27], v[68:71], v[76:79]
  s_waitcnt vmcnt(0)
  v_mfma_f32_16x16x32_bf16 v[76:79], v[24:27], v[72:75], v[76:79]
  s_mov_b32 s23, 0xffff0000
  v_lshlrev_b32 v44, 16, v80
  v_and_b32 v45, s23, v80
  v_lshlrev_b32 v46, 16, v81
  v_and_b32 v47, s23, v81
  v_lshlrev_b32 v48, 16, v84
  v_and_b32 v49, s23, v84
  v_lshlrev_b32 v50, 16, v85
  v_and_b32 v51, s23, v85
  v_add_f32 v44, v44, v48
  v_add_f32 v76, v76, v44
  v_add_f32 v45, v45, v49
  v_add_f32 v77, v77, v45
  v_add_f32 v46, v46, v50
  v_add_f32 v78, v78, v46
  v_add_f32 v47, v47, v51
  v_add_f32 v79, v79, v47
  s_mov_b64 exec, s[46:47]
  buffer_store_dwordx4 v[76:79], v16, s[4:7], s25 offen
  s_mov_b64 exec, -1
  s_cmp_eq_u32 s17, 3
  s_cbranch_scc0 rx_171
  s_cmp_lt_u32 s16, 16
  s_cbranch_scc0 rx_171
  s_lshr_b32 s23, s16, 2
  s_bfe_u32 s24, s16, 0x10001
  s_and_b32 s25, s16, 1
  s_mul_i32 s26, s23, 9216
  s_mul_i32 s27, s24, 4608
  s_add_u32 s26, s26, s27
  s_lshl_b32 s27, s25, 8
  s_add_u32 s26, s26, s27
  s_add_u32 s26, s26, 4096
  s_mul_i32 s28, s23, 288
  s_lshl_b32 s27, s25, 4
  s_add_u32 s28, s28, s27
  s_add_u32 s28, s28, 256
  s_lshl_b32 s27, s20, 5
  s_lshl_b32 s24, s24, 4
  s_add_u32 s27, s27, s24
  s_mul_i32 s27, s27, 1152
  s_add_u32 s27, s27, s28
  s_add_u32 s26, s26, s36
  s_lshl_b32 s25, s27, 1
  s_add_u32 s25, s25, 60817408
  buffer_load_dwordx2 v[80:81], v21, s[8:11], s27 offen
  v_add_u32 v86, s28, v29
  global_load_dwordx2 v[84:85], v86, s[34:35]
  s_mov_b32 s57, s26
  buffer_load_dwordx4 v[44:47], v14, s[4:7], s57 offen sc1
  s_add_u32 s57, s57, 147456
  buffer_load_dwordx4 v[48:51], v14, s[4:7], s57 offen sc1
  s_add_u32 s57, s57, 147456
  buffer_load_dwordx4 v[52:55], v14, s[4:7], s57 offen sc1
  s_add_u32 s57, s57, 147456
  buffer_load_dwordx4 v[56:59], v14, s[4:7], s57 offen sc1
  s_add_u32 s57, s57, 147456
  buffer_load_dwordx4 v[60:63], v14, s[4:7], s57 offen sc1
  s_add_u32 s57, s57, 147456
  buffer_load_dwordx4 v[64:67], v14, s[4:7], s57 offen sc1
  s_add_u32 s57, s57, 147456
  buffer_load_dwordx4 v[68:71], v14, s[4:7], s57 offen sc1
  s_add_u32 s57, s57, 147456
  buffer_load_dwordx4 v[72:75], v14, s[4:7], s57 offen sc1
  s_waitcnt vmcnt(7)
  v_mfma_f32_16x16x32_bf16 v[76:79], v[24:27], v[44:47], 0
  s_waitcnt vmcnt(6)
  v_mfma_f32_16x16x32_bf16 v[76:79], v[24:27], v[48:51], v[76:79]
  s_waitcnt vmcnt(5)
  v_mfma_f32_16x16x32_bf16 v[76:79], v[24:27], v[52:55], v[76:79]
  s_waitcnt vmcnt(4)
  v_mfma_f32_16x16x32_bf16 v[76:79], v[24:27], v[56:59], v[76:79]
  s_waitcnt vmcnt(3)
  v_mfma_f32_16x16x32_bf16 v[76:79], v[24:27], v[60:63], v[76:79]
  s_waitcnt vmcnt(2)
  v_mfma_f32_16x16x32_bf16 v[76:79], v[24:27], v[64:67], v[76:79]
  s_waitcnt vmcnt(1)
  v_mfma_f32_16x16x32_bf16 v[76:79], v[24:27], v[68:71], v[76:79]
  s_waitcnt vmcnt(0)
  v_mfma_f32_16x16x32_bf16 v[76:79], v[24:27], v[72:75], v[76:79]
  s_mov_b32 s23, 0xffff0000
  v_lshlrev_b32 v44, 16, v80
  v_and_b32 v45, s23, v80
  v_lshlrev_b32 v46, 16, v81
  v_and_b32 v47, s23, v81
  v_lshlrev_b32 v48, 16, v84
  v_and_b32 v49, s23, v84
  v_lshlrev_b32 v50, 16, v85
  v_and_b32 v51, s23, v85
  v_add_f32 v44, v44, v48
  v_add_f32 v76, v76, v44
  v_add_f32 v45, v45, v49
  v_add_f32 v77, v77, v45
  v_add_f32 v46, v46, v50
  v_add_f32 v78, v78, v46
  v_add_f32 v47, v47, v51
  v_add_f32 v79, v79, v47
  s_mov_b64 exec, s[46:47]
  buffer_store_dwordx4 v[76:79], v22, s[4:7], s25 offen
  s_mov_b64 exec, -1
  s_waitcnt vmcnt(0) lgkmcnt(0)
rx_171:
  s_xor_b32 s37, s37, 45056
  s_add_u32 s20, s20, 7
  s_add_u32 s19, s19, 1
  s_cmp_lt_u32 s19, s21
  s_cbranch_scc1 pc_loop_159
  s_waitcnt vmcnt(0) lgkmcnt(0)
  s_barrier
  v_mov_b32 v2, 192
  v_mul_u32_u24 v2, v2, v0
  global_load_dword v3, v2, s[30:31] offset:0
  global_load_dword v4, v2, s[30:31] offset:12
  global_load_dword v5, v2, s[30:31] offset:24
  global_load_dword v9, v2, s[30:31] offset:48
  global_load_dword v10, v2, s[30:31] offset:52
  global_load_dword v11, v2, s[30:31] offset:56
  global_load_dword v12, v2, s[30:31] offset:64
  global_load_dword v13, v2, s[30:31] offset:76
  global_load_dword v14, v2, s[30:31] offset:88
  global_load_dword v15, v2, s[30:31] offset:92
  global_load_dword v16, v2, s[30:31] offset:96
  global_load_dword v17, v2, s[30:31] offset:100
  global_load_dword v18, v2, s[30:31] offset:80
  global_load_dword v19, v2, s[30:31] offset:84
  global_load_dword v21, v2, s[30:31] offset:116
  global_load_dword v22, v2, s[30:31] offset:120
  global_load_dword v23, v2, s[30:31] offset:124
  global_load_dword v24, v2, s[30:31] offset:160
  global_load_dword v25, v2, s[30:31] offset:164
  global_load_dword v26, v2, s[30:31] offset:168
  global_load_dword v27, v2, s[30:31] offset:172
  global_load_dword v28, v2, s[30:31] offset:128
  global_load_dword v29, v2, s[30:31] offset:132
  global_load_dword v30, v2, s[30:31] offset:136
  global_load_dword v31, v2, s[30:31] offset:140
  global_load_dword v32, v2, s[30:31] offset:144
  global_load_dword v33, v2, s[30:31] offset:148
  global_load_dword v34, v2, s[30:31] offset:152
  global_load_dword v35, v2, s[30:31] offset:156
  s_waitcnt vmcnt(0)
  s_load_dwordx2 s[32:33], s[0:1], 16
  s_waitcnt lgkmcnt(0)
  s_mov_b32 s8, s32
  s_and_b32 s9, s33, 0xffff
  s_mov_b32 s10, 4718592
  s_mov_b32 s11, 0x20000
  s_lshl_b32 s36, s16, 8
  s_mul_i32 s23, s17, 131072
  s_add_u32 s36, s36, s23
  s_lshl_b32 s45, s17, 12
  s_lshl_b32 s42, s17, 10
  s_add_u32 s43, s36, 0
  s_add_u32 m0, s45, 0
  s_nop 0
  buffer_load_dwordx4 v4, s[8:11], s43 offen lds
  s_add_u32 s43, s36, 32768
  s_add_u32 m0, s45, 1024
  s_nop 0
  buffer_load_dwordx4 v4, s[8:11], s43 offen lds
  s_add_u32 s43, s36, 65536
  s_add_u32 m0, s45, 2048
  s_nop 0
  buffer_load_dwordx4 v4, s[8:11], s43 offen lds
  s_add_u32 s43, s36, 98304
  s_add_u32 m0, s45, 3072
  s_nop 0
  buffer_load_dwordx4 v4, s[8:11], s43 offen lds
  s_add_u32 s43, s36, 524288
  s_add_u32 m0, s45, 16384
  s_nop 0
  buffer_load_dwordx4 v4, s[8:11], s43 offen lds
  s_add_u32 s43, s36, 557056
  s_add_u32 m0, s45, 17408
  s_nop 0
  buffer_load_dwordx4 v4, s[8:11], s43 offen lds
  s_add_u32 s43, s36, 589824
  s_add_u32 m0, s45, 18432
  s_nop 0
  buffer_load_dwordx4 v4, s[8:11], s43 offen lds
  s_add_u32 s43, s36, 622592
  s_add_u32 m0, s45, 19456
  s_nop 0
  buffer_load_dwordx4 v4, s[8:11], s43 offen lds
  s_add_u32 s43, s36, 1048576
  s_add_u32 m0, s45, 32768
  s_nop 0
  buffer_load_dwordx4 v4, s[8:11], s43 offen lds
  s_add_u32 s43, s36, 1081344
  s_add_u32 m0, s45, 33792
  s_nop 0
  buffer_load_dwordx4 v4, s[8:11], s43 offen lds
  s_add_u32 s43, s36, 1114112
  s_add_u32 m0, s45, 34816
  s_nop 0
  buffer_load_dwordx4 v4, s[8:11], s43 offen lds
  s_add_u32 s43, s36, 1146880
  s_add_u32 m0, s45, 35840
  s_nop 0
  buffer_load_dwordx4 v4, s[8:11], s43 offen lds
  s_add_u32 s43, s36, 1572864
  s_add_u32 m0, s45, 49152
  s_nop 0
  buffer_load_dwordx4 v4, s[8:11], s43 offen lds
  s_add_u32 s43, s36, 1605632
  s_add_u32 m0, s45, 50176
  s_nop 0
  buffer_load_dwordx4 v4, s[8:11], s43 offen lds
  s_add_u32 s43, s36, 1638400
  s_add_u32 m0, s45, 51200
  s_nop 0
  buffer_load_dwordx4 v4, s[8:11], s43 offen lds
  s_add_u32 s43, s36, 1671168
  s_add_u32 m0, s45, 52224
  s_nop 0
  buffer_load_dwordx4 v4, s[8:11], s43 offen lds
  s_add_u32 s43, s36, 2097152
  s_add_u32 m0, s45, 65536
  s_nop 0
  buffer_load_dwordx4 v4, s[8:11], s43 offen lds
  s_add_u32 s43, s36, 2129920
  s_add_u32 m0, s45, 66560
  s_nop 0
  buffer_load_dwordx4 v4, s[8:11], s43 offen lds
  s_add_u32 s43, s36, 2162688
  s_add_u32 m0, s45, 67584
  s_nop 0
  buffer_load_dwordx4 v4, s[8:11], s43 offen lds
  s_add_u32 s43, s36, 2195456
  s_add_u32 m0, s45, 68608
  s_nop 0
  buffer_load_dwordx4 v4, s[8:11], s43 offen lds
  s_add_u32 s43, s36, 2621440
  s_add_u32 m0, s45, 81920
  s_nop 0
  buffer_load_dwordx4 v4, s[8:11], s43 offen lds
  s_add_u32 s43, s36, 2654208
  s_add_u32 m0, s45, 82944
  s_nop 0
  buffer_load_dwordx4 v4, s[8:11], s43 offen lds
  s_add_u32 s43, s36, 2686976
  s_add_u32 m0, s45, 83968
  s_nop 0
  buffer_load_dwordx4 v4, s[8:11], s43 offen lds
  s_add_u32 s43, s36, 2719744
  s_add_u32 m0, s45, 84992
  s_nop 0
  buffer_load_dwordx4 v4, s[8:11], s43 offen lds
  s_waitcnt vmcnt(20) lgkmcnt(0)
  s_barrier
  v_add_u32 v60, 0, v5
  ds_read_b64_tr_b16 a[0:1], v60 offset:0
  ds_read_b64_tr_b16 a[2:3], v60 offset:1024
  ds_read_b64_tr_b16 a[4:5], v60 offset:4096
  ds_read_b64_tr_b16 a[6:7], v60 offset:5120
  ds_read_b64_tr_b16 a[8:9], v60 offset:8192
  ds_read_b64_tr_b16 a[10:11], v60 offset:9216
  ds_read_b64_tr_b16 a[12:13], v60 offset:12288
  ds_read_b64_tr_b16 a[14:15], v60 offset:13312
  s_waitcnt vmcnt(16) lgkmcnt(0)
  s_barrier
  s_add_u32 s43, s36, 3145728
  s_add_u32 m0, s45, 98304
  s_nop 0
  buffer_load_dwordx4 v4, s[8:11], s43 offen lds
  s_add_u32 s43, s36, 3178496
  s_add_u32 m0, s45, 99328
  s_nop 0
  buffer_load_dwordx4 v4, s[8:11], s43 offen lds
  s_add_u32 s43, s36, 3211264
  s_add_u32 m0, s45, 100352
  s_nop 0
  buffer_load_dwordx4 v4, s[8:11], s43 offen lds
  s_add_u32 s43, s36, 3244032
  s_add_u32 m0, s45, 101376
  s_nop 0
  buffer_load_dwordx4 v4, s[8:11], s43 offen lds
  v_add_u32 v60, 16384, v5
  ds_read_b64_tr_b16 a[16:17], v60 offset:0
  ds_read_b64_tr_b16 a[18:19], v60 offset:1024
  ds_read_b64_tr_b16 a[20:21], v60 offset:4096
  ds_read_b64_tr_b16 a[22:23], v60 offset:5120
  ds_read_b64_tr_b16 a[24:25], v60 offset:8192
  ds_read_b64_tr_b16 a[26:27], v60 offset:9216
  ds_read_b64_tr_b16 a[28:29], v60 offset:12288
  ds_read_b64_tr_b16 a[30:31], v60 offset:13312
  s_waitcnt vmcnt(16) lgkmcnt(0)
  s_barrier
  s_add_u32 s43, s36, 3670016
  s_add_u32 m0, s45, 114688
  s_nop 0
  buffer_load_dwordx4 v4, s[8:11], s43 offen lds
  s_add_u32 s43, s36, 3702784
  s_add_u32 m0, s45, 115712
  s_nop 0
  buffer_load_dwordx4 v4, s[8:11], s43 offen lds
  s_add_u32 s43, s36, 3735552
  s_add_u32 m0, s45, 116736
  s_nop 0
  buffer_load_dwordx4 v4, s[8:11], s43 offen lds
  s_add_u32 s43, s36, 3768320
  s_add_u32 m0, s45, 117760
  s_nop 0
  buffer_load_dwordx4 v4, s[8:11], s43 offen lds
  v_add_u32 v60, 32768, v5
  ds_read_b64_tr_b16 a[32:33], v60 offset:0
  ds_read_b64_tr_b16 a[34:35], v60 offset:1024
  ds_read_b64_tr_b16 a[36:37], v60 offset:4096
  ds_read_b64_tr_b16 a[38:39], v60 offset:5120
  ds_read_b64_tr_b16 a[40:41], v60 offset:8192
  ds_read_b64_tr_b16 a[42:43], v60 offset:9216
  ds_read_b64_tr_b16 a[44:45], v60 offset:12288
  ds_read_b64_tr_b16 a[46:47], v60 offset:13312
  s_waitcnt vmcnt(16) lgkmcnt(0)
  s_barrier
  s_add_u32 s43, s36, 4194304
  s_add_u32 m0, s45, 131072
  s_nop 0
  buffer_load_dwordx4 v4, s[8:11], s43 offen lds
  s_add_u32 s43, s36, 4227072
  s_add_u32 m0, s45, 132096
  s_nop 0
  buffer_load_dwordx4 v4, s[8:11], s43 offen lds
  s_add_u32 s43, s36, 4259840
  s_add_u32 m0, s45, 133120
  s_nop 0
  buffer_load_dwordx4 v4, s[8:11], s43 offen lds
  s_add_u32 s43, s36, 4292608
  s_add_u32 m0, s45, 134144
  s_nop 0
  buffer_load_dwordx4 v4, s[8:11], s43 offen lds
  v_add_u32 v60, 49152, v5
  ds_read_b64_tr_b16 a[48:49], v60 offset:0
  ds_read_b64_tr_b16 a[50:51], v60 offset:1024
  ds_read_b64_tr_b16 a[52:53], v60 offset:4096
  ds_read_b64_tr_b16 a[54:55], v60 offset:5120
  ds_read_b64_tr_b16 a[56:57], v60 offset:8192
  ds_read_b64_tr_b16 a[58:59], v60 offset:9216
  ds_read_b64_tr_b16 a[60:61], v60 offset:12288
  ds_read_b64_tr_b16 a[62:63], v60 offset:13312
  s_waitcnt vmcnt(16) lgkmcnt(0)
  s_barrier
  v_add_u32 v60, 65536, v5
  ds_read_b64_tr_b16 a[64:65], v60 offset:0
  ds_read_b64_tr_b16 a[66:67], v60 offset:1024
  ds_read_b64_tr_b16 a[68:69], v60 offset:4096
  ds_read_b64_tr_b16 a[70:71], v60 offset:5120
  ds_read_b64_tr_b16 a[72:73], v60 offset:8192
  ds_read_b64_tr_b16 a[74:75], v60 offset:9216
  ds_read_b64_tr_b16 a[76:77], v60 offset:12288
  ds_read_b64_tr_b16 a[78:79], v60 offset:13312
  s_waitcnt vmcnt(12) lgkmcnt(0)
  s_barrier
  v_add_u32 v60, 81920, v5
  ds_read_b64_tr_b16 a[80:81], v60 offset:0
  ds_read_b64_tr_b16 a[82:83], v60 offset:1024
  ds_read_b64_tr_b16 a[84:85], v60 offset:4096
  ds_read_b64_tr_b16 a[86:87], v60 offset:5120
  ds_read_b64_tr_b16 a[88:89], v60 offset:8192
  ds_read_b64_tr_b16 a[90:91], v60 offset:9216
  ds_read_b64_tr_b16 a[92:93], v60 offset:12288
  ds_read_b64_tr_b16 a[94:95], v60 offset:13312
  s_waitcnt vmcnt(8) lgkmcnt(0)
  s_barrier
  v_add_u32 v60, 98304, v5
  ds_read_b64_tr_b16 a[96:97], v60 offset:0
  ds_read_b64_tr_b16 a[98:99], v60 offset:1024
  ds_read_b64_tr_b16 a[100:101], v60 offset:4096
  ds_read_b64_tr_b16 a[102:103], v60 offset:5120
  ds_read_b64_tr_b16 a[104:105], v60 offset:8192
  ds_read_b64_tr_b16 a[106:107], v60 offset:9216
  ds_read_b64_tr_b16 a[108:109], v60 offset:12288
  ds_read_b64_tr_b16 a[110:111], v60 offset:13312
  s_waitcnt vmcnt(4) lgkmcnt(0)
  s_barrier
  v_add_u32 v60, 114688, v5
  ds_read_b64_tr_b16 a[112:113], v60 offset:0
  ds_read_b64_tr_b16 a[114:115], v60 offset:1024
  ds_read_b64_tr_b16 a[116:117], v60 offset:4096
  ds_read_b64_tr_b16 a[118:119], v60 offset:5120
  ds_read_b64_tr_b16 a[120:121], v60 offset:8192
  ds_read_b64_tr_b16 a[122:123], v60 offset:9216
  ds_read_b64_tr_b16 a[124:125], v60 offset:12288
  ds_read_b64_tr_b16 a[126:127], v60 offset:13312
  s_waitcnt vmcnt(0) lgkmcnt(0)
  s_barrier
  v_add_u32 v60, 131072, v5
  ds_read_b64_tr_b16 a[128:129], v60 offset:0
  ds_read_b64_tr_b16 a[130:131], v60 offset:1024
  ds_read_b64_tr_b16 a[132:133], v60 offset:4096
  ds_read_b64_tr_b16 a[134:135], v60 offset:5120
  ds_read_b64_tr_b16 a[136:137], v60 offset:8192
  ds_read_b64_tr_b16 a[138:139], v60 offset:9216
  ds_read_b64_tr_b16 a[140:141], v60 offset:12288
  ds_read_b64_tr_b16 a[142:143], v60 offset:13312
  s_waitcnt lgkmcnt(0)
  s_barrier
  s_load_dwordx2 s[32:33], s[0:1], 40
  s_waitcnt lgkmcnt(0)
  s_mov_b32 s8, s32
  s_and_b32 s9, s33, 0xffff
  s_mov_b32 s10, 4718592
  s_mov_b32 s11, 0x20000
  s_lshl_b32 s36, s16, 7
  s_lshl_b32 s23, s17, 2
  s_add_u32 s36, s36, s23
  s_mul_i32 s37, s36, 1152
  s_add_u32 s43, s37, 0
  s_add_u32 m0, s42, 0
  s_nop 0
  buffer_load_dwordx4 v9, s[8:11], s43 offen lds
  s_add_u32 s43, s37, 18432
  s_add_u32 m0, s42, 4096
  s_nop 0
  buffer_load_dwordx4 v9, s[8:11], s43 offen lds
  s_add_u32 s43, s37, 36864
  s_add_u32 m0, s42, 8192
  s_nop 0
  buffer_load_dwordx4 v9, s[8:11], s43 offen lds
  s_add_u32 s43, s37, 55296
  s_add_u32 m0, s42, 12288
  s_nop 0
  buffer_load_dwordx4 v9, s[8:11], s43 offen lds
  s_add_u32 s43, s37, 73728
  s_add_u32 m0, s42, 16384
  s_nop 0
  buffer_load_dwordx4 v9, s[8:11], s43 offen lds
  s_add_u32 s43, s37, 92160
  s_add_u32 m0, s42, 20480
  s_nop 0
  buffer_load_dwordx4 v9, s[8:11], s43 offen lds
  s_add_u32 s43, s37, 110592
  s_add_u32 m0, s42, 24576
  s_nop 0
  buffer_load_dwordx4 v9, s[8:11], s43 offen lds
  s_add_u32 s43, s37, 129024
  s_add_u32 m0, s42, 28672
  s_nop 0
  buffer_load_dwordx4 v9, s[8:11], s43 offen lds
  s_add_u32 s43, s37, 64
  s_add_u32 m0, s42, 32768
  s_nop 0
  buffer_load_dwordx4 v9, s[8:11], s43 offen lds
  s_add_u32 s43, s37, 18496
  s_add_u32 m0, s42, 36864
  s_nop 0
  buffer_load_dwordx4 v9, s[8:11], s43 offen lds
  s_add_u32 s43, s37, 36928
  s_add_u32 m0, s42, 40960
  s_nop 0
  buffer_load_dwordx4 v9, s[8:11], s43 offen lds
  s_add_u32 s43, s37, 55360
  s_add_u32 m0, s42, 45056
  s_nop 0
  buffer_load_dwordx4 v9, s[8:11], s43 offen lds
  s_add_u32 s43, s37, 73792
  s_add_u32 m0, s42, 49152
  s_nop 0
  buffer_load_dwordx4 v9, s[8:11], s43 offen lds
  s_add_u32 s43, s37, 92224
  s_add_u32 m0, s42, 53248
  s_nop 0
  buffer_load_dwordx4 v9, s[8:11], s43 offen lds
  s_add_u32 s43, s37, 110656
  s_add_u32 m0, s42, 57344
  s_nop 0
  buffer_load_dwordx4 v9, s[8:11], s43 offen lds
  s_add_u32 s43, s37, 129088
  s_add_u32 m0, s42, 61440
  s_nop 0
  buffer_load_dwordx4 v9, s[8:11], s43 offen lds
  s_add_u32 s43, s37, 128
  s_add_u32 m0, s42, 65536
  s_nop 0
  buffer_load_dwordx4 v9, s[8:11], s43 offen lds
  s_add_u32 s43, s37, 18560
  s_add_u32 m0, s42, 69632
  s_nop 0
  buffer_load_dwordx4 v9, s[8:11], s43 offen lds
  s_add_u32 s43, s37, 36992
  s_add_u32 m0, s42, 73728
  s_nop 0
  buffer_load_dwordx4 v9, s[8:11], s43 offen lds
  s_add_u32 s43, s37, 55424
  s_add_u32 m0, s42, 77824
  s_nop 0
  buffer_load_dwordx4 v9, s[8:11], s43 offen lds
  s_add_u32 s43, s37, 73856
  s_add_u32 m0, s42, 81920
  s_nop 0
  buffer_load_dwordx4 v9, s[8:11], s43 offen lds
  s_add_u32 s43, s37, 92288
  s_add_u32 m0, s42, 86016
  s_nop 0
  buffer_load_dwordx4 v9, s[8:11], s43 offen lds
  s_add_u32 s43, s37, 110720
  s_add_u32 m0, s42, 90112
  s_nop 0
  buffer_load_dwordx4 v9, s[8:11], s43 offen lds
  s_add_u32 s43, s37, 129152
  s_add_u32 m0, s42, 94208
  s_nop 0
  buffer_load_dwordx4 v9, s[8:11], s43 offen lds
  s_waitcnt vmcnt(20) lgkmcnt(0)
  s_barrier
  v_add_u32 v60, 0, v10
  ds_read_b64_tr_b16 a[144:145], v60 offset:0
  ds_read_b64_tr_b16 a[146:147], v60 offset:4096
  v_add_u32 v61, 0, v11
  ds_read_b64_tr_b16 a[160:161], v61 offset:0
  ds_read_b64_tr_b16 a[162:163], v61 offset:4096
  ds_read_b64_tr_b16 a[148:149], v60 offset:8192
  ds_read_b64_tr_b16 a[150:151], v60 offset:12288
  ds_read_b64_tr_b16 a[164:165], v61 offset:8192
  ds_read_b64_tr_b16 a[166:167], v61 offset:12288
  s_waitcnt vmcnt(16) lgkmcnt(0)
  s_barrier
  s_add_u32 s43, s37, 192
  s_add_u32 m0, s42, 98304
  s_nop 0
  buffer_load_dwordx4 v9, s[8:11], s43 offen lds
  s_add_u32 s43, s37, 18624
  s_add_u32 m0, s42, 102400
  s_nop 0
  buffer_load_dwordx4 v9, s[8:11], s43 offen lds
  s_add_u32 s43, s37, 37056
  s_add_u32 m0, s42, 106496
  s_nop 0
  buffer_load_dwordx4 v9, s[8:11], s43 offen lds
  s_add_u32 s43, s37, 55488
  s_add_u32 m0, s42, 110592
  s_nop 0
  buffer_load_dwordx4 v9, s[8:11], s43 offen lds
  v_add_u32 v60, 16384, v10
  ds_read_b64_tr_b16 a[152:153], v60 offset:0
  ds_read_b64_tr_b16 a[154:155], v60 offset:4096
  v_add_u32 v61, 16384, v11
  ds_read_b64_tr_b16 a[168:169], v61 offset:0
  ds_read_b64_tr_b16 a[170:171], v61 offset:4096
  ds_read_b64_tr_b16 a[156:157], v60 offset:8192
  ds_read_b64_tr_b16 a[158:159], v60 offset:12288
  ds_read_b64_tr_b16 a[172:173], v61 offset:8192
  ds_read_b64_tr_b16 a[174:175], v61 offset:12288
  s_waitcnt vmcnt(16) lgkmcnt(0)
  s_barrier
  s_add_u32 s43, s37, 73920
  s_add_u32 m0, s42, 114688
  s_nop 0
  buffer_load_dwordx4 v9, s[8:11], s43 offen lds
  s_add_u32 s43, s37, 92352
  s_add_u32 m0, s42, 118784
  s_nop 0
  buffer_load_dwordx4 v9, s[8:11], s43 offen lds
  s_add_u32 s43, s37, 110784
  s_add_u32 m0, s42, 122880
  s_nop 0
  buffer_load_dwordx4 v9, s[8:11], s43 offen lds
  s_add_u32 s43, s37, 129216
  s_add_u32 m0, s42, 126976
  s_nop 0
  buffer_load_dwordx4 v9, s[8:11], s43 offen lds
  v_add_u32 v60, 32768, v10
  ds_read_b64_tr_b16 a[176:177], v60 offset:0
  ds_read_b64_tr_b16 a[178:179], v60 offset:4096
  v_add_u32 v61, 32768, v11
  ds_read_b64_tr_b16 a[192:193], v61 offset:0
  ds_read_b64_tr_b16 a[194:195], v61 offset:4096
  ds_read_b64_tr_b16 a[180:181], v60 offset:8192
  ds_read_b64_tr_b16 a[182:183], v60 offset:12288
  ds_read_b64_tr_b16 a[196:197], v61 offset:8192
  ds_read_b64_tr_b16 a[198:199], v61 offset:12288
  s_waitcnt vmcnt(16) lgkmcnt(0)
  s_barrier
  s_add_u32 s43, s37, 256
  s_add_u32 m0, s42, 131072
  s_nop 0
  buffer_load_dwordx4 v9, s[8:11], s43 offen lds
  s_add_u32 s43, s37, 18688
  s_add_u32 m0, s42, 135168
  s_nop 0
  buffer_load_dwordx4 v9, s[8:11], s43 offen lds
  s_add_u32 s43, s37, 37120
  s_add_u32 m0, s42, 139264
  s_nop 0
  buffer_load_dwordx4 v9, s[8:11], s43 offen lds
  s_add_u32 s43, s37, 55552
  s_add_u32 m0, s42, 143360
  s_nop 0
  buffer_load_dwordx4 v9, s[8:11], s43 offen lds
  v_add_u32 v60, 49152, v10
  ds_read_b64_tr_b16 a[184:185], v60 offset:0
  ds_read_b64_tr_b16 a[186:187], v60 offset:4096
  v_add_u32 v61, 49152, v11
  ds_read_b64_tr_b16 a[200:201], v61 offset:0
  ds_read_b64_tr_b16 a[202:203], v61 offset:4096
  ds_read_b64_tr_b16 a[188:189], v60 offset:8192
  ds_read_b64_tr_b16 a[190:191], v60 offset:12288
  ds_read_b64_tr_b16 a[204:205], v61 offset:8192
  ds_read_b64_tr_b16 a[206:207], v61 offset:12288
  s_waitcnt vmcnt(16) lgkmcnt(0)
  s_barrier
  s_add_u32 s43, s37, 73984
  s_add_u32 m0, s42, 0
  s_nop 0
  buffer_load_dwordx4 v9, s[8:11], s43 offen lds
  s_add_u32 s43, s37, 92416
  s_add_u32 m0, s42, 4096
  s_nop 0
  buffer_load_dwordx4 v9, s[8:11], s43 offen lds
  s_add_u32 s43, s37, 110848
  s_add_u32 m0, s42, 8192
  s_nop 0
  buffer_load_dwordx4 v9, s[8:11], s43 offen lds
  s_add_u32 s43, s37, 129280
  s_add_u32 m0, s42, 12288
  s_nop 0
  buffer_load_dwordx4 v9, s[8:11], s43 offen lds
  v_add_u32 v60, 65536, v10
  ds_read_b64_tr_b16 a[208:209], v60 offset:0
  ds_read_b64_tr_b16 a[210:211], v60 offset:4096
  v_add_u32 v61, 65536, v11
  ds_read_b64_tr_b16 a[224:225], v61 offset:0
  ds_read_b64_tr_b16 a[226:227], v61 offset:4096
  ds_read_b64_tr_b16 a[212:213], v60 offset:8192
  ds_read_b64_tr_b16 a[214:215], v60 offset:12288
  ds_read_b64_tr_b16 a[228:229], v61 offset:8192
  ds_read_b64_tr_b16 a[230:231], v61 offset:12288
  s_waitcnt vmcnt(16) lgkmcnt(0)
  s_barrier
  v_add_u32 v60, 81920, v10
  ds_read_b64_tr_b16 a[216:217], v60 offset:0
  ds_read_b64_tr_b16 a[218:219], v60 offset:4096
  v_add_u32 v61, 81920, v11
  ds_read_b64_tr_b16 a[232:233], v61 offset:0
  ds_read_b64_tr_b16 a[234:235], v61 offset:4096
  ds_read_b64_tr_b16 a[220:221], v60 offset:8192
  ds_read_b64_tr_b16 a[222:223], v60 offset:12288
  ds_read_b64_tr_b16 a[236:237], v61 offset:8192
  ds_read_b64_tr_b16 a[238:239], v61 offset:12288
  s_waitcnt vmcnt(12) lgkmcnt(0)
  s_barrier
  v_add_u32 v60, 98304, v10
  ds_read_b64_tr_b16 a[240:241], v60 offset:0
  ds_read_b64_tr_b16 a[242:243], v60 offset:4096
  v_add_u32 v61, 98304, v11
  ds_read_b64_tr_b16 v[224:225], v61 offset:0
  ds_read_b64_tr_b16 v[226:227], v61 offset:4096
  ds_read_b64_tr_b16 a[244:245], v60 offset:8192
  ds_read_b64_tr_b16 a[246:247], v60 offset:12288
  ds_read_b64_tr_b16 v[228:229], v61 offset:8192
  ds_read_b64_tr_b16 v[230:231], v61 offset:12288
  s_waitcnt vmcnt(8) lgkmcnt(0)
  s_barrier
  v_add_u32 v60, 114688, v10
  ds_read_b64_tr_b16 a[248:249], v60 offset:0
  ds_read_b64_tr_b16 a[250:251], v60 offset:4096
  v_add_u32 v61, 114688, v11
  ds_read_b64_tr_b16 v[232:233], v61 offset:0
  ds_read_b64_tr_b16 v[234:235], v61 offset:4096
  ds_read_b64_tr_b16 a[252:253], v60 offset:8192
  ds_read_b64_tr_b16 a[254:255], v60 offset:12288
  ds_read_b64_tr_b16 v[236:237], v61 offset:8192
  ds_read_b64_tr_b16 v[238:239], v61 offset:12288
  s_waitcnt vmcnt(4) lgkmcnt(0)
  s_barrier
  v_add_u32 v60, 131072, v10
  ds_read_b64_tr_b16 v[240:241], v60 offset:0
  ds_read_b64_tr_b16 v[242:243], v60 offset:4096
  ds_read_b64_tr_b16 v[244:245], v60 offset:8192
  ds_read_b64_tr_b16 v[246:247], v60 offset:12288
  s_waitcnt vmcnt(0) lgkmcnt(0)
  s_barrier
  v_add_u32 v60, 0, v10
  ds_read_b64_tr_b16 v[248:249], v60 offset:0
  ds_read_b64_tr_b16 v[250:251], v60 offset:4096
  ds_read_b64_tr_b16 v[252:253], v60 offset:8192
  ds_read_b64_tr_b16 v[254:255], v60 offset:12288
  s_waitcnt lgkmcnt(0)
  s_barrier
  s_load_dwordx2 s[32:33], s[0:1], 96
  s_waitcnt lgkmcnt(0)
  s_mov_b32 s8, s32
  s_and_b32 s9, s33, 0xffff
  s_mov_b32 s10, 2359296
  s_mov_b32 s11, 0x20000
  s_mov_b32 s46, -1
  s_mov_b32 s47, 0
  s_mov_b32 s40, 0x3e0293ee
  s_mov_b32 s41, 0x3e0293ee
  s_and_b32 s23, s17, 1
  s_lshl_b32 s23, s23, 10
  v_add_u32 v36, s23, v3
  s_lshl_b32 s48, s16, 7
  s_add_u32 s48, s48, 2166784
  s_mov_b32 s19, 0
  s_mov_b32 s20, s18
  s_mov_b32 s37, 22528
  s_mul_i32 s23, s20, 36864
  s_mul_i32 s24, s17, 9216
  s_add_u32 s23, s23, s24
  s_add_u32 s23, s23, 54525952
  s_add_u32 s24, s24, s37
  s_add_u32 m0, s24, 0
  s_nop 0
  buffer_load_dwordx4 v3, s[4:7], s23 offen offset:0 sc1 lds
  s_add_u32 m0, s24, 0
  s_nop 0
  buffer_load_dwordx4 v3, s[4:7], s23 offen offset:1024 sc1 lds
  s_add_u32 m0, s24, 0
  s_nop 0
  buffer_load_dwordx4 v3, s[4:7], s23 offen offset:2048 sc1 lds
  s_add_u32 m0, s24, 0
  s_nop 0
  buffer_load_dwordx4 v3, s[4:7], s23 offen offset:3072 sc1 lds
  s_add_u32 m0, s24, 4096
  s_add_u32 s23, s23, 4096
  buffer_load_dwordx4 v3, s[4:7], s23 offen offset:0 sc1 lds
  s_add_u32 m0, s24, 4096
  s_nop 0
  buffer_load_dwordx4 v3, s[4:7], s23 offen offset:1024 sc1 lds
  s_add_u32 m0, s24, 4096
  s_nop 0
  buffer_load_dwordx4 v3, s[4:7], s23 offen offset:2048 sc1 lds
  s_add_u32 m0, s24, 4096
  s_nop 0
  buffer_load_dwordx4 v3, s[4:7], s23 offen offset:3072 sc1 lds
  s_add_u32 m0, s24, 8192
  s_add_u32 s23, s23, 4096
  buffer_load_dwordx4 v3, s[4:7], s23 offen offset:0 sc1 lds
pd_loop_174:
  v_add_u32 v8, s37, v3
  s_waitcnt vmcnt(0)
  s_barrier
  s_add_u32 s39, s19, 1
  s_cmp_lt_u32 s39, s21
  s_cbranch_scc0 pd_nn_175
  s_add_u32 s39, s20, 7
  s_xor_b32 s25, s37, 45056
  s_mul_i32 s23, s39, 36864
  s_mul_i32 s24, s17, 9216
  s_add_u32 s23, s23, s24
  s_add_u32 s23, s23, 54525952
  s_add_u32 s24, s24, s25
  s_add_u32 m0, s24, 0
  s_nop 0
  buffer_load_dwordx4 v3, s[4:7], s23 offen offset:0 sc1 lds
  s_add_u32 m0, s24, 0
  s_nop 0
  buffer_load_dwordx4 v3, s[4:7], s23 offen offset:1024 sc1 lds
  s_add_u32 m0, s24, 0
  s_nop 0
  buffer_load_dwordx4 v3, s[4:7], s23 offen offset:2048 sc1 lds
  s_add_u32 m0, s24, 0
  s_nop 0
  buffer_load_dwordx4 v3, s[4:7], s23 offen offset:3072 sc1 lds
  s_add_u32 m0, s24, 4096
  s_add_u32 s23, s23, 4096
  buffer_load_dwordx4 v3, s[4:7], s23 offen offset:0 sc1 lds
  s_add_u32 m0, s24, 4096
  s_nop 0
  buffer_load_dwordx4 v3, s[4:7], s23 offen offset:1024 sc1 lds
  s_add_u32 m0, s24, 4096
  s_nop 0
  buffer_load_dwordx4 v3, s[4:7], s23 offen offset:2048 sc1 lds
  s_add_u32 m0, s24, 4096
  s_nop 0
  buffer_load_dwordx4 v3, s[4:7], s23 offen offset:3072 sc1 lds
  s_add_u32 m0, s24, 8192
  s_add_u32 s23, s23, 4096
  buffer_load_dwordx4 v3, s[4:7], s23 offen offset:0 sc1 lds
pd_nn_175:
  s_lshl_b32 s49, s20, 5
  s_add_u32 s49, s49, s16
  s_lshl_b32 s50, s49, 11
  s_lshl_b32 s49, s49, 13
  s_add_u32 s23, s49, 4194304
  buffer_load_dwordx4 v[128:131], v3, s[4:7], s23 offen offset:0 sc1
  buffer_load_dwordx4 v[132:135], v3, s[4:7], s23 offen offset:1024 sc1
  buffer_load_dwordx4 v[136:139], v3, s[4:7], s23 offen offset:2048 sc1
  buffer_load_dwordx4 v[140:143], v3, s[4:7], s23 offen offset:3072 sc1
  s_add_u32 s23, s23, 4096
  buffer_load_dwordx4 v[144:147], v3, s[4:7], s23 offen offset:0 sc1
  buffer_load_dwordx4 v[148:151], v3, s[4:7], s23 offen offset:1024 sc1
  buffer_load_dwordx4 v[152:155], v3, s[4:7], s23 offen offset:2048 sc1
  buffer_load_dwordx4 v[156:159], v3, s[4:7], s23 offen offset:3072 sc1
  s_lshr_b32 s24, s17, 1
  s_lshl_b32 s24, s24, 12
  s_add_u32 s23, s49, s24
  s_add_u32 s23, s23, 20971520
  buffer_load_dwordx4 v[160:163], v3, s[4:7], s23 offen offset:0 sc1
  buffer_load_dwordx4 v[164:167], v3, s[4:7], s23 offen offset:1024 sc1
  buffer_load_dwordx4 v[168:171], v3, s[4:7], s23 offen offset:2048 sc1
  buffer_load_dwordx4 v[172:175], v3, s[4:7], s23 offen offset:3072 sc1
  ds_read_b128 v[96:99], v8 offset:0
  ds_read_b128 v[100:103], v8 offset:1024
  ds_read_b128 v[104:107], v8 offset:2048
  ds_read_b128 v[108:111], v8 offset:3072
  s_waitcnt lgkmcnt(3)
  v_mfma_f32_32x32x16_bf16 v[64:79], a[0:3], v[96:99], 0
  ds_read_b128 v[96:99], v8 offset:4096
  s_waitcnt lgkmcnt(3)
  v_mfma_f32_32x32x16_bf16 v[64:79], a[4:7], v[100:103], v[64:79]
  ds_read_b128 v[100:103], v8 offset:5120
  s_waitcnt lgkmcnt(3)
  v_mfma_f32_32x32x16_bf16 v[64:79], a[8:11], v[104:107], v[64:79]
  ds_read_b128 v[104:107], v8 offset:6144
  s_waitcnt lgkmcnt(3)
  v_mfma_f32_32x32x16_bf16 v[64:79], a[12:15], v[108:111], v[64:79]
  ds_read_b128 v[108:111], v8 offset:7168
  s_waitcnt lgkmcnt(3)
  v_mfma_f32_32x32x16_bf16 v[64:79], a[16:19], v[96:99], v[64:79]
  ds_read_b128 v[96:99], v8 offset:8192
  s_waitcnt lgkmcnt(3)
  v_mfma_f32_32x32x16_bf16 v[64:79], a[20:23], v[100:103], v[64:79]
  ds_read_b128 v[100:103], v8 offset:9216
  s_waitcnt lgkmcnt(3)
  v_mfma_f32_32x32x16_bf16 v[64:79], a[24:27], v[104:107], v[64:79]
  ds_read_b128 v[104:107], v8 offset:10240
  s_waitcnt lgkmcnt(3)
  v_mfma_f32_32x32x16_bf16 v[64:79], a[28:31], v[108:111], v[64:79]
  ds_read_b128 v[108:111], v8 offset:11264
  s_waitcnt lgkmcnt(3)
  v_mfma_f32_32x32x16_bf16 v[64:79], a[32:35], v[96:99], v[64:79]
  ds_read_b128 v[96:99], v8 offset:12288
  s_waitcnt lgkmcnt(3)
  v_mfma_f32_32x32x16_bf16 v[64:79], a[36:39], v[100:103], v[64:79]
  ds_read_b128 v[100:103], v8 offset:13312
  s_waitcnt lgkmcnt(3)
  v_mfma_f32_32x32x16_bf16 v[64:79], a[40:43], v[104:107], v[64:79]
  ds_read_b128 v[104:107], v8 offset:14336
  s_waitcnt lgkmcnt(3)
  v_mfma_f32_32x32x16_bf16 v[64:79], a[44:47], v[108:111], v[64:79]
  ds_read_b128 v[108:111], v8 offset:15360
  s_waitcnt lgkmcnt(3)
  v_mfma_f32_32x32x16_bf16 v[64:79], a[48:51], v[96:99], v[64:79]
  ds_read_b128 v[96:99], v8 offset:16384
  s_waitcnt lgkmcnt(3)
  v_mfma_f32_32x32x16_bf16 v[64:79], a[52:55], v[100:103], v[64:79]
  ds_read_b128 v[100:103], v8 offset:17408
  s_waitcnt lgkmcnt(3)
  v_mfma_f32_32x32x16_bf16 v[64:79], a[56:59], v[104:107], v[64:79]
  ds_read_b128 v[104:107], v8 offset:18432
  s_waitcnt lgkmcnt(3)
  v_mfma_f32_32x32x16_bf16 v[64:79], a[60:63], v[108:111], v[64:79]
  ds_read_b128 v[108:111], v8 offset:19456
  s_waitcnt lgkmcnt(3)
  v_mfma_f32_32x32x16_bf16 v[64:79], a[64:67], v[96:99], v[64:79]
  ds_read_b128 v[96:99], v8 offset:20480
  s_waitcnt lgkmcnt(3)
  v_mfma_f32_32x32x16_bf16 v[64:79], a[68:71], v[100:103], v[64:79]
  ds_read_b128 v[100:103], v8 offset:21504
  s_waitcnt lgkmcnt(3)
  v_mfma_f32_32x32x16_bf16 v[64:79], a[72:75], v[104:107], v[64:79]
  ds_read_b128 v[104:107], v8 offset:22528
  s_waitcnt lgkmcnt(3)
  v_mfma_f32_32x32x16_bf16 v[64:79], a[76:79], v[108:111], v[64:79]
  ds_read_b128 v[108:111], v8 offset:23552
  s_waitcnt lgkmcnt(3)
  v_mfma_f32_32x32x16_bf16 v[64:79], a[80:83], v[96:99], v[64:79]
  ds_read_b128 v[96:99], v8 offset:24576
  s_waitcnt lgkmcnt(3)
  v_mfma_f32_32x32x16_bf16 v[64:79], a[84:87], v[100:103], v[64:79]
  ds_read_b128 v[100:103], v8 offset:25600
  s_waitcnt lgkmcnt(3)
  v_mfma_f32_32x32x16_bf16 v[64:79], a[88:91], v[104:107], v[64:79]
  ds_read_b128 v[104:107], v8 offset:26624
  s_waitcnt lgkmcnt(3)
  v_mfma_f32_32x32x16_bf16 v[64:79], a[92:95], v[108:111], v[64:79]
  ds_read_b128 v[108:111], v8 offset:27648
  s_waitcnt lgkmcnt(3)
  v_mfma_f32_32x32x16_bf16 v[64:79], a[96:99], v[96:99], v[64:79]
  ds_read_b128 v[96:99], v8 offset:28672
  s_waitcnt lgkmcnt(3)
  v_mfma_f32_32x32x16_bf16 v[64:79], a[100:103], v[100:103], v[64:79]
  ds_read_b128 v[100:103], v8 offset:29696
  s_waitcnt lgkmcnt(3)
  v_mfma_f32_32x32x16_bf16 v[64:79], a[104:107], v[104:107], v[64:79]
  ds_read_b128 v[104:107], v8 offset:30720
  s_waitcnt lgkmcnt(3)
  v_mfma_f32_32x32x16_bf16 v[64:79], a[108:111], v[108:111], v[64:79]
  ds_read_b128 v[108:111], v8 offset:31744
  s_waitcnt lgkmcnt(3)
  v_mfma_f32_32x32x16_bf16 v[64:79], a[112:115], v[96:99], v[64:79]
  ds_read_b128 v[96:99], v8 offset:32768
  s_waitcnt lgkmcnt(3)
  v_mfma_f32_32x32x16_bf16 v[64:79], a[116:119], v[100:103], v[64:79]
  ds_read_b128 v[100:103], v8 offset:33792
  s_waitcnt lgkmcnt(3)
  v_mfma_f32_32x32x16_bf16 v[64:79], a[120:123], v[104:107], v[64:79]
  ds_read_b128 v[104:107], v8 offset:34816
  s_waitcnt lgkmcnt(3)
  v_mfma_f32_32x32x16_bf16 v[64:79], a[124:127], v[108:111], v[64:79]
  ds_read_b128 v[108:111], v8 offset:35840
  s_waitcnt lgkmcnt(3)
  v_mfma_f32_32x32x16_bf16 v[64:79], a[128:131], v[96:99], v[64:79]
  s_waitcnt lgkmcnt(2)
  v_mfma_f32_32x32x16_bf16 v[64:79], a[132:135], v[100:103], v[64:79]
  s_waitcnt lgkmcnt(1)
  v_mfma_f32_32x32x16_bf16 v[64:79], a[136:139], v[104:107], v[64:79]
  s_waitcnt lgkmcnt(0)
  v_mfma_f32_32x32x16_bf16 v[64:79], a[140:143], v[108:111], v[64:79]
  s_nop 11
  v_cvt_pk_bf16_f32 v112, v64, v65
  v_cvt_pk_bf16_f32 v113, v66, v67
  v_cvt_pk_bf16_f32 v114, v68, v69
  v_cvt_pk_bf16_f32 v115, v70, v71
  ds_write_b128 v12, v[112:115] offset:0
  v_cvt_pk_bf16_f32 v116, v72, v73
  v_cvt_pk_bf16_f32 v117, v74, v75
  v_cvt_pk_bf16_f32 v118, v76, v77
  v_cvt_pk_bf16_f32 v119, v78, v79
  ds_write_b128 v12, v[116:119] offset:512
  s_lshl_b32 s24, s17, 9
  s_add_u32 s54, s50, s24
  s_add_u32 s54, s54, 37748736
  s_lshr_b32 s24, s17, 1
  s_lshl_b32 s24, s24, 10
  s_add_u32 s55, s50, s24
  s_add_u32 s55, s55, 46137344
  s_cmp_eq_u32 s20, 63
  s_cbranch_scc1 pd_ft_176
  s_add_u32 s39, s20, 1
  s_cmp_eq_u32 s17, 0
  s_cbranch_scc0 wws_180
  v_mov_b32 v60, 0
  s_mov_b32 s23, 0
www_178:
  buffer_load_dword v61, v60, s[4:7], s48 offen sc1
  s_add_u32 s23, s23, 1
  s_waitcnt vmcnt(0)
  v_readfirstlane_b32 s24, v61
  s_nop 3
  s_cmp_ge_u32 s24, s39
  s_cbranch_scc1 wwd_179
  s_add_u32 s24, s24, 1
  s_cmp_ge_u32 s24, s39
  s_cbranch_scc1 wwn_181
  s_sleep 24
  s_branch wwc_182
wwn_181:
  s_sleep 3
wwc_182:
  s_cmp_lg_u32 s44, 0
  s_cbranch_scc1 wwd_179
  s_cmp_lt_u32 s23, 0x40000
  s_cbranch_scc1 www_178
  s_mov_b32 s44, 1
wwd_179:
wws_180:
  s_barrier
  buffer_load_dwordx2 v[120:121], v23, s[4:7], s54 offen sc1
  buffer_load_dwordx2 v[176:177], v23, s[4:7], s55 offen sc1
  buffer_load_dwordx2 v[178:179], v23, s[4:7], s55 offen offset:512 sc1
  s_waitcnt vmcnt(0)
  s_branch pd_j_177
pd_ft_176:
  s_mov_b32 s23, 0
pd_ft_176_p:
  buffer_load_dwordx2 v[120:121], v23, s[4:7], s54 offen sc1
  buffer_load_dwordx2 v[176:177], v23, s[4:7], s55 offen sc1
  buffer_load_dwordx2 v[178:179], v23, s[4:7], s55 offen offset:512 sc1
  s_add_u32 s23, s23, 1
  s_waitcnt vmcnt(0)
  v_max3_u32 v60, v120, v121, v176
  v_max3_u32 v61, v177, v178, v179
  v_max_u32 v60, v60, v61
  v_cmp_eq_u32 vcc, -1, v60
  s_cbranch_vccz pd_j_177
  s_cmp_lg_u32 s44, 0
  s_cbranch_scc1 pd_j_177
  s_cmp_lt_u32 s23, 0x40000
  s_cbranch_scc1 pd_ft_176_p
  s_mov_b32 s44, 1
pd_j_177:
  ds_write2_b32 v18, v120, v120 offset0:0 offset1:1
  ds_write2_b32 v18, v121, v121 offset0:128 offset1:129
  s_waitcnt lgkmcnt(0)
  s_barrier
  ds_read_b128 v[64:67], v36 offset:0
  ds_read_b64_tr_b16 v[80:81], v19 offset:0
  ds_read_b64_tr_b16 v[82:83], v19 offset:256
  ds_read_b128 v[68:71], v36 offset:2048
  ds_read_b64_tr_b16 v[84:85], v19 offset:1024
  ds_read_b64_tr_b16 v[86:87], v19 offset:1280
  ds_read_b128 v[72:75], v36 offset:4096
  ds_read_b64_tr_b16 v[88:89], v19 offset:2048
  ds_read_b64_tr_b16 v[90:91], v19 offset:2304
  ds_read_b128 v[76:79], v36 offset:6144
  ds_read_b64_tr_b16 v[92:93], v19 offset:3072
  ds_read_b64_tr_b16 v[94:95], v19 offset:3328
  s_waitcnt lgkmcnt(11)
  v_mfma_f32_16x16x32_bf16 v[96:99], v[128:131], v[64:67], 0
  v_mfma_f32_16x16x32_bf16 v[100:103], v[132:135], v[64:67], 0
  s_waitcnt lgkmcnt(9)
  v_mfma_f32_16x16x32_bf16 v[104:107], v[80:83], v[64:67], 0
  s_waitcnt lgkmcnt(8)
  v_mfma_f32_16x16x32_bf16 v[96:99], v[136:139], v[68:71], v[96:99]
  v_mfma_f32_16x16x32_bf16 v[100:103], v[140:143], v[68:71], v[100:103]
  s_waitcnt lgkmcnt(6)
  v_mfma_f32_16x16x32_bf16 v[104:107], v[84:87], v[68:71], v[104:107]
  s_waitcnt lgkmcnt(5)
  v_mfma_f32_16x16x32_bf16 v[96:99], v[144:147], v[72:75], v[96:99]
  v_mfma_f32_16x16x32_bf16 v[100:103], v[148:151], v[72:75], v[100:103]
  s_waitcnt lgkmcnt(3)
  v_mfma_f32_16x16x32_bf16 v[104:107], v[88:91], v[72:75], v[104:107]
  s_waitcnt lgkmcnt(2)
  v_mfma_f32_16x16x32_bf16 v[96:99], v[152:155], v[76:79], v[96:99]
  v_mfma_f32_16x16x32_bf16 v[100:103], v[156:159], v[76:79], v[100:103]
  s_waitcnt lgkmcnt(0)
  v_mfma_f32_16x16x32_bf16 v[104:107], v[92:95], v[76:79], v[104:107]
  v_mov_b32 v108, 0x3f803f80
  v_mov_b32 v109, 0x3f803f80
  v_mov_b32 v110, 0x3f803f80
  v_mov_b32 v111, 0x3f803f80
  v_mov_b32 v113, 0
  v_mov_b32 v114, 0
  v_add_f32 v96, v96, v28
  v_add_f32 v100, v100, v32
  v_add_f32 v97, v97, v29
  v_add_f32 v101, v101, v33
  v_add_f32 v98, v98, v30
  v_add_f32 v102, v102, v34
  v_add_f32 v99, v99, v31
  v_add_f32 v103, v103, v35
  v_max3_f32 v61, v96, v97, v98
  v_max3_f32 v62, v100, v101, v102
  v_max3_f32 v61, v61, v99, v103
  v_max_f32 v61, v61, v62
  v_max3_f32 v61, v61, v104, v105
  v_mov_b32 v62, v61
  s_nop 1
  v_permlane16_swap_b32 v61, v62
  v_max_f32 v61, v61, v62
  v_mov_b32 v62, v61
  s_nop 1
  v_permlane32_swap_b32 v61, v62
  v_max_f32 v61, v61, v62
  v_mul_f32 v62, s40, v61
  v_pk_fma_f32 v[96:97], v[96:97], s[40:41], v[62:63] op_sel_hi:[1,1,0] neg_lo:[0,0,1] neg_hi:[0,0,1]
  v_pk_fma_f32 v[98:99], v[98:99], s[40:41], v[62:63] op_sel_hi:[1,1,0] neg_lo:[0,0,1] neg_hi:[0,0,1]
  v_pk_fma_f32 v[100:101], v[100:101], s[40:41], v[62:63] op_sel_hi:[1,1,0] neg_lo:[0,0,1] neg_hi:[0,0,1]
  v_pk_fma_f32 v[102:103], v[102:103], s[40:41], v[62:63] op_sel_hi:[1,1,0] neg_lo:[0,0,1] neg_hi:[0,0,1]
  v_pk_fma_f32 v[104:105], v[104:105], s[40:41], v[62:63] op_sel_hi:[1,1,0] neg_lo:[0,0,1] neg_hi:[0,0,1]
  v_exp_f32 v96, v96
  v_exp_f32 v97, v97
  v_exp_f32 v98, v98
  v_exp_f32 v99, v99
  v_exp_f32 v100, v100
  v_exp_f32 v101, v101
  v_exp_f32 v102, v102
  v_exp_f32 v103, v103
  v_exp_f32 v104, v104
  v_exp_f32 v105, v105
  v_cvt_pk_bf16_f32 v116, v96, v97
  v_cvt_pk_bf16_f32 v117, v98, v99
  v_cvt_pk_bf16_f32 v118, v100, v101
  v_cvt_pk_bf16_f32 v119, v102, v103
  v_cvt_pk_bf16_f32 v112, v104, v105
  v_cvt_pk_bf16_f32 v115, v104, v105
  v_mfma_f32_16x16x32_bf16 v[80:83], v[108:111], v[116:119], 0
  v_mfma_f32_16x16x32_bf16 v[64:67], v[160:163], v[116:119], 0
  v_mfma_f32_16x16x32_bf16 v[68:71], v[164:167], v[116:119], 0
  v_mfma_f32_16x16x32_bf16 v[72:75], v[168:171], v[116:119], 0
  v_mfma_f32_16x16x32_bf16 v[76:79], v[172:175], v[116:119], 0
  v_mfma_f32_16x16x16_bf16 v[80:83], v[108:109], v[112:113], v[80:83]
  v_mfma_f32_16x16x16_bf16 v[64:67], v[176:177], v[112:113], v[64:67]
  v_mfma_f32_16x16x16_bf16 v[68:71], v[176:177], v[114:115], v[68:71]
  v_mfma_f32_16x16x16_bf16 v[72:75], v[178:179], v[112:113], v[72:75]
  v_mfma_f32_16x16x16_bf16 v[76:79], v[178:179], v[114:115], v[76:79]
  s_nop 7
  v_rcp_f32 v61, v80
  s_nop 0
  v_mul_f32 v64, v61, v64
  v_mul_f32 v65, v61, v65
  v_mul_f32 v66, v61, v66
  v_mul_f32 v67, v61, v67
  v_mul_f32 v68, v61, v68
  v_mul_f32 v69, v61, v69
  v_mul_f32 v70, v61, v70
  v_mul_f32 v71, v61, v71
  v_mul_f32 v72, v61, v72
  v_mul_f32 v73, v61, v73
  v_mul_f32 v74, v61, v74
  v_mul_f32 v75, v61, v75
  v_mul_f32 v76, v61, v76
  v_mul_f32 v77, v61, v77
  v_mul_f32 v78, v61, v78
  v_mul_f32 v79, v61, v79
  v_cvt_pk_bf16_f32 v84, v64, v65
  v_cvt_pk_bf16_f32 v85, v66, v67
  v_cvt_pk_bf16_f32 v86, v68, v69
  v_cvt_pk_bf16_f32 v87, v70, v71
  ds_write_b128 v13, v[84:87] offset:0
  v_cvt_pk_bf16_f32 v88, v72, v73
  v_cvt_pk_bf16_f32 v89, v74, v75
  v_cvt_pk_bf16_f32 v90, v76, v77
  v_cvt_pk_bf16_f32 v91, v78, v79
  ds_write_b128 v13, v[88:91] offset:1024
  s_waitcnt lgkmcnt(0)
  s_barrier
  s_mul_i32 s36, s18, 2359296
  s_and_b32 s23, s19, 1
  s_mul_i32 s23, s23, 1179648
  s_add_u32 s36, s36, s23
  s_cmp_eq_u32 s20, 63
  s_cselect_b32 s36, 16515072, s36
  s_add_u32 s36, s36, 67108864
  s_mul_i32 s38, s16, 36864
  s_mul_i32 s23, s17, 9216
  s_add_u32 s38, s38, s23
  s_add_u32 s38, s38, s36
  ds_read_b128 v[100:103], v3 offset:8192
  ds_read_b128 v[104:107], v3 offset:9216
  ds_read_b128 v[108:111], v3 offset:10240
  ds_read_b128 v[112:115], v3 offset:11264
  ds_read_b128 v[132:135], v3 offset:12288
  ds_read_b128 v[136:139], v3 offset:13312
  ds_read_b128 v[140:143], v3 offset:14336
  ds_read_b128 v[144:147], v3 offset:15360
  s_add_u32 s58, s38, 4608
  s_add_u32 s59, s38, 4096
  s_add_u32 s60, s58, 4096
  s_cmp_eq_u32 s22, 0
  s_cbranch_scc0 g2s_183
  s_waitcnt lgkmcnt(7)
  v_mfma_f32_16x16x32_bf16 v[64:67], a[144:147], v[100:103], 0
  v_mfma_f32_16x16x32_bf16 v[68:71], a[160:163], v[100:103], 0
  s_waitcnt lgkmcnt(6)
  v_mfma_f32_16x16x32_bf16 v[64:67], a[148:151], v[104:107], v[64:67]
  v_mfma_f32_16x16x32_bf16 v[68:71], a[164:167], v[104:107], v[68:71]
  s_waitcnt lgkmcnt(5)
  v_mfma_f32_16x16x32_bf16 v[64:67], a[152:155], v[108:111], v[64:67]
  v_mfma_f32_16x16x32_bf16 v[68:71], a[168:171], v[108:111], v[68:71]
  s_waitcnt lgkmcnt(4)
  v_mfma_f32_16x16x32_bf16 v[64:67], a[156:159], v[112:115], v[64:67]
  v_mfma_f32_16x16x32_bf16 v[68:71], a[172:175], v[112:115], v[68:71]
  v_mfma_f32_16x16x32_bf16 v[72:75], a[176:179], v[100:103], 0
  v_mfma_f32_16x16x32_bf16 v[76:79], a[192:195], v[100:103], 0
  s_nop 4
  v_cvt_pk_bf16_f32 v120, v64, v65
  v_cvt_pk_bf16_f32 v121, v66, v67
  v_mfma_f32_16x16x32_bf16 v[72:75], a[180:183], v[104:107], v[72:75]
  v_cvt_pk_bf16_f32 v122, v68, v69
  v_cvt_pk_bf16_f32 v123, v70, v71
  v_mfma_f32_16x16x32_bf16 v[76:79], a[196:199], v[104:107], v[76:79]
  buffer_store_dwordx4 v[120:123], v3, s[4:7], s38 offen offset:0
  v_mfma_f32_16x16x32_bf16 v[72:75], a[184:187], v[108:111], v[72:75]
  v_mfma_f32_16x16x32_bf16 v[76:79], a[200:203], v[108:111], v[76:79]
  v_mfma_f32_16x16x32_bf16 v[72:75], a[188:191], v[112:115], v[72:75]
  v_mfma_f32_16x16x32_bf16 v[76:79], a[204:207], v[112:115], v[76:79]
  v_mfma_f32_16x16x32_bf16 v[80:83], a[208:211], v[100:103], 0
  v_mfma_f32_16x16x32_bf16 v[84:87], a[224:227], v[100:103], 0
  s_nop 4
  v_cvt_pk_bf16_f32 v124, v72, v73
  v_cvt_pk_bf16_f32 v125, v74, v75
  v_mfma_f32_16x16x32_bf16 v[80:83], a[212:215], v[104:107], v[80:83]
  v_cvt_pk_bf16_f32 v126, v76, v77
  v_cvt_pk_bf16_f32 v127, v78, v79
  v_mfma_f32_16x16x32_bf16 v[84:87], a[228:231], v[104:107], v[84:87]
  buffer_store_dwordx4 v[124:127], v3, s[4:7], s38 offen offset:1024
  v_mfma_f32_16x16x32_bf16 v[80:83], a[216:219], v[108:111], v[80:83]
  v_mfma_f32_16x16x32_bf16 v[84:87], a[232:235], v[108:111], v[84:87]
  v_mfma_f32_16x16x32_bf16 v[80:83], a[220:223], v[112:115], v[80:83]
  v_mfma_f32_16x16x32_bf16 v[84:87], a[236:239], v[112:115], v[84:87]
  v_mfma_f32_16x16x32_bf16 v[88:91], a[240:243], v[100:103], 0
  v_mfma_f32_16x16x32_bf16 v[92:95], v[224:227], v[100:103], 0
  s_nop 4
  v_cvt_pk_bf16_f32 v120, v80, v81
  v_cvt_pk_bf16_f32 v121, v82, v83
  v_mfma_f32_16x16x32_bf16 v[88:91], a[244:247], v[104:107], v[88:91]
  v_cvt_pk_bf16_f32 v122, v84, v85
  v_cvt_pk_bf16_f32 v123, v86, v87
  v_mfma_f32_16x16x32_bf16 v[92:95], v[228:231], v[104:107], v[92:95]
  buffer_store_dwordx4 v[120:123], v3, s[4:7], s38 offen offset:2048
  v_mfma_f32_16x16x32_bf16 v[88:91], a[248:251], v[108:111], v[88:91]
  v_mfma_f32_16x16x32_bf16 v[92:95], v[232:235], v[108:111], v[92:95]
  v_mfma_f32_16x16x32_bf16 v[88:91], a[252:255], v[112:115], v[88:91]
  v_mfma_f32_16x16x32_bf16 v[92:95], v[236:239], v[112:115], v[92:95]
  v_mfma_f32_16x16x32_bf16 v[96:99], v[240:243], v[100:103], 0
  v_mfma_f32_16x16x32_bf16 v[96:99], v[244:247], v[104:107], v[96:99]
  s_nop 4
  v_cvt_pk_bf16_f32 v124, v88, v89
  v_cvt_pk_bf16_f32 v125, v90, v91
  v_mfma_f32_16x16x32_bf16 v[96:99], v[248:251], v[108:111], v[96:99]
  v_cvt_pk_bf16_f32 v126, v92, v93
  v_cvt_pk_bf16_f32 v127, v94, v95
  v_mfma_f32_16x16x32_bf16 v[96:99], v[252:255], v[112:115], v[96:99]
  buffer_store_dwordx4 v[124:127], v3, s[4:7], s38 offen offset:3072
  s_waitcnt lgkmcnt(3)
  v_mfma_f32_16x16x32_bf16 v[64:67], a[144:147], v[132:135], 0
  v_mfma_f32_16x16x32_bf16 v[68:71], a[160:163], v[132:135], 0
  s_nop 3
  v_cvt_pk_bf16_f32 v128, v96, v97
  v_cvt_pk_bf16_f32 v129, v98, v99
  s_waitcnt lgkmcnt(2)
  v_mfma_f32_16x16x32_bf16 v[64:67], a[148:151], v[136:139], v[64:67]
  buffer_store_dwordx2 v[128:129], v17, s[4:7], s59 offen
  v_mfma_f32_16x16x32_bf16 v[68:71], a[164:167], v[136:139], v[68:71]
  s_waitcnt lgkmcnt(1)
  v_mfma_f32_16x16x32_bf16 v[64:67], a[152:155], v[140:143], v[64:67]
  v_mfma_f32_16x16x32_bf16 v[68:71], a[168:171], v[140:143], v[68:71]
  s_waitcnt lgkmcnt(0)
  v_mfma_f32_16x16x32_bf16 v[64:67], a[156:159], v[144:147], v[64:67]
  v_mfma_f32_16x16x32_bf16 v[68:71], a[172:175], v[144:147], v[68:71]
  v_mfma_f32_16x16x32_bf16 v[72:75], a[176:179], v[132:135], 0
  v_mfma_f32_16x16x32_bf16 v[76:79], a[192:195], v[132:135], 0
  s_nop 4
  v_cvt_pk_bf16_f32 v124, v64, v65
  v_cvt_pk_bf16_f32 v125, v66, v67
  v_mfma_f32_16x16x32_bf16 v[72:75], a[180:183], v[136:139], v[72:75]
  v_cvt_pk_bf16_f32 v126, v68, v69
  v_cvt_pk_bf16_f32 v127, v70, v71
  v_mfma_f32_16x16x32_bf16 v[76:79], a[196:199], v[136:139], v[76:79]
  buffer_store_dwordx4 v[124:127], v3, s[4:7], s58 offen offset:0
  v_mfma_f32_16x16x32_bf16 v[72:75], a[184:187], v[140:143], v[72:75]
  v_mfma_f32_16x16x32_bf16 v[76:79], a[200:203], v[140:143], v[76:79]
  v_mfma_f32_16x16x32_bf16 v[72:75], a[188:191], v[144:147], v[72:75]
  v_mfma_f32_16x16x32_bf16 v[76:79], a[204:207], v[144:147], v[76:79]
  v_mfma_f32_16x16x32_bf16 v[80:83], a[208:211], v[132:135], 0
  v_mfma_f32_16x16x32_bf16 v[84:87], a[224:227], v[132:135], 0
  s_nop 4
  v_cvt_pk_bf16_f32 v120, v72, v73
  v_cvt_pk_bf16_f32 v121, v74, v75
  v_mfma_f32_16x16x32_bf16 v[80:83], a[212:215], v[136:139], v[80:83]
  v_cvt_pk_bf16_f32 v122, v76, v77
  v_cvt_pk_bf16_f32 v123, v78, v79
  v_mfma_f32_16x16x32_bf16 v[84:87], a[228:231], v[136:139], v[84:87]
  buffer_store_dwordx4 v[120:123], v3, s[4:7], s58 offen offset:1024
  v_mfma_f32_16x16x32_bf16 v[80:83], a[216:219], v[140:143], v[80:83]
  v_mfma_f32_16x16x32_bf16 v[84:87], a[232:235], v[140:143], v[84:87]
  v_mfma_f32_16x16x32_bf16 v[80:83], a[220:223], v[144:147], v[80:83]
  v_mfma_f32_16x16x32_bf16 v[84:87], a[236:239], v[144:147], v[84:87]
  v_mfma_f32_16x16x32_bf16 v[88:91], a[240:243], v[132:135], 0
  v_mfma_f32_16x16x32_bf16 v[92:95], v[224:227], v[132:135], 0
  s_nop 4
  v_cvt_pk_bf16_f32 v124, v80, v81
  v_cvt_pk_bf16_f32 v125, v82, v83
  v_mfma_f32_16x16x32_bf16 v[88:91], a[244:247], v[136:139], v[88:91]
  v_cvt_pk_bf16_f32 v126, v84, v85
  v_cvt_pk_bf16_f32 v127, v86, v87
  v_mfma_f32_16x16x32_bf16 v[92:95], v[228:231], v[136:139], v[92:95]
  buffer_store_dwordx4 v[124:127], v3, s[4:7], s58 offen offset:2048
  v_mfma_f32_16x16x32_bf16 v[88:91], a[248:251], v[140:143], v[88:91]
  v_mfma_f32_16x16x32_bf16 v[92:95], v[232:235], v[140:143], v[92:95]
  v_mfma_f32_16x16x32_bf16 v[88:91], a[252:255], v[144:147], v[88:91]
  v_mfma_f32_16x16x32_bf16 v[92:95], v[236:239], v[144:147], v[92:95]
  v_mfma_f32_16x16x32_bf16 v[96:99], v[240:243], v[132:135], 0
  v_mfma_f32_16x16x32_bf16 v[96:99], v[244:247], v[136:139], v[96:99]
  s_nop 4
  v_cvt_pk_bf16_f32 v120, v88, v89
  v_cvt_pk_bf16_f32 v121, v90, v91
  v_mfma_f32_16x16x32_bf16 v[96:99], v[248:251], v[140:143], v[96:99]
  v_cvt_pk_bf16_f32 v122, v92, v93
  v_cvt_pk_bf16_f32 v123, v94, v95
  v_mfma_f32_16x16x32_bf16 v[96:99], v[252:255], v[144:147], v[96:99]
  buffer_store_dwordx4 v[120:123], v3, s[4:7], s58 offen offset:3072
  s_nop 6
  v_cvt_pk_bf16_f32 v128, v96, v97
  v_cvt_pk_bf16_f32 v129, v98, v99
  buffer_store_dwordx2 v[128:129], v17, s[4:7], s60 offen
  s_branch g2e_184
g2s_183:
  s_waitcnt lgkmcnt(7)
  v_mfma_f32_16x16x32_bf16 v[64:67], a[144:147], v[100:103], 0
  v_mfma_f32_16x16x32_bf16 v[68:71], a[160:163], v[100:103], 0
  s_waitcnt lgkmcnt(6)
  v_mfma_f32_16x16x32_bf16 v[64:67], a[148:151], v[104:107], v[64:67]
  v_mfma_f32_16x16x32_bf16 v[68:71], a[164:167], v[104:107], v[68:71]
  s_waitcnt lgkmcnt(5)
  v_mfma_f32_16x16x32_bf16 v[64:67], a[152:155], v[108:111], v[64:67]
  v_mfma_f32_16x16x32_bf16 v[68:71], a[168:171], v[108:111], v[68:71]
  s_waitcnt lgkmcnt(4)
  v_mfma_f32_16x16x32_bf16 v[64:67], a[156:159], v[112:115], v[64:67]
  v_mfma_f32_16x16x32_bf16 v[68:71], a[172:175], v[112:115], v[68:71]
  v_mfma_f32_16x16x32_bf16 v[72:75], a[176:179], v[100:103], 0
  v_mfma_f32_16x16x32_bf16 v[76:79], a[192:195], v[100:103], 0
  s_nop 4
  v_cvt_pk_bf16_f32 v120, v64, v65
  v_cvt_pk_bf16_f32 v121, v66, v67
  v_mfma_f32_16x16x32_bf16 v[72:75], a[180:183], v[104:107], v[72:75]
  v_cvt_pk_bf16_f32 v122, v68, v69
  v_cvt_pk_bf16_f32 v123, v70, v71
  v_mfma_f32_16x16x32_bf16 v[76:79], a[196:199], v[104:107], v[76:79]
  buffer_store_dwordx4 v[120:123], v3, s[4:7], s38 offen offset:0 sc1
  v_mfma_f32_16x16x32_bf16 v[72:75], a[184:187], v[108:111], v[72:75]
  v_mfma_f32_16x16x32_bf16 v[76:79], a[200:203], v[108:111], v[76:79]
  v_mfma_f32_16x16x32_bf16 v[72:75], a[188:191], v[112:115], v[72:75]
  v_mfma_f32_16x16x32_bf16 v[76:79], a[204:207], v[112:115], v[76:79]
  v_mfma_f32_16x16x32_bf16 v[80:83], a[208:211], v[100:103], 0
  v_mfma_f32_16x16x32_bf16 v[84:87], a[224:227], v[100:103], 0
  s_nop 4
  v_cvt_pk_bf16_f32 v124, v72, v73
  v_cvt_pk_bf16_f32 v125, v74, v75
  v_mfma_f32_16x16x32_bf16 v[80:83], a[212:215], v[104:107], v[80:83]
  v_cvt_pk_bf16_f32 v126, v76, v77
  v_cvt_pk_bf16_f32 v127, v78, v79
  v_mfma_f32_16x16x32_bf16 v[84:87], a[228:231], v[104:107], v[84:87]
  buffer_store_dwordx4 v[124:127], v3, s[4:7], s38 offen offset:1024 sc1
  v_mfma_f32_16x16x32_bf16 v[80:83], a[216:219], v[108:111], v[80:83]
  v_mfma_f32_16x16x32_bf16 v[84:87], a[232:235], v[108:111], v[84:87]
  v_mfma_f32_16x16x32_bf16 v[80:83], a[220:223], v[112:115], v[80:83]
  v_mfma_f32_16x16x32_bf16 v[84:87], a[236:239], v[112:115], v[84:87]
  v_mfma_f32_16x16x32_bf16 v[88:91], a[240:243], v[100:103], 0
  v_mfma_f32_16x16x32_bf16 v[92:95], v[224:227], v[100:103], 0
  s_nop 4
  v_cvt_pk_bf16_f32 v120, v80, v81
  v_cvt_pk_bf16_f32 v121, v82, v83
  v_mfma_f32_16x16x32_bf16 v[88:91], a[244:247], v[104:107], v[88:91]
  v_cvt_pk_bf16_f32 v122, v84, v85
  v_cvt_pk_bf16_f32 v123, v86, v87
  v_mfma_f32_16x16x32_bf16 v[92:95], v[228:231], v[104:107], v[92:95]
  buffer_store_dwordx4 v[120:123], v3, s[4:7], s38 offen offset:2048 sc1
  v_mfma_f32_16x16x32_bf16 v[88:91], a[248:251], v[108:111], v[88:91]
  v_mfma_f32_16x16x32_bf16 v[92:95], v[232:235], v[108:111], v[92:95]
  v_mfma_f32_16x16x32_bf16 v[88:91], a[252:255], v[112:115], v[88:91]
  v_mfma_f32_16x16x32_bf16 v[92:95], v[236:239], v[112:115], v[92:95]
  v_mfma_f32_16x16x32_bf16 v[96:99], v[240:243], v[100:103], 0
  v_mfma_f32_16x16x32_bf16 v[96:99], v[244:247], v[104:107], v[96:99]
  s_nop 4
  v_cvt_pk_bf16_f32 v124, v88, v89
  v_cvt_pk_bf16_f32 v125, v90, v91
  v_mfma_f32_16x16x32_bf16 v[96:99], v[248:251], v[108:111], v[96:99]
  v_cvt_pk_bf16_f32 v126, v92, v93
  v_cvt_pk_bf16_f32 v127, v94, v95
  v_mfma_f32_16x16x32_bf16 v[96:99], v[252:255], v[112:115], v[96:99]
  buffer_store_dwordx4 v[124:127], v3, s[4:7], s38 offen offset:3072 sc1
  s_waitcnt lgkmcnt(3)
  v_mfma_f32_16x16x32_bf16 v[64:67], a[144:147], v[132:135], 0
  v_mfma_f32_16x16x32_bf16 v[68:71], a[160:163], v[132:135], 0
  s_nop 3
  v_cvt_pk_bf16_f32 v128, v96, v97
  v_cvt_pk_bf16_f32 v129, v98, v99
  s_waitcnt lgkmcnt(2)
  v_mfma_f32_16x16x32_bf16 v[64:67], a[148:151], v[136:139], v[64:67]
  buffer_store_dwordx2 v[128:129], v17, s[4:7], s59 offen sc1
  v_mfma_f32_16x16x32_bf16 v[68:71], a[164:167], v[136:139], v[68:71]
  s_waitcnt lgkmcnt(1)
  v_mfma_f32_16x16x32_bf16 v[64:67], a[152:155], v[140:143], v[64:67]
  v_mfma_f32_16x16x32_bf16 v[68:71], a[168:171], v[140:143], v[68:71]
  s_waitcnt lgkmcnt(0)
  v_mfma_f32_16x16x32_bf16 v[64:67], a[156:159], v[144:147], v[64:67]
  v_mfma_f32_16x16x32_bf16 v[68:71], a[172:175], v[144:147], v[68:71]
  v_mfma_f32_16x16x32_bf16 v[72:75], a[176:179], v[132:135], 0
  v_mfma_f32_16x16x32_bf16 v[76:79], a[192:195], v[132:135], 0
  s_nop 4
  v_cvt_pk_bf16_f32 v124, v64, v65
  v_cvt_pk_bf16_f32 v125, v66, v67
  v_mfma_f32_16x16x32_bf16 v[72:75], a[180:183], v[136:139], v[72:75]
  v_cvt_pk_bf16_f32 v126, v68, v69
  v_cvt_pk_bf16_f32 v127, v70, v71
  v_mfma_f32_16x16x32_bf16 v[76:79], a[196:199], v[136:139], v[76:79]
  buffer_store_dwordx4 v[124:127], v3, s[4:7], s58 offen offset:0 sc1
  v_mfma_f32_16x16x32_bf16 v[72:75], a[184:187], v[140:143], v[72:75]
  v_mfma_f32_16x16x32_bf16 v[76:79], a[200:203], v[140:143], v[76:79]
  v_mfma_f32_16x16x32_bf16 v[72:75], a[188:191], v[144:147], v[72:75]
  v_mfma_f32_16x16x32_bf16 v[76:79], a[204:207], v[144:147], v[76:79]
  v_mfma_f32_16x16x32_bf16 v[80:83], a[208:211], v[132:135], 0
  v_mfma_f32_16x16x32_bf16 v[84:87], a[224:227], v[132:135], 0
  s_nop 4
  v_cvt_pk_bf16_f32 v120, v72, v73
  v_cvt_pk_bf16_f32 v121, v74, v75
  v_mfma_f32_16x16x32_bf16 v[80:83], a[212:215], v[136:139], v[80:83]
  v_cvt_pk_bf16_f32 v122, v76, v77
  v_cvt_pk_bf16_f32 v123, v78, v79
  v_mfma_f32_16x16x32_bf16 v[84:87], a[228:231], v[136:139], v[84:87]
  buffer_store_dwordx4 v[120:123], v3, s[4:7], s58 offen offset:1024 sc1
  v_mfma_f32_16x16x32_bf16 v[80:83], a[216:219], v[140:143], v[80:83]
  v_mfma_f32_16x16x32_bf16 v[84:87], a[232:235], v[140:143], v[84:87]
  v_mfma_f32_16x16x32_bf16 v[80:83], a[220:223], v[144:147], v[80:83]
  v_mfma_f32_16x16x32_bf16 v[84:87], a[236:239], v[144:147], v[84:87]
  v_mfma_f32_16x16x32_bf16 v[88:91], a[240:243], v[132:135], 0
  v_mfma_f32_16x16x32_bf16 v[92:95], v[224:227], v[132:135], 0
  s_nop 4
  v_cvt_pk_bf16_f32 v124, v80, v81
  v_cvt_pk_bf16_f32 v125, v82, v83
  v_mfma_f32_16x16x32_bf16 v[88:91], a[244:247], v[136:139], v[88:91]
  v_cvt_pk_bf16_f32 v126, v84, v85
  v_cvt_pk_bf16_f32 v127, v86, v87
  v_mfma_f32_16x16x32_bf16 v[92:95], v[228:231], v[136:139], v[92:95]
  buffer_store_dwordx4 v[124:127], v3, s[4:7], s58 offen offset:2048 sc1
  v_mfma_f32_16x16x32_bf16 v[88:91], a[248:251], v[140:143], v[88:91]
  v_mfma_f32_16x16x32_bf16 v[92:95], v[232:235], v[140:143], v[92:95]
  v_mfma_f32_16x16x32_bf16 v[88:91], a[252:255], v[144:147], v[88:91]
  v_mfma_f32_16x16x32_bf16 v[92:95], v[236:239], v[144:147], v[92:95]
  v_mfma_f32_16x16x32_bf16 v[96:99], v[240:243], v[132:135], 0
  v_mfma_f32_16x16x32_bf16 v[96:99], v[244:247], v[136:139], v[96:99]
  s_nop 4
  v_cvt_pk_bf16_f32 v120, v88, v89
  v_cvt_pk_bf16_f32 v121, v90, v91
  v_mfma_f32_16x16x32_bf16 v[96:99], v[248:251], v[140:143], v[96:99]
  v_cvt_pk_bf16_f32 v122, v92, v93
  v_cvt_pk_bf16_f32 v123, v94, v95
  v_mfma_f32_16x16x32_bf16 v[96:99], v[252:255], v[144:147], v[96:99]
  buffer_store_dwordx4 v[120:123], v3, s[4:7], s58 offen offset:3072 sc1
  s_nop 6
  v_cvt_pk_bf16_f32 v128, v96, v97
  v_cvt_pk_bf16_f32 v129, v98, v99
  buffer_store_dwordx2 v[128:129], v17, s[4:7], s60 offen sc1
g2e_184:
  s_cmp_eq_u32 s20, 63
  s_cbranch_scc1 rns_185
  s_waitcnt vmcnt(0)
  s_barrier
  s_cmp_eq_u32 s17, 0
  s_cbranch_scc0 gs_186
  s_lshl_b32 s23, s18, 8
  s_add_u32 s23, s23, 2171008
  s_add_u32 s25, s19, 1
  s_lshl_b32 s24, s16, 2
  s_mov_b64 exec, 1
  v_mov_b32 v60, s24
  v_mov_b32 v61, s25
  s_cmp_eq_u32 s22, 0
  s_cbranch_scc0 ms_189
  buffer_store_dword v61, v60, s[4:7], s23 offen
  s_branch me_190
ms_189:
  buffer_store_dword v61, v60, s[4:7], s23 offen sc1
me_190:
  s_mov_b64 exec, -1
  v_mbcnt_lo_u32_b32 v60, -1, 0
  v_mbcnt_hi_u32_b32 v60, -1, v60
  v_and_b32 v60, 31, v60
  v_lshlrev_b32 v60, 2, v60
  s_mov_b32 s24, 0
gsp_187:
  buffer_load_dword v61, v60, s[4:7], s23 offen sc1
  s_add_u32 s24, s24, 1
  s_waitcnt vmcnt(0)
  v_cmp_gt_u32 vcc, s25, v61
  s_cbranch_vccz gsd_188
  s_cmp_lg_u32 s44, 0
  s_cbranch_scc1 gsd_188
  s_cmp_lt_u32 s24, 0x100000
  s_cbranch_scc1 gsp_187
  s_mov_b32 s44, 1
gsd_188:
gs_186:
  s_barrier
rns_185:
  s_lshr_b32 s23, s16, 3
  s_bfe_u32 s24, s16, 0x10002
  s_and_b32 s25, s16, 3
  s_mul_i32 s26, s23, 9216
  s_mul_i32 s27, s24, 4608
  s_add_u32 s26, s26, s27
  s_lshl_b32 s27, s25, 10
  s_add_u32 s26, s26, s27
  s_lshl_b32 s27, s17, 8
  s_add_u32 s26, s26, s27
  s_mul_i32 s28, s23, 288
  s_lshl_b32 s27, s25, 6
  s_add_u32 s28, s28, s27
  s_lshl_b32 s27, s17, 3
  s_add_u32 s28, s28, s27
  s_lshl_b32 s27, s20, 5
  s_lshl_b32 s24, s24, 4
  s_add_u32 s27, s27, s24
  s_mul_i32 s27, s27, 1152
  s_add_u32 s27, s27, s28
  s_add_u32 s26, s26, s36
  s_lshl_b32 s25, s27, 1
  s_add_u32 s25, s25, 60817408
  buffer_load_dwordx4 v[100:103], v16, s[4:7], s25 offen sc1
  s_mov_b32 s56, 0
rp_191:
  s_mov_b32 s57, s26
  buffer_load_dwordx4 v[64:67], v14, s[4:7], s57 offen sc1
  s_add_u32 s57, s57, 147456
  buffer_load_dwordx4 v[68:71], v14, s[4:7], s57 offen sc1
  s_add_u32 s57, s57, 147456
  buffer_load_dwordx4 v[72:75], v14, s[4:7], s57 offen sc1
  s_add_u32 s57, s57, 147456
  buffer_load_dwordx4 v[76:79], v14, s[4:7], s57 offen sc1
  s_add_u32 s57, s57, 147456
  buffer_load_dwordx4 v[80:83], v14, s[4:7], s57 offen sc1
  s_add_u32 s57, s57, 147456
  buffer_load_dwordx4 v[84:87], v14, s[4:7], s57 offen sc1
  s_add_u32 s57, s57, 147456
  buffer_load_dwordx4 v[88:91], v14, s[4:7], s57 offen sc1
  s_add_u32 s57, s57, 147456
  buffer_load_dwordx4 v[92:95], v14, s[4:7], s57 offen sc1
  s_waitcnt vmcnt(7)
  v_mfma_f32_16x16x32_bf16 v[96:99], v[24:27], v[64:67], 0
  s_waitcnt vmcnt(6)
  v_mfma_f32_16x16x32_bf16 v[96:99], v[24:27], v[68:71], v[96:99]
  s_waitcnt vmcnt(5)
  v_mfma_f32_16x16x32_bf16 v[96:99], v[24:27], v[72:75], v[96:99]
  s_waitcnt vmcnt(4)
  v_mfma_f32_16x16x32_bf16 v[96:99], v[24:27], v[76:79], v[96:99]
  s_waitcnt vmcnt(3)
  v_mfma_f32_16x16x32_bf16 v[96:99], v[24:27], v[80:83], v[96:99]
  s_waitcnt vmcnt(2)
  v_mfma_f32_16x16x32_bf16 v[96:99], v[24:27], v[84:87], v[96:99]
  s_waitcnt vmcnt(1)
  v_mfma_f32_16x16x32_bf16 v[96:99], v[24:27], v[88:91], v[96:99]
  s_waitcnt vmcnt(0)
  v_mfma_f32_16x16x32_bf16 v[96:99], v[24:27], v[92:95], v[96:99]
  s_cmp_eq_u32 s20, 63
  s_cbranch_scc0 ro_192
  s_nop 7
  v_cmp_u_f32 vcc, v96, v97
  v_cmp_u_f32 s[58:59], v98, v99
  s_nop 3
  s_or_b64 vcc, vcc, s[58:59]
  s_cbranch_vccz ro_192
  s_add_u32 s56, s56, 1
  s_cmp_lg_u32 s44, 0
  s_cbranch_scc1 ro_192
  s_cmp_lt_u32 s56, 0x40000
  s_cbranch_scc1 rp_191
  s_mov_b32 s44, 1
ro_192:
  s_nop 7
  v_add_f32 v96, v96, v100
  v_add_f32 v97, v97, v101
  v_add_f32 v98, v98, v102
  v_add_f32 v99, v99, v103
  v_cvt_pk_bf16_f32 v96, v96, v97
  v_cvt_pk_bf16_f32 v97, v98, v99
  s_mov_b64 exec, s[46:47]
  buffer_store_dwordx2 v[96:97], v15, s[8:11], s27 offen
  s_mov_b64 exec, -1
  s_cmp_eq_u32 s17, 3
  s_cbranch_scc0 rx_193
  s_cmp_lt_u32 s16, 16
  s_cbranch_scc0 rx_193
  s_lshr_b32 s23, s16, 2
  s_bfe_u32 s24, s16, 0x10001
  s_and_b32 s25, s16, 1
  s_mul_i32 s26, s23, 9216
  s_mul_i32 s27, s24, 4608
  s_add_u32 s26, s26, s27
  s_lshl_b32 s27, s25, 8
  s_add_u32 s26, s26, s27
  s_add_u32 s26, s26, 4096
  s_mul_i32 s28, s23, 288
  s_lshl_b32 s27, s25, 4
  s_add_u32 s28, s28, s27
  s_add_u32 s28, s28, 256
  s_lshl_b32 s27, s20, 5
  s_lshl_b32 s24, s24, 4
  s_add_u32 s27, s27, s24
  s_mul_i32 s27, s27, 1152
  s_add_u32 s27, s27, s28
  s_add_u32 s26, s26, s36
  s_lshl_b32 s25, s27, 1
  s_add_u32 s25, s25, 60817408
  buffer_load_dwordx4 v[100:103], v22, s[4:7], s25 offen sc1
  s_mov_b32 s56, 0
rp_194:
  s_mov_b32 s57, s26
  buffer_load_dwordx4 v[64:67], v14, s[4:7], s57 offen sc1
  s_add_u32 s57, s57, 147456
  buffer_load_dwordx4 v[68:71], v14, s[4:7], s57 offen sc1
  s_add_u32 s57, s57, 147456
  buffer_load_dwordx4 v[72:75], v14, s[4:7], s57 offen sc1
  s_add_u32 s57, s57, 147456
  buffer_load_dwordx4 v[76:79], v14, s[4:7], s57 offen sc1
  s_add_u32 s57, s57, 147456
  buffer_load_dwordx4 v[80:83], v14, s[4:7], s57 offen sc1
  s_add_u32 s57, s57, 147456
  buffer_load_dwordx4 v[84:87], v14, s[4:7], s57 offen sc1
  s_add_u32 s57, s57, 147456
  buffer_load_dwordx4 v[88:91], v14, s[4:7], s57 offen sc1
  s_add_u32 s57, s57, 147456
  buffer_load_dwordx4 v[92:95], v14, s[4:7], s57 offen sc1
  s_waitcnt vmcnt(7)
  v_mfma_f32_16x16x32_bf16 v[96:99], v[24:27], v[64:67], 0
  s_waitcnt vmcnt(6)
  v_mfma_f32_16x16x32_bf16 v[96:99], v[24:27], v[68:71], v[96:99]
  s_waitcnt vmcnt(5)
  v_mfma_f32_16x16x32_bf16 v[96:99], v[24:27], v[72:75], v[96:99]
  s_waitcnt vmcnt(4)
  v_mfma_f32_16x16x32_bf16 v[96:99], v[24:27], v[76:79], v[96:99]
  s_waitcnt vmcnt(3)
  v_mfma_f32_16x16x32_bf16 v[96:99], v[24:27], v[80:83], v[96:99]
  s_waitcnt vmcnt(2)
  v_mfma_f32_16x16x32_bf16 v[96:99], v[24:27], v[84:87], v[96:99]
  s_waitcnt vmcnt(1)
  v_mfma_f32_16x16x32_bf16 v[96:99], v[24:27], v[88:91], v[96:99]
  s_waitcnt vmcnt(0)
  v_mfma_f32_16x16x32_bf16 v[96:99], v[24:27], v[92:95], v[96:99]
  s_cmp_eq_u32 s20, 63
  s_cbranch_scc0 ro_195
  s_nop 7
  v_cmp_u_f32 vcc, v96, v97
  v_cmp_u_f32 s[58:59], v98, v99
  s_nop 3
  s_or_b64 vcc, vcc, s[58:59]
  s_cbranch_vccz ro_195
  s_add_u32 s56, s56, 1
  s_cmp_lg_u32 s44, 0
  s_cbranch_scc1 ro_195
  s_cmp_lt_u32 s56, 0x40000
  s_cbranch_scc1 rp_194
  s_mov_b32 s44, 1
ro_195:
  s_nop 7
  v_add_f32 v96, v96, v100
  v_add_f32 v97, v97, v101
  v_add_f32 v98, v98, v102
  v_add_f32 v99, v99, v103
  v_cvt_pk_bf16_f32 v96, v96, v97
  v_cvt_pk_bf16_f32 v97, v98, v99
  s_mov_b64 exec, s[46:47]
  buffer_store_dwordx2 v[96:97], v21, s[8:11], s27 offen
  s_mov_b64 exec, -1
  s_waitcnt vmcnt(0) lgkmcnt(0)
rx_193:
  s_xor_b32 s37, s37, 45056
  s_add_u32 s20, s20, 7
  s_add_u32 s19, s19, 1
  s_cmp_lt_u32 s19, s21
  s_cbranch_scc1 pd_loop_174
  s_waitcnt vmcnt(0) lgkmcnt(0)
k_end:
  s_endpgm
k_code_end:

.section .rodata,"a"
.p2align 6
.amdhsa_kernel parallel_sum__memory_aug_recurrent_mem_tr__mixer_channel_mlp__prompt_kernel
  .amdhsa_next_free_vgpr 512
  .amdhsa_next_free_sgpr 102
  .amdhsa_accum_offset 256
  .amdhsa_group_segment_fixed_size 0
  .amdhsa_kernarg_size 120
  .amdhsa_user_sgpr_count 2
  .amdhsa_user_sgpr_kernarg_segment_ptr 1
  .amdhsa_system_sgpr_workgroup_id_x 1
.end_amdhsa_kernel
.section .rodata,"a"
.p2align 8
chain_tab:
.long 131072,0,65536,131072,17476,148480,150528,148480,150528,139264,0,0,0,0,0,0,32,0,16256,0,0,0,0,0,0,0,0,0,0,0,0,0
.long 131088,16,65552,131088,17476,148496,150560,148488,150536,139280,16,16,16,16,16,8,40,1152,1065353216,0,0,0,0,0,0,0,0,0,0,0,0,0
.long 131104,32,65568,131104,61166,148512,150592,148480,150544,139328,32,256,32,32,73728,16,48,16,0,16256,0,0,0,0,0,0,0,0,0,0,0,0
.long 131120,48,65584,131120,61166,148528,150624,148488,150552,139344,48,272,48,48,73744,24,56,1168,0,1065353216,0,0,0,0,0,0,0,0,0,0,0,0
.long 131136,64,65600,131136,17476,148544,150656,148496,150560,139392,64,512,64,288,288,288,256,2304,0,0,16256,0,0,0,0,0,0,0,0,0,0,0
.long 131152,80,65616,131152,17476,148560,150688,148504,150568,139408,80,528,80,304,304,296,264,3456,0,0,1065353216,0,0,0,0,0,0,0,0,0,0,0
.long 131168,96,65632,131168,61166,148576,150720,148496,150576,139456,96,768,96,320,74016,304,272,2320,0,0,0,16256,0,0,0,0,0,0,0,0,0,0
.long 131184,112,65648,131184,61166,148592,150752,148504,150584,139472,112,784,112,336,74032,312,280,3472,0,0,0,1065353216,0,0,0,0,0,0,0,0,0,0
.long 131200,128,65664,131200,17476,148608,150784,148512,150592,139264,9472,0,128,576,576,576,608,4608,0,0,0,0,0,0,0,0,0,0,0,0,0,0
.long 131216,144,65680,131216,17476,148624,150816,148520,150600,139280,9488,16,144,592,592,584,616,5760,0,0,0,0,0,0,0,0,0,0,0,0,0,0
.long 131232,160,65696,131232,61166,148640,150848,148512,150608,139328,9504,256,160,608,74304,592,624,4624,0,0,0,0,0,0,0,0,0,0,0,0,0,0
.long 131248,176,65712,131248,61166,148656,150880,148520,150616,139344,9520,272,176,624,74320,600,632,5776,0,0,0,0,0,0,0,0,0,0,0,0,0,0
.long 131264,192,65728,131264,17476,148672,150912,148528,150624,139392,9536,512,192,864,864,864,832,6912,0,0,0,0,0,0,0,0,0,0,0,0,0,0
.long 131280,208,65744,131280,17476,148688,150944,148536,150632,139408,9552,528,208,880,880,872,840,8064,0,0,0,0,0,0,0,0,0,0,0,0,0,0
.long 131296,224,65760,131296,61166,148704,150976,148528,150640,139456,9568,768,224,896,74592,880,848,6928,0,0,0,0,0,0,0,0,0,0,0,0,0,0
.long 131312,240,65776,131312,61166,148720,151008,148536,150648,139472,9584,784,240,912,74608,888,856,8080,0,0,0,0,0,0,0,0,0,0,0,0,0,0
.long 131328,256,65792,131328,17476,148484,150536,148544,150656,139296,18944,4,16416,1184,74880,2176,2208,32,16256,0,0,0,0,0,0,0,0,0,0,0,0,0
.long 131344,272,65808,131344,17476,148500,150568,148552,150664,139312,18960,20,16432,1200,74896,2184,2216,1184,1065353216,0,0,0,0,0,0,0,0,0,0,0,0,0
.long 131360,288,65824,131360,61166,148516,150600,148544,150672,139360,18976,260,16384,1152,1152,2192,2224,48,0,16256,0,0,0,0,0,0,0,0,0,0,0,0
.long 131376,304,65840,131376,61166,148532,150632,148552,150680,139376,18992,276,16400,1168,1168,2200,2232,1200,0,1065353216,0,0,0,0,0,0,0,0,0,0,0,0
.long 131392,320,65856,131392,17476,148548,150664,148560,150688,139424,19008,516,16480,1472,75168,2464,2432,2336,0,0,16256,0,0,0,0,0,0,0,0,0,0,0
.long 131408,336,65872,131408,17476,148564,150696,148568,150696,139440,19024,532,16496,1488,75184,2472,2440,3488,0,0,1065353216,0,0,0,0,0,0,0,0,0,0,0
.long 131424,352,65888,131424,61166,148580,150728,148560,150704,139488,19040,772,16448,1440,1440,2480,2448,2352,0,0,0,16256,0,0,0,0,0,0,0,0,0,0
.long 131440,368,65904,131440,61166,148596,150760,148568,150712,139504,19056,788,16464,1456,1456,2488,2456,3504,0,0,0,1065353216,0,0,0,0,0,0,0,0,0,0
.long 131456,384,65920,131456,17476,148612,150792,148576,150720,139296,28416,4,16544,1760,75456,2752,2784,4640,0,0,0,0,0,0,0,0,0,0,0,0,0,0
.long 131472,400,65936,131472,17476,148628,150824,148584,150728,139312,28432,20,16560,1776,75472,2760,2792,5792,0,0,0,0,0,0,0,0,0,0,0,0,0,0
.long 131488,416,65952,131488,61166,148644,150856,148576,150736,139360,28448,260,16512,1728,1728,2768,2800,4656,0,0,0,0,0,0,0,0,0,0,0,0,0,0
.long 131504,432,65968,131504,61166,148660,150888,148584,150744,139376,28464,276,16528,1744,1744,2776,2808,5808,0,0,0,0,0,0,0,0,0,0,0,0,0,0
.long 131520,448,65984,131520,17476,148676,150920,148592,150752,139424,28480,516,16608,2048,75744,3040,3008,6944,0,0,0,0,0,0,0,0,0,0,0,0,0,0
.long 131536,464,66000,131536,17476,148692,150952,148600,150760,139440,28496,532,16624,2064,75760,3048,3016,8096,0,0,0,0,0,0,0,0,0,0,0,0,0,0
.long 131552,480,66016,131552,61166,148708,150984,148592,150768,139488,28512,772,16576,2016,2016,3056,3024,6960,0,0,0,0,0,0,0,0,0,0,0,0,0,0
.long 131568,496,66032,131568,61166,148724,151016,148600,150776,139504,28528,788,16592,2032,2032,3064,3032,8112,0,0,0,0,0,0,0,0,0,0,0,0,0,0
.long 131584,512,66048,131584,17476,148488,150544,148736,151040,139520,37888,8,65600,4896,4896,4096,4128,64,16256,0,0,0,0,0,0,0,0,0,0,0,0,0
.long 131600,528,66064,131600,17476,148504,150576,148744,151048,139536,37904,24,65616,4912,4912,4104,4136,1216,1065353216,0,0,0,0,0,0,0,0,0,0,0,0,0
.long 131616,544,66080,131616,61166,148520,150608,148736,151056,139584,37920,264,65632,4928,78624,4112,4144,80,0,16256,0,0,0,0,0,0,0,0,0,0,0,0
.long 131632,560,66096,131632,61166,148536,150640,148744,151064,139600,37936,280,65648,4944,78640,4120,4152,1232,0,1065353216,0,0,0,0,0,0,0,0,0,0,0,0
.long 131648,576,66112,131648,17476,148552,150672,148752,151072,139648,37952,520,65536,4608,4608,4384,4352,2368,0,0,16256,0,0,0,0,0,0,0,0,0,0,0
.long 131664,592,66128,131664,17476,148568,150704,148760,151080,139664,37968,536,65552,4624,4624,4392,4360,3520,0,0,1065353216,0,0,0,0,0,0,0,0,0,0,0
.long 131680,608,66144,131680,61166,148584,150736,148752,151088,139712,37984,776,65568,4640,78336,4400,4368,2384,0,0,0,16256,0,0,0,0,0,0,0,0,0,0
.long 131696,624,66160,131696,61166,148600,150768,148760,151096,139728,38000,792,65584,4656,78352,4408,4376,3536,0,0,0,1065353216,0,0,0,0,0,0,0,0,0,0
.long 131712,640,66176,131712,17476,148616,150800,148768,151104,139520,47360,8,65728,5472,5472,4672,4704,4672,0,0,0,0,0,0,0,0,0,0,0,0,0,0
.long 131728,656,66192,131728,17476,148632,150832,148776,151112,139536,47376,24,65744,5488,5488,4680,4712,5824,0,0,0,0,0,0,0,0,0,0,0,0,0,0
.long 131744,672,66208,131744,61166,148648,150864,148768,151120,139584,47392,264,65760,5504,79200,4688,4720,4688,0,0,0,0,0,0,0,0,0,0,0,0,0,0
.long 131760,688,66224,131760,61166,148664,150896,148776,151128,139600,47408,280,65776,5520,79216,4696,4728,5840,0,0,0,0,0,0,0,0,0,0,0,0,0,0
.long 131776,704,66240,131776,17476,148680,150928,148784,151136,139648,47424,520,65664,5184,5184,4960,4928,6976,0,0,0,0,0,0,0,0,0,0,0,0,0,0
.long 131792,720,66256,131792,17476,148696,150960,148792,151144,139664,47440,536,65680,5200,5200,4968,4936,8128,0,0,0,0,0,0,0,0,0,0,0,0,0,0
.long 131808,736,66272,131808,61166,148712,150992,148784,151152,139712,47456,776,65696,5216,78912,4976,4944,6992,0,0,0,0,0,0,0,0,0,0,0,0,0,0
.long 131824,752,66288,131824,61166,148728,151024,148792,151160,139728,47472,792,65712,5232,78928,4984,4952,8144,0,0,0,0,0,0,0,0,0,0,0,0,0,0
.long 131840,768,66304,131840,17476,148492,150552,148800,151168,139552,56832,12,82016,6080,79776,6272,6304,96,16256,0,0,0,0,0,0,0,0,0,0,0,0,0
.long 131856,784,66320,131856,17476,148508,150584,148808,151176,139568,56848,28,82032,6096,79792,6280,6312,1248,1065353216,0,0,0,0,0,0,0,0,0,0,0,0,0
.long 131872,800,66336,131872,61166,148524,150616,148800,151184,139616,56864,268,81984,6048,6048,6288,6320,112,0,16256,0,0,0,0,0,0,0,0,0,0,0,0
.long 131888,816,66352,131888,61166,148540,150648,148808,151192,139632,56880,284,82000,6064,6064,6296,6328,1264,0,1065353216,0,0,0,0,0,0,0,0,0,0,0,0
.long 131904,832,66368,131904,17476,148556,150680,148816,151200,139680,56896,524,81952,5792,79488,6560,6528,2400,0,0,16256,0,0,0,0,0,0,0,0,0,0,0
.long 131920,848,66384,131920,17476,148572,150712,148824,151208,139696,56912,540,81968,5808,79504,6568,6536,3552,0,0,1065353216,0,0,0,0,0,0,0,0,0,0,0
.long 131936,864,66400,131936,61166,148588,150744,148816,151216,139744,56928,780,81920,5760,5760,6576,6544,2416,0,0,0,16256,0,0,0,0,0,0,0,0,0,0
.long 131952,880,66416,131952,61166,148604,150776,148824,151224,139760,56944,796,81936,5776,5776,6584,6552,3568,0,0,0,1065353216,0,0,0,0,0,0,0,0,0,0
.long 131968,896,66432,131968,17476,148620,150808,148832,151232,139552,66304,12,82144,6656,80352,6848,6880,4704,0,0,0,0,0,0,0,0,0,0,0,0,0,0
.long 131984,912,66448,131984,17476,148636,150840,148840,151240,139568,66320,28,82160,6672,80368,6856,6888,5856,0,0,0,0,0,0,0,0,0,0,0,0,0,0
.long 132000,928,66464,132000,61166,148652,150872,148832,151248,139616,66336,268,82112,6624,6624,6864,6896,4720,0,0,0,0,0,0,0,0,0,0,0,0,0,0
.long 132016,944,66480,132016,61166,148668,150904,148840,151256,139632,66352,284,82128,6640,6640,6872,6904,5872,0,0,0,0,0,0,0,0,0,0,0,0,0,0
.long 132032,960,66496,132032,17476,148684,150936,148848,151264,139680,66368,524,82080,6368,80064,7136,7104,7008,0,0,0,0,0,0,0,0,0,0,0,0,0,0
.long 132048,976,66512,132048,17476,148700,150968,148856,151272,139696,66384,540,82096,6384,80080,7144,7112,8160,0,0,0,0,0,0,0,0,0,0,0,0,0,0
.long 132064,992,66528,132064,61166,148716,151000,148848,151280,139744,66400,780,82048,6336,6336,7152,7120,7024,0,0,0,0,0,0,0,0,0,0,0,0,0,0
.long 132080,1008,66544,132080,61166,148732,151032,148856,151288,139760,66416,796,82064,6352,6352,7160,7128,8176,0,0,0,0,0,0,0,0,0,0,0,0,0,0
.long 131072,2048,67584,133120,17476,148992,151552,148480,150528,139776,0,0,32768,2304,2304,64,96,0,16256,0,0,0,0,0,0,0,0,0,0,0,0,0
.long 131088,2064,67600,133136,17476,149008,151584,148488,150536,139792,16,16,32784,2320,2320,72,104,1152,1065353216,0,0,0,0,0,0,0,0,0,0,0,0,0
.long 131104,2080,67616,133152,61166,149024,151616,148480,150544,139840,32,256,32800,2336,76032,80,112,16,0,16256,0,0,0,0,0,0,0,0,0,0,0,0
.long 131120,2096,67632,133168,61166,149040,151648,148488,150552,139856,48,272,32816,2352,76048,88,120,1168,0,1065353216,0,0,0,0,0,0,0,0,0,0,0,0
.long 131136,2112,67648,133184,17476,149056,151680,148496,150560,139904,64,512,32832,2592,2592,352,320,2304,0,0,16256,0,0,0,0,0,0,0,0,0,0,0
.long 131152,2128,67664,133200,17476,149072,151712,148504,150568,139920,80,528,32848,2608,2608,360,328,3456,0,0,1065353216,0,0,0,0,0,0,0,0,0,0,0
.long 131168,2144,67680,133216,61166,149088,151744,148496,150576,139968,96,768,32864,2624,76320,368,336,2320,0,0,0,16256,0,0,0,0,0,0,0,0,0,0
.long 131184,2160,67696,133232,61166,149104,151776,148504,150584,139984,112,784,32880,2640,76336,376,344,3472,0,0,0,1065353216,0,0,0,0,0,0,0,0,0,0
.long 131200,2176,67712,133248,17476,149120,151808,148512,150592,139776,9472,0,32896,2880,2880,512,544,4608,0,0,0,0,0,0,0,0,0,0,0,0,0,0
.long 131216,2192,67728,133264,17476,149136,151840,148520,150600,139792,9488,16,32912,2896,2896,520,552,5760,0,0,0,0,0,0,0,0,0,0,0,0,0,0
.long 131232,2208,67744,133280,61166,149152,151872,148512,150608,139840,9504,256,32928,2912,76608,528,560,4624,0,0,0,0,0,0,0,0,0,0,0,0,0,0
.long 131248,2224,67760,133296,61166,149168,151904,148520,150616,139856,9520,272,32944,2928,76624,536,568,5776,0,0,0,0,0,0,0,0,0,0,0,0,0,0
.long 131264,2240,67776,133312,17476,149184,151936,148528,150624,139904,9536,512,32960,3168,3168,800,768,6912,0,0,0,0,0,0,0,0,0,0,0,0,0,0
.long 131280,2256,67792,133328,17476,149200,151968,148536,150632,139920,9552,528,32976,3184,3184,808,776,8064,0,0,0,0,0,0,0,0,0,0,0,0,0,0
.long 131296,2272,67808,133344,61166,149216,152000,148528,150640,139968,9568,768,32992,3200,76896,816,784,6928,0,0,0,0,0,0,0,0,0,0,0,0,0,0
.long 131312,2288,67824,133360,61166,149232,152032,148536,150648,139984,9584,784,33008,3216,76912,824,792,8080,0,0,0,0,0,0,0,0,0,0,0,0,0,0
.long 131328,2304,67840,133376,17476,148996,151560,148544,150656,139808,18944,4,49184,3488,77184,2240,2272,32,16256,0,0,0,0,0,0,0,0,0,0,0,0,0
.long 131344,2320,67856,133392,17476,149012,151592,148552,150664,139824,18960,20,49200,3504,77200,2248,2280,1184,1065353216,0,0,0,0,0,0,0,0,0,0,0,0,0
.long 131360,2336,67872,133408,61166,149028,151624,148544,150672,139872,18976,260,49152,3456,3456,2256,2288,48,0,16256,0,0,0,0,0,0,0,0,0,0,0,0
.long 131376,2352,67888,133424,61166,149044,151656,148552,150680,139888,18992,276,49168,3472,3472,2264,2296,1200,0,1065353216,0,0,0,0,0,0,0,0,0,0,0,0
.long 131392,2368,67904,133440,17476,149060,151688,148560,150688,139936,19008,516,49248,3776,77472,2528,2496,2336,0,0,16256,0,0,0,0,0,0,0,0,0,0,0
.long 131408,2384,67920,133456,17476,149076,151720,148568,150696,139952,19024,532,49264,3792,77488,2536,2504,3488,0,0,1065353216,0,0,0,0,0,0,0,0,0,0,0
.long 131424,2400,67936,133472,61166,149092,151752,148560,150704,140000,19040,772,49216,3744,3744,2544,2512,2352,0,0,0,16256,0,0,0,0,0,0,0,0,0,0
.long 131440,2416,67952,133488,61166,149108,151784,148568,150712,140016,19056,788,49232,3760,3760,2552,2520,3504,0,0,0,1065353216,0,0,0,0,0,0,0,0,0,0
.long 131456,2432,67968,133504,17476,149124,151816,148576,150720,139808,28416,4,49312,4064,77760,2688,2720,4640,0,0,0,0,0,0,0,0,0,0,0,0,0,0
.long 131472,2448,67984,133520,17476,149140,151848,148584,150728,139824,28432,20,49328,4080,77776,2696,2728,5792,0,0,0,0,0,0,0,0,0,0,0,0,0,0
.long 131488,2464,68000,133536,61166,149156,151880,148576,150736,139872,28448,260,49280,4032,4032,2704,2736,4656,0,0,0,0,0,0,0,0,0,0,0,0,0,0
.long 131504,2480,68016,133552,61166,149172,151912,148584,150744,139888,28464,276,49296,4048,4048,2712,2744,5808,0,0,0,0,0,0,0,0,0,0,0,0,0,0
.long 131520,2496,68032,133568,17476,149188,151944,148592,150752,139936,28480,516,49376,4352,78048,2976,2944,6944,0,0,0,0,0,0,0,0,0,0,0,0,0,0
.long 131536,2512,68048,133584,17476,149204,151976,148600,150760,139952,28496,532,49392,4368,78064,2984,2952,8096,0,0,0,0,0,0,0,0,0,0,0,0,0,0
.long 131552,2528,68064,133600,61166,149220,152008,148592,150768,140000,28512,772,49344,4320,4320,2992,2960,6960,0,0,0,0,0,0,0,0,0,0,0,0,0,0
.long 131568,2544,68080,133616,61166,149236,152040,148600,150776,140016,28528,788,49360,4336,4336,3000,2968,8112,0,0,0,0,0,0,0,0,0,0,0,0,0,0
.long 131584,2560,68096,133632,17476,149000,151568,148736,151040,140032,37888,8,98368,7200,7200,4160,4192,64,16256,0,0,0,0,0,0,0,0,0,0,0,0,0
.long 131600,2576,68112,133648,17476,149016,151600,148744,151048,140048,37904,24,98384,7216,7216,4168,4200,1216,1065353216,0,0,0,0,0,0,0,0,0,0,0,0,0
.long 131616,2592,68128,133664,61166,149032,151632,148736,151056,140096,37920,264,98400,7232,80928,4176,4208,80,0,16256,0,0,0,0,0,0,0,0,0,0,0,0
.long 131632,2608,68144,133680,61166,149048,151664,148744,151064,140112,37936,280,98416,7248,80944,4184,4216,1232,0,1065353216,0,0,0,0,0,0,0,0,0,0,0,0
.long 131648,2624,68160,133696,17476,149064,151696,148752,151072,140160,37952,520,98304,6912,6912,4448,4416,2368,0,0,16256,0,0,0,0,0,0,0,0,0,0,0
.long 131664,2640,68176,133712,17476,149080,151728,148760,151080,140176,37968,536,98320,6928,6928,4456,4424,3520,0,0,1065353216,0,0,0,0,0,0,0,0,0,0,0
.long 131680,2656,68192,133728,61166,149096,151760,148752,151088,140224,37984,776,98336,6944,80640,4464,4432,2384,0,0,0,16256,0,0,0,0,0,0,0,0,0,0
.long 131696,2672,68208,133744,61166,149112,151792,148760,151096,140240,38000,792,98352,6960,80656,4472,4440,3536,0,0,0,1065353216,0,0,0,0,0,0,0,0,0,0
.long 131712,2688,68224,133760,17476,149128,151824,148768,151104,140032,47360,8,98496,7776,7776,4608,4640,4672,0,0,0,0,0,0,0,0,0,0,0,0,0,0
.long 131728,2704,68240,133776,17476,149144,151856,148776,151112,140048,47376,24,98512,7792,7792,4616,4648,5824,0,0,0,0,0,0,0,0,0,0,0,0,0,0
.long 131744,2720,68256,133792,61166,149160,151888,148768,151120,140096,47392,264,98528,7808,81504,4624,4656,4688,0,0,0,0,0,0,0,0,0,0,0,0,0,0
.long 131760,2736,68272,133808,61166,149176,151920,148776,151128,140112,47408,280,98544,7824,81520,4632,4664,5840,0,0,0,0,0,0,0,0,0,0,0,0,0,0
.long 131776,2752,68288,133824,17476,149192,151952,148784,151136,140160,47424,520,98432,7488,7488,4896,4864,6976,0,0,0,0,0,0,0,0,0,0,0,0,0,0
.long 131792,2768,68304,133840,17476,149208,151984,148792,151144,140176,47440,536,98448,7504,7504,4904,4872,8128,0,0,0,0,0,0,0,0,0,0,0,0,0,0
.long 131808,2784,68320,133856,61166,149224,152016,148784,151152,140224,47456,776,98464,7520,81216,4912,4880,6992,0,0,0,0,0,0,0,0,0,0,0,0,0,0
.long 131824,2800,68336,133872,61166,149240,152048,148792,151160,140240,47472,792,98480,7536,81232,4920,4888,8144,0,0,0,0,0,0,0,0,0,0,0,0,0,0
.long 131840,2816,68352,133888,17476,149004,151576,148800,151168,140064,56832,12,114784,8384,82080,6336,6368,96,16256,0,0,0,0,0,0,0,0,0,0,0,0,0
.long 131856,2832,68368,133904,17476,149020,151608,148808,151176,140080,56848,28,114800,8400,82096,6344,6376,1248,1065353216,0,0,0,0,0,0,0,0,0,0,0,0,0
.long 131872,2848,68384,133920,61166,149036,151640,148800,151184,140128,56864,268,114752,8352,8352,6352,6384,112,0,16256,0,0,0,0,0,0,0,0,0,0,0,0
.long 131888,2864,68400,133936,61166,149052,151672,148808,151192,140144,56880,284,114768,8368,8368,6360,6392,1264,0,1065353216,0,0,0,0,0,0,0,0,0,0,0,0
.long 131904,2880,68416,133952,17476,149068,151704,148816,151200,140192,56896,524,114720,8096,81792,6624,6592,2400,0,0,16256,0,0,0,0,0,0,0,0,0,0,0
.long 131920,2896,68432,133968,17476,149084,151736,148824,151208,140208,56912,540,114736,8112,81808,6632,6600,3552,0,0,1065353216,0,0,0,0,0,0,0,0,0,0,0
.long 131936,2912,68448,133984,61166,149100,151768,148816,151216,140256,56928,780,114688,8064,8064,6640,6608,2416,0,0,0,16256,0,0,0,0,0,0,0,0,0,0
.long 131952,2928,68464,134000,61166,149116,151800,148824,151224,140272,56944,796,114704,8080,8080,6648,6616,3568,0,0,0,1065353216,0,0,0,0,0,0,0,0,0,0
.long 131968,2944,68480,134016,17476,149132,151832,148832,151232,140064,66304,12,114912,8960,82656,6784,6816,4704,0,0,0,0,0,0,0,0,0,0,0,0,0,0
.long 131984,2960,68496,134032,17476,149148,151864,148840,151240,140080,66320,28,114928,8976,82672,6792,6824,5856,0,0,0,0,0,0,0,0,0,0,0,0,0,0
.long 132000,2976,68512,134048,61166,149164,151896,148832,151248,140128,66336,268,114880,8928,8928,6800,6832,4720,0,0,0,0,0,0,0,0,0,0,0,0,0,0
.long 132016,2992,68528,134064,61166,149180,151928,148840,151256,140144,66352,284,114896,8944,8944,6808,6840,5872,0,0,0,0,0,0,0,0,0,0,0,0,0,0
.long 132032,3008,68544,134080,17476,149196,151960,148848,151264,140192,66368,524,114848,8672,82368,7072,7040,7008,0,0,0,0,0,0,0,0,0,0,0,0,0,0
.long 132048,3024,68560,134096,17476,149212,151992,148856,151272,140208,66384,540,114864,8688,82384,7080,7048,8160,0,0,0,0,0,0,0,0,0,0,0,0,0,0
.long 132064,3040,68576,134112,61166,149228,152024,148848,151280,140256,66400,780,114816,8640,8640,7088,7056,7024,0,0,0,0,0,0,0,0,0,0,0,0,0,0
.long 132080,3056,68592,134128,61166,149244,152056,148856,151288,140272,66416,796,114832,8656,8656,7096,7064,8176,0,0,0,0,0,0,0,0,0,0,0,0,0,0
.long 131072,4096,69632,135168,17476,149504,152576,148480,150528,140288,0,0,8320,19008,19008,128,160,0,16256,0,0,0,0,0,0,0,0,0,0,0,0,0
.long 131088,4112,69648,135184,17476,149520,152608,148488,150536,140304,16,16,8336,19024,19024,136,168,1152,1065353216,0,0,0,0,0,0,0,0,0,0,0,0,0
.long 131104,4128,69664,135200,61166,149536,152640,148480,150544,140352,32,64,8352,19040,92736,144,176,16,0,16256,0,0,0,0,0,0,0,0,0,0,0,0
.long 131120,4144,69680,135216,61166,149552,152672,148488,150552,140368,48,80,8368,19056,92752,152,184,1168,0,1065353216,0,0,0,0,0,0,0,0,0,0,0,0
.long 131136,4160,69696,135232,17476,149568,152704,148496,150560,140416,64,128,8384,19296,19296,416,384,2304,0,0,16256,0,0,0,0,0,0,0,0,0,0,0
.long 131152,4176,69712,135248,17476,149584,152736,148504,150568,140432,80,144,8400,19312,19312,424,392,3456,0,0,1065353216,0,0,0,0,0,0,0,0,0,0,0
.long 131168,4192,69728,135264,61166,149600,152768,148496,150576,140480,96,192,8416,19328,93024,432,400,2320,0,0,0,16256,0,0,0,0,0,0,0,0,0,0
.long 131184,4208,69744,135280,61166,149616,152800,148504,150584,140496,112,208,8432,19344,93040,440,408,3472,0,0,0,1065353216,0,0,0,0,0,0,0,0,0,0
.long 131200,4224,69760,135296,17476,149632,152832,148512,150592,140288,9472,0,8192,18432,18432,704,736,4608,0,0,0,0,0,0,0,0,0,0,0,0,0,0
.long 131216,4240,69776,135312,17476,149648,152864,148520,150600,140304,9488,16,8208,18448,18448,712,744,5760,0,0,0,0,0,0,0,0,0,0,0,0,0,0
.long 131232,4256,69792,135328,61166,149664,152896,148512,150608,140352,9504,64,8224,18464,92160,720,752,4624,0,0,0,0,0,0,0,0,0,0,0,0,0,0
.long 131248,4272,69808,135344,61166,149680,152928,148520,150616,140368,9520,80,8240,18480,92176,728,760,5776,0,0,0,0,0,0,0,0,0,0,0,0,0,0
.long 131264,4288,69824,135360,17476,149696,152960,148528,150624,140416,9536,128,8256,18720,18720,992,960,6912,0,0,0,0,0,0,0,0,0,0,0,0,0,0
.long 131280,4304,69840,135376,17476,149712,152992,148536,150632,140432,9552,144,8272,18736,18736,1000,968,8064,0,0,0,0,0,0,0,0,0,0,0,0,0,0
.long 131296,4320,69856,135392,61166,149728,153024,148528,150640,140480,9568,192,8288,18752,92448,1008,976,6928,0,0,0,0,0,0,0,0,0,0,0,0,0,0
.long 131312,4336,69872,135408,61166,149744,153056,148536,150648,140496,9584,208,8304,18768,92464,1016,984,8080,0,0,0,0,0,0,0,0,0,0,0,0,0,0
.long 131328,4352,69888,135424,17476,149508,152584,148544,150656,140320,18944,4,24736,20192,93888,2048,2080,32,16256,0,0,0,0,0,0,0,0,0,0,0,0,0
.long 131344,4368,69904,135440,17476,149524,152616,148552,150664,140336,18960,20,24752,20208,93904,2056,2088,1184,1065353216,0,0,0,0,0,0,0,0,0,0,0,0,0
.long 131360,4384,69920,135456,61166,149540,152648,148544,150672,140384,18976,68,24704,20160,20160,2064,2096,48,0,16256,0,0,0,0,0,0,0,0,0,0,0,0
.long 131376,4400,69936,135472,61166,149556,152680,148552,150680,140400,18992,84,24720,20176,20176,2072,2104,1200,0,1065353216,0,0,0,0,0,0,0,0,0,0,0,0
.long 131392,4416,69952,135488,17476,149572,152712,148560,150688,140448,19008,132,24800,20480,94176,2336,2304,2336,0,0,16256,0,0,0,0,0,0,0,0,0,0,0
.long 131408,4432,69968,135504,17476,149588,152744,148568,150696,140464,19024,148,24816,20496,94192,2344,2312,3488,0,0,1065353216,0,0,0,0,0,0,0,0,0,0,0
.long 131424,4448,69984,135520,61166,149604,152776,148560,150704,140512,19040,196,24768,20448,20448,2352,2320,2352,0,0,0,16256,0,0,0,0,0,0,0,0,0,0
.long 131440,4464,70000,135536,61166,149620,152808,148568,150712,140528,19056,212,24784,20464,20464,2360,2328,3504,0,0,0,1065353216,0,0,0,0,0,0,0,0,0,0
.long 131456,4480,70016,135552,17476,149636,152840,148576,150720,140320,28416,4,24608,19616,93312,2624,2656,4640,0,0,0,0,0,0,0,0,0,0,0,0,0,0
.long 131472,4496,70032,135568,17476,149652,152872,148584,150728,140336,28432,20,24624,19632,93328,2632,2664,5792,0,0,0,0,0,0,0,0,0,0,0,0,0,0
.long 131488,4512,70048,135584,61166,149668,152904,148576,150736,140384,28448,68,24576,19584,19584,2640,2672,4656,0,0,0,0,0,0,0,0,0,0,0,0,0,0
.long 131504,4528,70064,135600,61166,149684,152936,148584,150744,140400,28464,84,24592,19600,19600,2648,2680,5808,0,0,0,0,0,0,0,0,0,0,0,0,0,0
.long 131520,4544,70080,135616,17476,149700,152968,148592,150752,140448,28480,132,24672,19904,93600,2912,2880,6944,0,0,0,0,0,0,0,0,0,0,0,0,0,0
.long 131536,4560,70096,135632,17476,149716,153000,148600,150760,140464,28496,148,24688,19920,93616,2920,2888,8096,0,0,0,0,0,0,0,0,0,0,0,0,0,0
.long 131552,4576,70112,135648,61166,149732,153032,148592,150768,140512,28512,196,24640,19872,19872,2928,2896,6960,0,0,0,0,0,0,0,0,0,0,0,0,0,0
.long 131568,4592,70128,135664,61166,149748,153064,148600,150776,140528,28528,212,24656,19888,19888,2936,2904,8112,0,0,0,0,0,0,0,0,0,0,0,0,0,0
.long 131584,4608,70144,135680,17476,149512,152592,148736,151040,140544,37888,8,73920,23904,23904,4224,4256,64,16256,0,0,0,0,0,0,0,0,0,0,0,0,0
.long 131600,4624,70160,135696,17476,149528,152624,148744,151048,140560,37904,24,73936,23920,23920,4232,4264,1216,1065353216,0,0,0,0,0,0,0,0,0,0,0,0,0
.long 131616,4640,70176,135712,61166,149544,152656,148736,151056,140608,37920,72,73952,23936,97632,4240,4272,80,0,16256,0,0,0,0,0,0,0,0,0,0,0,0
.long 131632,4656,70192,135728,61166,149560,152688,148744,151064,140624,37936,88,73968,23952,97648,4248,4280,1232,0,1065353216,0,0,0,0,0,0,0,0,0,0,0,0
.long 131648,4672,70208,135744,17476,149576,152720,148752,151072,140672,37952,136,73856,23616,23616,4512,4480,2368,0,0,16256,0,0,0,0,0,0,0,0,0,0,0
.long 131664,4688,70224,135760,17476,149592,152752,148760,151080,140688,37968,152,73872,23632,23632,4520,4488,3520,0,0,1065353216,0,0,0,0,0,0,0,0,0,0,0
.long 131680,4704,70240,135776,61166,149608,152784,148752,151088,140736,37984,200,73888,23648,97344,4528,4496,2384,0,0,0,16256,0,0,0,0,0,0,0,0,0,0
.long 131696,4720,70256,135792,61166,149624,152816,148760,151096,140752,38000,216,73904,23664,97360,4536,4504,3536,0,0,0,1065353216,0,0,0,0,0,0,0,0,0,0
.long 131712,4736,70272,135808,17476,149640,152848,148768,151104,140544,47360,8,73792,23328,23328,4800,4832,4672,0,0,0,0,0,0,0,0,0,0,0,0,0,0
.long 131728,4752,70288,135824,17476,149656,152880,148776,151112,140560,47376,24,73808,23344,23344,4808,4840,5824,0,0,0,0,0,0,0,0,0,0,0,0,0,0
.long 131744,4768,70304,135840,61166,149672,152912,148768,151120,140608,47392,72,73824,23360,97056,4816,4848,4688,0,0,0,0,0,0,0,0,0,0,0,0,0,0
.long 131760,4784,70320,135856,61166,149688,152944,148776,151128,140624,47408,88,73840,23376,97072,4824,4856,5840,0,0,0,0,0,0,0,0,0,0,0,0,0,0
.long 131776,4800,70336,135872,17476,149704,152976,148784,151136,140672,47424,136,73728,23040,23040,5088,5056,6976,0,0,0,0,0,0,0,0,0,0,0,0,0,0
.long 131792,4816,70352,135888,17476,149720,153008,148792,151144,140688,47440,152,73744,23056,23056,5096,5064,8128,0,0,0,0,0,0,0,0,0,0,0,0,0,0
.long 131808,4832,70368,135904,61166,149736,153040,148784,151152,140736,47456,200,73760,23072,96768,5104,5072,6992,0,0,0,0,0,0,0,0,0,0,0,0,0,0
.long 131824,4848,70384,135920,61166,149752,153072,148792,151160,140752,47472,216,73776,23088,96784,5112,5080,8144,0,0,0,0,0,0,0,0,0,0,0,0,0,0
.long 131840,4864,70400,135936,17476,149516,152600,148800,151168,140576,56832,12,90336,25088,98784,6144,6176,96,16256,0,0,0,0,0,0,0,0,0,0,0,0,0
.long 131856,4880,70416,135952,17476,149532,152632,148808,151176,140592,56848,28,90352,25104,98800,6152,6184,1248,1065353216,0,0,0,0,0,0,0,0,0,0,0,0,0
.long 131872,4896,70432,135968,61166,149548,152664,148800,151184,140640,56864,76,90304,25056,25056,6160,6192,112,0,16256,0,0,0,0,0,0,0,0,0,0,0,0
.long 131888,4912,70448,135984,61166,149564,152696,148808,151192,140656,56880,92,90320,25072,25072,6168,6200,1264,0,1065353216,0,0,0,0,0,0,0,0,0,0,0,0
.long 131904,4928,70464,136000,17476,149580,152728,148816,151200,140704,56896,140,90272,24800,98496,6432,6400,2400,0,0,16256,0,0,0,0,0,0,0,0,0,0,0
.long 131920,4944,70480,136016,17476,149596,152760,148824,151208,140720,56912,156,90288,24816,98512,6440,6408,3552,0,0,1065353216,0,0,0,0,0,0,0,0,0,0,0
.long 131936,4960,70496,136032,61166,149612,152792,148816,151216,140768,56928,204,90240,24768,24768,6448,6416,2416,0,0,0,16256,0,0,0,0,0,0,0,0,0,0
.long 131952,4976,70512,136048,61166,149628,152824,148824,151224,140784,56944,220,90256,24784,24784,6456,6424,3568,0,0,0,1065353216,0,0,0,0,0,0,0,0,0,0
.long 131968,4992,70528,136064,17476,149644,152856,148832,151232,140576,66304,12,90208,24512,98208,6720,6752,4704,0,0,0,0,0,0,0,0,0,0,0,0,0,0
.long 131984,5008,70544,136080,17476,149660,152888,148840,151240,140592,66320,28,90224,24528,98224,6728,6760,5856,0,0,0,0,0,0,0,0,0,0,0,0,0,0
.long 132000,5024,70560,136096,61166,149676,152920,148832,151248,140640,66336,76,90176,24480,24480,6736,6768,4720,0,0,0,0,0,0,0,0,0,0,0,0,0,0
.long 132016,5040,70576,136112,61166,149692,152952,148840,151256,140656,66352,92,90192,24496,24496,6744,6776,5872,0,0,0,0,0,0,0,0,0,0,0,0,0,0
.long 132032,5056,70592,136128,17476,149708,152984,148848,151264,140704,66368,140,90144,24224,97920,7008,6976,7008,0,0,0,0,0,0,0,0,0,0,0,0,0,0
.long 132048,5072,70608,136144,17476,149724,153016,148856,151272,140720,66384,156,90160,24240,97936,7016,6984,8160,0,0,0,0,0,0,0,0,0,0,0,0,0,0
.long 132064,5088,70624,136160,61166,149740,153048,148848,151280,140768,66400,204,90112,24192,24192,7024,6992,7024,0,0,0,0,0,0,0,0,0,0,0,0,0,0
.long 132080,5104,70640,136176,61166,149756,153080,148856,151288,140784,66416,220,90128,24208,24208,7032,7000,8176,0,0,0,0,0,0,0,0,0,0,0,0,0,0
.long 131072,6144,71680,137216,17476,150016,153600,148480,150528,140800,0,0,41088,21312,21312,192,224,0,16256,0,0,0,0,0,0,0,0,0,0,0,0,0
.long 131088,6160,71696,137232,17476,150032,153632,148488,150536,140816,16,16,41104,21328,21328,200,232,1152,1065353216,0,0,0,0,0,0,0,0,0,0,0,0,0
.long 131104,6176,71712,137248,61166,150048,153664,148480,150544,140864,32,256,41120,21344,95040,208,240,16,0,16256,0,0,0,0,0,0,0,0,0,0,0,0
.long 131120,6192,71728,137264,61166,150064,153696,148488,150552,140880,48,272,41136,21360,95056,216,248,1168,0,1065353216,0,0,0,0,0,0,0,0,0,0,0,0
.long 131136,6208,71744,137280,17476,150080,153728,148496,150560,140928,64,512,41152,21600,21600,480,448,2304,0,0,16256,0,0,0,0,0,0,0,0,0,0,0
.long 131152,6224,71760,137296,17476,150096,153760,148504,150568,140944,80,528,41168,21616,21616,488,456,3456,0,0,1065353216,0,0,0,0,0,0,0,0,0,0,0
.long 131168,6240,71776,137312,61166,150112,153792,148496,150576,140992,96,768,41184,21632,95328,496,464,2320,0,0,0,16256,0,0,0,0,0,0,0,0,0,0
.long 131184,6256,71792,137328,61166,150128,153824,148504,150584,141008,112,784,41200,21648,95344,504,472,3472,0,0,0,1065353216,0,0,0,0,0,0,0,0,0,0
.long 131200,6272,71808,137344,17476,150144,153856,148512,150592,140800,9472,0,40960,20736,20736,640,672,4608,0,0,0,0,0,0,0,0,0,0,0,0,0,0
.long 131216,6288,71824,137360,17476,150160,153888,148520,150600,140816,9488,16,40976,20752,20752,648,680,5760,0,0,0,0,0,0,0,0,0,0,0,0,0,0
.long 131232,6304,71840,137376,61166,150176,153920,148512,150608,140864,9504,256,40992,20768,94464,656,688,4624,0,0,0,0,0,0,0,0,0,0,0,0,0,0
.long 131248,6320,71856,137392,61166,150192,153952,148520,150616,140880,9520,272,41008,20784,94480,664,696,5776,0,0,0,0,0,0,0,0,0,0,0,0,0,0
.long 131264,6336,71872,137408,17476,150208,153984,148528,150624,140928,9536,512,41024,21024,21024,928,896,6912,0,0,0,0,0,0,0,0,0,0,0,0,0,0
.long 131280,6352,71888,137424,17476,150224,154016,148536,150632,140944,9552,528,41040,21040,21040,936,904,8064,0,0,0,0,0,0,0,0,0,0,0,0,0,0
.long 131296,6368,71904,137440,61166,150240,154048,148528,150640,140992,9568,768,41056,21056,94752,944,912,6928,0,0,0,0,0,0,0,0,0,0,0,0,0,0
.long 131312,6384,71920,137456,61166,150256,154080,148536,150648,141008,9584,784,41072,21072,94768,952,920,8080,0,0,0,0,0,0,0,0,0,0,0,0,0,0
.long 131328,6400,71936,137472,17476,150020,153608,148544,150656,140832,18944,4,57504,22496,96192,2112,2144,32,16256,0,0,0,0,0,0,0,0,0,0,0,0,0
.long 131344,6416,71952,137488,17476,150036,153640,148552,150664,140848,18960,20,57520,22512,96208,2120,2152,1184,1065353216,0,0,0,0,0,0,0,0,0,0,0,0,0
.long 131360,6432,71968,137504,61166,150052,153672,148544,150672,140896,18976,260,57472,22464,22464,2128,2160,48,0,16256,0,0,0,0,0,0,0,0,0,0,0,0
.long 131376,6448,71984,137520,61166,150068,153704,148552,150680,140912,18992,276,57488,22480,22480,2136,2168,1200,0,1065353216,0,0,0,0,0,0,0,0,0,0,0,0
.long 131392,6464,72000,137536,17476,150084,153736,148560,150688,140960,19008,516,57568,22784,96480,2400,2368,2336,0,0,16256,0,0,0,0,0,0,0,0,0,0,0
.long 131408,6480,72016,137552,17476,150100,153768,148568,150696,140976,19024,532,57584,22800,96496,2408,2376,3488,0,0,1065353216,0,0,0,0,0,0,0,0,0,0,0
.long 131424,6496,72032,137568,61166,150116,153800,148560,150704,141024,19040,772,57536,22752,22752,2416,2384,2352,0,0,0,16256,0,0,0,0,0,0,0,0,0,0
.long 131440,6512,72048,137584,61166,150132,153832,148568,150712,141040,19056,788,57552,22768,22768,2424,2392,3504,0,0,0,1065353216,0,0,0,0,0,0,0,0,0,0
.long 131456,6528,72064,137600,17476,150148,153864,148576,150720,140832,28416,4,57376,21920,95616,2560,2592,4640,0,0,0,0,0,0,0,0,0,0,0,0,0,0
.long 131472,6544,72080,137616,17476,150164,153896,148584,150728,140848,28432,20,57392,21936,95632,2568,2600,5792,0,0,0,0,0,0,0,0,0,0,0,0,0,0
.long 131488,6560,72096,137632,61166,150180,153928,148576,150736,140896,28448,260,57344,21888,21888,2576,2608,4656,0,0,0,0,0,0,0,0,0,0,0,0,0,0
.long 131504,6576,72112,137648,61166,150196,153960,148584,150744,140912,28464,276,57360,21904,21904,2584,2616,5808,0,0,0,0,0,0,0,0,0,0,0,0,0,0
.long 131520,6592,72128,137664,17476,150212,153992,148592,150752,140960,28480,516,57440,22208,95904,2848,2816,6944,0,0,0,0,0,0,0,0,0,0,0,0,0,0
.long 131536,6608,72144,137680,17476,150228,154024,148600,150760,140976,28496,532,57456,22224,95920,2856,2824,8096,0,0,0,0,0,0,0,0,0,0,0,0,0,0
.long 131552,6624,72160,137696,61166,150244,154056,148592,150768,141024,28512,772,57408,22176,22176,2864,2832,6960,0,0,0,0,0,0,0,0,0,0,0,0,0,0
.long 131568,6640,72176,137712,61166,150260,154088,148600,150776,141040,28528,788,57424,22192,22192,2872,2840,8112,0,0,0,0,0,0,0,0,0,0,0,0,0,0
.long 131584,6656,72192,137728,17476,150024,153616,148736,151040,141056,37888,8,106688,26208,26208,4288,4320,64,16256,0,0,0,0,0,0,0,0,0,0,0,0,0
.long 131600,6672,72208,137744,17476,150040,153648,148744,151048,141072,37904,24,106704,26224,26224,4296,4328,1216,1065353216,0,0,0,0,0,0,0,0,0,0,0,0,0
.long 131616,6688,72224,137760,61166,150056,153680,148736,151056,141120,37920,264,106720,26240,99936,4304,4336,80,0,16256,0,0,0,0,0,0,0,0,0,0,0,0
.long 131632,6704,72240,137776,61166,150072,153712,148744,151064,141136,37936,280,106736,26256,99952,4312,4344,1232,0,1065353216,0,0,0,0,0,0,0,0,0,0,0,0
.long 131648,6720,72256,137792,17476,150088,153744,148752,151072,141184,37952,520,106624,25920,25920,4576,4544,2368,0,0,16256,0,0,0,0,0,0,0,0,0,0,0
.long 131664,6736,72272,137808,17476,150104,153776,148760,151080,141200,37968,536,106640,25936,25936,4584,4552,3520,0,0,1065353216,0,0,0,0,0,0,0,0,0,0,0
.long 131680,6752,72288,137824,61166,150120,153808,148752,151088,141248,37984,776,106656,25952,99648,4592,4560,2384,0,0,0,16256,0,0,0,0,0,0,0,0,0,0
.long 131696,6768,72304,137840,61166,150136,153840,148760,151096,141264,38000,792,106672,25968,99664,4600,4568,3536,0,0,0,1065353216,0,0,0,0,0,0,0,0,0,0
.long 131712,6784,72320,137856,17476,150152,153872,148768,151104,141056,47360,8,106560,25632,25632,4736,4768,4672,0,0,0,0,0,0,0,0,0,0,0,0,0,0
.long 131728,6800,72336,137872,17476,150168,153904,148776,151112,141072,47376,24,106576,25648,25648,4744,4776,5824,0,0,0,0,0,0,0,0,0,0,0,0,0,0
.long 131744,6816,72352,137888,61166,150184,153936,148768,151120,141120,47392,264,106592,25664,99360,4752,4784,4688,0,0,0,0,0,0,0,0,0,0,0,0,0,0
.long 131760,6832,72368,137904,61166,150200,153968,148776,151128,141136,47408,280,106608,25680,99376,4760,4792,5840,0,0,0,0,0,0,0,0,0,0,0,0,0,0
.long 131776,6848,72384,137920,17476,150216,154000,148784,151136,141184,47424,520,106496,25344,25344,5024,4992,6976,0,0,0,0,0,0,0,0,0,0,0,0,0,0
.long 131792,6864,72400,137936,17476,150232,154032,148792,151144,141200,47440,536,106512,25360,25360,5032,5000,8128,0,0,0,0,0,0,0,0,0,0,0,0,0,0
.long 131808,6880,72416,137952,61166,150248,154064,148784,151152,141248,47456,776,106528,25376,99072,5040,5008,6992,0,0,0,0,0,0,0,0,0,0,0,0,0,0
.long 131824,6896,72432,137968,61166,150264,154096,148792,151160,141264,47472,792,106544,25392,99088,5048,5016,8144,0,0,0,0,0,0,0,0,0,0,0,0,0,0
.long 131840,6912,72448,137984,17476,150028,153624,148800,151168,141088,56832,12,123104,27392,101088,6208,6240,96,16256,0,0,0,0,0,0,0,0,0,0,0,0,0
.long 131856,6928,72464,138000,17476,150044,153656,148808,151176,141104,56848,28,123120,27408,101104,6216,6248,1248,1065353216,0,0,0,0,0,0,0,0,0,0,0,0,0
.long 131872,6944,72480,138016,61166,150060,153688,148800,151184,141152,56864,268,123072,27360,27360,6224,6256,112,0,16256,0,0,0,0,0,0,0,0,0,0,0,0
.long 131888,6960,72496,138032,61166,150076,153720,148808,151192,141168,56880,284,123088,27376,27376,6232,6264,1264,0,1065353216,0,0,0,0,0,0,0,0,0,0,0,0
.long 131904,6976,72512,138048,17476,150092,153752,148816,151200,141216,56896,524,123040,27104,100800,6496,6464,2400,0,0,16256,0,0,0,0,0,0,0,0,0,0,0
.long 131920,6992,72528,138064,17476,150108,153784,148824,151208,141232,56912,540,123056,27120,100816,6504,6472,3552,0,0,1065353216,0,0,0,0,0,0,0,0,0,0,0
.long 131936,7008,72544,138080,61166,150124,153816,148816,151216,141280,56928,780,123008,27072,27072,6512,6480,2416,0,0,0,16256,0,0,0,0,0,0,0,0,0,0
.long 131952,7024,72560,138096,61166,150140,153848,148824,151224,141296,56944,796,123024,27088,27088,6520,6488,3568,0,0,0,1065353216,0,0,0,0,0,0,0,0,0,0
.long 131968,7040,72576,138112,17476,150156,153880,148832,151232,141088,66304,12,122976,26816,100512,6656,6688,4704,0,0,0,0,0,0,0,0,0,0,0,0,0,0
.long 131984,7056,72592,138128,17476,150172,153912,148840,151240,141104,66320,28,122992,26832,100528,6664,6696,5856,0,0,0,0,0,0,0,0,0,0,0,0,0,0
.long 132000,7072,72608,138144,61166,150188,153944,148832,151248,141152,66336,268,122944,26784,26784,6672,6704,4720,0,0,0,0,0,0,0,0,0,0,0,0,0,0
.long 132016,7088,72624,138160,61166,150204,153976,148840,151256,141168,66352,284,122960,26800,26800,6680,6712,5872,0,0,0,0,0,0,0,0,0,0,0,0,0,0
.long 132032,7104,72640,138176,17476,150220,154008,148848,151264,141216,66368,524,122912,26528,100224,6944,6912,7008,0,0,0,0,0,0,0,0,0,0,0,0,0,0
.long 132048,7120,72656,138192,17476,150236,154040,148856,151272,141232,66384,540,122928,26544,100240,6952,6920,8160,0,0,0,0,0,0,0,0,0,0,0,0,0,0
.long 132064,7136,72672,138208,61166,150252,154072,148848,151280,141280,66400,780,122880,26496,26496,6960,6928,7024,0,0,0,0,0,0,0,0,0,0,0,0,0,0
.long 132080,7152,72688,138224,61166,150268,154104,148856,151288,141296,66416,796,122896,26512,26512,6968,6936,8176,0,0,0,0,0,0,0,0,0,0,0,0,0,0
.p2align 8
worker_tab:
.long 0,0,0,0,0,64,0,0,0,0,32,0,0,0,32,0,0,8192,16384,8192,17408,17408,0,0,0,0,0,0,0,0,0,0,0,4048155338,4048155338,4048155338,4048155338,4048155338,4048155338,4048155338,16256,0,0,0,0,0,0,0
.long 16,16,512,16,8,72,8,16,16,8,40,8,16,8,40,16,16,8208,16392,8208,17440,17416,16,1152,2304,16,0,16,16,1152,2304,8,0,0,4048155338,4048155338,4048155338,4048155338,4048155338,4048155338,1065353216,0,0,0,0,0,0,0
.long 32,32,1024,32,16,80,16,32,9216,16,48,16,32,16,48,32,32,8224,16400,8224,17472,17424,32,2304,4608,32,0,32,32,2304,4608,16,0,0,0,4048155338,4048155338,4048155338,4048155338,4048155338,0,16256,0,0,0,0,0,0
.long 48,48,1536,48,24,88,24,48,9232,24,56,24,48,24,56,48,48,8240,16408,8240,17504,17432,48,3456,6912,48,0,48,48,3456,6912,24,0,0,0,0,4048155338,4048155338,4048155338,4048155338,0,1065353216,0,0,0,0,0,0
.long 64,64,2048,64,320,256,320,64,18432,288,256,32,288,288,256,64,64,8256,16416,8256,17536,17440,64,4608,9216,64,0,64,64,4608,9216,32,0,0,0,0,4048155338,4048155338,4048155338,4048155338,0,0,16256,0,0,0,0,0
.long 80,80,2560,80,328,264,328,80,18448,296,264,40,304,296,264,80,80,8272,16424,8272,17568,17448,80,5760,11520,80,0,80,80,5760,11520,40,0,0,0,0,4048155338,4048155338,4048155338,4048155338,0,0,1065353216,0,0,0,0,0
.long 96,96,3072,96,336,272,336,96,27648,304,272,48,320,304,272,96,96,8288,16432,8288,17600,17456,96,6912,13824,96,0,96,96,6912,13824,48,0,0,0,0,4048155338,4048155338,4048155338,4048155338,0,0,0,16256,0,0,0,0
.long 112,112,3584,112,344,280,344,112,27664,312,280,56,336,312,280,112,112,8304,16440,8304,17632,17464,112,8064,16128,112,0,112,112,8064,16128,56,0,0,0,0,4048155338,4048155338,4048155338,4048155338,0,0,0,1065353216,0,0,0,0
.long 128,1152,16,128,640,704,640,128,36864,576,608,64,576,576,608,1024,128,8320,16448,8320,17664,17472,128,9216,18432,128,0,128,128,9216,18432,64,0,0,0,0,0,4048155338,4048155338,4048155338,0,0,0,0,0,0,0,0
.long 144,1168,528,144,648,712,648,144,36880,584,616,72,592,584,616,1040,144,8336,16456,8336,17696,17480,144,10368,20736,144,0,144,144,10368,20736,72,0,0,0,0,0,0,4048155338,4048155338,0,0,0,0,0,0,0,0
.long 160,1184,1040,160,656,720,656,160,46080,592,624,80,608,592,624,1056,160,8352,16464,8352,17728,17488,160,11520,23040,160,0,160,160,11520,23040,80,0,0,0,0,0,0,0,4048155338,0,0,0,0,0,0,0,0
.long 176,1200,1552,176,664,728,664,176,46096,600,632,88,624,600,632,1072,176,8368,16472,8368,17760,17496,176,12672,25344,176,0,176,176,12672,25344,88,0,0,0,0,0,0,0,0,0,0,0,0,0,0,0,0
.long 192,1216,2064,192,960,896,960,192,55296,864,832,96,864,864,832,1088,192,8384,16480,8384,17792,17504,192,13824,27648,192,0,192,192,13824,27648,96,0,0,0,0,0,0,0,0,0,0,0,0,0,0,0,0
.long 208,1232,2576,208,968,904,968,208,55312,872,840,104,880,872,840,1104,208,8400,16488,8400,17824,17512,208,14976,29952,208,0,208,208,14976,29952,104,0,0,0,0,0,0,0,0,0,0,0,0,0,0,0,0
.long 224,1248,3088,224,976,912,976,224,64512,880,848,112,896,880,848,1120,224,8416,16496,8416,17856,17520,224,16128,32256,224,0,224,224,16128,32256,112,0,0,0,0,0,0,0,0,0,0,0,0,0,0,0,0
.long 240,1264,3600,240,984,920,984,240,64528,888,856,120,912,888,856,1136,240,8432,16504,8432,17888,17528,240,17280,34560,240,0,240,240,17280,34560,120,0,0,0,0,0,0,0,0,0,0,0,0,0,0,0,0
.long 256,2304,32,8256,32,96,32,9248,73728,2176,2208,256,1184,1152,1184,128,1024,8448,16512,8448,17416,17536,36864,32,64,8,8,512,512,8,16,128,4048155338,4048155338,4048155338,4048155338,4048155338,4048155338,4048155338,4048155338,16256,0,0,0,0,0,0,0
.long 272,2320,544,8272,40,104,40,9264,73744,2184,2216,264,1200,1160,1192,144,1040,8464,16520,8464,17448,17544,36880,1184,2368,24,8,528,528,1160,2320,136,4048155338,4048155338,4048155338,4048155338,4048155338,4048155338,4048155338,4048155338,1065353216,0,0,0,0,0,0,0
.long 288,2336,1056,8288,48,112,48,9216,82944,2192,2224,272,1152,1168,1200,160,1056,8480,16528,8480,17480,17552,36896,2336,4672,40,8,544,544,2312,4624,144,4048155338,4048155338,4048155338,4048155338,4048155338,4048155338,4048155338,4048155338,0,16256,0,0,0,0,0,0
.long 304,2352,1568,8304,56,120,56,9232,82960,2200,2232,280,1168,1176,1208,176,1072,8496,16536,8496,17512,17560,36912,3488,6976,56,8,560,560,3464,6928,152,4048155338,4048155338,4048155338,4048155338,4048155338,4048155338,4048155338,4048155338,0,1065353216,0,0,0,0,0,0
.long 320,2368,2080,8192,352,288,352,9312,92160,2464,2432,288,1472,1440,1408,192,1088,8512,16544,8512,17544,17568,36928,4640,9280,72,8,576,576,4616,9232,160,0,4048155338,4048155338,4048155338,4048155338,4048155338,4048155338,4048155338,0,0,16256,0,0,0,0,0
.long 336,2384,2592,8208,360,296,360,9328,92176,2472,2440,296,1488,1448,1416,208,1104,8528,16552,8528,17576,17576,36944,5792,11584,88,8,592,592,5768,11536,168,0,0,4048155338,4048155338,4048155338,4048155338,4048155338,4048155338,0,0,1065353216,0,0,0,0,0
.long 352,2400,3104,8224,368,304,368,9280,101376,2480,2448,304,1440,1456,1424,224,1120,8544,16560,8544,17608,17584,36960,6944,13888,104,8,608,608,6920,13840,176,0,0,0,4048155338,4048155338,4048155338,4048155338,4048155338,0,0,0,16256,0,0,0,0
.long 368,2416,3616,8240,376,312,376,9296,101392,2488,2456,312,1456,1464,1432,240,1136,8560,16568,8560,17640,17592,36976,8096,16192,120,8,624,624,8072,16144,184,0,0,0,0,4048155338,4048155338,4048155338,4048155338,0,0,0,1065353216,0,0,0,0
.long 384,3456,48,8384,672,736,672,9376,110592,2752,2784,320,1760,1728,1760,1152,1152,8576,16576,8576,17672,17600,36992,9248,18496,136,8,640,640,9224,18448,192,0,0,0,0,4048155338,4048155338,4048155338,4048155338,0,0,0,0,0,0,0,0
.long 400,3472,560,8400,680,744,680,9392,110608,2760,2792,328,1776,1736,1768,1168,1168,8592,16584,8592,17704,17608,37008,10400,20800,152,8,656,656,10376,20752,200,0,0,0,0,4048155338,4048155338,4048155338,4048155338,0,0,0,0,0,0,0,0
.long 416,3488,1072,8416,688,752,688,9344,119808,2768,2800,336,1728,1744,1776,1184,1184,8608,16592,8608,17736,17616,37024,11552,23104,168,8,672,672,11528,23056,208,0,0,0,0,4048155338,4048155338,4048155338,4048155338,0,0,0,0,0,0,0,0
.long 432,3504,1584,8432,696,760,696,9360,119824,2776,2808,344,1744,1752,1784,1200,1200,8624,16600,8624,17768,17624,37040,12704,25408,184,8,688,688,12680,25360,216,0,0,0,0,4048155338,4048155338,4048155338,4048155338,0,0,0,0,0,0,0,0
.long 448,3520,2096,8320,992,928,992,9440,129024,3040,3008,352,2048,2016,1984,1216,1216,8640,16608,8640,17800,17632,37056,13856,27712,200,8,704,704,13832,27664,224,0,0,0,0,0,4048155338,4048155338,4048155338,0,0,0,0,0,0,0,0
.long 464,3536,2608,8336,1000,936,1000,9456,129040,3048,3016,360,2064,2024,1992,1232,1232,8656,16616,8656,17832,17640,37072,15008,30016,216,8,720,720,14984,29968,232,0,0,0,0,0,0,4048155338,4048155338,0,0,0,0,0,0,0,0
.long 480,3552,3120,8352,1008,944,1008,9408,138240,3056,3024,368,2016,2032,2000,1248,1248,8672,16624,8672,17864,17648,37088,16160,32320,232,8,736,736,16136,32272,240,0,0,0,0,0,0,0,4048155338,0,0,0,0,0,0,0,0
.long 496,3568,3632,8368,1016,952,1016,9424,138256,3064,3032,376,2032,2040,2008,1264,1264,8688,16632,8688,17896,17656,37104,17312,34624,248,8,752,752,17288,34576,248,0,0,0,0,0,0,0,0,0,0,0,0,0,0,0,0
.long 512,4608,64,16512,2048,2112,2048,18496,147456,4096,4128,512,2592,2048,2080,256,256,8704,16640,8704,17424,17920,73728,0,0,256,16,1024,1024,0,0,256,4048155338,4048155338,4048155338,4048155338,4048155338,4048155338,4048155338,4048155338,16256,0,0,0,0,0,0,0
.long 528,4624,576,16528,2056,2120,2056,18512,147472,4104,4136,520,2608,2056,2088,272,272,8720,16648,8720,17456,17928,73744,1152,2304,272,16,1040,1040,1152,2304,264,4048155338,4048155338,4048155338,4048155338,4048155338,4048155338,4048155338,4048155338,1065353216,0,0,0,0,0,0,0
.long 544,4640,1088,16544,2064,2128,2064,18528,156672,4112,4144,528,2624,2064,2096,288,288,8736,16656,8736,17488,17936,73760,2304,4608,288,16,1056,1056,2304,4608,272,4048155338,4048155338,4048155338,4048155338,4048155338,4048155338,4048155338,4048155338,0,16256,0,0,0,0,0,0
.long 560,4656,1600,16560,2072,2136,2072,18544,156688,4120,4152,536,2640,2072,2104,304,304,8752,16664,8752,17520,17944,73776,3456,6912,304,16,1072,1072,3456,6912,280,4048155338,4048155338,4048155338,4048155338,4048155338,4048155338,4048155338,4048155338,0,1065353216,0,0,0,0,0,0
.long 576,4672,2112,16576,2368,2304,2368,18432,165888,4384,4352,544,2304,2336,2304,320,320,8768,16672,8768,17552,17952,73792,4608,9216,320,16,1088,1088,4608,9216,288,4048155338,4048155338,4048155338,4048155338,4048155338,4048155338,4048155338,4048155338,0,0,16256,0,0,0,0,0
.long 592,4688,2624,16592,2376,2312,2376,18448,165904,4392,4360,552,2320,2344,2312,336,336,8784,16680,8784,17584,17960,73808,5760,11520,336,16,1104,1104,5760,11520,296,4048155338,4048155338,4048155338,4048155338,4048155338,4048155338,4048155338,4048155338,0,0,1065353216,0,0,0,0,0
.long 608,4704,3136,16608,2384,2320,2384,18464,175104,4400,4368,560,2336,2352,2320,352,352,8800,16688,8800,17616,17968,73824,6912,13824,352,16,1120,1120,6912,13824,304,4048155338,4048155338,4048155338,4048155338,4048155338,4048155338,4048155338,4048155338,0,0,0,16256,0,0,0,0
.long 624,4720,3648,16624,2392,2328,2392,18480,175120,4408,4376,568,2352,2360,2328,368,368,8816,16696,8816,17648,17976,73840,8064,16128,368,16,1136,1136,8064,16128,312,4048155338,4048155338,4048155338,4048155338,4048155338,4048155338,4048155338,4048155338,0,0,0,1065353216,0,0,0,0
.long 640,5760,80,16384,2688,2752,2688,18624,184320,4672,4704,576,3168,2624,2656,1280,384,8832,16704,8832,17680,17984,73856,9216,18432,384,16,1152,1152,9216,18432,320,4048155338,4048155338,4048155338,4048155338,4048155338,4048155338,4048155338,4048155338,0,0,0,0,0,0,0,0
.long 656,5776,592,16400,2696,2760,2696,18640,184336,4680,4712,584,3184,2632,2664,1296,400,8848,16712,8848,17712,17992,73872,10368,20736,400,16,1168,1168,10368,20736,328,4048155338,4048155338,4048155338,4048155338,4048155338,4048155338,4048155338,4048155338,0,0,0,0,0,0,0,0
.long 672,5792,1104,16416,2704,2768,2704,18656,193536,4688,4720,592,3200,2640,2672,1312,416,8864,16720,8864,17744,18000,73888,11520,23040,416,16,1184,1184,11520,23040,336,4048155338,4048155338,4048155338,4048155338,4048155338,4048155338,4048155338,4048155338,0,0,0,0,0,0,0,0
.long 688,5808,1616,16432,2712,2776,2712,18672,193552,4696,4728,600,3216,2648,2680,1328,432,8880,16728,8880,17776,18008,73904,12672,25344,432,16,1200,1200,12672,25344,344,4048155338,4048155338,4048155338,4048155338,4048155338,4048155338,4048155338,4048155338,0,0,0,0,0,0,0,0
.long 704,5824,2128,16448,3008,2944,3008,18560,202752,4960,4928,608,2880,2912,2880,1344,448,8896,16736,8896,17808,18016,73920,13824,27648,448,16,1216,1216,13824,27648,352,4048155338,4048155338,4048155338,4048155338,4048155338,4048155338,4048155338,4048155338,0,0,0,0,0,0,0,0
.long 720,5840,2640,16464,3016,2952,3016,18576,202768,4968,4936,616,2896,2920,2888,1360,464,8912,16744,8912,17840,18024,73936,14976,29952,464,16,1232,1232,14976,29952,360,4048155338,4048155338,4048155338,4048155338,4048155338,4048155338,4048155338,4048155338,0,0,0,0,0,0,0,0
.long 736,5856,3152,16480,3024,2960,3024,18592,211968,4976,4944,624,2912,2928,2896,1376,480,8928,16752,8928,17872,18032,73952,16128,32256,480,16,1248,1248,16128,32256,368,4048155338,4048155338,4048155338,4048155338,4048155338,4048155338,4048155338,4048155338,0,0,0,0,0,0,0,0
.long 752,5872,3664,16496,3032,2968,3032,18608,211984,4984,4952,632,2928,2936,2904,1392,496,8944,16760,8944,17904,18040,73968,17280,34560,496,16,1264,1264,17280,34560,376,4048155338,4048155338,4048155338,4048155338,4048155338,4048155338,4048155338,4048155338,0,0,0,0,0,0,0,0
.long 768,6912,96,24768,2080,2144,2080,27744,221184,6272,6304,768,3776,3200,3232,384,1280,8960,16768,8960,17432,18048,110592,32,64,264,24,1536,1536,8,16,384,4048155338,4048155338,4048155338,4048155338,4048155338,4048155338,4048155338,4048155338,16256,0,0,0,0,0,0,0
.long 784,6928,608,24784,2088,2152,2088,27760,221200,6280,6312,776,3792,3208,3240,400,1296,8976,16776,8976,17464,18056,110608,1184,2368,280,24,1552,1552,1160,2320,392,4048155338,4048155338,4048155338,4048155338,4048155338,4048155338,4048155338,4048155338,1065353216,0,0,0,0,0,0,0
.long 800,6944,1120,24800,2096,2160,2096,27712,230400,6288,6320,784,3744,3216,3248,416,1312,8992,16784,8992,17496,18064,110624,2336,4672,296,24,1568,1568,2312,4624,400,4048155338,4048155338,4048155338,4048155338,4048155338,4048155338,4048155338,4048155338,0,16256,0,0,0,0,0,0
.long 816,6960,1632,24816,2104,2168,2104,27728,230416,6296,6328,792,3760,3224,3256,432,1328,9008,16792,9008,17528,18072,110640,3488,6976,312,24,1584,1584,3464,6928,408,4048155338,4048155338,4048155338,4048155338,4048155338,4048155338,4048155338,4048155338,0,1065353216,0,0,0,0,0,0
.long 832,6976,2144,24704,2400,2336,2400,27680,239616,6560,6528,800,3488,3488,3456,448,1344,9024,16800,9024,17560,18080,110656,4640,9280,328,24,1600,1600,4616,9232,416,4048155338,4048155338,4048155338,4048155338,4048155338,4048155338,4048155338,4048155338,0,0,16256,0,0,0,0,0
.long 848,6992,2656,24720,2408,2344,2408,27696,239632,6568,6536,808,3504,3496,3464,464,1360,9040,16808,9040,17592,18088,110672,5792,11584,344,24,1616,1616,5768,11536,424,4048155338,4048155338,4048155338,4048155338,4048155338,4048155338,4048155338,4048155338,0,0,1065353216,0,0,0,0,0
.long 864,7008,3168,24736,2416,2352,2416,27648,248832,6576,6544,816,3456,3504,3472,480,1376,9056,16816,9056,17624,18096,110688,6944,13888,360,24,1632,1632,6920,13840,432,4048155338,4048155338,4048155338,4048155338,4048155338,4048155338,4048155338,4048155338,0,0,0,16256,0,0,0,0
.long 880,7024,3680,24752,2424,2360,2424,27664,248848,6584,6552,824,3472,3512,3480,496,1392,9072,16824,9072,17656,18104,110704,8096,16192,376,24,1648,1648,8072,16144,440,4048155338,4048155338,4048155338,4048155338,4048155338,4048155338,4048155338,4048155338,0,0,0,1065353216,0,0,0,0
.long 896,8064,112,24640,2720,2784,2720,27872,258048,6848,6880,832,4352,3776,3808,1408,1408,9088,16832,9088,17688,18112,110720,9248,18496,392,24,1664,1664,9224,18448,448,4048155338,4048155338,4048155338,4048155338,4048155338,4048155338,4048155338,4048155338,0,0,0,0,0,0,0,0
.long 912,8080,624,24656,2728,2792,2728,27888,258064,6856,6888,840,4368,3784,3816,1424,1424,9104,16840,9104,17720,18120,110736,10400,20800,408,24,1680,1680,10376,20752,456,4048155338,4048155338,4048155338,4048155338,4048155338,4048155338,4048155338,4048155338,0,0,0,0,0,0,0,0
.long 928,8096,1136,24672,2736,2800,2736,27840,267264,6864,6896,848,4320,3792,3824,1440,1440,9120,16848,9120,17752,18128,110752,11552,23104,424,24,1696,1696,11528,23056,464,4048155338,4048155338,4048155338,4048155338,4048155338,4048155338,4048155338,4048155338,0,0,0,0,0,0,0,0
.long 944,8112,1648,24688,2744,2808,2744,27856,267280,6872,6904,856,4336,3800,3832,1456,1456,9136,16856,9136,17784,18136,110768,12704,25408,440,24,1712,1712,12680,25360,472,4048155338,4048155338,4048155338,4048155338,4048155338,4048155338,4048155338,4048155338,0,0,0,0,0,0,0,0
.long 960,8128,2160,24576,3040,2976,3040,27808,276480,7136,7104,864,4064,4064,4032,1472,1472,9152,16864,9152,17816,18144,110784,13856,27712,456,24,1728,1728,13832,27664,480,4048155338,4048155338,4048155338,4048155338,4048155338,4048155338,4048155338,4048155338,0,0,0,0,0,0,0,0
.long 976,8144,2672,24592,3048,2984,3048,27824,276496,7144,7112,872,4080,4072,4040,1488,1488,9168,16872,9168,17848,18152,110800,15008,30016,472,24,1744,1744,14984,29968,488,4048155338,4048155338,4048155338,4048155338,4048155338,4048155338,4048155338,4048155338,0,0,0,0,0,0,0,0
.long 992,8160,3184,24608,3056,2992,3056,27776,285696,7152,7120,880,4032,4080,4048,1504,1504,9184,16880,9184,17880,18160,110816,16160,32320,488,24,1760,1760,16136,32272,496,4048155338,4048155338,4048155338,4048155338,4048155338,4048155338,4048155338,4048155338,0,0,0,0,0,0,0,0
.long 1008,8176,3696,24624,3064,3000,3064,27792,285712,7160,7128,888,4048,4088,4056,1520,1520,9200,16888,9200,17912,18168,110832,17312,34624,504,24,1776,1776,17288,34576,504,4048155338,4048155338,4048155338,4048155338,4048155338,4048155338,4048155338,4048155338,0,0,0,0,0,0,0,0
.long 0,0,0,0,128,192,64,0,0,64,96,0,576,64,96,4096,2048,9216,16896,12288,18432,17408,0,0,0,0,0,0,256,0,0,0,0,0,0,0,0,0,0,0,16256,0,0,0,0,0,0,0
.long 16,16,512,16,136,200,72,16,16,72,104,8,592,72,104,4112,2064,9232,16904,12304,18464,17416,16,1152,2304,16,0,16,272,1152,2304,8,0,0,0,0,0,0,0,0,1065353216,0,0,0,0,0,0,0
.long 32,32,1024,32,144,208,80,32,9216,80,112,16,608,80,112,4128,2080,9248,16912,12320,18496,17424,32,2304,4608,32,0,32,288,2304,4608,16,0,0,0,0,0,0,0,0,0,16256,0,0,0,0,0,0
.long 48,48,1536,48,152,216,88,48,9232,88,120,24,624,88,120,4144,2096,9264,16920,12336,18528,17432,48,3456,6912,48,0,48,304,3456,6912,24,0,0,0,0,0,0,0,0,0,1065353216,0,0,0,0,0,0
.long 64,64,2048,64,448,384,256,64,18432,352,320,32,864,352,320,4160,2112,9280,16928,12352,18560,17440,64,4608,9216,64,0,64,320,4608,9216,32,0,0,0,0,0,0,0,0,0,0,16256,0,0,0,0,0
.long 80,80,2560,80,456,392,264,80,18448,360,328,40,880,360,328,4176,2128,9296,16936,12368,18592,17448,80,5760,11520,80,0,80,336,5760,11520,40,0,0,0,0,0,0,0,0,0,0,1065353216,0,0,0,0,0
.long 96,96,3072,96,464,400,272,96,27648,368,336,48,896,368,336,4192,2144,9312,16944,12384,18624,17456,96,6912,13824,96,0,96,352,6912,13824,48,0,0,0,0,0,0,0,0,0,0,0,16256,0,0,0,0
.long 112,112,3584,112,472,408,280,112,27664,376,344,56,912,376,344,4208,2160,9328,16952,12400,18656,17464,112,8064,16128,112,0,112,368,8064,16128,56,0,0,0,0,0,0,0,0,0,0,0,1065353216,0,0,0,0
.long 128,1152,16,128,512,576,704,128,36864,512,544,64,0,512,544,5120,2176,9344,16960,12416,18688,17472,128,9216,18432,128,0,128,384,9216,18432,64,0,0,0,0,0,0,0,0,0,0,0,0,0,0,0,0
.long 144,1168,528,144,520,584,712,144,36880,520,552,72,16,520,552,5136,2192,9360,16968,12432,18720,17480,144,10368,20736,144,0,144,400,10368,20736,72,0,0,0,0,0,0,0,0,0,0,0,0,0,0,0,0
.long 160,1184,1040,160,528,592,720,160,46080,528,560,80,32,528,560,5152,2208,9376,16976,12448,18752,17488,160,11520,23040,160,0,160,416,11520,23040,80,0,0,0,0,0,0,0,0,0,0,0,0,0,0,0,0
.long 176,1200,1552,176,536,600,728,176,46096,536,568,88,48,536,568,5168,2224,9392,16984,12464,18784,17496,176,12672,25344,176,0,176,432,12672,25344,88,0,0,0,0,0,0,0,0,0,0,0,0,0,0,0,0
.long 192,1216,2064,192,832,768,896,192,55296,800,768,96,288,800,768,5184,2240,9408,16992,12480,18816,17504,192,13824,27648,192,0,192,448,13824,27648,96,0,0,0,0,0,0,0,0,0,0,0,0,0,0,0,0
.long 208,1232,2576,208,840,776,904,208,55312,808,776,104,304,808,776,5200,2256,9424,17000,12496,18848,17512,208,14976,29952,208,0,208,464,14976,29952,104,0,0,0,0,0,0,0,0,0,0,0,0,0,0,0,0
.long 224,1248,3088,224,848,784,912,224,64512,816,784,112,320,816,784,5216,2272,9440,17008,12512,18880,17520,224,16128,32256,224,0,224,480,16128,32256,112,0,0,0,0,0,0,0,0,0,0,0,0,0,0,0,0
.long 240,1264,3600,240,856,792,920,240,64528,824,792,120,336,824,792,5232,2288,9456,17016,12528,18912,17528,240,17280,34560,240,0,240,496,17280,34560,120,0,0,0,0,0,0,0,0,0,0,0,0,0,0,0,0
.long 256,2304,32,8256,160,224,96,9248,73728,2240,2272,256,1760,1216,1248,4224,3072,9472,17024,12544,18440,17536,36864,32,64,8,8,512,768,8,16,128,0,0,0,0,0,0,0,0,16256,0,0,0,0,0,0,0
.long 272,2320,544,8272,168,232,104,9264,73744,2248,2280,264,1776,1224,1256,4240,3088,9488,17032,12560,18472,17544,36880,1184,2368,24,8,528,784,1160,2320,136,0,0,0,0,0,0,0,0,1065353216,0,0,0,0,0,0,0
.long 288,2336,1056,8288,176,240,112,9216,82944,2256,2288,272,1728,1232,1264,4256,3104,9504,17040,12576,18504,17552,36896,2336,4672,40,8,544,800,2312,4624,144,0,0,0,0,0,0,0,0,0,16256,0,0,0,0,0,0
.long 304,2352,1568,8304,184,248,120,9232,82960,2264,2296,280,1744,1240,1272,4272,3120,9520,17048,12592,18536,17560,36912,3488,6976,56,8,560,816,3464,6928,152,0,0,0,0,0,0,0,0,0,1065353216,0,0,0,0,0,0
.long 320,2368,2080,8192,480,416,288,9312,92160,2528,2496,288,2048,1504,1472,4288,3136,9536,17056,12608,18568,17568,36928,4640,9280,72,8,576,832,4616,9232,160,0,0,0,0,0,0,0,0,0,0,16256,0,0,0,0,0
.long 336,2384,2592,8208,488,424,296,9328,92176,2536,2504,296,2064,1512,1480,4304,3152,9552,17064,12624,18600,17576,36944,5792,11584,88,8,592,848,5768,11536,168,0,0,0,0,0,0,0,0,0,0,1065353216,0,0,0,0,0
.long 352,2400,3104,8224,496,432,304,9280,101376,2544,2512,304,2016,1520,1488,4320,3168,9568,17072,12640,18632,17584,36960,6944,13888,104,8,608,864,6920,13840,176,0,0,0,0,0,0,0,0,0,0,0,16256,0,0,0,0
.long 368,2416,3616,8240,504,440,312,9296,101392,2552,2520,312,2032,1528,1496,4336,3184,9584,17080,12656,18664,17592,36976,8096,16192,120,8,624,880,8072,16144,184,0,0,0,0,0,0,0,0,0,0,0,1065353216,0,0,0,0
.long 384,3456,48,8384,544,608,736,9376,110592,2688,2720,320,1184,1664,1696,5248,3200,9600,17088,12672,18696,17600,36992,9248,18496,136,8,640,896,9224,18448,192,0,0,0,0,0,0,0,0,0,0,0,0,0,0,0,0
.long 400,3472,560,8400,552,616,744,9392,110608,2696,2728,328,1200,1672,1704,5264,3216,9616,17096,12688,18728,17608,37008,10400,20800,152,8,656,912,10376,20752,200,0,0,0,0,0,0,0,0,0,0,0,0,0,0,0,0
.long 416,3488,1072,8416,560,624,752,9344,119808,2704,2736,336,1152,1680,1712,5280,3232,9632,17104,12704,18760,17616,37024,11552,23104,168,8,672,928,11528,23056,208,0,0,0,0,0,0,0,0,0,0,0,0,0,0,0,0
.long 432,3504,1584,8432,568,632,760,9360,119824,2712,2744,344,1168,1688,1720,5296,3248,9648,17112,12720,18792,17624,37040,12704,25408,184,8,688,944,12680,25360,216,0,0,0,0,0,0,0,0,0,0,0,0,0,0,0,0
.long 448,3520,2096,8320,864,800,928,9440,129024,2976,2944,352,1472,1952,1920,5312,3264,9664,17120,12736,18824,17632,37056,13856,27712,200,8,704,960,13832,27664,224,0,0,0,0,0,0,0,0,0,0,0,0,0,0,0,0
.long 464,3536,2608,8336,872,808,936,9456,129040,2984,2952,360,1488,1960,1928,5328,3280,9680,17128,12752,18856,17640,37072,15008,30016,216,8,720,976,14984,29968,232,0,0,0,0,0,0,0,0,0,0,0,0,0,0,0,0
.long 480,3552,3120,8352,880,816,944,9408,138240,2992,2960,368,1440,1968,1936,5344,3296,9696,17136,12768,18888,17648,37088,16160,32320,232,8,736,992,16136,32272,240,0,0,0,0,0,0,0,0,0,0,0,0,0,0,0,0
.long 496,3568,3632,8368,888,824,952,9424,138256,3000,2968,376,1456,1976,1944,5360,3312,9712,17144,12784,18920,17656,37104,17312,34624,248,8,752,1008,17288,34576,248,0,0,0,0,0,0,0,0,0,0,0,0,0,0,0,0
.long 512,4608,64,16512,2176,2240,2112,18496,147456,4160,4192,512,3168,2112,2144,4352,2304,9728,17152,12800,18448,17920,73728,0,0,256,16,1024,1280,0,0,256,0,4048155338,4048155338,4048155338,4048155338,4048155338,4048155338,4048155338,16256,0,0,0,0,0,0,0
.long 528,4624,576,16528,2184,2248,2120,18512,147472,4168,4200,520,3184,2120,2152,4368,2320,9744,17160,12816,18480,17928,73744,1152,2304,272,16,1040,1296,1152,2304,264,0,0,4048155338,4048155338,4048155338,4048155338,4048155338,4048155338,1065353216,0,0,0,0,0,0,0
.long 544,4640,1088,16544,2192,2256,2128,18528,156672,4176,4208,528,3200,2128,2160,4384,2336,9760,17168,12832,18512,17936,73760,2304,4608,288,16,1056,1312,2304,4608,272,0,0,0,4048155338,4048155338,4048155338,4048155338,4048155338,0,16256,0,0,0,0,0,0
.long 560,4656,1600,16560,2200,2264,2136,18544,156688,4184,4216,536,3216,2136,2168,4400,2352,9776,17176,12848,18544,17944,73776,3456,6912,304,16,1072,1328,3456,6912,280,0,0,0,0,4048155338,4048155338,4048155338,4048155338,0,1065353216,0,0,0,0,0,0
.long 576,4672,2112,16576,2496,2432,2304,18432,165888,4448,4416,544,2880,2400,2368,4416,2368,9792,17184,12864,18576,17952,73792,4608,9216,320,16,1088,1344,4608,9216,288,0,0,0,0,4048155338,4048155338,4048155338,4048155338,0,0,16256,0,0,0,0,0
.long 592,4688,2624,16592,2504,2440,2312,18448,165904,4456,4424,552,2896,2408,2376,4432,2384,9808,17192,12880,18608,17960,73808,5760,11520,336,16,1104,1360,5760,11520,296,0,0,0,0,4048155338,4048155338,4048155338,4048155338,0,0,1065353216,0,0,0,0,0
.long 608,4704,3136,16608,2512,2448,2320,18464,175104,4464,4432,560,2912,2416,2384,4448,2400,9824,17200,12896,18640,17968,73824,6912,13824,352,16,1120,1376,6912,13824,304,0,0,0,0,4048155338,4048155338,4048155338,4048155338,0,0,0,16256,0,0,0,0
.long 624,4720,3648,16624,2520,2456,2328,18480,175120,4472,4440,568,2928,2424,2392,4464,2416,9840,17208,12912,18672,17976,73840,8064,16128,368,16,1136,1392,8064,16128,312,0,0,0,0,4048155338,4048155338,4048155338,4048155338,0,0,0,1065353216,0,0,0,0
.long 640,5760,80,16384,2560,2624,2752,18624,184320,4608,4640,576,2592,2560,2592,5376,2432,9856,17216,12928,18704,17984,73856,9216,18432,384,16,1152,1408,9216,18432,320,0,0,0,0,0,4048155338,4048155338,4048155338,0,0,0,0,0,0,0,0
.long 656,5776,592,16400,2568,2632,2760,18640,184336,4616,4648,584,2608,2568,2600,5392,2448,9872,17224,12944,18736,17992,73872,10368,20736,400,16,1168,1424,10368,20736,328,0,0,0,0,0,0,4048155338,4048155338,0,0,0,0,0,0,0,0
.long 672,5792,1104,16416,2576,2640,2768,18656,193536,4624,4656,592,2624,2576,2608,5408,2464,9888,17232,12960,18768,18000,73888,11520,23040,416,16,1184,1440,11520,23040,336,0,0,0,0,0,0,0,4048155338,0,0,0,0,0,0,0,0
.long 688,5808,1616,16432,2584,2648,2776,18672,193552,4632,4664,600,2640,2584,2616,5424,2480,9904,17240,12976,18800,18008,73904,12672,25344,432,16,1200,1456,12672,25344,344,0,0,0,0,0,0,0,0,0,0,0,0,0,0,0,0
.long 704,5824,2128,16448,2880,2816,2944,18560,202752,4896,4864,608,2304,2848,2816,5440,2496,9920,17248,12992,18832,18016,73920,13824,27648,448,16,1216,1472,13824,27648,352,0,0,0,0,0,0,0,0,0,0,0,0,0,0,0,0
.long 720,5840,2640,16464,2888,2824,2952,18576,202768,4904,4872,616,2320,2856,2824,5456,2512,9936,17256,13008,18864,18024,73936,14976,29952,464,16,1232,1488,14976,29952,360,0,0,0,0,0,0,0,0,0,0,0,0,0,0,0,0
.long 736,5856,3152,16480,2896,2832,2960,18592,211968,4912,4880,624,2336,2864,2832,5472,2528,9952,17264,13024,18896,18032,73952,16128,32256,480,16,1248,1504,16128,32256,368,0,0,0,0,0,0,0,0,0,0,0,0,0,0,0,0
.long 752,5872,3664,16496,2904,2840,2968,18608,211984,4920,4888,632,2352,2872,2840,5488,2544,9968,17272,13040,18928,18040,73968,17280,34560,496,16,1264,1520,17280,34560,376,0,0,0,0,0,0,0,0,0,0,0,0,0,0,0,0
.long 768,6912,96,24768,2208,2272,2144,27744,221184,6336,6368,768,4352,3264,3296,4480,3328,9984,17280,13056,18456,18048,110592,32,64,264,24,1536,1792,8,16,384,4048155338,4048155338,4048155338,4048155338,4048155338,4048155338,4048155338,4048155338,16256,0,0,0,0,0,0,0
.long 784,6928,608,24784,2216,2280,2152,27760,221200,6344,6376,776,4368,3272,3304,4496,3344,10000,17288,13072,18488,18056,110608,1184,2368,280,24,1552,1808,1160,2320,392,4048155338,4048155338,4048155338,4048155338,4048155338,4048155338,4048155338,4048155338,1065353216,0,0,0,0,0,0,0
.long 800,6944,1120,24800,2224,2288,2160,27712,230400,6352,6384,784,4320,3280,3312,4512,3360,10016,17296,13088,18520,18064,110624,2336,4672,296,24,1568,1824,2312,4624,400,4048155338,4048155338,4048155338,4048155338,4048155338,4048155338,4048155338,4048155338,0,16256,0,0,0,0,0,0
.long 816,6960,1632,24816,2232,2296,2168,27728,230416,6360,6392,792,4336,3288,3320,4528,3376,10032,17304,13104,18552,18072,110640,3488,6976,312,24,1584,1840,3464,6928,408,4048155338,4048155338,4048155338,4048155338,4048155338,4048155338,4048155338,4048155338,0,1065353216,0,0,0,0,0,0
.long 832,6976,2144,24704,2528,2464,2336,27680,239616,6624,6592,800,4064,3552,3520,4544,3392,10048,17312,13120,18584,18080,110656,4640,9280,328,24,1600,1856,4616,9232,416,0,4048155338,4048155338,4048155338,4048155338,4048155338,4048155338,4048155338,0,0,16256,0,0,0,0,0
.long 848,6992,2656,24720,2536,2472,2344,27696,239632,6632,6600,808,4080,3560,3528,4560,3408,10064,17320,13136,18616,18088,110672,5792,11584,344,24,1616,1872,5768,11536,424,0,0,4048155338,4048155338,4048155338,4048155338,4048155338,4048155338,0,0,1065353216,0,0,0,0,0
.long 864,7008,3168,24736,2544,2480,2352,27648,248832,6640,6608,816,4032,3568,3536,4576,3424,10080,17328,13152,18648,18096,110688,6944,13888,360,24,1632,1888,6920,13840,432,0,0,0,4048155338,4048155338,4048155338,4048155338,4048155338,0,0,0,16256,0,0,0,0
.long 880,7024,3680,24752,2552,2488,2360,27664,248848,6648,6616,824,4048,3576,3544,4592,3440,10096,17336,13168,18680,18104,110704,8096,16192,376,24,1648,1904,8072,16144,440,0,0,0,0,4048155338,4048155338,4048155338,4048155338,0,0,0,1065353216,0,0,0,0
.long 896,8064,112,24640,2592,2656,2784,27872,258048,6784,6816,832,3776,3712,3744,5504,3456,10112,17344,13184,18712,18112,110720,9248,18496,392,24,1664,1920,9224,18448,448,0,0,0,0,4048155338,4048155338,4048155338,4048155338,0,0,0,0,0,0,0,0
.long 912,8080,624,24656,2600,2664,2792,27888,258064,6792,6824,840,3792,3720,3752,5520,3472,10128,17352,13200,18744,18120,110736,10400,20800,408,24,1680,1936,10376,20752,456,0,0,0,0,4048155338,4048155338,4048155338,4048155338,0,0,0,0,0,0,0,0
.long 928,8096,1136,24672,2608,2672,2800,27840,267264,6800,6832,848,3744,3728,3760,5536,3488,10144,17360,13216,18776,18128,110752,11552,23104,424,24,1696,1952,11528,23056,464,0,0,0,0,4048155338,4048155338,4048155338,4048155338,0,0,0,0,0,0,0,0
.long 944,8112,1648,24688,2616,2680,2808,27856,267280,6808,6840,856,3760,3736,3768,5552,3504,10160,17368,13232,18808,18136,110768,12704,25408,440,24,1712,1968,12680,25360,472,0,0,0,0,4048155338,4048155338,4048155338,4048155338,0,0,0,0,0,0,0,0
.long 960,8128,2160,24576,2912,2848,2976,27808,276480,7072,7040,864,3488,4000,3968,5568,3520,10176,17376,13248,18840,18144,110784,13856,27712,456,24,1728,1984,13832,27664,480,0,0,0,0,0,4048155338,4048155338,4048155338,0,0,0,0,0,0,0,0
.long 976,8144,2672,24592,2920,2856,2984,27824,276496,7080,7048,872,3504,4008,3976,5584,3536,10192,17384,13264,18872,18152,110800,15008,30016,472,24,1744,2000,14984,29968,488,0,0,0,0,0,0,4048155338,4048155338,0,0,0,0,0,0,0,0
.long 992,8160,3184,24608,2928,2864,2992,27776,285696,7088,7056,880,3456,4016,3984,5600,3552,10208,17392,13280,18904,18160,110816,16160,32320,488,24,1760,2016,16136,32272,496,0,0,0,0,0,0,0,4048155338,0,0,0,0,0,0,0,0
.long 1008,8176,3696,24624,2936,2872,3000,27792,285712,7096,7064,888,3472,4024,3992,5616,3568,10224,17400,13296,18936,18168,110832,17312,34624,504,24,1776,2032,17288,34576,504,0,0,0,0,0,0,0,0,0,0,0,0,0,0,0,0
.long 0,0,0,0,8192,8256,128,128,0,128,160,0,0,128,160,0,4096,10240,16384,10240,19456,17408,0,0,0,0,0,0,0,0,0,0,0,4048155338,4048155338,4048155338,4048155338,4048155338,4048155338,4048155338,16256,0,0,0,0,0,0,0
.long 16,16,512,16,8200,8264,136,144,16,136,168,8,16,136,168,16,4112,10256,16392,10256,19488,17416,16,1152,2304,16,0,16,16,1152,2304,8,0,0,4048155338,4048155338,4048155338,4048155338,4048155338,4048155338,1065353216,0,0,0,0,0,0,0
.long 32,32,1024,32,8208,8272,144,160,9216,144,176,16,32,144,176,32,4128,10272,16400,10272,19520,17424,32,2304,4608,32,0,32,32,2304,4608,16,0,0,0,4048155338,4048155338,4048155338,4048155338,4048155338,0,16256,0,0,0,0,0,0
.long 48,48,1536,48,8216,8280,152,176,9232,152,184,24,48,152,184,48,4144,10288,16408,10288,19552,17432,48,3456,6912,48,0,48,48,3456,6912,24,0,0,0,0,4048155338,4048155338,4048155338,4048155338,0,1065353216,0,0,0,0,0,0
.long 64,64,2048,64,8512,8448,448,192,18432,416,384,32,288,416,384,64,4160,10304,16416,10304,19584,17440,64,4608,9216,64,0,64,64,4608,9216,32,0,0,0,0,4048155338,4048155338,4048155338,4048155338,0,0,16256,0,0,0,0,0
.long 80,80,2560,80,8520,8456,456,208,18448,424,392,40,304,424,392,80,4176,10320,16424,10320,19616,17448,80,5760,11520,80,0,80,80,5760,11520,40,0,0,0,0,4048155338,4048155338,4048155338,4048155338,0,0,1065353216,0,0,0,0,0
.long 96,96,3072,96,8528,8464,464,224,27648,432,400,48,320,432,400,96,4192,10336,16432,10336,19648,17456,96,6912,13824,96,0,96,96,6912,13824,48,0,0,0,0,4048155338,4048155338,4048155338,4048155338,0,0,0,16256,0,0,0,0
.long 112,112,3584,112,8536,8472,472,240,27664,440,408,56,336,440,408,112,4208,10352,16440,10352,19680,17464,112,8064,16128,112,0,112,112,8064,16128,56,0,0,0,0,4048155338,4048155338,4048155338,4048155338,0,0,0,1065353216,0,0,0,0
.long 128,1152,16,128,8832,8896,512,0,36864,704,736,64,576,704,736,128,4224,10368,16448,10368,19712,17472,128,9216,18432,128,0,128,128,9216,18432,64,0,0,0,0,0,4048155338,4048155338,4048155338,0,0,0,0,0,0,0,0
.long 144,1168,528,144,8840,8904,520,16,36880,712,744,72,592,712,744,144,4240,10384,16456,10384,19744,17480,144,10368,20736,144,0,144,144,10368,20736,72,0,0,0,0,0,0,4048155338,4048155338,0,0,0,0,0,0,0,0
.long 160,1184,1040,160,8848,8912,528,32,46080,720,752,80,608,720,752,160,4256,10400,16464,10400,19776,17488,160,11520,23040,160,0,160,160,11520,23040,80,0,0,0,0,0,0,0,4048155338,0,0,0,0,0,0,0,0
.long 176,1200,1552,176,8856,8920,536,48,46096,728,760,88,624,728,760,176,4272,10416,16472,10416,19808,17496,176,12672,25344,176,0,176,176,12672,25344,88,0,0,0,0,0,0,0,0,0,0,0,0,0,0,0,0
.long 192,1216,2064,192,9152,9088,832,64,55296,992,960,96,864,992,960,192,4288,10432,16480,10432,19840,17504,192,13824,27648,192,0,192,192,13824,27648,96,0,0,0,0,0,0,0,0,0,0,0,0,0,0,0,0
.long 208,1232,2576,208,9160,9096,840,80,55312,1000,968,104,880,1000,968,208,4304,10448,16488,10448,19872,17512,208,14976,29952,208,0,208,208,14976,29952,104,0,0,0,0,0,0,0,0,0,0,0,0,0,0,0,0
.long 224,1248,3088,224,9168,9104,848,96,64512,1008,976,112,896,1008,976,224,4320,10464,16496,10464,19904,17520,224,16128,32256,224,0,224,224,16128,32256,112,0,0,0,0,0,0,0,0,0,0,0,0,0,0,0,0
.long 240,1264,3600,240,9176,9112,856,112,64528,1016,984,120,912,1016,984,240,4336,10480,16504,10480,19936,17528,240,17280,34560,240,0,240,240,17280,34560,120,0,0,0,0,0,0,0,0,0,0,0,0,0,0,0,0
.long 256,2304,32,8256,8224,8288,160,9376,73728,2048,2080,256,1184,1024,1056,1024,5120,10496,16512,10496,19464,17536,36864,32,64,8,8,512,512,8,16,128,4048155338,4048155338,4048155338,4048155338,4048155338,4048155338,4048155338,4048155338,16256,0,0,0,0,0,0,0
.long 272,2320,544,8272,8232,8296,168,9392,73744,2056,2088,264,1200,1032,1064,1040,5136,10512,16520,10512,19496,17544,36880,1184,2368,24,8,528,528,1160,2320,136,4048155338,4048155338,4048155338,4048155338,4048155338,4048155338,4048155338,4048155338,1065353216,0,0,0,0,0,0,0
.long 288,2336,1056,8288,8240,8304,176,9344,82944,2064,2096,272,1152,1040,1072,1056,5152,10528,16528,10528,19528,17552,36896,2336,4672,40,8,544,544,2312,4624,144,4048155338,4048155338,4048155338,4048155338,4048155338,4048155338,4048155338,4048155338,0,16256,0,0,0,0,0,0
.long 304,2352,1568,8304,8248,8312,184,9360,82960,2072,2104,280,1168,1048,1080,1072,5168,10544,16536,10544,19560,17560,36912,3488,6976,56,8,560,560,3464,6928,152,4048155338,4048155338,4048155338,4048155338,4048155338,4048155338,4048155338,4048155338,0,1065353216,0,0,0,0,0,0
.long 320,2368,2080,8192,8544,8480,480,9440,92160,2336,2304,288,1472,1312,1280,1088,5184,10560,16544,10560,19592,17568,36928,4640,9280,72,8,576,576,4616,9232,160,0,4048155338,4048155338,4048155338,4048155338,4048155338,4048155338,4048155338,0,0,16256,0,0,0,0,0
.long 336,2384,2592,8208,8552,8488,488,9456,92176,2344,2312,296,1488,1320,1288,1104,5200,10576,16552,10576,19624,17576,36944,5792,11584,88,8,592,592,5768,11536,168,0,0,4048155338,4048155338,4048155338,4048155338,4048155338,4048155338,0,0,1065353216,0,0,0,0,0
.long 352,2400,3104,8224,8560,8496,496,9408,101376,2352,2320,304,1440,1328,1296,1120,5216,10592,16560,10592,19656,17584,36960,6944,13888,104,8,608,608,6920,13840,176,0,0,0,4048155338,4048155338,4048155338,4048155338,4048155338,0,0,0,16256,0,0,0,0
.long 368,2416,3616,8240,8568,8504,504,9424,101392,2360,2328,312,1456,1336,1304,1136,5232,10608,16568,10608,19688,17592,36976,8096,16192,120,8,624,624,8072,16144,184,0,0,0,0,4048155338,4048155338,4048155338,4048155338,0,0,0,1065353216,0,0,0,0
.long 384,3456,48,8384,8864,8928,544,9248,110592,2624,2656,320,1760,1600,1632,1152,5248,10624,16576,10624,19720,17600,36992,9248,18496,136,8,640,640,9224,18448,192,0,0,0,0,4048155338,4048155338,4048155338,4048155338,0,0,0,0,0,0,0,0
.long 400,3472,560,8400,8872,8936,552,9264,110608,2632,2664,328,1776,1608,1640,1168,5264,10640,16584,10640,19752,17608,37008,10400,20800,152,8,656,656,10376,20752,200,0,0,0,0,4048155338,4048155338,4048155338,4048155338,0,0,0,0,0,0,0,0
.long 416,3488,1072,8416,8880,8944,560,9216,119808,2640,2672,336,1728,1616,1648,1184,5280,10656,16592,10656,19784,17616,37024,11552,23104,168,8,672,672,11528,23056,208,0,0,0,0,4048155338,4048155338,4048155338,4048155338,0,0,0,0,0,0,0,0
.long 432,3504,1584,8432,8888,8952,568,9232,119824,2648,2680,344,1744,1624,1656,1200,5296,10672,16600,10672,19816,17624,37040,12704,25408,184,8,688,688,12680,25360,216,0,0,0,0,4048155338,4048155338,4048155338,4048155338,0,0,0,0,0,0,0,0
.long 448,3520,2096,8320,9184,9120,864,9312,129024,2912,2880,352,2048,1888,1856,1216,5312,10688,16608,10688,19848,17632,37056,13856,27712,200,8,704,704,13832,27664,224,0,0,0,0,0,4048155338,4048155338,4048155338,0,0,0,0,0,0,0,0
.long 464,3536,2608,8336,9192,9128,872,9328,129040,2920,2888,360,2064,1896,1864,1232,5328,10704,16616,10704,19880,17640,37072,15008,30016,216,8,720,720,14984,29968,232,0,0,0,0,0,0,4048155338,4048155338,0,0,0,0,0,0,0,0
.long 480,3552,3120,8352,9200,9136,880,9280,138240,2928,2896,368,2016,1904,1872,1248,5344,10720,16624,10720,19912,17648,37088,16160,32320,232,8,736,736,16136,32272,240,0,0,0,0,0,0,0,4048155338,0,0,0,0,0,0,0,0
.long 496,3568,3632,8368,9208,9144,888,9296,138256,2936,2904,376,2032,1912,1880,1264,5360,10736,16632,10736,19944,17656,37104,17312,34624,248,8,752,752,17288,34576,248,0,0,0,0,0,0,0,0,0,0,0,0,0,0,0,0
.long 512,4608,64,16512,10240,10304,2176,18624,147456,4224,4256,512,2592,2176,2208,256,4352,10752,16640,10752,19472,17920,73728,0,0,256,16,1024,1024,0,0,256,4048155338,4048155338,4048155338,4048155338,4048155338,4048155338,4048155338,4048155338,16256,0,0,0,0,0,0,0
.long 528,4624,576,16528,10248,10312,2184,18640,147472,4232,4264,520,2608,2184,2216,272,4368,10768,16648,10768,19504,17928,73744,1152,2304,272,16,1040,1040,1152,2304,264,4048155338,4048155338,4048155338,4048155338,4048155338,4048155338,4048155338,4048155338,1065353216,0,0,0,0,0,0,0
.long 544,4640,1088,16544,10256,10320,2192,18656,156672,4240,4272,528,2624,2192,2224,288,4384,10784,16656,10784,19536,17936,73760,2304,4608,288,16,1056,1056,2304,4608,272,4048155338,4048155338,4048155338,4048155338,4048155338,4048155338,4048155338,4048155338,0,16256,0,0,0,0,0,0
.long 560,4656,1600,16560,10264,10328,2200,18672,156688,4248,4280,536,2640,2200,2232,304,4400,10800,16664,10800,19568,17944,73776,3456,6912,304,16,1072,1072,3456,6912,280,4048155338,4048155338,4048155338,4048155338,4048155338,4048155338,4048155338,4048155338,0,1065353216,0,0,0,0,0,0
.long 576,4672,2112,16576,10560,10496,2496,18560,165888,4512,4480,544,2304,2464,2432,320,4416,10816,16672,10816,19600,17952,73792,4608,9216,320,16,1088,1088,4608,9216,288,4048155338,4048155338,4048155338,4048155338,4048155338,4048155338,4048155338,4048155338,0,0,16256,0,0,0,0,0
.long 592,4688,2624,16592,10568,10504,2504,18576,165904,4520,4488,552,2320,2472,2440,336,4432,10832,16680,10832,19632,17960,73808,5760,11520,336,16,1104,1104,5760,11520,296,4048155338,4048155338,4048155338,4048155338,4048155338,4048155338,4048155338,4048155338,0,0,1065353216,0,0,0,0,0
.long 608,4704,3136,16608,10576,10512,2512,18592,175104,4528,4496,560,2336,2480,2448,352,4448,10848,16688,10848,19664,17968,73824,6912,13824,352,16,1120,1120,6912,13824,304,4048155338,4048155338,4048155338,4048155338,4048155338,4048155338,4048155338,4048155338,0,0,0,16256,0,0,0,0
.long 624,4720,3648,16624,10584,10520,2520,18608,175120,4536,4504,568,2352,2488,2456,368,4464,10864,16696,10864,19696,17976,73840,8064,16128,368,16,1136,1136,8064,16128,312,4048155338,4048155338,4048155338,4048155338,4048155338,4048155338,4048155338,4048155338,0,0,0,1065353216,0,0,0,0
.long 640,5760,80,16384,10880,10944,2560,18496,184320,4800,4832,576,3168,2752,2784,384,4480,10880,16704,10880,19728,17984,73856,9216,18432,384,16,1152,1152,9216,18432,320,4048155338,4048155338,4048155338,4048155338,4048155338,4048155338,4048155338,4048155338,0,0,0,0,0,0,0,0
.long 656,5776,592,16400,10888,10952,2568,18512,184336,4808,4840,584,3184,2760,2792,400,4496,10896,16712,10896,19760,17992,73872,10368,20736,400,16,1168,1168,10368,20736,328,4048155338,4048155338,4048155338,4048155338,4048155338,4048155338,4048155338,4048155338,0,0,0,0,0,0,0,0
.long 672,5792,1104,16416,10896,10960,2576,18528,193536,4816,4848,592,3200,2768,2800,416,4512,10912,16720,10912,19792,18000,73888,11520,23040,416,16,1184,1184,11520,23040,336,4048155338,4048155338,4048155338,4048155338,4048155338,4048155338,4048155338,4048155338,0,0,0,0,0,0,0,0
.long 688,5808,1616,16432,10904,10968,2584,18544,193552,4824,4856,600,3216,2776,2808,432,4528,10928,16728,10928,19824,18008,73904,12672,25344,432,16,1200,1200,12672,25344,344,4048155338,4048155338,4048155338,4048155338,4048155338,4048155338,4048155338,4048155338,0,0,0,0,0,0,0,0
.long 704,5824,2128,16448,11200,11136,2880,18432,202752,5088,5056,608,2880,3040,3008,448,4544,10944,16736,10944,19856,18016,73920,13824,27648,448,16,1216,1216,13824,27648,352,4048155338,4048155338,4048155338,4048155338,4048155338,4048155338,4048155338,4048155338,0,0,0,0,0,0,0,0
.long 720,5840,2640,16464,11208,11144,2888,18448,202768,5096,5064,616,2896,3048,3016,464,4560,10960,16744,10960,19888,18024,73936,14976,29952,464,16,1232,1232,14976,29952,360,4048155338,4048155338,4048155338,4048155338,4048155338,4048155338,4048155338,4048155338,0,0,0,0,0,0,0,0
.long 736,5856,3152,16480,11216,11152,2896,18464,211968,5104,5072,624,2912,3056,3024,480,4576,10976,16752,10976,19920,18032,73952,16128,32256,480,16,1248,1248,16128,32256,368,4048155338,4048155338,4048155338,4048155338,4048155338,4048155338,4048155338,4048155338,0,0,0,0,0,0,0,0
.long 752,5872,3664,16496,11224,11160,2904,18480,211984,5112,5080,632,2928,3064,3032,496,4592,10992,16760,10992,19952,18040,73968,17280,34560,496,16,1264,1264,17280,34560,376,4048155338,4048155338,4048155338,4048155338,4048155338,4048155338,4048155338,4048155338,0,0,0,0,0,0,0,0
.long 768,6912,96,24768,10272,10336,2208,27872,221184,6144,6176,768,3776,3072,3104,1280,5376,11008,16768,11008,19480,18048,110592,32,64,264,24,1536,1536,8,16,384,4048155338,4048155338,4048155338,4048155338,4048155338,4048155338,4048155338,4048155338,16256,0,0,0,0,0,0,0
.long 784,6928,608,24784,10280,10344,2216,27888,221200,6152,6184,776,3792,3080,3112,1296,5392,11024,16776,11024,19512,18056,110608,1184,2368,280,24,1552,1552,1160,2320,392,4048155338,4048155338,4048155338,4048155338,4048155338,4048155338,4048155338,4048155338,1065353216,0,0,0,0,0,0,0
.long 800,6944,1120,24800,10288,10352,2224,27840,230400,6160,6192,784,3744,3088,3120,1312,5408,11040,16784,11040,19544,18064,110624,2336,4672,296,24,1568,1568,2312,4624,400,4048155338,4048155338,4048155338,4048155338,4048155338,4048155338,4048155338,4048155338,0,16256,0,0,0,0,0,0
.long 816,6960,1632,24816,10296,10360,2232,27856,230416,6168,6200,792,3760,3096,3128,1328,5424,11056,16792,11056,19576,18072,110640,3488,6976,312,24,1584,1584,3464,6928,408,4048155338,4048155338,4048155338,4048155338,4048155338,4048155338,4048155338,4048155338,0,1065353216,0,0,0,0,0,0
.long 832,6976,2144,24704,10592,10528,2528,27808,239616,6432,6400,800,3488,3360,3328,1344,5440,11072,16800,11072,19608,18080,110656,4640,9280,328,24,1600,1600,4616,9232,416,4048155338,4048155338,4048155338,4048155338,4048155338,4048155338,4048155338,4048155338,0,0,16256,0,0,0,0,0
.long 848,6992,2656,24720,10600,10536,2536,27824,239632,6440,6408,808,3504,3368,3336,1360,5456,11088,16808,11088,19640,18088,110672,5792,11584,344,24,1616,1616,5768,11536,424,4048155338,4048155338,4048155338,4048155338,4048155338,4048155338,4048155338,4048155338,0,0,1065353216,0,0,0,0,0
.long 864,7008,3168,24736,10608,10544,2544,27776,248832,6448,6416,816,3456,3376,3344,1376,5472,11104,16816,11104,19672,18096,110688,6944,13888,360,24,1632,1632,6920,13840,432,4048155338,4048155338,4048155338,4048155338,4048155338,4048155338,4048155338,4048155338,0,0,0,16256,0,0,0,0
.long 880,7024,3680,24752,10616,10552,2552,27792,248848,6456,6424,824,3472,3384,3352,1392,5488,11120,16824,11120,19704,18104,110704,8096,16192,376,24,1648,1648,8072,16144,440,4048155338,4048155338,4048155338,4048155338,4048155338,4048155338,4048155338,4048155338,0,0,0,1065353216,0,0,0,0
.long 896,8064,112,24640,10912,10976,2592,27744,258048,6720,6752,832,4352,3648,3680,1408,5504,11136,16832,11136,19736,18112,110720,9248,18496,392,24,1664,1664,9224,18448,448,4048155338,4048155338,4048155338,4048155338,4048155338,4048155338,4048155338,4048155338,0,0,0,0,0,0,0,0
.long 912,8080,624,24656,10920,10984,2600,27760,258064,6728,6760,840,4368,3656,3688,1424,5520,11152,16840,11152,19768,18120,110736,10400,20800,408,24,1680,1680,10376,20752,456,4048155338,4048155338,4048155338,4048155338,4048155338,4048155338,4048155338,4048155338,0,0,0,0,0,0,0,0
.long 928,8096,1136,24672,10928,10992,2608,27712,267264,6736,6768,848,4320,3664,3696,1440,5536,11168,16848,11168,19800,18128,110752,11552,23104,424,24,1696,1696,11528,23056,464,4048155338,4048155338,4048155338,4048155338,4048155338,4048155338,4048155338,4048155338,0,0,0,0,0,0,0,0
.long 944,8112,1648,24688,10936,11000,2616,27728,267280,6744,6776,856,4336,3672,3704,1456,5552,11184,16856,11184,19832,18136,110768,12704,25408,440,24,1712,1712,12680,25360,472,4048155338,4048155338,4048155338,4048155338,4048155338,4048155338,4048155338,4048155338,0,0,0,0,0,0,0,0
.long 960,8128,2160,24576,11232,11168,2912,27680,276480,7008,6976,864,4064,3936,3904,1472,5568,11200,16864,11200,19864,18144,110784,13856,27712,456,24,1728,1728,13832,27664,480,4048155338,4048155338,4048155338,4048155338,4048155338,4048155338,4048155338,4048155338,0,0,0,0,0,0,0,0
.long 976,8144,2672,24592,11240,11176,2920,27696,276496,7016,6984,872,4080,3944,3912,1488,5584,11216,16872,11216,19896,18152,110800,15008,30016,472,24,1744,1744,14984,29968,488,4048155338,4048155338,4048155338,4048155338,4048155338,4048155338,4048155338,4048155338,0,0,0,0,0,0,0,0
.long 992,8160,3184,24608,11248,11184,2928,27648,285696,7024,6992,880,4032,3952,3920,1504,5600,11232,16880,11232,19928,18160,110816,16160,32320,488,24,1760,1760,16136,32272,496,4048155338,4048155338,4048155338,4048155338,4048155338,4048155338,4048155338,4048155338,0,0,0,0,0,0,0,0
.long 1008,8176,3696,24624,11256,11192,2936,27664,285712,7032,7000,888,4048,3960,3928,1520,5616,11248,16888,11248,19960,18168,110832,17312,34624,504,24,1776,1776,17288,34576,504,4048155338,4048155338,4048155338,4048155338,4048155338,4048155338,4048155338,4048155338,0,0,0,0,0,0,0,0
.long 0,0,0,0,8320,8384,192,128,0,192,224,0,576,192,224,4096,6144,11264,16896,14336,20480,17408,0,0,0,0,0,0,256,0,0,0,0,0,0,0,0,0,0,0,16256,0,0,0,0,0,0,0
.long 16,16,512,16,8328,8392,200,144,16,200,232,8,592,200,232,4112,6160,11280,16904,14352,20512,17416,16,1152,2304,16,0,16,272,1152,2304,8,0,0,0,0,0,0,0,0,1065353216,0,0,0,0,0,0,0
.long 32,32,1024,32,8336,8400,208,160,9216,208,240,16,608,208,240,4128,6176,11296,16912,14368,20544,17424,32,2304,4608,32,0,32,288,2304,4608,16,0,0,0,0,0,0,0,0,0,16256,0,0,0,0,0,0
.long 48,48,1536,48,8344,8408,216,176,9232,216,248,24,624,216,248,4144,6192,11312,16920,14384,20576,17432,48,3456,6912,48,0,48,304,3456,6912,24,0,0,0,0,0,0,0,0,0,1065353216,0,0,0,0,0,0
.long 64,64,2048,64,8640,8576,384,192,18432,480,448,32,864,480,448,4160,6208,11328,16928,14400,20608,17440,64,4608,9216,64,0,64,320,4608,9216,32,0,0,0,0,0,0,0,0,0,0,16256,0,0,0,0,0
.long 80,80,2560,80,8648,8584,392,208,18448,488,456,40,880,488,456,4176,6224,11344,16936,14416,20640,17448,80,5760,11520,80,0,80,336,5760,11520,40,0,0,0,0,0,0,0,0,0,0,1065353216,0,0,0,0,0
.long 96,96,3072,96,8656,8592,400,224,27648,496,464,48,896,496,464,4192,6240,11360,16944,14432,20672,17456,96,6912,13824,96,0,96,352,6912,13824,48,0,0,0,0,0,0,0,0,0,0,0,16256,0,0,0,0
.long 112,112,3584,112,8664,8600,408,240,27664,504,472,56,912,504,472,4208,6256,11376,16952,14448,20704,17464,112,8064,16128,112,0,112,368,8064,16128,56,0,0,0,0,0,0,0,0,0,0,0,1065353216,0,0,0,0
.long 128,1152,16,128,8704,8768,576,0,36864,640,672,64,0,640,672,4224,6272,11392,16960,14464,20736,17472,128,9216,18432,128,0,128,384,9216,18432,64,0,0,0,0,0,0,0,0,0,0,0,0,0,0,0,0
.long 144,1168,528,144,8712,8776,584,16,36880,648,680,72,16,648,680,4240,6288,11408,16968,14480,20768,17480,144,10368,20736,144,0,144,400,10368,20736,72,0,0,0,0,0,0,0,0,0,0,0,0,0,0,0,0
.long 160,1184,1040,160,8720,8784,592,32,46080,656,688,80,32,656,688,4256,6304,11424,16976,14496,20800,17488,160,11520,23040,160,0,160,416,11520,23040,80,0,0,0,0,0,0,0,0,0,0,0,0,0,0,0,0
.long 176,1200,1552,176,8728,8792,600,48,46096,664,696,88,48,664,696,4272,6320,11440,16984,14512,20832,17496,176,12672,25344,176,0,176,432,12672,25344,88,0,0,0,0,0,0,0,0,0,0,0,0,0,0,0,0
.long 192,1216,2064,192,9024,8960,768,64,55296,928,896,96,288,928,896,4288,6336,11456,16992,14528,20864,17504,192,13824,27648,192,0,192,448,13824,27648,96,0,0,0,0,0,0,0,0,0,0,0,0,0,0,0,0
.long 208,1232,2576,208,9032,8968,776,80,55312,936,904,104,304,936,904,4304,6352,11472,17000,14544,20896,17512,208,14976,29952,208,0,208,464,14976,29952,104,0,0,0,0,0,0,0,0,0,0,0,0,0,0,0,0
.long 224,1248,3088,224,9040,8976,784,96,64512,944,912,112,320,944,912,4320,6368,11488,17008,14560,20928,17520,224,16128,32256,224,0,224,480,16128,32256,112,0,0,0,0,0,0,0,0,0,0,0,0,0,0,0,0
.long 240,1264,3600,240,9048,8984,792,112,64528,952,920,120,336,952,920,4336,6384,11504,17016,14576,20960,17528,240,17280,34560,240,0,240,496,17280,34560,120,0,0,0,0,0,0,0,0,0,0,0,0,0,0,0,0
.long 256,2304,32,8256,8352,8416,224,9376,73728,2112,2144,256,1760,1088,1120,5120,7168,11520,17024,14592,20488,17536,36864,32,64,8,8,512,768,8,16,128,0,0,0,0,0,0,0,0,16256,0,0,0,0,0,0,0
.long 272,2320,544,8272,8360,8424,232,9392,73744,2120,2152,264,1776,1096,1128,5136,7184,11536,17032,14608,20520,17544,36880,1184,2368,24,8,528,784,1160,2320,136,0,0,0,0,0,0,0,0,1065353216,0,0,0,0,0,0,0
.long 288,2336,1056,8288,8368,8432,240,9344,82944,2128,2160,272,1728,1104,1136,5152,7200,11552,17040,14624,20552,17552,36896,2336,4672,40,8,544,800,2312,4624,144,0,0,0,0,0,0,0,0,0,16256,0,0,0,0,0,0
.long 304,2352,1568,8304,8376,8440,248,9360,82960,2136,2168,280,1744,1112,1144,5168,7216,11568,17048,14640,20584,17560,36912,3488,6976,56,8,560,816,3464,6928,152,0,0,0,0,0,0,0,0,0,1065353216,0,0,0,0,0,0
.long 320,2368,2080,8192,8672,8608,416,9440,92160,2400,2368,288,2048,1376,1344,5184,7232,11584,17056,14656,20616,17568,36928,4640,9280,72,8,576,832,4616,9232,160,0,0,0,0,0,0,0,0,0,0,16256,0,0,0,0,0
.long 336,2384,2592,8208,8680,8616,424,9456,92176,2408,2376,296,2064,1384,1352,5200,7248,11600,17064,14672,20648,17576,36944,5792,11584,88,8,592,848,5768,11536,168,0,0,0,0,0,0,0,0,0,0,1065353216,0,0,0,0,0
.long 352,2400,3104,8224,8688,8624,432,9408,101376,2416,2384,304,2016,1392,1360,5216,7264,11616,17072,14688,20680,17584,36960,6944,13888,104,8,608,864,6920,13840,176,0,0,0,0,0,0,0,0,0,0,0,16256,0,0,0,0
.long 368,2416,3616,8240,8696,8632,440,9424,101392,2424,2392,312,2032,1400,1368,5232,7280,11632,17080,14704,20712,17592,36976,8096,16192,120,8,624,880,8072,16144,184,0,0,0,0,0,0,0,0,0,0,0,1065353216,0,0,0,0
.long 384,3456,48,8384,8736,8800,608,9248,110592,2560,2592,320,1184,1536,1568,5248,7296,11648,17088,14720,20744,17600,36992,9248,18496,136,8,640,896,9224,18448,192,0,0,0,0,0,0,0,0,0,0,0,0,0,0,0,0
.long 400,3472,560,8400,8744,8808,616,9264,110608,2568,2600,328,1200,1544,1576,5264,7312,11664,17096,14736,20776,17608,37008,10400,20800,152,8,656,912,10376,20752,200,0,0,0,0,0,0,0,0,0,0,0,0,0,0,0,0
.long 416,3488,1072,8416,8752,8816,624,9216,119808,2576,2608,336,1152,1552,1584,5280,7328,11680,17104,14752,20808,17616,37024,11552,23104,168,8,672,928,11528,23056,208,0,0,0,0,0,0,0,0,0,0,0,0,0,0,0,0
.long 432,3504,1584,8432,8760,8824,632,9232,119824,2584,2616,344,1168,1560,1592,5296,7344,11696,17112,14768,20840,17624,37040,12704,25408,184,8,688,944,12680,25360,216,0,0,0,0,0,0,0,0,0,0,0,0,0,0,0,0
.long 448,3520,2096,8320,9056,8992,800,9312,129024,2848,2816,352,1472,1824,1792,5312,7360,11712,17120,14784,20872,17632,37056,13856,27712,200,8,704,960,13832,27664,224,0,0,0,0,0,0,0,0,0,0,0,0,0,0,0,0
.long 464,3536,2608,8336,9064,9000,808,9328,129040,2856,2824,360,1488,1832,1800,5328,7376,11728,17128,14800,20904,17640,37072,15008,30016,216,8,720,976,14984,29968,232,0,0,0,0,0,0,0,0,0,0,0,0,0,0,0,0
.long 480,3552,3120,8352,9072,9008,816,9280,138240,2864,2832,368,1440,1840,1808,5344,7392,11744,17136,14816,20936,17648,37088,16160,32320,232,8,736,992,16136,32272,240,0,0,0,0,0,0,0,0,0,0,0,0,0,0,0,0
.long 496,3568,3632,8368,9080,9016,824,9296,138256,2872,2840,376,1456,1848,1816,5360,7408,11760,17144,14832,20968,17656,37104,17312,34624,248,8,752,1008,17288,34576,248,0,0,0,0,0,0,0,0,0,0,0,0,0,0,0,0
.long 512,4608,64,16512,10368,10432,2240,18624,147456,4288,4320,512,3168,2240,2272,4352,6400,11776,17152,14848,20496,17920,73728,0,0,256,16,1024,1280,0,0,256,0,4048155338,4048155338,4048155338,4048155338,4048155338,4048155338,4048155338,16256,0,0,0,0,0,0,0
.long 528,4624,576,16528,10376,10440,2248,18640,147472,4296,4328,520,3184,2248,2280,4368,6416,11792,17160,14864,20528,17928,73744,1152,2304,272,16,1040,1296,1152,2304,264,0,0,4048155338,4048155338,4048155338,4048155338,4048155338,4048155338,1065353216,0,0,0,0,0,0,0
.long 544,4640,1088,16544,10384,10448,2256,18656,156672,4304,4336,528,3200,2256,2288,4384,6432,11808,17168,14880,20560,17936,73760,2304,4608,288,16,1056,1312,2304,4608,272,0,0,0,4048155338,4048155338,4048155338,4048155338,4048155338,0,16256,0,0,0,0,0,0
.long 560,4656,1600,16560,10392,10456,2264,18672,156688,4312,4344,536,3216,2264,2296,4400,6448,11824,17176,14896,20592,17944,73776,3456,6912,304,16,1072,1328,3456,6912,280,0,0,0,0,4048155338,4048155338,4048155338,4048155338,0,1065353216,0,0,0,0,0,0
.long 576,4672,2112,16576,10688,10624,2432,18560,165888,4576,4544,544,2880,2528,2496,4416,6464,11840,17184,14912,20624,17952,73792,4608,9216,320,16,1088,1344,4608,9216,288,0,0,0,0,4048155338,4048155338,4048155338,4048155338,0,0,16256,0,0,0,0,0
.long 592,4688,2624,16592,10696,10632,2440,18576,165904,4584,4552,552,2896,2536,2504,4432,6480,11856,17192,14928,20656,17960,73808,5760,11520,336,16,1104,1360,5760,11520,296,0,0,0,0,4048155338,4048155338,4048155338,4048155338,0,0,1065353216,0,0,0,0,0
.long 608,4704,3136,16608,10704,10640,2448,18592,175104,4592,4560,560,2912,2544,2512,4448,6496,11872,17200,14944,20688,17968,73824,6912,13824,352,16,1120,1376,6912,13824,304,0,0,0,0,4048155338,4048155338,4048155338,4048155338,0,0,0,16256,0,0,0,0
.long 624,4720,3648,16624,10712,10648,2456,18608,175120,4600,4568,568,2928,2552,2520,4464,6512,11888,17208,14960,20720,17976,73840,8064,16128,368,16,1136,1392,8064,16128,312,0,0,0,0,4048155338,4048155338,4048155338,4048155338,0,0,0,1065353216,0,0,0,0
.long 640,5760,80,16384,10752,10816,2624,18496,184320,4736,4768,576,2592,2688,2720,4480,6528,11904,17216,14976,20752,17984,73856,9216,18432,384,16,1152,1408,9216,18432,320,0,0,0,0,0,4048155338,4048155338,4048155338,0,0,0,0,0,0,0,0
.long 656,5776,592,16400,10760,10824,2632,18512,184336,4744,4776,584,2608,2696,2728,4496,6544,11920,17224,14992,20784,17992,73872,10368,20736,400,16,1168,1424,10368,20736,328,0,0,0,0,0,0,4048155338,4048155338,0,0,0,0,0,0,0,0
.long 672,5792,1104,16416,10768,10832,2640,18528,193536,4752,4784,592,2624,2704,2736,4512,6560,11936,17232,15008,20816,18000,73888,11520,23040,416,16,1184,1440,11520,23040,336,0,0,0,0,0,0,0,4048155338,0,0,0,0,0,0,0,0
.long 688,5808,1616,16432,10776,10840,2648,18544,193552,4760,4792,600,2640,2712,2744,4528,6576,11952,17240,15024,20848,18008,73904,12672,25344,432,16,1200,1456,12672,25344,344,0,0,0,0,0,0,0,0,0,0,0,0,0,0,0,0
.long 704,5824,2128,16448,11072,11008,2816,18432,202752,5024,4992,608,2304,2976,2944,4544,6592,11968,17248,15040,20880,18016,73920,13824,27648,448,16,1216,1472,13824,27648,352,0,0,0,0,0,0,0,0,0,0,0,0,0,0,0,0
.long 720,5840,2640,16464,11080,11016,2824,18448,202768,5032,5000,616,2320,2984,2952,4560,6608,11984,17256,15056,20912,18024,73936,14976,29952,464,16,1232,1488,14976,29952,360,0,0,0,0,0,0,0,0,0,0,0,0,0,0,0,0
.long 736,5856,3152,16480,11088,11024,2832,18464,211968,5040,5008,624,2336,2992,2960,4576,6624,12000,17264,15072,20944,18032,73952,16128,32256,480,16,1248,1504,16128,32256,368,0,0,0,0,0,0,0,0,0,0,0,0,0,0,0,0
.long 752,5872,3664,16496,11096,11032,2840,18480,211984,5048,5016,632,2352,3000,2968,4592,6640,12016,17272,15088,20976,18040,73968,17280,34560,496,16,1264,1520,17280,34560,376,0,0,0,0,0,0,0,0,0,0,0,0,0,0,0,0
.long 768,6912,96,24768,10400,10464,2272,27872,221184,6208,6240,768,4352,3136,3168,5376,7424,12032,17280,15104,20504,18048,110592,32,64,264,24,1536,1792,8,16,384,4048155338,4048155338,4048155338,4048155338,4048155338,4048155338,4048155338,4048155338,16256,0,0,0,0,0,0,0
.long 784,6928,608,24784,10408,10472,2280,27888,221200,6216,6248,776,4368,3144,3176,5392,7440,12048,17288,15120,20536,18056,110608,1184,2368,280,24,1552,1808,1160,2320,392,4048155338,4048155338,4048155338,4048155338,4048155338,4048155338,4048155338,4048155338,1065353216,0,0,0,0,0,0,0
.long 800,6944,1120,24800,10416,10480,2288,27840,230400,6224,6256,784,4320,3152,3184,5408,7456,12064,17296,15136,20568,18064,110624,2336,4672,296,24,1568,1824,2312,4624,400,4048155338,4048155338,4048155338,4048155338,4048155338,4048155338,4048155338,4048155338,0,16256,0,0,0,0,0,0
.long 816,6960,1632,24816,10424,10488,2296,27856,230416,6232,6264,792,4336,3160,3192,5424,7472,12080,17304,15152,20600,18072,110640,3488,6976,312,24,1584,1840,3464,6928,408,4048155338,4048155338,4048155338,4048155338,4048155338,4048155338,4048155338,4048155338,0,1065353216,0,0,0,0,0,0
.long 832,6976,2144,24704,10720,10656,2464,27808,239616,6496,6464,800,4064,3424,3392,5440,7488,12096,17312,15168,20632,18080,110656,4640,9280,328,24,1600,1856,4616,9232,416,0,4048155338,4048155338,4048155338,4048155338,4048155338,4048155338,4048155338,0,0,16256,0,0,0,0,0
.long 848,6992,2656,24720,10728,10664,2472,27824,239632,6504,6472,808,4080,3432,3400,5456,7504,12112,17320,15184,20664,18088,110672,5792,11584,344,24,1616,1872,5768,11536,424,0,0,4048155338,4048155338,4048155338,4048155338,4048155338,4048155338,0,0,1065353216,0,0,0,0,0
.long 864,7008,3168,24736,10736,10672,2480,27776,248832,6512,6480,816,4032,3440,3408,5472,7520,12128,17328,15200,20696,18096,110688,6944,13888,360,24,1632,1888,6920,13840,432,0,0,0,4048155338,4048155338,4048155338,4048155338,4048155338,0,0,0,16256,0,0,0,0
.long 880,7024,3680,24752,10744,10680,2488,27792,248848,6520,6488,824,4048,3448,3416,5488,7536,12144,17336,15216,20728,18104,110704,8096,16192,376,24,1648,1904,8072,16144,440,0,0,0,0,4048155338,4048155338,4048155338,4048155338,0,0,0,1065353216,0,0,0,0
.long 896,8064,112,24640,10784,10848,2656,27744,258048,6656,6688,832,3776,3584,3616,5504,7552,12160,17344,15232,20760,18112,110720,9248,18496,392,24,1664,1920,9224,18448,448,0,0,0,0,4048155338,4048155338,4048155338,4048155338,0,0,0,0,0,0,0,0
.long 912,8080,624,24656,10792,10856,2664,27760,258064,6664,6696,840,3792,3592,3624,5520,7568,12176,17352,15248,20792,18120,110736,10400,20800,408,24,1680,1936,10376,20752,456,0,0,0,0,4048155338,4048155338,4048155338,4048155338,0,0,0,0,0,0,0,0
.long 928,8096,1136,24672,10800,10864,2672,27712,267264,6672,6704,848,3744,3600,3632,5536,7584,12192,17360,15264,20824,18128,110752,11552,23104,424,24,1696,1952,11528,23056,464,0,0,0,0,4048155338,4048155338,4048155338,4048155338,0,0,0,0,0,0,0,0
.long 944,8112,1648,24688,10808,10872,2680,27728,267280,6680,6712,856,3760,3608,3640,5552,7600,12208,17368,15280,20856,18136,110768,12704,25408,440,24,1712,1968,12680,25360,472,0,0,0,0,4048155338,4048155338,4048155338,4048155338,0,0,0,0,0,0,0,0
.long 960,8128,2160,24576,11104,11040,2848,27680,276480,6944,6912,864,3488,3872,3840,5568,7616,12224,17376,15296,20888,18144,110784,13856,27712,456,24,1728,1984,13832,27664,480,0,0,0,0,0,4048155338,4048155338,4048155338,0,0,0,0,0,0,0,0
.long 976,8144,2672,24592,11112,11048,2856,27696,276496,6952,6920,872,3504,3880,3848,5584,7632,12240,17384,15312,20920,18152,110800,15008,30016,472,24,1744,2000,14984,29968,488,0,0,0,0,0,0,4048155338,4048155338,0,0,0,0,0,0,0,0
.long 992,8160,3184,24608,11120,11056,2864,27648,285696,6960,6928,880,3456,3888,3856,5600,7648,12256,17392,15328,20952,18160,110816,16160,32320,488,24,1760,2016,16136,32272,496,0,0,0,0,0,0,0,4048155338,0,0,0,0,0,0,0,0
.long 1008,8176,3696,24624,11128,11064,2872,27664,285712,6968,6936,888,3472,3896,3864,5616,7664,12272,17400,15344,20984,18168,110832,17312,34624,504,24,1776,2032,17288,34576,504,0,0,0,0,0,0,0,0,0,0,0,0,0,0,0,0
```
